```python
import torch

def _softmax(x, axis=-1):
    return torch.softmax(x, dim=axis)

def _gelu(x):
    return torch.nn.functional.gelu(x, approximate='tanh')

def _silu(x):
    return torch.nn.functional.silu(x)

def _sigmoid(x):
    return torch.sigmoid(x)

def _layernorm(x, axis=-1, eps=1e-05):
    m = x.mean(dim=axis, keepdim=True)
    v = x.var(dim=axis, keepdim=True, unbiased=False)
    return (x - m) / torch.sqrt(v + eps)

def _scatter_add(tgt, idx, src, axis=0):
    return tgt.clone().index_add_(axis, idx, src)

def _segment_sum(src, seg, n):
    out = torch.zeros((n,) + src.shape[1:], dtype=src.dtype)
    return out.index_add_(0, seg, src)

def _pad(x, pw):
    flat = tuple((v for pair in reversed(pw) for v in pair))
    return torch.nn.functional.pad(x, flat)
kernel_name = 'adaLN_cond__memory_aug_recurrent_mem_tr__dense_activation_relu__prompt'

def setup_inputs():

    _w = lambda a: (lambda t: t.to(torch.bfloat16) if t.is_floating_point() else t)(torch.as_tensor(a))

    def _A_setup():
        B, S, Dm = (1, 2048, 1024)
        H, Dh = (32, 128)
        M, seg = (8, 32)
        seg = min(seg, S)
        S = S // seg * seg
        return {'x': _w((lambda *s: torch.randn(*s, dtype=torch.bfloat16) * 0.05)(B, S, Dm)), 'mem0': _w((lambda *s: torch.randn(*s, dtype=torch.bfloat16) * 0.4)(B, M, Dm)), 'Wq': _w((lambda *s: torch.randn(*s, dtype=torch.bfloat16) * 3.2)(Dm, H, Dh) * Dm ** (-0.5)), 'Wk': _w((lambda *s: torch.randn(*s, dtype=torch.bfloat16) * 3.2)(Dm, H, Dh) * Dm ** (-0.5)), 'Wv': _w((lambda *s: torch.randn(*s, dtype=torch.bfloat16) * 0.4)(Dm, H, Dh) * Dm ** (-0.5)), 'Wo': _w((lambda *s: torch.randn(*s, dtype=torch.bfloat16) * 0.4)(H, Dh, Dm) * (H * Dh) ** (-0.5)), 'seg_len': seg}
    _A_in = _A_setup()

    def _B_setup():
        B, S, D, Dff = (1, 2048, 1024, 3584)
        return {'x': _w((lambda *s: torch.randn(*s, dtype=torch.bfloat16) * 0.05)(B, S, D)), 'w1': _w((lambda *s: torch.randn(*s, dtype=torch.bfloat16) * 0.05)(D, Dff)), 'w2': _w((lambda *s: torch.randn(*s, dtype=torch.bfloat16) * 0.05)(Dff, D))}
    _B_in = _B_setup()
    return {'A_x': _A_in['x'], 'A_mem0': _A_in['mem0'], 'A_Wq': _A_in['Wq'], 'A_Wk': _A_in['Wk'], 'A_Wv': _A_in['Wv'], 'A_Wo': _A_in['Wo'], 'A_seg_len': _A_in['seg_len'], 'B_x': _B_in['x'], 'B_w1': _B_in['w1'], 'B_w2': _B_in['w2'], 'c': _w((lambda *s: torch.randn(*s, dtype=torch.bfloat16) * 0.1)(1, 1024) * 8.0), 'w_mod': _w((lambda *s: torch.randn(*s, dtype=torch.bfloat16) * 0.1)(1024, 6 * 1024) * 1024 ** (-0.5) * 8.0)}

def reference(A_x, A_mem0, A_Wq, A_Wk, A_Wv, A_Wo, A_seg_len, B_x, B_w1, B_w2, c, w_mod):

    def _A_ref(x, mem0, Wq, Wk, Wv, Wo, seg_len):
        B, S, Dm = x.shape
        H, Dh = (Wq.shape[1], Wq.shape[2])
        M = mem0.shape[1]
        scale = Dh ** (-0.5)
        n_seg = S // seg_len
        L = M + seg_len
        idx = torch.arange(L)
        mask = (idx[:, None] < M) | (idx[:, None] >= idx[None, :])
        mem = mem0
        outs = []
        for s in range(n_seg):
            xs = x[:, s * seg_len:(s + 1) * seg_len, :].clone()
            h = torch.concatenate([mem, xs], axis=1)
            q = torch.einsum('btd,dhe->bhte', h, Wq)
            k = torch.einsum('btd,dhe->bhte', h, Wk)
            v = torch.einsum('btd,dhe->bhte', h, Wv)
            scores = torch.einsum('bhqe,bhke->bhqk', q, k) * scale
            scores = torch.where(mask[None, None], scores, -1000000000.0)
            p = _softmax(scores, axis=-1)
            o = torch.einsum('bhqk,bhke->bhqe', p, v)
            o = torch.einsum('bhte,hed->btd', o, Wo)
            mem = o[:, :M, :].clone()
            outs.append(o[:, M:, :])
        return torch.concatenate(outs, axis=1)

    def _B_ref(x, w1, w2):
        h = torch.einsum('bsd,df->bsf', x, w1)
        zero = torch.zeros_like(h)
        h = torch.maximum(h, zero)
        return torch.einsum('bsf,fd->bsd', h, w2)
    x = A_x
    mod = (_silu(c) @ w_mod).reshape(c.shape[0], 6, 1, -1)
    sa, ca, ga, sb, cb, gb = (mod[:, 0].clone(), mod[:, 1].clone(), mod[:, 2].clone(), mod[:, 3].clone(), mod[:, 4].clone(), mod[:, 5].clone())
    h = _layernorm(x, axis=-1) * (1 + ca) + sa
    x = x + ga * _A_ref(h, A_mem0, A_Wq, A_Wk, A_Wv, A_Wo, A_seg_len)
    h = _layernorm(x, axis=-1) * (1 + cb) + sb
    x = x + gb * _B_ref(h, B_w1, B_w2)
    return x
```

```asm
; @launch grid=(256,1,1) block=(256,1,1) lds=147456
.amdgcn_target "amdgcn-amd-amdhsa--gfx950"
.text
.globl adaLN_cond__memory_aug_recurrent_mem_tr__dense_activation_relu__prompt_kernel
.p2align 8
.type adaLN_cond__memory_aug_recurrent_mem_tr__dense_activation_relu__prompt_kernel,@function
adaLN_cond__memory_aug_recurrent_mem_tr__dense_activation_relu__prompt_kernel:
  s_cmp_ge_u32 s2, 256
  s_cbranch_scc1 EXIT
  s_load_dwordx16 s[24:39], s[0:1], 0
  s_load_dwordx8 s[40:47], s[0:1], 64
  s_load_dwordx4 s[48:51], s[0:1], 96
  s_load_dwordx2 s[52:53], s[0:1], 112
  s_getreg_b32 s3, hwreg(HW_REG_XCC_ID)
  s_and_b32 s3, s3, 7
  v_lshrrev_b32 v1, 6, v0
  s_nop 0
  v_readfirstlane_b32 s54, v1
  v_and_b32 v0, 63, v0
  s_mov_b32 s57, 100000
  s_mov_b32 s71, 0x3e0293ee
  s_mov_b32 s72, 0
  s_waitcnt lgkmcnt(0)
  v_mov_b32 v1, 0x7ff00000
  v_mov_b32 v2, 0x7ff00000
  v_mov_b32 v3, 0x7ff00000
  v_mov_b32 v4, 0x7ff00000
  v_mov_b32 v5, 0x7ff00000
  v_mov_b32 v6, 0x7ff00000
  v_mov_b32 v7, 0x7ff00000
  v_mov_b32 v8, 0x7ff00000
  v_mov_b32 v9, 0x7ff00000
  v_mov_b32 v10, 0x7ff00000
  v_mov_b32 v11, 0x7ff00000
  v_mov_b32 v12, 0x7ff00000
  v_mov_b32 v13, 0x7ff00000
  v_mov_b32 v14, 0x7ff00000
  v_mov_b32 v15, 0x7ff00000
  v_mov_b32 v16, 0x7ff00000
  v_mov_b32 v17, 0x7ff00000
  v_mov_b32 v18, 0x7ff00000
  v_mov_b32 v19, 0x7ff00000
  v_mov_b32 v20, 0x7ff00000
  v_mov_b32 v21, 0x7ff00000
  v_mov_b32 v22, 0x7ff00000
  v_mov_b32 v23, 0x7ff00000
  v_mov_b32 v24, 0x7ff00000
  v_mov_b32 v25, 0x7ff00000
  v_mov_b32 v26, 0x7ff00000
  v_mov_b32 v27, 0x7ff00000
  v_mov_b32 v28, 0x7ff00000
  v_mov_b32 v29, 0x7ff00000
  v_mov_b32 v30, 0x7ff00000
  v_mov_b32 v31, 0x7ff00000
  v_mov_b32 v152, 0x7ff00000
  v_mov_b32 v153, 0x7ff00000
  v_mov_b32 v154, 0x7ff00000
  v_mov_b32 v155, 0x7ff00000
  v_mov_b32 v156, 0x7ff00000
  v_mov_b32 v157, 0x7ff00000
  v_mov_b32 v158, 0x7ff00000
  v_mov_b32 v159, 0x7ff00000
  v_mov_b32 v160, 0x7ff00000
  v_mov_b32 v161, 0x7ff00000
  v_mov_b32 v162, 0x7ff00000
  v_mov_b32 v163, 0x7ff00000
  v_mov_b32 v164, 0x7ff00000
  v_mov_b32 v165, 0x7ff00000
  v_mov_b32 v166, 0x7ff00000
  v_mov_b32 v167, 0x7ff00000
  s_mov_b32 s8, s52
  s_mov_b32 s9, s53
  s_mov_b32 s10, 0x10000000
  s_mov_b32 s11, 0x00020000
  s_mov_b32 s20, s50
  s_mov_b32 s21, s51
  s_mov_b32 s22, 0x100
  s_mov_b32 s23, 0x00020000
  s_cmp_lg_u32 s54, 0
  s_cbranch_scc1 tk_1
  v_mov_b32 v3, 1
  v_mov_b32 v1, 0x7ff00000
  s_lshl_b32 s59, s3, 2
  v_mov_b32 v2, s59
  v_cmp_eq_u32 vcc, 0, v0
  s_nop 1
  v_cndmask_b32 v2, v1, v2, vcc
  buffer_atomic_add v3, v2, s[20:23], 0 offen sc0 sc1
  v_mov_b32 v4, 0
  v_mov_b32 v5, 0
  v_mov_b32 v6, 0
  v_mov_b32 v7, 0
  s_lshl_b32 s59, s2, 10
  s_add_u32 s59, s59, 2097152
  v_lshlrev_b32 v1, 4, v0
  buffer_store_dwordx4 v[4:7], v1, s[8:11], s59 offen sc1
tk_1:
  s_mov_b32 s12, s46
  s_mov_b32 s13, s47
  s_mov_b32 s14, 0xc00000
  s_mov_b32 s15, 0x00020000
  s_mov_b32 s16, s44
  s_mov_b32 s17, s45
  s_mov_b32 s18, 0x800
  s_mov_b32 s19, 0x00020000
  v_lshrrev_b32 v68, 2, v0
  v_and_b32 v69, 3, v0
  s_lshl_b32 s59, s54, 9
  v_lshl_add_u32 v70, v68, 1, s59
  buffer_load_ushort v44, v70, s[16:19], 0 offen offset:0
  buffer_load_ushort v45, v70, s[16:19], 0 offen offset:32
  buffer_load_ushort v46, v70, s[16:19], 0 offen offset:64
  buffer_load_ushort v47, v70, s[16:19], 0 offen offset:96
  buffer_load_ushort v48, v70, s[16:19], 0 offen offset:128
  buffer_load_ushort v49, v70, s[16:19], 0 offen offset:160
  buffer_load_ushort v50, v70, s[16:19], 0 offen offset:192
  buffer_load_ushort v51, v70, s[16:19], 0 offen offset:224
  buffer_load_ushort v52, v70, s[16:19], 0 offen offset:256
  buffer_load_ushort v53, v70, s[16:19], 0 offen offset:288
  buffer_load_ushort v54, v70, s[16:19], 0 offen offset:320
  buffer_load_ushort v55, v70, s[16:19], 0 offen offset:352
  buffer_load_ushort v56, v70, s[16:19], 0 offen offset:384
  buffer_load_ushort v57, v70, s[16:19], 0 offen offset:416
  buffer_load_ushort v58, v70, s[16:19], 0 offen offset:448
  buffer_load_ushort v59, v70, s[16:19], 0 offen offset:480
  s_mul_i32 s59, s54, 3145728
  s_cmp_lt_u32 s2, 192
  s_cselect_b32 s59, s59, 0x7ff00000
  v_mul_u32_u24 v71, 12288, v68
  v_lshl_add_u32 v71, v69, 4, v71
  v_add_u32 v71, s59, v71
  s_lshl_b32 s59, s2, 6
  buffer_load_dwordx4 v[176:179], v71, s[12:15], s59 offen
  s_add_u32 s59, s59, 196608
  buffer_load_dwordx4 v[180:183], v71, s[12:15], s59 offen
  s_add_u32 s59, s59, 196608
  buffer_load_dwordx4 v[184:187], v71, s[12:15], s59 offen
  s_add_u32 s59, s59, 196608
  buffer_load_dwordx4 v[188:191], v71, s[12:15], s59 offen
  s_add_u32 s59, s59, 196608
  buffer_load_dwordx4 v[192:195], v71, s[12:15], s59 offen
  s_add_u32 s59, s59, 196608
  buffer_load_dwordx4 v[196:199], v71, s[12:15], s59 offen
  s_add_u32 s59, s59, 196608
  buffer_load_dwordx4 v[200:203], v71, s[12:15], s59 offen
  s_add_u32 s59, s59, 196608
  buffer_load_dwordx4 v[204:207], v71, s[12:15], s59 offen
  s_add_u32 s59, s59, 196608
  buffer_load_dwordx4 v[208:211], v71, s[12:15], s59 offen
  s_add_u32 s59, s59, 196608
  buffer_load_dwordx4 v[212:215], v71, s[12:15], s59 offen
  s_add_u32 s59, s59, 196608
  buffer_load_dwordx4 v[216:219], v71, s[12:15], s59 offen
  s_add_u32 s59, s59, 196608
  buffer_load_dwordx4 v[220:223], v71, s[12:15], s59 offen
  s_add_u32 s59, s59, 196608
  buffer_load_dwordx4 v[224:227], v71, s[12:15], s59 offen
  s_add_u32 s59, s59, 196608
  buffer_load_dwordx4 v[228:231], v71, s[12:15], s59 offen
  s_add_u32 s59, s59, 196608
  buffer_load_dwordx4 v[232:235], v71, s[12:15], s59 offen
  s_add_u32 s59, s59, 196608
  buffer_load_dwordx4 v[236:239], v71, s[12:15], s59 offen
  s_mov_b32 s16, s24
  s_mov_b32 s17, s25
  s_mov_b32 s18, 0x400000
  s_mov_b32 s19, 0x00020000
  v_lshrrev_b32 v68, 2, v0
  v_and_b32 v69, 3, v0
  s_lshl_b32 s59, s54, 10
  v_lshl_add_u32 v72, v68, 4, s59
  s_lshl_b32 s59, s54, 14
  v_lshl_add_u32 v73, v68, 10, s59
  v_lshl_add_u32 v73, v69, 4, v73
  s_lshl_b32 s59, s54, 9
  v_lshl_add_u32 v74, v68, 3, s59
  v_lshl_add_u32 v74, v69, 11, v74
  v_lshlrev_b32 v76, 5, v69
  v_add_u32 v76, 132096, v76
  s_lshl_b32 s59, s54, 3
  v_add_u32 v75, s59, v76
  s_lshr_b32 s59, s2, 3
  s_xor_b32 s59, s59, 16
  s_lshl_b32 s59, s59, 2
  s_and_b32 s60, s2, 3
  s_or_b32 s59, s59, s60
  s_andn2_b32 s60, 4, s2
  s_lshl_b32 s60, s60, 5
  s_or_b32 s101, s59, s60
  s_lshl_b32 s59, s101, 14
  s_add_u32 s60, s59, 8192
  buffer_load_dwordx2 v[240:241], v74, s[16:19], s59 offen offset:0
  buffer_load_dwordx2 v[242:243], v74, s[16:19], s59 offen offset:128
  buffer_load_dwordx2 v[244:245], v74, s[16:19], s59 offen offset:256
  buffer_load_dwordx2 v[246:247], v74, s[16:19], s59 offen offset:384
  buffer_load_dwordx2 v[248:249], v74, s[16:19], s60 offen offset:0
  buffer_load_dwordx2 v[250:251], v74, s[16:19], s60 offen offset:128
  buffer_load_dwordx2 v[252:253], v74, s[16:19], s60 offen offset:256
  buffer_load_dwordx2 v[254:255], v74, s[16:19], s60 offen offset:384
  v_mov_b32 v1, 131072
  s_cmp_lg_u32 s54, 0
  s_cbranch_scc1 tf_2
  s_waitcnt vmcnt(41)
  v_readfirstlane_b32 s59, v3
  s_nop 1
  v_mov_b32 v3, s59
  ds_write_b32 v1, v3
  s_waitcnt lgkmcnt(0)
tf_2:
  s_barrier
  ds_read_b32 v3, v1
  s_waitcnt lgkmcnt(0)
  v_readfirstlane_b32 s56, v3
  s_mov_b32 s55, s3
  s_barrier
ROLE0:
  s_mov_b32 s75, 0
  s_mov_b32 s87, 0
  s_mov_b32 s88, 0
  s_mov_b32 s78, 6
  v_mov_b32 v31, 0x7ff00000
  s_cmp_lt_u32 s56, 32
  s_cbranch_scc1 ROLE1
C0:
  buffer_load_dword v30, v31, s[8:11], 0 offen
  buffer_load_dword v30, v31, s[8:11], 0 offen
  buffer_load_dword v30, v31, s[8:11], 0 offen
  buffer_load_dword v30, v31, s[8:11], 0 offen
  buffer_load_dword v30, v31, s[8:11], 0 offen
  buffer_load_dword v30, v31, s[8:11], 0 offen
  buffer_load_dword v30, v31, s[8:11], 0 offen
  buffer_load_dword v30, v31, s[8:11], 0 offen
  buffer_load_dword v30, v31, s[8:11], 0 offen
  buffer_load_dword v30, v31, s[8:11], 0 offen
  buffer_load_dword v30, v31, s[8:11], 0 offen
  buffer_load_dword v30, v31, s[8:11], 0 offen
  buffer_load_dword v30, v31, s[8:11], 0 offen
  buffer_load_dword v30, v31, s[8:11], 0 offen
  buffer_load_dword v30, v31, s[8:11], 0 offen
  buffer_load_dword v30, v31, s[8:11], 0 offen
  buffer_load_dword v30, v31, s[8:11], 0 offen
C1:
  s_cmp_eq_u32 s72, 0
  s_cbranch_scc0 C2
  s_cmp_ge_u32 s2, 192
  s_cbranch_scc1 nomod_3
  s_waitcnt vmcnt(41)
  v_lshlrev_b32 v44, 16, v44
  v_mul_f32 v96, 0xbfb8aa3b, v44
  v_lshlrev_b32 v45, 16, v45
  v_mul_f32 v97, 0xbfb8aa3b, v45
  v_lshlrev_b32 v46, 16, v46
  v_mul_f32 v98, 0xbfb8aa3b, v46
  v_lshlrev_b32 v47, 16, v47
  v_mul_f32 v99, 0xbfb8aa3b, v47
  v_lshlrev_b32 v48, 16, v48
  v_mul_f32 v100, 0xbfb8aa3b, v48
  v_lshlrev_b32 v49, 16, v49
  v_mul_f32 v101, 0xbfb8aa3b, v49
  v_lshlrev_b32 v50, 16, v50
  v_mul_f32 v102, 0xbfb8aa3b, v50
  v_lshlrev_b32 v51, 16, v51
  v_mul_f32 v103, 0xbfb8aa3b, v51
  v_lshlrev_b32 v52, 16, v52
  v_mul_f32 v104, 0xbfb8aa3b, v52
  v_lshlrev_b32 v53, 16, v53
  v_mul_f32 v105, 0xbfb8aa3b, v53
  v_lshlrev_b32 v54, 16, v54
  v_mul_f32 v106, 0xbfb8aa3b, v54
  v_lshlrev_b32 v55, 16, v55
  v_mul_f32 v107, 0xbfb8aa3b, v55
  v_lshlrev_b32 v56, 16, v56
  v_mul_f32 v108, 0xbfb8aa3b, v56
  v_lshlrev_b32 v57, 16, v57
  v_mul_f32 v109, 0xbfb8aa3b, v57
  v_lshlrev_b32 v58, 16, v58
  v_mul_f32 v110, 0xbfb8aa3b, v58
  v_lshlrev_b32 v59, 16, v59
  v_mul_f32 v111, 0xbfb8aa3b, v59
  v_exp_f32 v96, v96
  v_exp_f32 v97, v97
  v_exp_f32 v98, v98
  v_exp_f32 v99, v99
  v_exp_f32 v100, v100
  v_exp_f32 v101, v101
  v_exp_f32 v102, v102
  v_exp_f32 v103, v103
  v_exp_f32 v104, v104
  v_exp_f32 v105, v105
  v_exp_f32 v106, v106
  v_exp_f32 v107, v107
  v_exp_f32 v108, v108
  v_exp_f32 v109, v109
  v_exp_f32 v110, v110
  v_exp_f32 v111, v111
  v_add_f32 v96, 1.0, v96
  v_add_f32 v97, 1.0, v97
  v_add_f32 v98, 1.0, v98
  v_add_f32 v99, 1.0, v99
  v_add_f32 v100, 1.0, v100
  v_add_f32 v101, 1.0, v101
  v_add_f32 v102, 1.0, v102
  v_add_f32 v103, 1.0, v103
  v_add_f32 v104, 1.0, v104
  v_add_f32 v105, 1.0, v105
  v_add_f32 v106, 1.0, v106
  v_add_f32 v107, 1.0, v107
  v_add_f32 v108, 1.0, v108
  v_add_f32 v109, 1.0, v109
  v_add_f32 v110, 1.0, v110
  v_add_f32 v111, 1.0, v111
  v_rcp_f32 v96, v96
  v_rcp_f32 v97, v97
  v_rcp_f32 v98, v98
  v_rcp_f32 v99, v99
  v_rcp_f32 v100, v100
  v_rcp_f32 v101, v101
  v_rcp_f32 v102, v102
  v_rcp_f32 v103, v103
  v_rcp_f32 v104, v104
  v_rcp_f32 v105, v105
  v_rcp_f32 v106, v106
  v_rcp_f32 v107, v107
  v_rcp_f32 v108, v108
  v_rcp_f32 v109, v109
  v_rcp_f32 v110, v110
  v_rcp_f32 v111, v111
  v_mul_f32 v44, v44, v96
  v_mul_f32 v45, v45, v97
  v_mul_f32 v46, v46, v98
  v_mul_f32 v47, v47, v99
  v_mul_f32 v48, v48, v100
  v_mul_f32 v49, v49, v101
  v_mul_f32 v50, v50, v102
  v_mul_f32 v51, v51, v103
  v_mul_f32 v52, v52, v104
  v_mul_f32 v53, v53, v105
  v_mul_f32 v54, v54, v106
  v_mul_f32 v55, v55, v107
  v_mul_f32 v56, v56, v108
  v_mul_f32 v57, v57, v109
  v_mul_f32 v58, v58, v110
  v_mul_f32 v59, v59, v111
  v_cvt_pk_bf16_f32 v96, v44, v45
  v_lshlrev_b32 v44, 16, v96
  v_and_b32 v45, 0xffff0000, v96
  v_cvt_pk_bf16_f32 v98, v46, v47
  v_lshlrev_b32 v46, 16, v98
  v_and_b32 v47, 0xffff0000, v98
  v_cvt_pk_bf16_f32 v100, v48, v49
  v_lshlrev_b32 v48, 16, v100
  v_and_b32 v49, 0xffff0000, v100
  v_cvt_pk_bf16_f32 v102, v50, v51
  v_lshlrev_b32 v50, 16, v102
  v_and_b32 v51, 0xffff0000, v102
  v_cvt_pk_bf16_f32 v104, v52, v53
  v_lshlrev_b32 v52, 16, v104
  v_and_b32 v53, 0xffff0000, v104
  v_cvt_pk_bf16_f32 v106, v54, v55
  v_lshlrev_b32 v54, 16, v106
  v_and_b32 v55, 0xffff0000, v106
  v_cvt_pk_bf16_f32 v108, v56, v57
  v_lshlrev_b32 v56, 16, v108
  v_and_b32 v57, 0xffff0000, v108
  v_cvt_pk_bf16_f32 v110, v58, v59
  v_lshlrev_b32 v58, 16, v110
  v_and_b32 v59, 0xffff0000, v110
  s_waitcnt vmcnt(40)
  v_lshlrev_b32 v96, 16, v176
  v_and_b32 v97, 0xffff0000, v176
  v_lshlrev_b32 v98, 16, v177
  v_and_b32 v99, 0xffff0000, v177
  v_lshlrev_b32 v100, 16, v178
  v_and_b32 v101, 0xffff0000, v178
  v_lshlrev_b32 v102, 16, v179
  v_and_b32 v103, 0xffff0000, v179
  v_mul_f32 v60, v96, v44
  v_mul_f32 v61, v97, v44
  v_mul_f32 v62, v98, v44
  v_mul_f32 v63, v99, v44
  v_mul_f32 v64, v100, v44
  v_mul_f32 v65, v101, v44
  v_mul_f32 v66, v102, v44
  v_mul_f32 v67, v103, v44
  s_waitcnt vmcnt(39)
  v_lshlrev_b32 v104, 16, v180
  v_and_b32 v105, 0xffff0000, v180
  v_lshlrev_b32 v106, 16, v181
  v_and_b32 v107, 0xffff0000, v181
  v_lshlrev_b32 v108, 16, v182
  v_and_b32 v109, 0xffff0000, v182
  v_lshlrev_b32 v110, 16, v183
  v_and_b32 v111, 0xffff0000, v183
  v_fmac_f32 v60, v104, v45
  v_fmac_f32 v61, v105, v45
  v_fmac_f32 v62, v106, v45
  v_fmac_f32 v63, v107, v45
  v_fmac_f32 v64, v108, v45
  v_fmac_f32 v65, v109, v45
  v_fmac_f32 v66, v110, v45
  v_fmac_f32 v67, v111, v45
  s_waitcnt vmcnt(38)
  v_lshlrev_b32 v96, 16, v184
  v_and_b32 v97, 0xffff0000, v184
  v_lshlrev_b32 v98, 16, v185
  v_and_b32 v99, 0xffff0000, v185
  v_lshlrev_b32 v100, 16, v186
  v_and_b32 v101, 0xffff0000, v186
  v_lshlrev_b32 v102, 16, v187
  v_and_b32 v103, 0xffff0000, v187
  v_fmac_f32 v60, v96, v46
  v_fmac_f32 v61, v97, v46
  v_fmac_f32 v62, v98, v46
  v_fmac_f32 v63, v99, v46
  v_fmac_f32 v64, v100, v46
  v_fmac_f32 v65, v101, v46
  v_fmac_f32 v66, v102, v46
  v_fmac_f32 v67, v103, v46
  s_waitcnt vmcnt(37)
  v_lshlrev_b32 v104, 16, v188
  v_and_b32 v105, 0xffff0000, v188
  v_lshlrev_b32 v106, 16, v189
  v_and_b32 v107, 0xffff0000, v189
  v_lshlrev_b32 v108, 16, v190
  v_and_b32 v109, 0xffff0000, v190
  v_lshlrev_b32 v110, 16, v191
  v_and_b32 v111, 0xffff0000, v191
  v_fmac_f32 v60, v104, v47
  v_fmac_f32 v61, v105, v47
  v_fmac_f32 v62, v106, v47
  v_fmac_f32 v63, v107, v47
  v_fmac_f32 v64, v108, v47
  v_fmac_f32 v65, v109, v47
  v_fmac_f32 v66, v110, v47
  v_fmac_f32 v67, v111, v47
  s_waitcnt vmcnt(36)
  v_lshlrev_b32 v96, 16, v192
  v_and_b32 v97, 0xffff0000, v192
  v_lshlrev_b32 v98, 16, v193
  v_and_b32 v99, 0xffff0000, v193
  v_lshlrev_b32 v100, 16, v194
  v_and_b32 v101, 0xffff0000, v194
  v_lshlrev_b32 v102, 16, v195
  v_and_b32 v103, 0xffff0000, v195
  v_fmac_f32 v60, v96, v48
  v_fmac_f32 v61, v97, v48
  v_fmac_f32 v62, v98, v48
  v_fmac_f32 v63, v99, v48
  v_fmac_f32 v64, v100, v48
  v_fmac_f32 v65, v101, v48
  v_fmac_f32 v66, v102, v48
  v_fmac_f32 v67, v103, v48
  s_waitcnt vmcnt(35)
  v_lshlrev_b32 v104, 16, v196
  v_and_b32 v105, 0xffff0000, v196
  v_lshlrev_b32 v106, 16, v197
  v_and_b32 v107, 0xffff0000, v197
  v_lshlrev_b32 v108, 16, v198
  v_and_b32 v109, 0xffff0000, v198
  v_lshlrev_b32 v110, 16, v199
  v_and_b32 v111, 0xffff0000, v199
  v_fmac_f32 v60, v104, v49
  v_fmac_f32 v61, v105, v49
  v_fmac_f32 v62, v106, v49
  v_fmac_f32 v63, v107, v49
  v_fmac_f32 v64, v108, v49
  v_fmac_f32 v65, v109, v49
  v_fmac_f32 v66, v110, v49
  v_fmac_f32 v67, v111, v49
  s_waitcnt vmcnt(34)
  v_lshlrev_b32 v96, 16, v200
  v_and_b32 v97, 0xffff0000, v200
  v_lshlrev_b32 v98, 16, v201
  v_and_b32 v99, 0xffff0000, v201
  v_lshlrev_b32 v100, 16, v202
  v_and_b32 v101, 0xffff0000, v202
  v_lshlrev_b32 v102, 16, v203
  v_and_b32 v103, 0xffff0000, v203
  v_fmac_f32 v60, v96, v50
  v_fmac_f32 v61, v97, v50
  v_fmac_f32 v62, v98, v50
  v_fmac_f32 v63, v99, v50
  v_fmac_f32 v64, v100, v50
  v_fmac_f32 v65, v101, v50
  v_fmac_f32 v66, v102, v50
  v_fmac_f32 v67, v103, v50
  s_waitcnt vmcnt(33)
  v_lshlrev_b32 v104, 16, v204
  v_and_b32 v105, 0xffff0000, v204
  v_lshlrev_b32 v106, 16, v205
  v_and_b32 v107, 0xffff0000, v205
  v_lshlrev_b32 v108, 16, v206
  v_and_b32 v109, 0xffff0000, v206
  v_lshlrev_b32 v110, 16, v207
  v_and_b32 v111, 0xffff0000, v207
  v_fmac_f32 v60, v104, v51
  v_fmac_f32 v61, v105, v51
  v_fmac_f32 v62, v106, v51
  v_fmac_f32 v63, v107, v51
  v_fmac_f32 v64, v108, v51
  v_fmac_f32 v65, v109, v51
  v_fmac_f32 v66, v110, v51
  v_fmac_f32 v67, v111, v51
  s_waitcnt vmcnt(32)
  v_lshlrev_b32 v96, 16, v208
  v_and_b32 v97, 0xffff0000, v208
  v_lshlrev_b32 v98, 16, v209
  v_and_b32 v99, 0xffff0000, v209
  v_lshlrev_b32 v100, 16, v210
  v_and_b32 v101, 0xffff0000, v210
  v_lshlrev_b32 v102, 16, v211
  v_and_b32 v103, 0xffff0000, v211
  v_fmac_f32 v60, v96, v52
  v_fmac_f32 v61, v97, v52
  v_fmac_f32 v62, v98, v52
  v_fmac_f32 v63, v99, v52
  v_fmac_f32 v64, v100, v52
  v_fmac_f32 v65, v101, v52
  v_fmac_f32 v66, v102, v52
  v_fmac_f32 v67, v103, v52
  s_waitcnt vmcnt(31)
  v_lshlrev_b32 v104, 16, v212
  v_and_b32 v105, 0xffff0000, v212
  v_lshlrev_b32 v106, 16, v213
  v_and_b32 v107, 0xffff0000, v213
  v_lshlrev_b32 v108, 16, v214
  v_and_b32 v109, 0xffff0000, v214
  v_lshlrev_b32 v110, 16, v215
  v_and_b32 v111, 0xffff0000, v215
  v_fmac_f32 v60, v104, v53
  v_fmac_f32 v61, v105, v53
  v_fmac_f32 v62, v106, v53
  v_fmac_f32 v63, v107, v53
  v_fmac_f32 v64, v108, v53
  v_fmac_f32 v65, v109, v53
  v_fmac_f32 v66, v110, v53
  v_fmac_f32 v67, v111, v53
  s_waitcnt vmcnt(30)
  v_lshlrev_b32 v96, 16, v216
  v_and_b32 v97, 0xffff0000, v216
  v_lshlrev_b32 v98, 16, v217
  v_and_b32 v99, 0xffff0000, v217
  v_lshlrev_b32 v100, 16, v218
  v_and_b32 v101, 0xffff0000, v218
  v_lshlrev_b32 v102, 16, v219
  v_and_b32 v103, 0xffff0000, v219
  v_fmac_f32 v60, v96, v54
  v_fmac_f32 v61, v97, v54
  v_fmac_f32 v62, v98, v54
  v_fmac_f32 v63, v99, v54
  v_fmac_f32 v64, v100, v54
  v_fmac_f32 v65, v101, v54
  v_fmac_f32 v66, v102, v54
  v_fmac_f32 v67, v103, v54
  s_waitcnt vmcnt(29)
  v_lshlrev_b32 v104, 16, v220
  v_and_b32 v105, 0xffff0000, v220
  v_lshlrev_b32 v106, 16, v221
  v_and_b32 v107, 0xffff0000, v221
  v_lshlrev_b32 v108, 16, v222
  v_and_b32 v109, 0xffff0000, v222
  v_lshlrev_b32 v110, 16, v223
  v_and_b32 v111, 0xffff0000, v223
  v_fmac_f32 v60, v104, v55
  v_fmac_f32 v61, v105, v55
  v_fmac_f32 v62, v106, v55
  v_fmac_f32 v63, v107, v55
  v_fmac_f32 v64, v108, v55
  v_fmac_f32 v65, v109, v55
  v_fmac_f32 v66, v110, v55
  v_fmac_f32 v67, v111, v55
  s_waitcnt vmcnt(28)
  v_lshlrev_b32 v96, 16, v224
  v_and_b32 v97, 0xffff0000, v224
  v_lshlrev_b32 v98, 16, v225
  v_and_b32 v99, 0xffff0000, v225
  v_lshlrev_b32 v100, 16, v226
  v_and_b32 v101, 0xffff0000, v226
  v_lshlrev_b32 v102, 16, v227
  v_and_b32 v103, 0xffff0000, v227
  v_fmac_f32 v60, v96, v56
  v_fmac_f32 v61, v97, v56
  v_fmac_f32 v62, v98, v56
  v_fmac_f32 v63, v99, v56
  v_fmac_f32 v64, v100, v56
  v_fmac_f32 v65, v101, v56
  v_fmac_f32 v66, v102, v56
  v_fmac_f32 v67, v103, v56
  s_waitcnt vmcnt(27)
  v_lshlrev_b32 v104, 16, v228
  v_and_b32 v105, 0xffff0000, v228
  v_lshlrev_b32 v106, 16, v229
  v_and_b32 v107, 0xffff0000, v229
  v_lshlrev_b32 v108, 16, v230
  v_and_b32 v109, 0xffff0000, v230
  v_lshlrev_b32 v110, 16, v231
  v_and_b32 v111, 0xffff0000, v231
  v_fmac_f32 v60, v104, v57
  v_fmac_f32 v61, v105, v57
  v_fmac_f32 v62, v106, v57
  v_fmac_f32 v63, v107, v57
  v_fmac_f32 v64, v108, v57
  v_fmac_f32 v65, v109, v57
  v_fmac_f32 v66, v110, v57
  v_fmac_f32 v67, v111, v57
  s_waitcnt vmcnt(26)
  v_lshlrev_b32 v96, 16, v232
  v_and_b32 v97, 0xffff0000, v232
  v_lshlrev_b32 v98, 16, v233
  v_and_b32 v99, 0xffff0000, v233
  v_lshlrev_b32 v100, 16, v234
  v_and_b32 v101, 0xffff0000, v234
  v_lshlrev_b32 v102, 16, v235
  v_and_b32 v103, 0xffff0000, v235
  v_fmac_f32 v60, v96, v58
  v_fmac_f32 v61, v97, v58
  v_fmac_f32 v62, v98, v58
  v_fmac_f32 v63, v99, v58
  v_fmac_f32 v64, v100, v58
  v_fmac_f32 v65, v101, v58
  v_fmac_f32 v66, v102, v58
  v_fmac_f32 v67, v103, v58
  s_waitcnt vmcnt(25)
  v_lshlrev_b32 v104, 16, v236
  v_and_b32 v105, 0xffff0000, v236
  v_lshlrev_b32 v106, 16, v237
  v_and_b32 v107, 0xffff0000, v237
  v_lshlrev_b32 v108, 16, v238
  v_and_b32 v109, 0xffff0000, v238
  v_lshlrev_b32 v110, 16, v239
  v_and_b32 v111, 0xffff0000, v239
  v_fmac_f32 v60, v104, v59
  v_fmac_f32 v61, v105, v59
  v_fmac_f32 v62, v106, v59
  v_fmac_f32 v63, v107, v59
  v_fmac_f32 v64, v108, v59
  v_fmac_f32 v65, v109, v59
  v_fmac_f32 v66, v110, v59
  v_fmac_f32 v67, v111, v59
  v_add_f32_dpp v60, v60, v60 row_ror:4 row_mask:0xf bank_mask:0xf
  v_add_f32_dpp v61, v61, v61 row_ror:4 row_mask:0xf bank_mask:0xf
  v_add_f32_dpp v62, v62, v62 row_ror:4 row_mask:0xf bank_mask:0xf
  v_add_f32_dpp v63, v63, v63 row_ror:4 row_mask:0xf bank_mask:0xf
  v_add_f32_dpp v64, v64, v64 row_ror:4 row_mask:0xf bank_mask:0xf
  v_add_f32_dpp v65, v65, v65 row_ror:4 row_mask:0xf bank_mask:0xf
  v_add_f32_dpp v66, v66, v66 row_ror:4 row_mask:0xf bank_mask:0xf
  v_add_f32_dpp v67, v67, v67 row_ror:4 row_mask:0xf bank_mask:0xf
  v_add_f32_dpp v60, v60, v60 row_ror:8 row_mask:0xf bank_mask:0xf
  v_add_f32_dpp v61, v61, v61 row_ror:8 row_mask:0xf bank_mask:0xf
  v_add_f32_dpp v62, v62, v62 row_ror:8 row_mask:0xf bank_mask:0xf
  v_add_f32_dpp v63, v63, v63 row_ror:8 row_mask:0xf bank_mask:0xf
  v_add_f32_dpp v64, v64, v64 row_ror:8 row_mask:0xf bank_mask:0xf
  v_add_f32_dpp v65, v65, v65 row_ror:8 row_mask:0xf bank_mask:0xf
  v_add_f32_dpp v66, v66, v66 row_ror:8 row_mask:0xf bank_mask:0xf
  v_add_f32_dpp v67, v67, v67 row_ror:8 row_mask:0xf bank_mask:0xf
  v_mov_b32 v96, v60
  v_mov_b32 v97, v61
  v_mov_b32 v98, v62
  v_mov_b32 v99, v63
  v_mov_b32 v100, v64
  v_mov_b32 v101, v65
  v_mov_b32 v102, v66
  v_mov_b32 v103, v67
  v_permlane16_swap_b32 v96, v60
  v_permlane16_swap_b32 v97, v61
  v_permlane16_swap_b32 v98, v62
  v_permlane16_swap_b32 v99, v63
  v_permlane16_swap_b32 v100, v64
  v_permlane16_swap_b32 v101, v65
  v_permlane16_swap_b32 v102, v66
  v_permlane16_swap_b32 v103, v67
  v_add_f32 v60, v60, v96
  v_add_f32 v61, v61, v97
  v_add_f32 v62, v62, v98
  v_add_f32 v63, v63, v99
  v_add_f32 v64, v64, v100
  v_add_f32 v65, v65, v101
  v_add_f32 v66, v66, v102
  v_add_f32 v67, v67, v103
  v_mov_b32 v96, v60
  v_mov_b32 v97, v61
  v_mov_b32 v98, v62
  v_mov_b32 v99, v63
  v_mov_b32 v100, v64
  v_mov_b32 v101, v65
  v_mov_b32 v102, v66
  v_mov_b32 v103, v67
  v_permlane32_swap_b32 v96, v60
  v_permlane32_swap_b32 v97, v61
  v_permlane32_swap_b32 v98, v62
  v_permlane32_swap_b32 v99, v63
  v_permlane32_swap_b32 v100, v64
  v_permlane32_swap_b32 v101, v65
  v_permlane32_swap_b32 v102, v66
  v_permlane32_swap_b32 v103, v67
  v_add_f32 v60, v60, v96
  v_add_f32 v61, v61, v97
  v_add_f32 v62, v62, v98
  v_add_f32 v63, v63, v99
  v_add_f32 v64, v64, v100
  v_add_f32 v65, v65, v101
  v_add_f32 v66, v66, v102
  v_add_f32 v67, v67, v103
  v_lshlrev_b32 v96, 5, v0
  s_lshl_b32 s59, s54, 7
  s_add_u32 s59, s59, 131136
  v_add_u32 v96, s59, v96
  s_mov_b64 exec, 15
  ds_write_b128 v96, v[60:63]
  ds_write_b128 v96, v[64:67] offset:16
  s_mov_b64 exec, -1
  s_waitcnt lgkmcnt(0)
  s_barrier
  s_cmp_lg_u32 s54, 0
  s_cbranch_scc1 nomod_3
  v_and_b32 v97, 31, v0
  v_lshlrev_b32 v97, 2, v97
  v_add_u32 v96, 131136, v97
  ds_read_b32 v98, v96 offset:0
  ds_read_b32 v99, v96 offset:128
  ds_read_b32 v100, v96 offset:256
  ds_read_b32 v101, v96 offset:384
  s_lshl_b32 s59, s2, 7
  s_add_u32 s59, s59, 2359296
  s_waitcnt lgkmcnt(0)
  v_add_f32 v98, v98, v99
  v_add_f32 v100, v100, v101
  v_add_f32 v98, v98, v100
  v_cvt_pk_bf16_f32 v98, v98, v98
  v_and_b32 v98, 0xffff0000, v98
  buffer_store_dword v98, v97, s[8:11], s59 offen sc1
nomod_3:
  s_waitcnt vmcnt(16)
  v_mov_b32 v228, v72
  v_mov_b32 v229, v73
  v_lshlrev_b32 v96, 16, v240
  v_and_b32 v97, 0xffff0000, v240
  v_lshlrev_b32 v98, 16, v241
  v_and_b32 v99, 0xffff0000, v241
  v_lshlrev_b32 v100, 16, v242
  v_and_b32 v101, 0xffff0000, v242
  v_lshlrev_b32 v102, 16, v243
  v_and_b32 v103, 0xffff0000, v243
  v_lshlrev_b32 v104, 16, v244
  v_and_b32 v105, 0xffff0000, v244
  v_lshlrev_b32 v106, 16, v245
  v_and_b32 v107, 0xffff0000, v245
  v_lshlrev_b32 v108, 16, v246
  v_and_b32 v109, 0xffff0000, v246
  v_lshlrev_b32 v110, 16, v247
  v_and_b32 v111, 0xffff0000, v247
  v_lshlrev_b32 v112, 16, v248
  v_and_b32 v113, 0xffff0000, v248
  v_lshlrev_b32 v114, 16, v249
  v_and_b32 v115, 0xffff0000, v249
  v_lshlrev_b32 v116, 16, v250
  v_and_b32 v117, 0xffff0000, v250
  v_lshlrev_b32 v118, 16, v251
  v_and_b32 v119, 0xffff0000, v251
  v_lshlrev_b32 v120, 16, v252
  v_and_b32 v121, 0xffff0000, v252
  v_lshlrev_b32 v122, 16, v253
  v_and_b32 v123, 0xffff0000, v253
  v_lshlrev_b32 v124, 16, v254
  v_and_b32 v125, 0xffff0000, v254
  v_lshlrev_b32 v126, 16, v255
  v_and_b32 v127, 0xffff0000, v255
  v_pk_add_f32 v[168:169], v[96:97], v[104:105]
  v_pk_add_f32 v[170:171], v[98:99], v[106:107]
  v_pk_add_f32 v[172:173], v[100:101], v[108:109]
  v_pk_add_f32 v[174:175], v[102:103], v[110:111]
  v_pk_add_f32 v[168:169], v[168:169], v[172:173]
  v_pk_add_f32 v[170:171], v[170:171], v[174:175]
  v_pk_add_f32 v[168:169], v[168:169], v[170:171]
  v_add_f32 v184, v168, v169
  v_pk_add_f32 v[196:197], v[112:113], v[120:121]
  v_pk_add_f32 v[198:199], v[114:115], v[122:123]
  v_pk_add_f32 v[200:201], v[116:117], v[124:125]
  v_pk_add_f32 v[202:203], v[118:119], v[126:127]
  v_pk_add_f32 v[196:197], v[196:197], v[200:201]
  v_pk_add_f32 v[198:199], v[198:199], v[202:203]
  v_pk_add_f32 v[196:197], v[196:197], v[198:199]
  v_add_f32 v212, v196, v197
  v_add_f32_dpp v184, v184, v184 row_ror:4 row_mask:0xf bank_mask:0xf
  s_nop 1
  v_add_f32_dpp v184, v184, v184 row_ror:8 row_mask:0xf bank_mask:0xf
  v_mov_b32 v186, v184
  s_nop 1
  v_permlane16_swap_b32 v186, v184
  v_add_f32 v184, v184, v186
  v_mov_b32 v186, v184
  s_nop 1
  v_permlane32_swap_b32 v186, v184
  v_add_f32 v184, v184, v186
  v_add_f32_dpp v212, v212, v212 row_ror:4 row_mask:0xf bank_mask:0xf
  s_nop 1
  v_add_f32_dpp v212, v212, v212 row_ror:8 row_mask:0xf bank_mask:0xf
  v_mov_b32 v214, v212
  s_nop 1
  v_permlane16_swap_b32 v214, v212
  v_add_f32 v212, v212, v214
  v_mov_b32 v214, v212
  s_nop 1
  v_permlane32_swap_b32 v214, v212
  v_add_f32 v212, v212, v214
  v_mul_f32 v184, 0x3b800000, v184
  v_mov_b32 v185, v184
  v_pk_add_f32 v[168:169], v[96:97], v[184:185] neg_lo:[0,1] neg_hi:[0,1]
  v_pk_add_f32 v[170:171], v[98:99], v[184:185] neg_lo:[0,1] neg_hi:[0,1]
  v_pk_add_f32 v[172:173], v[100:101], v[184:185] neg_lo:[0,1] neg_hi:[0,1]
  v_pk_add_f32 v[174:175], v[102:103], v[184:185] neg_lo:[0,1] neg_hi:[0,1]
  v_pk_add_f32 v[176:177], v[104:105], v[184:185] neg_lo:[0,1] neg_hi:[0,1]
  v_pk_add_f32 v[178:179], v[106:107], v[184:185] neg_lo:[0,1] neg_hi:[0,1]
  v_pk_add_f32 v[180:181], v[108:109], v[184:185] neg_lo:[0,1] neg_hi:[0,1]
  v_pk_add_f32 v[182:183], v[110:111], v[184:185] neg_lo:[0,1] neg_hi:[0,1]
  v_pk_mul_f32 v[168:169], v[168:169], v[168:169]
  v_pk_fma_f32 v[168:169], v[170:171], v[170:171], v[168:169]
  v_pk_fma_f32 v[168:169], v[172:173], v[172:173], v[168:169]
  v_pk_fma_f32 v[168:169], v[174:175], v[174:175], v[168:169]
  v_pk_fma_f32 v[168:169], v[176:177], v[176:177], v[168:169]
  v_pk_fma_f32 v[168:169], v[178:179], v[178:179], v[168:169]
  v_pk_fma_f32 v[168:169], v[180:181], v[180:181], v[168:169]
  v_pk_fma_f32 v[168:169], v[182:183], v[182:183], v[168:169]
  v_add_f32 v185, v168, v169
  v_mul_f32 v212, 0x3b800000, v212
  v_mov_b32 v213, v212
  v_pk_add_f32 v[196:197], v[112:113], v[212:213] neg_lo:[0,1] neg_hi:[0,1]
  v_pk_add_f32 v[198:199], v[114:115], v[212:213] neg_lo:[0,1] neg_hi:[0,1]
  v_pk_add_f32 v[200:201], v[116:117], v[212:213] neg_lo:[0,1] neg_hi:[0,1]
  v_pk_add_f32 v[202:203], v[118:119], v[212:213] neg_lo:[0,1] neg_hi:[0,1]
  v_pk_add_f32 v[204:205], v[120:121], v[212:213] neg_lo:[0,1] neg_hi:[0,1]
  v_pk_add_f32 v[206:207], v[122:123], v[212:213] neg_lo:[0,1] neg_hi:[0,1]
  v_pk_add_f32 v[208:209], v[124:125], v[212:213] neg_lo:[0,1] neg_hi:[0,1]
  v_pk_add_f32 v[210:211], v[126:127], v[212:213] neg_lo:[0,1] neg_hi:[0,1]
  v_pk_mul_f32 v[196:197], v[196:197], v[196:197]
  v_pk_fma_f32 v[196:197], v[198:199], v[198:199], v[196:197]
  v_pk_fma_f32 v[196:197], v[200:201], v[200:201], v[196:197]
  v_pk_fma_f32 v[196:197], v[202:203], v[202:203], v[196:197]
  v_pk_fma_f32 v[196:197], v[204:205], v[204:205], v[196:197]
  v_pk_fma_f32 v[196:197], v[206:207], v[206:207], v[196:197]
  v_pk_fma_f32 v[196:197], v[208:209], v[208:209], v[196:197]
  v_pk_fma_f32 v[196:197], v[210:211], v[210:211], v[196:197]
  v_add_f32 v213, v196, v197
  v_add_f32_dpp v185, v185, v185 row_ror:4 row_mask:0xf bank_mask:0xf
  s_nop 1
  v_add_f32_dpp v185, v185, v185 row_ror:8 row_mask:0xf bank_mask:0xf
  v_mov_b32 v186, v185
  s_nop 1
  v_permlane16_swap_b32 v186, v185
  v_add_f32 v185, v185, v186
  v_mov_b32 v186, v185
  s_nop 1
  v_permlane32_swap_b32 v186, v185
  v_add_f32 v185, v185, v186
  v_add_f32_dpp v213, v213, v213 row_ror:4 row_mask:0xf bank_mask:0xf
  s_nop 1
  v_add_f32_dpp v213, v213, v213 row_ror:8 row_mask:0xf bank_mask:0xf
  v_mov_b32 v214, v213
  s_nop 1
  v_permlane16_swap_b32 v214, v213
  v_add_f32 v213, v213, v214
  v_mov_b32 v214, v213
  s_nop 1
  v_permlane32_swap_b32 v214, v213
  v_add_f32 v213, v213, v214
  s_mov_b64 exec, 15
  ds_write_b64 v75, v[184:185] offset:0
  ds_write_b64 v75, v[212:213] offset:128
  s_mov_b64 exec, -1
  s_waitcnt lgkmcnt(0)
  s_barrier
  ds_read_b128 v[168:171], v76 offset:0
  ds_read_b128 v[172:175], v76 offset:16
  ds_read_b128 v[196:199], v76 offset:128
  ds_read_b128 v[200:203], v76 offset:144
  s_waitcnt lgkmcnt(0)
  v_pk_add_f32 v[176:177], v[168:169], v[170:171]
  v_pk_add_f32 v[178:179], v[172:173], v[174:175]
  v_pk_add_f32 v[176:177], v[176:177], v[178:179]
  v_mul_f32 v176, 0x3e800000, v176
  v_sub_f32 v168, v168, v176
  v_sub_f32 v170, v170, v176
  v_sub_f32 v172, v172, v176
  v_sub_f32 v174, v174, v176
  v_mul_f32 v168, v168, v168
  v_fmac_f32 v168, v170, v170
  v_fmac_f32 v168, v172, v172
  v_fmac_f32 v168, v174, v174
  v_mul_f32 v177, 0x3a800000, v177
  v_fmac_f32 v177, 0x3e800000, v168
  v_cvt_pk_bf16_f32 v178, v176, v177
  v_lshlrev_b32 v176, 16, v178
  v_and_b32 v177, 0xffff0000, v178
  v_add_f32 v177, 0x3727c5ac, v177
  v_cvt_pk_bf16_f32 v177, v177, v177
  v_and_b32 v177, 0xffff0000, v177
  v_sqrt_f32 v177, v177
  s_nop 0
  v_cvt_pk_bf16_f32 v177, v177, v177
  v_and_b32 v177, 0xffff0000, v177
  v_rcp_f32 v178, v177
  v_mov_b32 v177, v176
  v_mov_b32 v179, v178
  v_pk_add_f32 v[96:97], v[96:97], v[176:177] neg_lo:[0,1] neg_hi:[0,1]
  v_pk_add_f32 v[98:99], v[98:99], v[176:177] neg_lo:[0,1] neg_hi:[0,1]
  v_pk_add_f32 v[100:101], v[100:101], v[176:177] neg_lo:[0,1] neg_hi:[0,1]
  v_pk_add_f32 v[102:103], v[102:103], v[176:177] neg_lo:[0,1] neg_hi:[0,1]
  v_pk_add_f32 v[104:105], v[104:105], v[176:177] neg_lo:[0,1] neg_hi:[0,1]
  v_pk_add_f32 v[106:107], v[106:107], v[176:177] neg_lo:[0,1] neg_hi:[0,1]
  v_pk_add_f32 v[108:109], v[108:109], v[176:177] neg_lo:[0,1] neg_hi:[0,1]
  v_pk_add_f32 v[110:111], v[110:111], v[176:177] neg_lo:[0,1] neg_hi:[0,1]
  v_cvt_pk_bf16_f32 v180, v96, v97
  v_lshlrev_b32 v96, 16, v180
  v_and_b32 v97, 0xffff0000, v180
  v_cvt_pk_bf16_f32 v181, v98, v99
  v_lshlrev_b32 v98, 16, v181
  v_and_b32 v99, 0xffff0000, v181
  v_cvt_pk_bf16_f32 v182, v100, v101
  v_lshlrev_b32 v100, 16, v182
  v_and_b32 v101, 0xffff0000, v182
  v_cvt_pk_bf16_f32 v183, v102, v103
  v_lshlrev_b32 v102, 16, v183
  v_and_b32 v103, 0xffff0000, v183
  v_cvt_pk_bf16_f32 v180, v104, v105
  v_lshlrev_b32 v104, 16, v180
  v_and_b32 v105, 0xffff0000, v180
  v_cvt_pk_bf16_f32 v181, v106, v107
  v_lshlrev_b32 v106, 16, v181
  v_and_b32 v107, 0xffff0000, v181
  v_cvt_pk_bf16_f32 v182, v108, v109
  v_lshlrev_b32 v108, 16, v182
  v_and_b32 v109, 0xffff0000, v182
  v_cvt_pk_bf16_f32 v183, v110, v111
  v_lshlrev_b32 v110, 16, v183
  v_and_b32 v111, 0xffff0000, v183
  v_pk_mul_f32 v[96:97], v[96:97], v[178:179]
  v_pk_mul_f32 v[98:99], v[98:99], v[178:179]
  v_pk_mul_f32 v[100:101], v[100:101], v[178:179]
  v_pk_mul_f32 v[102:103], v[102:103], v[178:179]
  v_pk_mul_f32 v[104:105], v[104:105], v[178:179]
  v_pk_mul_f32 v[106:107], v[106:107], v[178:179]
  v_pk_mul_f32 v[108:109], v[108:109], v[178:179]
  v_pk_mul_f32 v[110:111], v[110:111], v[178:179]
  v_pk_add_f32 v[204:205], v[196:197], v[198:199]
  v_pk_add_f32 v[206:207], v[200:201], v[202:203]
  v_pk_add_f32 v[204:205], v[204:205], v[206:207]
  v_mul_f32 v204, 0x3e800000, v204
  v_sub_f32 v196, v196, v204
  v_sub_f32 v198, v198, v204
  v_sub_f32 v200, v200, v204
  v_sub_f32 v202, v202, v204
  v_mul_f32 v196, v196, v196
  v_fmac_f32 v196, v198, v198
  v_fmac_f32 v196, v200, v200
  v_fmac_f32 v196, v202, v202
  v_mul_f32 v205, 0x3a800000, v205
  v_fmac_f32 v205, 0x3e800000, v196
  v_cvt_pk_bf16_f32 v206, v204, v205
  v_lshlrev_b32 v204, 16, v206
  v_and_b32 v205, 0xffff0000, v206
  v_add_f32 v205, 0x3727c5ac, v205
  v_cvt_pk_bf16_f32 v205, v205, v205
  v_and_b32 v205, 0xffff0000, v205
  v_sqrt_f32 v205, v205
  s_nop 0
  v_cvt_pk_bf16_f32 v205, v205, v205
  v_and_b32 v205, 0xffff0000, v205
  v_rcp_f32 v206, v205
  v_mov_b32 v205, v204
  v_mov_b32 v207, v206
  v_pk_add_f32 v[112:113], v[112:113], v[204:205] neg_lo:[0,1] neg_hi:[0,1]
  v_pk_add_f32 v[114:115], v[114:115], v[204:205] neg_lo:[0,1] neg_hi:[0,1]
  v_pk_add_f32 v[116:117], v[116:117], v[204:205] neg_lo:[0,1] neg_hi:[0,1]
  v_pk_add_f32 v[118:119], v[118:119], v[204:205] neg_lo:[0,1] neg_hi:[0,1]
  v_pk_add_f32 v[120:121], v[120:121], v[204:205] neg_lo:[0,1] neg_hi:[0,1]
  v_pk_add_f32 v[122:123], v[122:123], v[204:205] neg_lo:[0,1] neg_hi:[0,1]
  v_pk_add_f32 v[124:125], v[124:125], v[204:205] neg_lo:[0,1] neg_hi:[0,1]
  v_pk_add_f32 v[126:127], v[126:127], v[204:205] neg_lo:[0,1] neg_hi:[0,1]
  v_cvt_pk_bf16_f32 v208, v112, v113
  v_lshlrev_b32 v112, 16, v208
  v_and_b32 v113, 0xffff0000, v208
  v_cvt_pk_bf16_f32 v209, v114, v115
  v_lshlrev_b32 v114, 16, v209
  v_and_b32 v115, 0xffff0000, v209
  v_cvt_pk_bf16_f32 v210, v116, v117
  v_lshlrev_b32 v116, 16, v210
  v_and_b32 v117, 0xffff0000, v210
  v_cvt_pk_bf16_f32 v211, v118, v119
  v_lshlrev_b32 v118, 16, v211
  v_and_b32 v119, 0xffff0000, v211
  v_cvt_pk_bf16_f32 v208, v120, v121
  v_lshlrev_b32 v120, 16, v208
  v_and_b32 v121, 0xffff0000, v208
  v_cvt_pk_bf16_f32 v209, v122, v123
  v_lshlrev_b32 v122, 16, v209
  v_and_b32 v123, 0xffff0000, v209
  v_cvt_pk_bf16_f32 v210, v124, v125
  v_lshlrev_b32 v124, 16, v210
  v_and_b32 v125, 0xffff0000, v210
  v_cvt_pk_bf16_f32 v211, v126, v127
  v_lshlrev_b32 v126, 16, v211
  v_and_b32 v127, 0xffff0000, v211
  v_pk_mul_f32 v[112:113], v[112:113], v[206:207]
  v_pk_mul_f32 v[114:115], v[114:115], v[206:207]
  v_pk_mul_f32 v[116:117], v[116:117], v[206:207]
  v_pk_mul_f32 v[118:119], v[118:119], v[206:207]
  v_pk_mul_f32 v[120:121], v[120:121], v[206:207]
  v_pk_mul_f32 v[122:123], v[122:123], v[206:207]
  v_pk_mul_f32 v[124:125], v[124:125], v[206:207]
  v_pk_mul_f32 v[126:127], v[126:127], v[206:207]
  v_cvt_pk_bf16_f32 v240, v96, v97
  v_cvt_pk_bf16_f32 v241, v98, v99
  v_cvt_pk_bf16_f32 v242, v100, v101
  v_cvt_pk_bf16_f32 v243, v102, v103
  v_cvt_pk_bf16_f32 v244, v104, v105
  v_cvt_pk_bf16_f32 v245, v106, v107
  v_cvt_pk_bf16_f32 v246, v108, v109
  v_cvt_pk_bf16_f32 v247, v110, v111
  v_cvt_pk_bf16_f32 v248, v112, v113
  v_cvt_pk_bf16_f32 v249, v114, v115
  v_cvt_pk_bf16_f32 v250, v116, v117
  v_cvt_pk_bf16_f32 v251, v118, v119
  v_cvt_pk_bf16_f32 v252, v120, v121
  v_cvt_pk_bf16_f32 v253, v122, v123
  v_cvt_pk_bf16_f32 v254, v124, v125
  v_cvt_pk_bf16_f32 v255, v126, v127
C2:
  s_waitcnt vmcnt(16)
  s_cmp_eq_u32 s78, 5
  s_cbranch_scc1 CH1
  s_cmp_eq_u32 s78, 6
  s_cbranch_scc0 WL1
  s_cmp_eq_u32 s72, 0
  s_cbranch_scc0 am_5
  s_waitcnt vmcnt(0) lgkmcnt(0)
  s_barrier
  s_cmp_lg_u32 s54, 0
  s_cbranch_scc1 ar_7
  s_cmp_ge_u32 s56, 32
  s_cselect_b32 s59, 0x10001, 1
  v_mov_b32 v230, s59
  s_and_b32 s59, s2, 7
  s_lshl_b32 s59, s59, 2
  s_add_u32 s59, s59, 128
  v_mov_b32 v231, s59
  v_mov_b32 v232, 0x7ff00000
  v_cmp_eq_u32 vcc, 0, v0
  s_nop 1
  v_cndmask_b32 v231, v232, v231, vcc
  buffer_atomic_add v230, v231, s[20:23], 0 offen sc1
ar_7:
  s_branch an_6
am_5:
  s_waitcnt vmcnt(0) lgkmcnt(0)
  s_barrier
  s_cmp_lg_u32 s54, 0
  s_cbranch_scc1 ar_8
  s_cmp_ge_u32 s56, 32
  s_cselect_b32 s59, 0x10001, 1
  v_mov_b32 v230, s59
  s_and_b32 s59, s2, 7
  s_lshl_b32 s59, s59, 2
  s_add_u32 s59, s59, 160
  v_mov_b32 v231, s59
  v_mov_b32 v232, 0x7ff00000
  v_cmp_eq_u32 vcc, 0, v0
  s_nop 1
  v_cndmask_b32 v231, v232, v231, vcc
  buffer_atomic_add v230, v231, s[20:23], 0 offen sc1
ar_8:
an_6:
  s_branch HOOK
ROLE1:
  s_sub_u32 s79, s55, 4
  s_cbranch_scc0 JOB0
  s_mov_b32 s78, 5
  s_and_b32 s59, s56, 14
  s_cmp_eq_u32 s59, 6
  s_cselect_b32 s88, 1, 0
  v_and_b32 v1, 15, v0
  v_lshrrev_b32 v2, 4, v0
  s_lshl_b32 s59, s55, 16
  s_lshl_b32 s60, s54, 12
  s_add_u32 s60, s60, s59
  v_lshlrev_b32 v4, 4, v0
  v_add_u32 v4, s60, v4
  v_mov_b32 v5, 0x4444
  v_mov_b32 v3, 0xeeee
  v_cmp_le_u32 vcc, 8, v1
  s_nop 1
  v_cndmask_b32 v5, v5, v3, vcc
  v_and_b32 v3, 1, v2
  v_mul_u32_u24 v6, 576, v3
  v_lshl_add_u32 v6, v1, 2, v6
  v_lshrrev_b32 v152, 1, v2
  v_lshl_add_u32 v6, v152, 6, v6
  s_mul_i32 s60, s54, 2304
  v_add_u32 v6, s60, v6
  v_lshlrev_b32 v7, 4, v3
  v_lshl_add_u32 v7, v1, 5, v7
  v_lshl_add_u32 v7, v152, 9, v7
  s_lshl_b32 s60, s54, 10
  v_add_u32 v7, s60, v7
  v_mul_u32_u24 v8, 144, v1
  v_lshl_add_u32 v8, v3, 4, v8
  v_lshl_add_u32 v8, v152, 6, v8
  v_lshlrev_b32 v9, 5, v1
  v_lshl_add_u32 v9, v2, 3, v9
  v_bfe_u32 v153, v0, 1, 3
  v_mul_u32_u24 v10, 144, v153
  v_lshl_add_u32 v10, v2, 5, v10
  v_and_b32 v153, 1, v0
  v_lshl_add_u32 v10, v153, 4, v10
  v_lshlrev_b32 v12, 10, v152
  v_lshl_add_u32 v12, v3, 9, v12
  v_add_u32 v12, 24576, v12
  v_lshrrev_b32 v153, 3, v1
  v_lshl_add_u32 v11, v153, 8, v12
  v_and_b32 v154, 7, v0
  v_lshl_add_u32 v11, v154, 4, v11
  v_lshl_add_u32 v12, v1, 4, v12
  s_mul_i32 s60, s55, 163840
  s_mul_i32 s61, s56, 1280
  s_add_u32 s61, s61, s60
  v_lshlrev_b32 v13, 7, v2
  v_lshl_add_u32 v13, v1, 4, v13
  s_lshl_b32 s62, s56, 9
  s_add_u32 s62, s62, s59
  v_add_u32 v17, s62, v13
  v_add_u32 v13, s61, v13
  v_add_u32 v14, 768, v13
  v_mov_b32 v155, 0x7ff00000
  v_cmp_le_u32 vcc, 8, v1
  s_nop 1
  v_cndmask_b32 v13, v13, v155, vcc
  v_cndmask_b32 v17, v17, v155, vcc
  v_cndmask_b32 v14, v14, v155, vcc
  v_cmp_gt_u32 vcc, 2, v2
  s_nop 1
  v_cndmask_b32 v14, v14, v155, vcc
  s_and_b32 s61, s56, 28
  s_mul_i32 s61, s61, 1280
  s_add_u32 s61, s61, s60
  v_lshlrev_b32 v15, 9, v153
  v_lshl_add_u32 v15, v2, 7, v15
  v_lshl_add_u32 v15, v154, 4, v15
  v_add_u32 v15, s61, v15
  v_lshrrev_b32 v16, 5, v0
  v_lshlrev_b32 v16, 7, v16
  v_lshl_add_u32 v16, v154, 4, v16
  v_bfe_u32 v156, v0, 3, 2
  v_lshl_add_u32 v16, v156, 2, v16
  s_add_u32 s61, s61, 1024
  v_add_u32 v16, s61, v16
  s_lshl_b32 s61, s56, 12
  v_lshlrev_b32 v19, 4, v0
  v_add_u32 v19, s61, v19
  s_lshl_b32 s61, s55, 10
  v_add_u32 v18, s61, v19
  v_lshlrev_b32 v20, 3, v0
  v_add_u32 v20, s62, v20
  v_mov_b32 v22, 0
  v_mov_b32 v24, -1
  v_mov_b32 v168, 0
  v_mov_b32 v25, -1
  v_mov_b32 v169, 0
  v_mov_b32 v26, -1
  v_mov_b32 v170, 0
  v_mov_b32 v27, -1
  v_mov_b32 v171, 0
  v_mov_b32 v141, 0
  v_mov_b32 v133, 0
  v_mov_b32 v135, 0
  s_mul_i32 s60, s55, 163840
  s_mul_i32 s61, s56, 1280
  s_add_u32 s61, s61, s60
  v_lshl_add_u32 v160, v0, 4, s61
  s_add_u32 s61, s61, 1024
  v_lshl_add_u32 v161, v0, 2, s61
  s_mov_b32 s12, s26
  s_mov_b32 s13, s27
  s_mov_b32 s14, 0x4000
  s_mov_b32 s15, 0x00020000
  v_bfe_u32 v152, v0, 1, 3
  v_lshlrev_b32 v152, 11, v152
  v_lshl_add_u32 v152, v2, 4, v152
  v_and_b32 v153, 1, v0
  v_lshl_add_u32 v152, v153, 3, v152
  s_lshl_b32 s59, s56, 6
  buffer_load_dwordx2 v[166:167], v152, s[12:15], s59 offen
  v_lshrrev_b32 v152, 2, v0
  v_and_b32 v3, 3, v0
  v_lshlrev_b32 v3, 4, v3
  s_lshl_b32 s59, s54, 8
  v_add_u32 v152, s59, v152
  s_lshl_b32 s60, s55, 11
  s_lshl_b32 s61, s56, 6
  s_add_u32 s60, s60, s61
  v_lshl_add_u32 v153, v152, 13, v3
  v_add_u32 v153, s60, v153
  s_lshl_b32 s60, s55, 21
  s_add_u32 s60, s60, s61
  v_lshl_add_u32 v154, v152, 11, v3
  v_add_u32 v154, s60, v154
  s_lshl_b32 s63, s54, 15
  s_add_u32 s63, s63, 0
  v_lshrrev_b32 v158, 1, v2
  v_and_b32 v159, 1, v2
  v_lshlrev_b32 v156, 4, v158
  v_lshl_add_u32 v156, v159, 2, v156
  v_lshlrev_b32 v157, 3, v158
  v_lshl_add_u32 v157, v159, 4, v157
  v_bfe_u32 v158, v0, 3, 1
  v_lshl_add_u32 v156, v158, 3, v156
  v_lshl_add_u32 v157, v158, 2, v157
  v_bfe_u32 v158, v0, 2, 1
  v_add_u32 v156, v156, v158
  v_add_u32 v157, v157, v158
  v_and_b32 v158, 3, v0
  v_lshlrev_b32 v158, 3, v158
  v_add_u32 v158, s63, v158
  v_lshl_add_u32 v156, v156, 6, v158
  v_lshl_add_u32 v157, v157, 6, v158
  s_cmp_eq_u32 s88, 0
  s_cbranch_scc1 ea_9
  s_mov_b32 s12, s28
  s_mov_b32 s13, s29
  s_mov_b32 s14, 0x800000
  s_mov_b32 s15, 0x00020000
  s_add_u32 m0, s63, 0
  s_mov_b32 s59, 0
  buffer_load_dwordx4 v153, s[12:15], s59 offen lds
  s_add_u32 m0, s63, 1024
  s_mov_b32 s59, 131072
  buffer_load_dwordx4 v153, s[12:15], s59 offen lds
  s_add_u32 m0, s63, 2048
  s_mov_b32 s59, 262144
  buffer_load_dwordx4 v153, s[12:15], s59 offen lds
  s_add_u32 m0, s63, 3072
  s_mov_b32 s59, 393216
  buffer_load_dwordx4 v153, s[12:15], s59 offen lds
  s_add_u32 m0, s63, 4096
  s_mov_b32 s59, 524288
  buffer_load_dwordx4 v153, s[12:15], s59 offen lds
  s_add_u32 m0, s63, 5120
  s_mov_b32 s59, 655360
  buffer_load_dwordx4 v153, s[12:15], s59 offen lds
  s_add_u32 m0, s63, 6144
  s_mov_b32 s59, 786432
  buffer_load_dwordx4 v153, s[12:15], s59 offen lds
  s_add_u32 m0, s63, 7168
  s_mov_b32 s59, 917504
  buffer_load_dwordx4 v153, s[12:15], s59 offen lds
  s_add_u32 m0, s63, 8192
  s_mov_b32 s59, 1048576
  buffer_load_dwordx4 v153, s[12:15], s59 offen lds
  s_add_u32 m0, s63, 9216
  s_mov_b32 s59, 1179648
  buffer_load_dwordx4 v153, s[12:15], s59 offen lds
  s_add_u32 m0, s63, 10240
  s_mov_b32 s59, 1310720
  buffer_load_dwordx4 v153, s[12:15], s59 offen lds
  s_add_u32 m0, s63, 11264
  s_mov_b32 s59, 1441792
  buffer_load_dwordx4 v153, s[12:15], s59 offen lds
  s_add_u32 m0, s63, 12288
  s_mov_b32 s59, 1572864
  buffer_load_dwordx4 v153, s[12:15], s59 offen lds
  s_add_u32 m0, s63, 13312
  s_mov_b32 s59, 1703936
  buffer_load_dwordx4 v153, s[12:15], s59 offen lds
  s_add_u32 m0, s63, 14336
  s_mov_b32 s59, 1835008
  buffer_load_dwordx4 v153, s[12:15], s59 offen lds
  s_add_u32 m0, s63, 15360
  s_mov_b32 s59, 1966080
  buffer_load_dwordx4 v153, s[12:15], s59 offen lds
  s_branch ea_10
ea_9:
  buffer_load_dword v30, v31, s[8:11], 0 offen
  buffer_load_dword v30, v31, s[8:11], 0 offen
  buffer_load_dword v30, v31, s[8:11], 0 offen
  buffer_load_dword v30, v31, s[8:11], 0 offen
  buffer_load_dword v30, v31, s[8:11], 0 offen
  buffer_load_dword v30, v31, s[8:11], 0 offen
  buffer_load_dword v30, v31, s[8:11], 0 offen
  buffer_load_dword v30, v31, s[8:11], 0 offen
  buffer_load_dword v30, v31, s[8:11], 0 offen
  buffer_load_dword v30, v31, s[8:11], 0 offen
  buffer_load_dword v30, v31, s[8:11], 0 offen
  buffer_load_dword v30, v31, s[8:11], 0 offen
  buffer_load_dword v30, v31, s[8:11], 0 offen
  buffer_load_dword v30, v31, s[8:11], 0 offen
  buffer_load_dword v30, v31, s[8:11], 0 offen
  buffer_load_dword v30, v31, s[8:11], 0 offen
ea_10:
  s_branch C1
CH1:
  v_mov_b32 v168, 0
  v_mov_b32 v169, 0
  v_mov_b32 v170, 0
  v_mov_b32 v171, 0
  s_cmp_lg_u32 s54, 0
  s_cbranch_scc1 ci_14
  s_lshl_b32 s59, s54, 14
  s_add_u32 s60, s59, 262144
  buffer_store_dwordx2 v[166:167], v20, s[8:11], s59 offen sc1
  buffer_store_dwordx2 v[24:25], v20, s[8:11], s60 offen sc1
  s_mul_i32 s59, s54, 40960
  s_add_u32 s59, s59, 524288
  s_lshl_b32 s60, s54, 17
  s_add_u32 s60, s60, 1572864
  buffer_store_dwordx4 v[24:27], v160, s[8:11], s59 offen sc1
  buffer_store_dword v24, v161, s[8:11], s59 offen sc1
  buffer_store_dwordx4 v[24:27], v18, s[8:11], s60 offen sc1
  s_branch cj_15
ci_14:
  s_lshl_b32 s59, s54, 14
  s_add_u32 s60, s59, 262144
  buffer_store_dwordx2 v[24:25], v20, s[8:11], s59 offen sc1
  buffer_store_dwordx2 v[24:25], v20, s[8:11], s60 offen sc1
  s_mul_i32 s59, s54, 40960
  s_add_u32 s59, s59, 524288
  s_lshl_b32 s60, s54, 17
  s_add_u32 s60, s60, 1572864
  buffer_store_dwordx4 v[24:27], v160, s[8:11], s59 offen sc1
  buffer_store_dword v24, v161, s[8:11], s59 offen sc1
  buffer_store_dwordx4 v[24:27], v18, s[8:11], s60 offen sc1
cj_15:
  s_cmp_eq_u32 s88, 0
  s_cbranch_scc0 ea_11
  s_cmp_eq_u32 s72, 0
  s_cbranch_scc0 am_16
  s_waitcnt vmcnt(0) lgkmcnt(0)
  s_barrier
  s_cmp_lg_u32 s54, 0
  s_cbranch_scc1 ar_18
  s_cmp_ge_u32 s56, 32
  s_cselect_b32 s59, 0x10001, 1
  v_mov_b32 v230, s59
  s_and_b32 s59, s2, 7
  s_lshl_b32 s59, s59, 2
  s_add_u32 s59, s59, 128
  v_mov_b32 v231, s59
  v_mov_b32 v232, 0x7ff00000
  v_cmp_eq_u32 vcc, 0, v0
  s_nop 1
  v_cndmask_b32 v231, v232, v231, vcc
  buffer_atomic_add v230, v231, s[20:23], 0 offen sc1
ar_18:
  s_branch an_17
am_16:
  s_waitcnt vmcnt(0) lgkmcnt(0)
  s_barrier
  s_cmp_lg_u32 s54, 0
  s_cbranch_scc1 ar_19
  s_cmp_ge_u32 s56, 32
  s_cselect_b32 s59, 0x10001, 1
  v_mov_b32 v230, s59
  s_and_b32 s59, s2, 7
  s_lshl_b32 s59, s59, 2
  s_add_u32 s59, s59, 160
  v_mov_b32 v231, s59
  v_mov_b32 v232, 0x7ff00000
  v_cmp_eq_u32 vcc, 0, v0
  s_nop 1
  v_cndmask_b32 v231, v232, v231, vcc
  buffer_atomic_add v230, v231, s[20:23], 0 offen sc1
ar_19:
an_17:
  s_mov_b32 s12, s28
  s_mov_b32 s13, s29
  s_mov_b32 s14, 0x800000
  s_mov_b32 s15, 0x00020000
  s_add_u32 m0, s63, 0
  s_mov_b32 s59, 0
  buffer_load_dwordx4 v153, s[12:15], s59 offen lds
  s_add_u32 m0, s63, 1024
  s_mov_b32 s59, 131072
  buffer_load_dwordx4 v153, s[12:15], s59 offen lds
  s_add_u32 m0, s63, 2048
  s_mov_b32 s59, 262144
  buffer_load_dwordx4 v153, s[12:15], s59 offen lds
  s_add_u32 m0, s63, 3072
  s_mov_b32 s59, 393216
  buffer_load_dwordx4 v153, s[12:15], s59 offen lds
  s_add_u32 m0, s63, 4096
  s_mov_b32 s59, 524288
  buffer_load_dwordx4 v153, s[12:15], s59 offen lds
  s_add_u32 m0, s63, 5120
  s_mov_b32 s59, 655360
  buffer_load_dwordx4 v153, s[12:15], s59 offen lds
  s_add_u32 m0, s63, 6144
  s_mov_b32 s59, 786432
  buffer_load_dwordx4 v153, s[12:15], s59 offen lds
  s_add_u32 m0, s63, 7168
  s_mov_b32 s59, 917504
  buffer_load_dwordx4 v153, s[12:15], s59 offen lds
  s_add_u32 m0, s63, 8192
  s_mov_b32 s59, 1048576
  buffer_load_dwordx4 v153, s[12:15], s59 offen lds
  s_add_u32 m0, s63, 9216
  s_mov_b32 s59, 1179648
  buffer_load_dwordx4 v153, s[12:15], s59 offen lds
  s_add_u32 m0, s63, 10240
  s_mov_b32 s59, 1310720
  buffer_load_dwordx4 v153, s[12:15], s59 offen lds
  s_add_u32 m0, s63, 11264
  s_mov_b32 s59, 1441792
  buffer_load_dwordx4 v153, s[12:15], s59 offen lds
  s_add_u32 m0, s63, 12288
  s_mov_b32 s59, 1572864
  buffer_load_dwordx4 v153, s[12:15], s59 offen lds
  s_add_u32 m0, s63, 13312
  s_mov_b32 s59, 1703936
  buffer_load_dwordx4 v153, s[12:15], s59 offen lds
  s_add_u32 m0, s63, 14336
  s_mov_b32 s59, 1835008
  buffer_load_dwordx4 v153, s[12:15], s59 offen lds
  s_add_u32 m0, s63, 15360
  s_mov_b32 s59, 1966080
  buffer_load_dwordx4 v153, s[12:15], s59 offen lds
  s_mov_b32 s16, s30
  s_mov_b32 s17, s31
  s_mov_b32 s18, 0x800000
  s_mov_b32 s19, 0x00020000
  s_add_u32 m0, s63, 16384
  s_mov_b32 s59, 0
  buffer_load_dwordx4 v153, s[16:19], s59 offen lds
  s_add_u32 m0, s63, 17408
  s_mov_b32 s59, 131072
  buffer_load_dwordx4 v153, s[16:19], s59 offen lds
  s_add_u32 m0, s63, 18432
  s_mov_b32 s59, 262144
  buffer_load_dwordx4 v153, s[16:19], s59 offen lds
  s_add_u32 m0, s63, 19456
  s_mov_b32 s59, 393216
  buffer_load_dwordx4 v153, s[16:19], s59 offen lds
  s_add_u32 m0, s63, 20480
  s_mov_b32 s59, 524288
  buffer_load_dwordx4 v153, s[16:19], s59 offen lds
  s_add_u32 m0, s63, 21504
  s_mov_b32 s59, 655360
  buffer_load_dwordx4 v153, s[16:19], s59 offen lds
  s_add_u32 m0, s63, 22528
  s_mov_b32 s59, 786432
  buffer_load_dwordx4 v153, s[16:19], s59 offen lds
  s_add_u32 m0, s63, 23552
  s_mov_b32 s59, 917504
  buffer_load_dwordx4 v153, s[16:19], s59 offen lds
  s_add_u32 m0, s63, 24576
  s_mov_b32 s59, 1048576
  buffer_load_dwordx4 v153, s[16:19], s59 offen lds
  s_add_u32 m0, s63, 25600
  s_mov_b32 s59, 1179648
  buffer_load_dwordx4 v153, s[16:19], s59 offen lds
  s_add_u32 m0, s63, 26624
  s_mov_b32 s59, 1310720
  buffer_load_dwordx4 v153, s[16:19], s59 offen lds
  s_add_u32 m0, s63, 27648
  s_mov_b32 s59, 1441792
  buffer_load_dwordx4 v153, s[16:19], s59 offen lds
  s_add_u32 m0, s63, 28672
  s_mov_b32 s59, 1572864
  buffer_load_dwordx4 v153, s[16:19], s59 offen lds
  s_add_u32 m0, s63, 29696
  s_mov_b32 s59, 1703936
  buffer_load_dwordx4 v153, s[16:19], s59 offen lds
  s_add_u32 m0, s63, 30720
  s_mov_b32 s59, 1835008
  buffer_load_dwordx4 v153, s[16:19], s59 offen lds
  s_add_u32 m0, s63, 31744
  s_mov_b32 s59, 1966080
  buffer_load_dwordx4 v153, s[16:19], s59 offen lds
  s_branch ea_12
ea_11:
  s_mov_b32 s16, s30
  s_mov_b32 s17, s31
  s_mov_b32 s18, 0x800000
  s_mov_b32 s19, 0x00020000
  s_add_u32 m0, s63, 16384
  s_mov_b32 s59, 0
  buffer_load_dwordx4 v153, s[16:19], s59 offen lds
  s_add_u32 m0, s63, 17408
  s_mov_b32 s59, 131072
  buffer_load_dwordx4 v153, s[16:19], s59 offen lds
  s_add_u32 m0, s63, 18432
  s_mov_b32 s59, 262144
  buffer_load_dwordx4 v153, s[16:19], s59 offen lds
  s_add_u32 m0, s63, 19456
  s_mov_b32 s59, 393216
  buffer_load_dwordx4 v153, s[16:19], s59 offen lds
  s_add_u32 m0, s63, 20480
  s_mov_b32 s59, 524288
  buffer_load_dwordx4 v153, s[16:19], s59 offen lds
  s_add_u32 m0, s63, 21504
  s_mov_b32 s59, 655360
  buffer_load_dwordx4 v153, s[16:19], s59 offen lds
  s_add_u32 m0, s63, 22528
  s_mov_b32 s59, 786432
  buffer_load_dwordx4 v153, s[16:19], s59 offen lds
  s_add_u32 m0, s63, 23552
  s_mov_b32 s59, 917504
  buffer_load_dwordx4 v153, s[16:19], s59 offen lds
  s_add_u32 m0, s63, 24576
  s_mov_b32 s59, 1048576
  buffer_load_dwordx4 v153, s[16:19], s59 offen lds
  s_add_u32 m0, s63, 25600
  s_mov_b32 s59, 1179648
  buffer_load_dwordx4 v153, s[16:19], s59 offen lds
  s_add_u32 m0, s63, 26624
  s_mov_b32 s59, 1310720
  buffer_load_dwordx4 v153, s[16:19], s59 offen lds
  s_add_u32 m0, s63, 27648
  s_mov_b32 s59, 1441792
  buffer_load_dwordx4 v153, s[16:19], s59 offen lds
  s_add_u32 m0, s63, 28672
  s_mov_b32 s59, 1572864
  buffer_load_dwordx4 v153, s[16:19], s59 offen lds
  s_add_u32 m0, s63, 29696
  s_mov_b32 s59, 1703936
  buffer_load_dwordx4 v153, s[16:19], s59 offen lds
  s_add_u32 m0, s63, 30720
  s_mov_b32 s59, 1835008
  buffer_load_dwordx4 v153, s[16:19], s59 offen lds
  s_add_u32 m0, s63, 31744
  s_mov_b32 s59, 1966080
  buffer_load_dwordx4 v153, s[16:19], s59 offen lds
  s_cmp_eq_u32 s72, 0
  s_cbranch_scc0 am_20
  s_waitcnt vmcnt(16) lgkmcnt(0)
  s_barrier
  s_cmp_lg_u32 s54, 0
  s_cbranch_scc1 ar_22
  s_cmp_ge_u32 s56, 32
  s_cselect_b32 s59, 0x10001, 1
  v_mov_b32 v230, s59
  s_and_b32 s59, s2, 7
  s_lshl_b32 s59, s59, 2
  s_add_u32 s59, s59, 128
  v_mov_b32 v231, s59
  v_mov_b32 v232, 0x7ff00000
  v_cmp_eq_u32 vcc, 0, v0
  s_nop 1
  v_cndmask_b32 v231, v232, v231, vcc
  buffer_atomic_add v230, v231, s[20:23], 0 offen sc1
ar_22:
  s_branch an_21
am_20:
  s_waitcnt vmcnt(16) lgkmcnt(0)
  s_barrier
  s_cmp_lg_u32 s54, 0
  s_cbranch_scc1 ar_23
  s_cmp_ge_u32 s56, 32
  s_cselect_b32 s59, 0x10001, 1
  v_mov_b32 v230, s59
  s_and_b32 s59, s2, 7
  s_lshl_b32 s59, s59, 2
  s_add_u32 s59, s59, 160
  v_mov_b32 v231, s59
  v_mov_b32 v232, 0x7ff00000
  v_cmp_eq_u32 vcc, 0, v0
  s_nop 1
  v_cndmask_b32 v231, v232, v231, vcc
  buffer_atomic_add v230, v231, s[20:23], 0 offen sc1
ar_23:
an_21:
ea_12:
  s_waitcnt vmcnt(16)
  ds_read_b64_tr_b16 a[0:1], v156 offset:0
  ds_read_b64_tr_b16 a[2:3], v156 offset:128
  ds_read_b64_tr_b16 a[4:5], v156 offset:2048
  ds_read_b64_tr_b16 a[6:7], v156 offset:2176
  ds_read_b64_tr_b16 a[8:9], v156 offset:4096
  ds_read_b64_tr_b16 a[10:11], v156 offset:4224
  ds_read_b64_tr_b16 a[12:13], v156 offset:6144
  ds_read_b64_tr_b16 a[14:15], v156 offset:6272
  ds_read_b64_tr_b16 a[16:17], v156 offset:8192
  ds_read_b64_tr_b16 a[18:19], v156 offset:8320
  ds_read_b64_tr_b16 a[20:21], v156 offset:10240
  ds_read_b64_tr_b16 a[22:23], v156 offset:10368
  ds_read_b64_tr_b16 a[24:25], v156 offset:12288
  ds_read_b64_tr_b16 a[26:27], v156 offset:12416
  ds_read_b64_tr_b16 a[28:29], v156 offset:14336
  ds_read_b64_tr_b16 a[30:31], v156 offset:14464
  ds_read_b64_tr_b16 a[32:33], v156 offset:32
  ds_read_b64_tr_b16 a[34:35], v156 offset:160
  ds_read_b64_tr_b16 a[36:37], v156 offset:2080
  ds_read_b64_tr_b16 a[38:39], v156 offset:2208
  ds_read_b64_tr_b16 a[40:41], v156 offset:4128
  ds_read_b64_tr_b16 a[42:43], v156 offset:4256
  ds_read_b64_tr_b16 a[44:45], v156 offset:6176
  ds_read_b64_tr_b16 a[46:47], v156 offset:6304
  ds_read_b64_tr_b16 a[48:49], v156 offset:8224
  ds_read_b64_tr_b16 a[50:51], v156 offset:8352
  ds_read_b64_tr_b16 a[52:53], v156 offset:10272
  ds_read_b64_tr_b16 a[54:55], v156 offset:10400
  ds_read_b64_tr_b16 a[56:57], v156 offset:12320
  ds_read_b64_tr_b16 a[58:59], v156 offset:12448
  ds_read_b64_tr_b16 a[60:61], v156 offset:14368
  ds_read_b64_tr_b16 a[62:63], v156 offset:14496
  s_waitcnt lgkmcnt(0)
  s_mov_b32 s12, s32
  s_mov_b32 s13, s33
  s_mov_b32 s14, 0x800000
  s_mov_b32 s15, 0x00020000
  s_add_u32 m0, s63, 0
  s_mov_b32 s59, 0
  buffer_load_dwordx4 v153, s[12:15], s59 offen lds
  s_add_u32 m0, s63, 1024
  s_mov_b32 s59, 131072
  buffer_load_dwordx4 v153, s[12:15], s59 offen lds
  s_add_u32 m0, s63, 2048
  s_mov_b32 s59, 262144
  buffer_load_dwordx4 v153, s[12:15], s59 offen lds
  s_add_u32 m0, s63, 3072
  s_mov_b32 s59, 393216
  buffer_load_dwordx4 v153, s[12:15], s59 offen lds
  s_add_u32 m0, s63, 4096
  s_mov_b32 s59, 524288
  buffer_load_dwordx4 v153, s[12:15], s59 offen lds
  s_add_u32 m0, s63, 5120
  s_mov_b32 s59, 655360
  buffer_load_dwordx4 v153, s[12:15], s59 offen lds
  s_add_u32 m0, s63, 6144
  s_mov_b32 s59, 786432
  buffer_load_dwordx4 v153, s[12:15], s59 offen lds
  s_add_u32 m0, s63, 7168
  s_mov_b32 s59, 917504
  buffer_load_dwordx4 v153, s[12:15], s59 offen lds
  s_add_u32 m0, s63, 8192
  s_mov_b32 s59, 1048576
  buffer_load_dwordx4 v153, s[12:15], s59 offen lds
  s_add_u32 m0, s63, 9216
  s_mov_b32 s59, 1179648
  buffer_load_dwordx4 v153, s[12:15], s59 offen lds
  s_add_u32 m0, s63, 10240
  s_mov_b32 s59, 1310720
  buffer_load_dwordx4 v153, s[12:15], s59 offen lds
  s_add_u32 m0, s63, 11264
  s_mov_b32 s59, 1441792
  buffer_load_dwordx4 v153, s[12:15], s59 offen lds
  s_add_u32 m0, s63, 12288
  s_mov_b32 s59, 1572864
  buffer_load_dwordx4 v153, s[12:15], s59 offen lds
  s_add_u32 m0, s63, 13312
  s_mov_b32 s59, 1703936
  buffer_load_dwordx4 v153, s[12:15], s59 offen lds
  s_add_u32 m0, s63, 14336
  s_mov_b32 s59, 1835008
  buffer_load_dwordx4 v153, s[12:15], s59 offen lds
  s_add_u32 m0, s63, 15360
  s_mov_b32 s59, 1966080
  buffer_load_dwordx4 v153, s[12:15], s59 offen lds
  s_waitcnt vmcnt(16)
  ds_read_b64_tr_b16 a[64:65], v156 offset:16384
  ds_read_b64_tr_b16 a[66:67], v156 offset:16512
  ds_read_b64_tr_b16 a[68:69], v156 offset:18432
  ds_read_b64_tr_b16 a[70:71], v156 offset:18560
  ds_read_b64_tr_b16 a[72:73], v156 offset:20480
  ds_read_b64_tr_b16 a[74:75], v156 offset:20608
  ds_read_b64_tr_b16 a[76:77], v156 offset:22528
  ds_read_b64_tr_b16 a[78:79], v156 offset:22656
  ds_read_b64_tr_b16 a[80:81], v156 offset:24576
  ds_read_b64_tr_b16 a[82:83], v156 offset:24704
  ds_read_b64_tr_b16 a[84:85], v156 offset:26624
  ds_read_b64_tr_b16 a[86:87], v156 offset:26752
  ds_read_b64_tr_b16 a[88:89], v156 offset:28672
  ds_read_b64_tr_b16 a[90:91], v156 offset:28800
  ds_read_b64_tr_b16 a[92:93], v156 offset:30720
  ds_read_b64_tr_b16 a[94:95], v156 offset:30848
  ds_read_b64_tr_b16 a[96:97], v156 offset:16416
  ds_read_b64_tr_b16 a[98:99], v156 offset:16544
  ds_read_b64_tr_b16 a[100:101], v156 offset:18464
  ds_read_b64_tr_b16 a[102:103], v156 offset:18592
  ds_read_b64_tr_b16 a[104:105], v156 offset:20512
  ds_read_b64_tr_b16 a[106:107], v156 offset:20640
  ds_read_b64_tr_b16 a[108:109], v156 offset:22560
  ds_read_b64_tr_b16 a[110:111], v156 offset:22688
  ds_read_b64_tr_b16 a[112:113], v156 offset:24608
  ds_read_b64_tr_b16 a[114:115], v156 offset:24736
  ds_read_b64_tr_b16 a[116:117], v156 offset:26656
  ds_read_b64_tr_b16 a[118:119], v156 offset:26784
  ds_read_b64_tr_b16 a[120:121], v156 offset:28704
  ds_read_b64_tr_b16 a[122:123], v156 offset:28832
  ds_read_b64_tr_b16 a[124:125], v156 offset:30752
  ds_read_b64_tr_b16 a[126:127], v156 offset:30880
  s_waitcnt lgkmcnt(0)
  s_mov_b32 s16, s34
  s_mov_b32 s17, s35
  s_mov_b32 s18, 0x800000
  s_mov_b32 s19, 0x00020000
  s_add_u32 m0, s63, 16384
  s_mov_b32 s59, 0
  buffer_load_dwordx4 v154, s[16:19], s59 offen lds
  s_add_u32 m0, s63, 17408
  s_mov_b32 s59, 32768
  buffer_load_dwordx4 v154, s[16:19], s59 offen lds
  s_add_u32 m0, s63, 18432
  s_mov_b32 s59, 65536
  buffer_load_dwordx4 v154, s[16:19], s59 offen lds
  s_add_u32 m0, s63, 19456
  s_mov_b32 s59, 98304
  buffer_load_dwordx4 v154, s[16:19], s59 offen lds
  s_add_u32 m0, s63, 20480
  s_mov_b32 s59, 131072
  buffer_load_dwordx4 v154, s[16:19], s59 offen lds
  s_add_u32 m0, s63, 21504
  s_mov_b32 s59, 163840
  buffer_load_dwordx4 v154, s[16:19], s59 offen lds
  s_add_u32 m0, s63, 22528
  s_mov_b32 s59, 196608
  buffer_load_dwordx4 v154, s[16:19], s59 offen lds
  s_add_u32 m0, s63, 23552
  s_mov_b32 s59, 229376
  buffer_load_dwordx4 v154, s[16:19], s59 offen lds
  s_add_u32 m0, s63, 24576
  s_mov_b32 s59, 262144
  buffer_load_dwordx4 v154, s[16:19], s59 offen lds
  s_add_u32 m0, s63, 25600
  s_mov_b32 s59, 294912
  buffer_load_dwordx4 v154, s[16:19], s59 offen lds
  s_add_u32 m0, s63, 26624
  s_mov_b32 s59, 327680
  buffer_load_dwordx4 v154, s[16:19], s59 offen lds
  s_add_u32 m0, s63, 27648
  s_mov_b32 s59, 360448
  buffer_load_dwordx4 v154, s[16:19], s59 offen lds
  s_add_u32 m0, s63, 28672
  s_mov_b32 s59, 393216
  buffer_load_dwordx4 v154, s[16:19], s59 offen lds
  s_add_u32 m0, s63, 29696
  s_mov_b32 s59, 425984
  buffer_load_dwordx4 v154, s[16:19], s59 offen lds
  s_add_u32 m0, s63, 30720
  s_mov_b32 s59, 458752
  buffer_load_dwordx4 v154, s[16:19], s59 offen lds
  s_add_u32 m0, s63, 31744
  s_mov_b32 s59, 491520
  buffer_load_dwordx4 v154, s[16:19], s59 offen lds
  s_waitcnt vmcnt(16)
  ds_read_b64_tr_b16 a[128:129], v156 offset:0
  ds_read_b64_tr_b16 a[130:131], v156 offset:128
  ds_read_b64_tr_b16 a[132:133], v156 offset:2048
  ds_read_b64_tr_b16 a[134:135], v156 offset:2176
  ds_read_b64_tr_b16 a[136:137], v156 offset:4096
  ds_read_b64_tr_b16 a[138:139], v156 offset:4224
  ds_read_b64_tr_b16 a[140:141], v156 offset:6144
  ds_read_b64_tr_b16 a[142:143], v156 offset:6272
  ds_read_b64_tr_b16 a[144:145], v156 offset:8192
  ds_read_b64_tr_b16 a[146:147], v156 offset:8320
  ds_read_b64_tr_b16 a[148:149], v156 offset:10240
  ds_read_b64_tr_b16 a[150:151], v156 offset:10368
  ds_read_b64_tr_b16 a[152:153], v156 offset:12288
  ds_read_b64_tr_b16 a[154:155], v156 offset:12416
  ds_read_b64_tr_b16 a[156:157], v156 offset:14336
  ds_read_b64_tr_b16 a[158:159], v156 offset:14464
  ds_read_b64_tr_b16 a[160:161], v156 offset:32
  ds_read_b64_tr_b16 a[162:163], v156 offset:160
  ds_read_b64_tr_b16 a[164:165], v156 offset:2080
  ds_read_b64_tr_b16 a[166:167], v156 offset:2208
  ds_read_b64_tr_b16 a[168:169], v156 offset:4128
  ds_read_b64_tr_b16 a[170:171], v156 offset:4256
  ds_read_b64_tr_b16 a[172:173], v156 offset:6176
  ds_read_b64_tr_b16 a[174:175], v156 offset:6304
  ds_read_b64_tr_b16 a[176:177], v156 offset:8224
  ds_read_b64_tr_b16 a[178:179], v156 offset:8352
  ds_read_b64_tr_b16 a[180:181], v156 offset:10272
  ds_read_b64_tr_b16 a[182:183], v156 offset:10400
  ds_read_b64_tr_b16 a[184:185], v156 offset:12320
  ds_read_b64_tr_b16 a[186:187], v156 offset:12448
  ds_read_b64_tr_b16 a[188:189], v156 offset:14368
  ds_read_b64_tr_b16 a[190:191], v156 offset:14496
  s_waitcnt vmcnt(0)
  ds_read_b64_tr_b16 a[192:193], v157 offset:16384
  ds_read_b64_tr_b16 a[194:195], v157 offset:16512
  ds_read_b64_tr_b16 a[196:197], v157 offset:18432
  ds_read_b64_tr_b16 a[198:199], v157 offset:18560
  ds_read_b64_tr_b16 a[200:201], v157 offset:20480
  ds_read_b64_tr_b16 a[202:203], v157 offset:20608
  ds_read_b64_tr_b16 a[204:205], v157 offset:22528
  ds_read_b64_tr_b16 a[206:207], v157 offset:22656
  ds_read_b64_tr_b16 a[208:209], v157 offset:24576
  ds_read_b64_tr_b16 a[210:211], v157 offset:24704
  ds_read_b64_tr_b16 a[212:213], v157 offset:26624
  ds_read_b64_tr_b16 a[214:215], v157 offset:26752
  ds_read_b64_tr_b16 a[216:217], v157 offset:28672
  ds_read_b64_tr_b16 a[218:219], v157 offset:28800
  ds_read_b64_tr_b16 a[220:221], v157 offset:30720
  ds_read_b64_tr_b16 a[222:223], v157 offset:30848
  ds_read_b64_tr_b16 a[224:225], v157 offset:16416
  ds_read_b64_tr_b16 a[226:227], v157 offset:16544
  ds_read_b64_tr_b16 a[228:229], v157 offset:18464
  ds_read_b64_tr_b16 a[230:231], v157 offset:18592
  ds_read_b64_tr_b16 a[232:233], v157 offset:20512
  ds_read_b64_tr_b16 a[234:235], v157 offset:20640
  ds_read_b64_tr_b16 a[236:237], v157 offset:22560
  ds_read_b64_tr_b16 a[238:239], v157 offset:22688
  ds_read_b64_tr_b16 a[240:241], v157 offset:24608
  ds_read_b64_tr_b16 a[242:243], v157 offset:24736
  ds_read_b64_tr_b16 a[244:245], v157 offset:26656
  ds_read_b64_tr_b16 a[246:247], v157 offset:26784
  ds_read_b64_tr_b16 a[248:249], v157 offset:28704
  ds_read_b64_tr_b16 a[250:251], v157 offset:28832
  ds_read_b64_tr_b16 a[252:253], v157 offset:30752
  ds_read_b64_tr_b16 a[254:255], v157 offset:30880
  s_waitcnt lgkmcnt(0)
  s_branch HOOK
JOB0:
  s_and_b32 s59, s56, 3
  s_cmp_eq_u32 s59, 1
  s_cselect_b32 s88, 0, 0
  s_cmp_lt_u32 s101, 0
  s_cbranch_scc0 JOB
  s_cmp_lt_u32 s56, 16
  s_cbranch_scc1 JOB
  s_mov_b32 s87, 1
  s_mov_b32 s88, 1
  s_branch C0
NEXT:
  s_add_u32 s75, s75, 1
  s_mov_b32 s88, 1
JOB:
  s_lshr_b32 s59, s56, 3
  s_and_b32 s60, s56, 7
  s_cmp_eq_u32 s59, 3
  s_cselect_b32 s61, s75, s59
  s_cmp_eq_u32 s61, 1
  s_cselect_b32 s65, 50, 44
  s_cmp_eq_u32 s61, 2
  s_cselect_b32 s65, 64, s65
  s_mov_b32 s64, 0
  s_cmp_eq_u32 s59, 3
  s_cbranch_scc0 JNT
  s_cmp_eq_u32 s75, 2
  s_cbranch_scc1 JMISC
  s_mov_b32 s59, s75
  s_mov_b32 s64, s65
  s_mov_b32 s65, 64
  s_branch JQKV
JNT:
  s_cmp_eq_u32 s75, 0
  s_cbranch_scc1 JQKV
  s_lshl_b32 s61, s59, 2
  s_add_u32 s61, s61, s75
  s_cmp_eq_u32 s61, 64
  s_cbranch_scc0 JB
  s_mov_b32 s59, 2
  s_mov_b32 s64, 64
  s_mov_b32 s65, 64
JQKV:
  s_lshl_b32 s61, s79, 3
  s_add_u32 s60, s60, s61
  s_lshl_b32 s77, s60, 8
  s_lshl_b32 s68, s60, 13
  s_lshl_b32 s69, s60, 4
  s_lshl_b32 s61, s54, 2
  s_add_u32 s69, s69, s61
  s_lshl_b32 s61, s59, 9
  s_add_u32 s69, s69, s61
  s_add_u32 s69, s69, 2097152
  s_mov_b32 s66, 4194304
  s_mov_b32 s67, 2342912
  s_mov_b32 s81, 3
  s_mov_b32 s78, 0
  s_cmp_eq_u32 s59, 1
  s_cbranch_scc1 JV
  s_cmp_eq_u32 s59, 2
  s_cbranch_scc1 JQ
  s_add_u32 s68, s68, 16777216
  s_mov_b32 s12, s30
  s_mov_b32 s13, s31
  s_mov_b32 s14, 0x800000
  s_mov_b32 s15, 0x00020000
  s_branch WLQ
JV:
  s_add_u32 s68, s68, 33554432
  s_mov_b32 s78, 1
  s_mov_b32 s12, s32
  s_mov_b32 s13, s33
  s_mov_b32 s14, 0x800000
  s_mov_b32 s15, 0x00020000
  s_branch WLQ
JQ:
  s_add_u32 s68, s68, 167772160
  s_mov_b32 s12, s28
  s_mov_b32 s13, s29
  s_mov_b32 s14, 0x800000
  s_mov_b32 s15, 0x00020000
WLQ:
  buffer_load_dword v30, v31, s[8:11], 0 offen
  v_lshrrev_b32 v10, 2, v0
  s_mov_b32 s59, 8192
  v_mul_lo_u32 v8, v10, s59
  v_and_b32 v11, 3, v0
  v_lshl_add_u32 v8, v11, 4, v8
  s_lshl_b32 s59, s54, 6
  s_add_u32 s59, s59, s77
  v_add_u32 v8, s59, v8
  s_lshl_b32 s63, s54, 15
  v_and_b32 v10, 3, v10
  v_mov_b32 v9, 0
  v_bfe_u32 v9, v0, 4, 1
  v_lshl_add_u32 v10, v9, 7, v10
  v_lshrrev_b32 v9, 5, v0
  v_lshl_add_u32 v10, v9, 2, v10
  v_lshlrev_b32 v9, 6, v10
  v_add_u32 v9, s63, v9
  v_lshlrev_b32 v10, 3, v11
  v_and_b32 v12, 2, v11
  v_lshl_add_u32 v12, v12, 3, v10
  s_cmp_eq_u32 s78, 1
  s_cselect_b64 vcc, -1, 0
  s_cselect_b32 s59, 32, 16
  v_cndmask_b32 v10, v12, v10, vcc
  v_add_u32 v9, v9, v10
  v_add_u32 v12, s59, v9
  s_cmp_eq_u32 s88, 0
  s_cbranch_scc1 ea_24
  s_add_u32 m0, s63, 0
  s_mov_b32 s59, 0
  buffer_load_dwordx4 v8, s[12:15], s59 offen lds
  s_add_u32 m0, s63, 1024
  s_mov_b32 s59, 131072
  buffer_load_dwordx4 v8, s[12:15], s59 offen lds
  s_add_u32 m0, s63, 2048
  s_mov_b32 s59, 262144
  buffer_load_dwordx4 v8, s[12:15], s59 offen lds
  s_add_u32 m0, s63, 3072
  s_mov_b32 s59, 393216
  buffer_load_dwordx4 v8, s[12:15], s59 offen lds
  s_add_u32 m0, s63, 4096
  s_mov_b32 s59, 524288
  buffer_load_dwordx4 v8, s[12:15], s59 offen lds
  s_add_u32 m0, s63, 5120
  s_mov_b32 s59, 655360
  buffer_load_dwordx4 v8, s[12:15], s59 offen lds
  s_add_u32 m0, s63, 6144
  s_mov_b32 s59, 786432
  buffer_load_dwordx4 v8, s[12:15], s59 offen lds
  s_add_u32 m0, s63, 7168
  s_mov_b32 s59, 917504
  buffer_load_dwordx4 v8, s[12:15], s59 offen lds
  s_add_u32 m0, s63, 8192
  s_mov_b32 s59, 1048576
  buffer_load_dwordx4 v8, s[12:15], s59 offen lds
  s_add_u32 m0, s63, 9216
  s_mov_b32 s59, 1179648
  buffer_load_dwordx4 v8, s[12:15], s59 offen lds
  s_add_u32 m0, s63, 10240
  s_mov_b32 s59, 1310720
  buffer_load_dwordx4 v8, s[12:15], s59 offen lds
  s_add_u32 m0, s63, 11264
  s_mov_b32 s59, 1441792
  buffer_load_dwordx4 v8, s[12:15], s59 offen lds
  s_add_u32 m0, s63, 12288
  s_mov_b32 s59, 1572864
  buffer_load_dwordx4 v8, s[12:15], s59 offen lds
  s_add_u32 m0, s63, 13312
  s_mov_b32 s59, 1703936
  buffer_load_dwordx4 v8, s[12:15], s59 offen lds
  s_add_u32 m0, s63, 14336
  s_mov_b32 s59, 1835008
  buffer_load_dwordx4 v8, s[12:15], s59 offen lds
  s_add_u32 m0, s63, 15360
  s_mov_b32 s59, 1966080
  buffer_load_dwordx4 v8, s[12:15], s59 offen lds
  s_branch ea_25
ea_24:
  buffer_load_dword v30, v31, s[8:11], 0 offen
  buffer_load_dword v30, v31, s[8:11], 0 offen
  buffer_load_dword v30, v31, s[8:11], 0 offen
  buffer_load_dword v30, v31, s[8:11], 0 offen
  buffer_load_dword v30, v31, s[8:11], 0 offen
  buffer_load_dword v30, v31, s[8:11], 0 offen
  buffer_load_dword v30, v31, s[8:11], 0 offen
  buffer_load_dword v30, v31, s[8:11], 0 offen
  buffer_load_dword v30, v31, s[8:11], 0 offen
  buffer_load_dword v30, v31, s[8:11], 0 offen
  buffer_load_dword v30, v31, s[8:11], 0 offen
  buffer_load_dword v30, v31, s[8:11], 0 offen
  buffer_load_dword v30, v31, s[8:11], 0 offen
  buffer_load_dword v30, v31, s[8:11], 0 offen
  buffer_load_dword v30, v31, s[8:11], 0 offen
  buffer_load_dword v30, v31, s[8:11], 0 offen
ea_25:
  s_or_b32 s59, s75, s87
  s_cbranch_scc0 C1
WL1:
  s_cmp_eq_u32 s88, 0
  s_cbranch_scc0 ea_26
  s_cmp_eq_u32 s72, 0
  s_cbranch_scc0 am_29
  s_waitcnt vmcnt(0) lgkmcnt(0)
  s_barrier
  s_cmp_lg_u32 s54, 0
  s_cbranch_scc1 ar_31
  s_cmp_ge_u32 s56, 32
  s_cselect_b32 s59, 0x10001, 1
  v_mov_b32 v230, s59
  s_and_b32 s59, s2, 7
  s_lshl_b32 s59, s59, 2
  s_add_u32 s59, s59, 128
  v_mov_b32 v231, s59
  v_mov_b32 v232, 0x7ff00000
  v_cmp_eq_u32 vcc, 0, v0
  s_nop 1
  v_cndmask_b32 v231, v232, v231, vcc
  buffer_atomic_add v230, v231, s[20:23], 0 offen sc1
ar_31:
  s_branch an_30
am_29:
  s_waitcnt vmcnt(0) lgkmcnt(0)
  s_barrier
  s_cmp_lg_u32 s54, 0
  s_cbranch_scc1 ar_32
  s_cmp_ge_u32 s56, 32
  s_cselect_b32 s59, 0x10001, 1
  v_mov_b32 v230, s59
  s_and_b32 s59, s2, 7
  s_lshl_b32 s59, s59, 2
  s_add_u32 s59, s59, 160
  v_mov_b32 v231, s59
  v_mov_b32 v232, 0x7ff00000
  v_cmp_eq_u32 vcc, 0, v0
  s_nop 1
  v_cndmask_b32 v231, v232, v231, vcc
  buffer_atomic_add v230, v231, s[20:23], 0 offen sc1
ar_32:
an_30:
  s_add_u32 m0, s63, 0
  s_mov_b32 s59, 0
  buffer_load_dwordx4 v8, s[12:15], s59 offen lds
  s_add_u32 m0, s63, 1024
  s_mov_b32 s59, 131072
  buffer_load_dwordx4 v8, s[12:15], s59 offen lds
  s_add_u32 m0, s63, 2048
  s_mov_b32 s59, 262144
  buffer_load_dwordx4 v8, s[12:15], s59 offen lds
  s_add_u32 m0, s63, 3072
  s_mov_b32 s59, 393216
  buffer_load_dwordx4 v8, s[12:15], s59 offen lds
  s_add_u32 m0, s63, 4096
  s_mov_b32 s59, 524288
  buffer_load_dwordx4 v8, s[12:15], s59 offen lds
  s_add_u32 m0, s63, 5120
  s_mov_b32 s59, 655360
  buffer_load_dwordx4 v8, s[12:15], s59 offen lds
  s_add_u32 m0, s63, 6144
  s_mov_b32 s59, 786432
  buffer_load_dwordx4 v8, s[12:15], s59 offen lds
  s_add_u32 m0, s63, 7168
  s_mov_b32 s59, 917504
  buffer_load_dwordx4 v8, s[12:15], s59 offen lds
  s_add_u32 m0, s63, 8192
  s_mov_b32 s59, 1048576
  buffer_load_dwordx4 v8, s[12:15], s59 offen lds
  s_add_u32 m0, s63, 9216
  s_mov_b32 s59, 1179648
  buffer_load_dwordx4 v8, s[12:15], s59 offen lds
  s_add_u32 m0, s63, 10240
  s_mov_b32 s59, 1310720
  buffer_load_dwordx4 v8, s[12:15], s59 offen lds
  s_add_u32 m0, s63, 11264
  s_mov_b32 s59, 1441792
  buffer_load_dwordx4 v8, s[12:15], s59 offen lds
  s_add_u32 m0, s63, 12288
  s_mov_b32 s59, 1572864
  buffer_load_dwordx4 v8, s[12:15], s59 offen lds
  s_add_u32 m0, s63, 13312
  s_mov_b32 s59, 1703936
  buffer_load_dwordx4 v8, s[12:15], s59 offen lds
  s_add_u32 m0, s63, 14336
  s_mov_b32 s59, 1835008
  buffer_load_dwordx4 v8, s[12:15], s59 offen lds
  s_add_u32 m0, s63, 15360
  s_mov_b32 s59, 1966080
  buffer_load_dwordx4 v8, s[12:15], s59 offen lds
  s_add_u32 m0, s63, 16384
  s_mov_b32 s59, 2097152
  buffer_load_dwordx4 v8, s[12:15], s59 offen lds
  s_add_u32 m0, s63, 17408
  s_mov_b32 s59, 2228224
  buffer_load_dwordx4 v8, s[12:15], s59 offen lds
  s_add_u32 m0, s63, 18432
  s_mov_b32 s59, 2359296
  buffer_load_dwordx4 v8, s[12:15], s59 offen lds
  s_add_u32 m0, s63, 19456
  s_mov_b32 s59, 2490368
  buffer_load_dwordx4 v8, s[12:15], s59 offen lds
  s_add_u32 m0, s63, 20480
  s_mov_b32 s59, 2621440
  buffer_load_dwordx4 v8, s[12:15], s59 offen lds
  s_add_u32 m0, s63, 21504
  s_mov_b32 s59, 2752512
  buffer_load_dwordx4 v8, s[12:15], s59 offen lds
  s_add_u32 m0, s63, 22528
  s_mov_b32 s59, 2883584
  buffer_load_dwordx4 v8, s[12:15], s59 offen lds
  s_add_u32 m0, s63, 23552
  s_mov_b32 s59, 3014656
  buffer_load_dwordx4 v8, s[12:15], s59 offen lds
  s_add_u32 m0, s63, 24576
  s_mov_b32 s59, 3145728
  buffer_load_dwordx4 v8, s[12:15], s59 offen lds
  s_add_u32 m0, s63, 25600
  s_mov_b32 s59, 3276800
  buffer_load_dwordx4 v8, s[12:15], s59 offen lds
  s_add_u32 m0, s63, 26624
  s_mov_b32 s59, 3407872
  buffer_load_dwordx4 v8, s[12:15], s59 offen lds
  s_add_u32 m0, s63, 27648
  s_mov_b32 s59, 3538944
  buffer_load_dwordx4 v8, s[12:15], s59 offen lds
  s_add_u32 m0, s63, 28672
  s_mov_b32 s59, 3670016
  buffer_load_dwordx4 v8, s[12:15], s59 offen lds
  s_add_u32 m0, s63, 29696
  s_mov_b32 s59, 3801088
  buffer_load_dwordx4 v8, s[12:15], s59 offen lds
  s_add_u32 m0, s63, 30720
  s_mov_b32 s59, 3932160
  buffer_load_dwordx4 v8, s[12:15], s59 offen lds
  s_add_u32 m0, s63, 31744
  s_mov_b32 s59, 4063232
  buffer_load_dwordx4 v8, s[12:15], s59 offen lds
  s_branch ea_27
ea_26:
  s_add_u32 m0, s63, 16384
  s_mov_b32 s59, 2097152
  buffer_load_dwordx4 v8, s[12:15], s59 offen lds
  s_add_u32 m0, s63, 17408
  s_mov_b32 s59, 2228224
  buffer_load_dwordx4 v8, s[12:15], s59 offen lds
  s_add_u32 m0, s63, 18432
  s_mov_b32 s59, 2359296
  buffer_load_dwordx4 v8, s[12:15], s59 offen lds
  s_add_u32 m0, s63, 19456
  s_mov_b32 s59, 2490368
  buffer_load_dwordx4 v8, s[12:15], s59 offen lds
  s_add_u32 m0, s63, 20480
  s_mov_b32 s59, 2621440
  buffer_load_dwordx4 v8, s[12:15], s59 offen lds
  s_add_u32 m0, s63, 21504
  s_mov_b32 s59, 2752512
  buffer_load_dwordx4 v8, s[12:15], s59 offen lds
  s_add_u32 m0, s63, 22528
  s_mov_b32 s59, 2883584
  buffer_load_dwordx4 v8, s[12:15], s59 offen lds
  s_add_u32 m0, s63, 23552
  s_mov_b32 s59, 3014656
  buffer_load_dwordx4 v8, s[12:15], s59 offen lds
  s_add_u32 m0, s63, 24576
  s_mov_b32 s59, 3145728
  buffer_load_dwordx4 v8, s[12:15], s59 offen lds
  s_add_u32 m0, s63, 25600
  s_mov_b32 s59, 3276800
  buffer_load_dwordx4 v8, s[12:15], s59 offen lds
  s_add_u32 m0, s63, 26624
  s_mov_b32 s59, 3407872
  buffer_load_dwordx4 v8, s[12:15], s59 offen lds
  s_add_u32 m0, s63, 27648
  s_mov_b32 s59, 3538944
  buffer_load_dwordx4 v8, s[12:15], s59 offen lds
  s_add_u32 m0, s63, 28672
  s_mov_b32 s59, 3670016
  buffer_load_dwordx4 v8, s[12:15], s59 offen lds
  s_add_u32 m0, s63, 29696
  s_mov_b32 s59, 3801088
  buffer_load_dwordx4 v8, s[12:15], s59 offen lds
  s_add_u32 m0, s63, 30720
  s_mov_b32 s59, 3932160
  buffer_load_dwordx4 v8, s[12:15], s59 offen lds
  s_add_u32 m0, s63, 31744
  s_mov_b32 s59, 4063232
  buffer_load_dwordx4 v8, s[12:15], s59 offen lds
  s_or_b32 s59, s75, s87
  s_cbranch_scc1 ea_27
  s_cmp_eq_u32 s72, 0
  s_cbranch_scc0 am_33
  s_waitcnt vmcnt(16) lgkmcnt(0)
  s_barrier
  s_cmp_lg_u32 s54, 0
  s_cbranch_scc1 ar_35
  s_cmp_ge_u32 s56, 32
  s_cselect_b32 s59, 0x10001, 1
  v_mov_b32 v230, s59
  s_and_b32 s59, s2, 7
  s_lshl_b32 s59, s59, 2
  s_add_u32 s59, s59, 128
  v_mov_b32 v231, s59
  v_mov_b32 v232, 0x7ff00000
  v_cmp_eq_u32 vcc, 0, v0
  s_nop 1
  v_cndmask_b32 v231, v232, v231, vcc
  buffer_atomic_add v230, v231, s[20:23], 0 offen sc1
ar_35:
  s_branch an_34
am_33:
  s_waitcnt vmcnt(16) lgkmcnt(0)
  s_barrier
  s_cmp_lg_u32 s54, 0
  s_cbranch_scc1 ar_36
  s_cmp_ge_u32 s56, 32
  s_cselect_b32 s59, 0x10001, 1
  v_mov_b32 v230, s59
  s_and_b32 s59, s2, 7
  s_lshl_b32 s59, s59, 2
  s_add_u32 s59, s59, 160
  v_mov_b32 v231, s59
  v_mov_b32 v232, 0x7ff00000
  v_cmp_eq_u32 vcc, 0, v0
  s_nop 1
  v_cndmask_b32 v231, v232, v231, vcc
  buffer_atomic_add v230, v231, s[20:23], 0 offen sc1
ar_36:
an_34:
ea_27:
  s_waitcnt vmcnt(16)
  ds_read_b64_tr_b16 a[0:1], v9 offset:0
  ds_read_b64_tr_b16 a[2:3], v9 offset:4096
  ds_read_b64_tr_b16 a[4:5], v12 offset:0
  ds_read_b64_tr_b16 a[6:7], v12 offset:4096
  ds_read_b64_tr_b16 a[8:9], v9 offset:512
  ds_read_b64_tr_b16 a[10:11], v9 offset:4608
  ds_read_b64_tr_b16 a[12:13], v12 offset:512
  ds_read_b64_tr_b16 a[14:15], v12 offset:4608
  ds_read_b64_tr_b16 a[16:17], v9 offset:1024
  ds_read_b64_tr_b16 a[18:19], v9 offset:5120
  ds_read_b64_tr_b16 a[20:21], v12 offset:1024
  ds_read_b64_tr_b16 a[22:23], v12 offset:5120
  ds_read_b64_tr_b16 a[24:25], v9 offset:1536
  ds_read_b64_tr_b16 a[26:27], v9 offset:5632
  ds_read_b64_tr_b16 a[28:29], v12 offset:1536
  ds_read_b64_tr_b16 a[30:31], v12 offset:5632
  ds_read_b64_tr_b16 a[32:33], v9 offset:2048
  ds_read_b64_tr_b16 a[34:35], v9 offset:6144
  ds_read_b64_tr_b16 a[36:37], v12 offset:2048
  ds_read_b64_tr_b16 a[38:39], v12 offset:6144
  ds_read_b64_tr_b16 a[40:41], v9 offset:2560
  ds_read_b64_tr_b16 a[42:43], v9 offset:6656
  ds_read_b64_tr_b16 a[44:45], v12 offset:2560
  ds_read_b64_tr_b16 a[46:47], v12 offset:6656
  ds_read_b64_tr_b16 a[48:49], v9 offset:3072
  ds_read_b64_tr_b16 a[50:51], v9 offset:7168
  ds_read_b64_tr_b16 a[52:53], v12 offset:3072
  ds_read_b64_tr_b16 a[54:55], v12 offset:7168
  ds_read_b64_tr_b16 a[56:57], v9 offset:3584
  ds_read_b64_tr_b16 a[58:59], v9 offset:7680
  ds_read_b64_tr_b16 a[60:61], v12 offset:3584
  ds_read_b64_tr_b16 a[62:63], v12 offset:7680
  s_waitcnt lgkmcnt(0)
  s_add_u32 m0, s63, 0
  s_mov_b32 s59, 4194304
  buffer_load_dwordx4 v8, s[12:15], s59 offen lds
  s_add_u32 m0, s63, 1024
  s_mov_b32 s59, 4325376
  buffer_load_dwordx4 v8, s[12:15], s59 offen lds
  s_add_u32 m0, s63, 2048
  s_mov_b32 s59, 4456448
  buffer_load_dwordx4 v8, s[12:15], s59 offen lds
  s_add_u32 m0, s63, 3072
  s_mov_b32 s59, 4587520
  buffer_load_dwordx4 v8, s[12:15], s59 offen lds
  s_add_u32 m0, s63, 4096
  s_mov_b32 s59, 4718592
  buffer_load_dwordx4 v8, s[12:15], s59 offen lds
  s_add_u32 m0, s63, 5120
  s_mov_b32 s59, 4849664
  buffer_load_dwordx4 v8, s[12:15], s59 offen lds
  s_add_u32 m0, s63, 6144
  s_mov_b32 s59, 4980736
  buffer_load_dwordx4 v8, s[12:15], s59 offen lds
  s_add_u32 m0, s63, 7168
  s_mov_b32 s59, 5111808
  buffer_load_dwordx4 v8, s[12:15], s59 offen lds
  s_add_u32 m0, s63, 8192
  s_mov_b32 s59, 5242880
  buffer_load_dwordx4 v8, s[12:15], s59 offen lds
  s_add_u32 m0, s63, 9216
  s_mov_b32 s59, 5373952
  buffer_load_dwordx4 v8, s[12:15], s59 offen lds
  s_add_u32 m0, s63, 10240
  s_mov_b32 s59, 5505024
  buffer_load_dwordx4 v8, s[12:15], s59 offen lds
  s_add_u32 m0, s63, 11264
  s_mov_b32 s59, 5636096
  buffer_load_dwordx4 v8, s[12:15], s59 offen lds
  s_add_u32 m0, s63, 12288
  s_mov_b32 s59, 5767168
  buffer_load_dwordx4 v8, s[12:15], s59 offen lds
  s_add_u32 m0, s63, 13312
  s_mov_b32 s59, 5898240
  buffer_load_dwordx4 v8, s[12:15], s59 offen lds
  s_add_u32 m0, s63, 14336
  s_mov_b32 s59, 6029312
  buffer_load_dwordx4 v8, s[12:15], s59 offen lds
  s_add_u32 m0, s63, 15360
  s_mov_b32 s59, 6160384
  buffer_load_dwordx4 v8, s[12:15], s59 offen lds
  s_waitcnt vmcnt(16)
  ds_read_b64_tr_b16 a[64:65], v9 offset:16384
  ds_read_b64_tr_b16 a[66:67], v9 offset:20480
  ds_read_b64_tr_b16 a[68:69], v12 offset:16384
  ds_read_b64_tr_b16 a[70:71], v12 offset:20480
  ds_read_b64_tr_b16 a[72:73], v9 offset:16896
  ds_read_b64_tr_b16 a[74:75], v9 offset:20992
  ds_read_b64_tr_b16 a[76:77], v12 offset:16896
  ds_read_b64_tr_b16 a[78:79], v12 offset:20992
  ds_read_b64_tr_b16 a[80:81], v9 offset:17408
  ds_read_b64_tr_b16 a[82:83], v9 offset:21504
  ds_read_b64_tr_b16 a[84:85], v12 offset:17408
  ds_read_b64_tr_b16 a[86:87], v12 offset:21504
  ds_read_b64_tr_b16 a[88:89], v9 offset:17920
  ds_read_b64_tr_b16 a[90:91], v9 offset:22016
  ds_read_b64_tr_b16 a[92:93], v12 offset:17920
  ds_read_b64_tr_b16 a[94:95], v12 offset:22016
  ds_read_b64_tr_b16 a[96:97], v9 offset:18432
  ds_read_b64_tr_b16 a[98:99], v9 offset:22528
  ds_read_b64_tr_b16 a[100:101], v12 offset:18432
  ds_read_b64_tr_b16 a[102:103], v12 offset:22528
  ds_read_b64_tr_b16 a[104:105], v9 offset:18944
  ds_read_b64_tr_b16 a[106:107], v9 offset:23040
  ds_read_b64_tr_b16 a[108:109], v12 offset:18944
  ds_read_b64_tr_b16 a[110:111], v12 offset:23040
  ds_read_b64_tr_b16 a[112:113], v9 offset:19456
  ds_read_b64_tr_b16 a[114:115], v9 offset:23552
  ds_read_b64_tr_b16 a[116:117], v12 offset:19456
  ds_read_b64_tr_b16 a[118:119], v12 offset:23552
  ds_read_b64_tr_b16 a[120:121], v9 offset:19968
  ds_read_b64_tr_b16 a[122:123], v9 offset:24064
  ds_read_b64_tr_b16 a[124:125], v12 offset:19968
  ds_read_b64_tr_b16 a[126:127], v12 offset:24064
  s_waitcnt lgkmcnt(0)
  s_add_u32 m0, s63, 16384
  s_mov_b32 s59, 6291456
  buffer_load_dwordx4 v8, s[12:15], s59 offen lds
  s_add_u32 m0, s63, 17408
  s_mov_b32 s59, 6422528
  buffer_load_dwordx4 v8, s[12:15], s59 offen lds
  s_add_u32 m0, s63, 18432
  s_mov_b32 s59, 6553600
  buffer_load_dwordx4 v8, s[12:15], s59 offen lds
  s_add_u32 m0, s63, 19456
  s_mov_b32 s59, 6684672
  buffer_load_dwordx4 v8, s[12:15], s59 offen lds
  s_add_u32 m0, s63, 20480
  s_mov_b32 s59, 6815744
  buffer_load_dwordx4 v8, s[12:15], s59 offen lds
  s_add_u32 m0, s63, 21504
  s_mov_b32 s59, 6946816
  buffer_load_dwordx4 v8, s[12:15], s59 offen lds
  s_add_u32 m0, s63, 22528
  s_mov_b32 s59, 7077888
  buffer_load_dwordx4 v8, s[12:15], s59 offen lds
  s_add_u32 m0, s63, 23552
  s_mov_b32 s59, 7208960
  buffer_load_dwordx4 v8, s[12:15], s59 offen lds
  s_add_u32 m0, s63, 24576
  s_mov_b32 s59, 7340032
  buffer_load_dwordx4 v8, s[12:15], s59 offen lds
  s_add_u32 m0, s63, 25600
  s_mov_b32 s59, 7471104
  buffer_load_dwordx4 v8, s[12:15], s59 offen lds
  s_add_u32 m0, s63, 26624
  s_mov_b32 s59, 7602176
  buffer_load_dwordx4 v8, s[12:15], s59 offen lds
  s_add_u32 m0, s63, 27648
  s_mov_b32 s59, 7733248
  buffer_load_dwordx4 v8, s[12:15], s59 offen lds
  s_add_u32 m0, s63, 28672
  s_mov_b32 s59, 7864320
  buffer_load_dwordx4 v8, s[12:15], s59 offen lds
  s_add_u32 m0, s63, 29696
  s_mov_b32 s59, 7995392
  buffer_load_dwordx4 v8, s[12:15], s59 offen lds
  s_add_u32 m0, s63, 30720
  s_mov_b32 s59, 8126464
  buffer_load_dwordx4 v8, s[12:15], s59 offen lds
  s_add_u32 m0, s63, 31744
  s_mov_b32 s59, 8257536
  buffer_load_dwordx4 v8, s[12:15], s59 offen lds
  s_waitcnt vmcnt(16)
  ds_read_b64_tr_b16 a[128:129], v9 offset:0
  ds_read_b64_tr_b16 a[130:131], v9 offset:4096
  ds_read_b64_tr_b16 a[132:133], v12 offset:0
  ds_read_b64_tr_b16 a[134:135], v12 offset:4096
  ds_read_b64_tr_b16 a[136:137], v9 offset:512
  ds_read_b64_tr_b16 a[138:139], v9 offset:4608
  ds_read_b64_tr_b16 a[140:141], v12 offset:512
  ds_read_b64_tr_b16 a[142:143], v12 offset:4608
  ds_read_b64_tr_b16 a[144:145], v9 offset:1024
  ds_read_b64_tr_b16 a[146:147], v9 offset:5120
  ds_read_b64_tr_b16 a[148:149], v12 offset:1024
  ds_read_b64_tr_b16 a[150:151], v12 offset:5120
  ds_read_b64_tr_b16 a[152:153], v9 offset:1536
  ds_read_b64_tr_b16 a[154:155], v9 offset:5632
  ds_read_b64_tr_b16 a[156:157], v12 offset:1536
  ds_read_b64_tr_b16 a[158:159], v12 offset:5632
  ds_read_b64_tr_b16 a[160:161], v9 offset:2048
  ds_read_b64_tr_b16 a[162:163], v9 offset:6144
  ds_read_b64_tr_b16 a[164:165], v12 offset:2048
  ds_read_b64_tr_b16 a[166:167], v12 offset:6144
  ds_read_b64_tr_b16 a[168:169], v9 offset:2560
  ds_read_b64_tr_b16 a[170:171], v9 offset:6656
  ds_read_b64_tr_b16 a[172:173], v12 offset:2560
  ds_read_b64_tr_b16 a[174:175], v12 offset:6656
  ds_read_b64_tr_b16 a[176:177], v9 offset:3072
  ds_read_b64_tr_b16 a[178:179], v9 offset:7168
  ds_read_b64_tr_b16 a[180:181], v12 offset:3072
  ds_read_b64_tr_b16 a[182:183], v12 offset:7168
  ds_read_b64_tr_b16 a[184:185], v9 offset:3584
  ds_read_b64_tr_b16 a[186:187], v9 offset:7680
  ds_read_b64_tr_b16 a[188:189], v12 offset:3584
  ds_read_b64_tr_b16 a[190:191], v12 offset:7680
  s_waitcnt lgkmcnt(0)
  s_waitcnt vmcnt(0)
  ds_read_b64_tr_b16 a[192:193], v9 offset:16384
  ds_read_b64_tr_b16 a[194:195], v9 offset:20480
  ds_read_b64_tr_b16 a[196:197], v12 offset:16384
  ds_read_b64_tr_b16 a[198:199], v12 offset:20480
  ds_read_b64_tr_b16 a[200:201], v9 offset:16896
  ds_read_b64_tr_b16 a[202:203], v9 offset:20992
  ds_read_b64_tr_b16 a[204:205], v12 offset:16896
  ds_read_b64_tr_b16 a[206:207], v12 offset:20992
  ds_read_b64_tr_b16 a[208:209], v9 offset:17408
  ds_read_b64_tr_b16 a[210:211], v9 offset:21504
  ds_read_b64_tr_b16 a[212:213], v12 offset:17408
  ds_read_b64_tr_b16 a[214:215], v12 offset:21504
  ds_read_b64_tr_b16 a[216:217], v9 offset:17920
  ds_read_b64_tr_b16 a[218:219], v9 offset:22016
  ds_read_b64_tr_b16 a[220:221], v12 offset:17920
  ds_read_b64_tr_b16 a[222:223], v12 offset:22016
  ds_read_b64_tr_b16 a[224:225], v9 offset:18432
  ds_read_b64_tr_b16 a[226:227], v9 offset:22528
  ds_read_b64_tr_b16 a[228:229], v12 offset:18432
  ds_read_b64_tr_b16 a[230:231], v12 offset:22528
  ds_read_b64_tr_b16 a[232:233], v9 offset:18944
  ds_read_b64_tr_b16 a[234:235], v9 offset:23040
  ds_read_b64_tr_b16 a[236:237], v12 offset:18944
  ds_read_b64_tr_b16 a[238:239], v12 offset:23040
  ds_read_b64_tr_b16 a[240:241], v9 offset:19456
  ds_read_b64_tr_b16 a[242:243], v9 offset:23552
  ds_read_b64_tr_b16 a[244:245], v12 offset:19456
  ds_read_b64_tr_b16 a[246:247], v12 offset:23552
  ds_read_b64_tr_b16 a[248:249], v9 offset:19968
  ds_read_b64_tr_b16 a[250:251], v9 offset:24064
  ds_read_b64_tr_b16 a[252:253], v12 offset:19968
  ds_read_b64_tr_b16 a[254:255], v12 offset:24064
  s_waitcnt lgkmcnt(0)
  s_or_b32 s59, s75, s87
  s_cbranch_scc1 MAIN2
HOOK:
  s_cmp_eq_u32 s72, 0
  s_cbranch_scc0 HOOK2
  v_and_b32 v231, 7, v0
  v_lshlrev_b32 v231, 2, v231
wa_37:
  buffer_load_dword v230, v231, s[20:23], 0 offen offset:128 sc1
  s_waitcnt vmcnt(0)
  v_and_b32 v232, 0xffff, v230
  v_cmp_ne_u32 vcc, 32, v232
  s_cbranch_vccz waok_38
  s_sub_u32 s57, s57, 1
  s_cbranch_scc0 wa_37
  s_branch ABORT
waok_38:
  v_cmp_ne_u32 vcc, 32, v230
  s_nop 0
  s_cmp_lg_u64 vcc, 0
  s_cselect_b32 s72, 1, 0
  s_mov_b32 s59, 2363392
  buffer_load_dwordx4 v[172:175], v228, s[8:11], s59 offen offset:0 sc1
  buffer_load_dwordx4 v[176:179], v228, s[8:11], s59 offen offset:256 sc1
  buffer_load_dwordx4 v[180:183], v228, s[8:11], s59 offen offset:512 sc1
  buffer_load_dwordx4 v[184:187], v228, s[8:11], s59 offen offset:768 sc1
  s_mov_b32 s59, 2359296
  buffer_load_dwordx4 v[188:191], v228, s[8:11], s59 offen offset:0 sc1
  buffer_load_dwordx4 v[192:195], v228, s[8:11], s59 offen offset:256 sc1
  buffer_load_dwordx4 v[196:199], v228, s[8:11], s59 offen offset:512 sc1
  buffer_load_dwordx4 v[200:203], v228, s[8:11], s59 offen offset:768 sc1
  s_lshr_b32 s60, s101, 2
  s_lshl_b32 s60, s60, 16
  s_and_b32 s61, s101, 3
  s_lshl_b32 s61, s61, 7
  s_add_u32 s60, s60, s61
  s_add_u32 s60, s60, 4194304
  s_waitcnt vmcnt(4)
  v_add_f32 v172, 1.0, v172
  v_add_f32 v173, 1.0, v173
  v_add_f32 v174, 1.0, v174
  v_add_f32 v175, 1.0, v175
  v_add_f32 v176, 1.0, v176
  v_add_f32 v177, 1.0, v177
  v_add_f32 v178, 1.0, v178
  v_add_f32 v179, 1.0, v179
  v_add_f32 v180, 1.0, v180
  v_add_f32 v181, 1.0, v181
  v_add_f32 v182, 1.0, v182
  v_add_f32 v183, 1.0, v183
  v_add_f32 v184, 1.0, v184
  v_add_f32 v185, 1.0, v185
  v_add_f32 v186, 1.0, v186
  v_add_f32 v187, 1.0, v187
  v_cvt_pk_bf16_f32 v220, v172, v173
  v_lshlrev_b32 v172, 16, v220
  v_and_b32 v173, 0xffff0000, v220
  v_cvt_pk_bf16_f32 v221, v174, v175
  v_lshlrev_b32 v174, 16, v221
  v_and_b32 v175, 0xffff0000, v221
  v_cvt_pk_bf16_f32 v222, v176, v177
  v_lshlrev_b32 v176, 16, v222
  v_and_b32 v177, 0xffff0000, v222
  v_cvt_pk_bf16_f32 v223, v178, v179
  v_lshlrev_b32 v178, 16, v223
  v_and_b32 v179, 0xffff0000, v223
  v_cvt_pk_bf16_f32 v220, v180, v181
  v_lshlrev_b32 v180, 16, v220
  v_and_b32 v181, 0xffff0000, v220
  v_cvt_pk_bf16_f32 v221, v182, v183
  v_lshlrev_b32 v182, 16, v221
  v_and_b32 v183, 0xffff0000, v221
  v_cvt_pk_bf16_f32 v222, v184, v185
  v_lshlrev_b32 v184, 16, v222
  v_and_b32 v185, 0xffff0000, v222
  v_cvt_pk_bf16_f32 v223, v186, v187
  v_lshlrev_b32 v186, 16, v223
  v_and_b32 v187, 0xffff0000, v223
  s_waitcnt vmcnt(0)
  v_lshlrev_b32 v204, 16, v240
  v_and_b32 v205, 0xffff0000, v240
  v_lshlrev_b32 v206, 16, v241
  v_and_b32 v207, 0xffff0000, v241
  v_lshlrev_b32 v208, 16, v242
  v_and_b32 v209, 0xffff0000, v242
  v_lshlrev_b32 v210, 16, v243
  v_and_b32 v211, 0xffff0000, v243
  v_lshlrev_b32 v212, 16, v244
  v_and_b32 v213, 0xffff0000, v244
  v_lshlrev_b32 v214, 16, v245
  v_and_b32 v215, 0xffff0000, v245
  v_lshlrev_b32 v216, 16, v246
  v_and_b32 v217, 0xffff0000, v246
  v_lshlrev_b32 v218, 16, v247
  v_and_b32 v219, 0xffff0000, v247
  v_pk_mul_f32 v[204:205], v[204:205], v[172:173]
  v_pk_mul_f32 v[206:207], v[206:207], v[174:175]
  v_pk_mul_f32 v[208:209], v[208:209], v[176:177]
  v_pk_mul_f32 v[210:211], v[210:211], v[178:179]
  v_pk_mul_f32 v[212:213], v[212:213], v[180:181]
  v_pk_mul_f32 v[214:215], v[214:215], v[182:183]
  v_pk_mul_f32 v[216:217], v[216:217], v[184:185]
  v_pk_mul_f32 v[218:219], v[218:219], v[186:187]
  v_cvt_pk_bf16_f32 v220, v204, v205
  v_lshlrev_b32 v204, 16, v220
  v_and_b32 v205, 0xffff0000, v220
  v_cvt_pk_bf16_f32 v221, v206, v207
  v_lshlrev_b32 v206, 16, v221
  v_and_b32 v207, 0xffff0000, v221
  v_cvt_pk_bf16_f32 v222, v208, v209
  v_lshlrev_b32 v208, 16, v222
  v_and_b32 v209, 0xffff0000, v222
  v_cvt_pk_bf16_f32 v223, v210, v211
  v_lshlrev_b32 v210, 16, v223
  v_and_b32 v211, 0xffff0000, v223
  v_cvt_pk_bf16_f32 v220, v212, v213
  v_lshlrev_b32 v212, 16, v220
  v_and_b32 v213, 0xffff0000, v220
  v_cvt_pk_bf16_f32 v221, v214, v215
  v_lshlrev_b32 v214, 16, v221
  v_and_b32 v215, 0xffff0000, v221
  v_cvt_pk_bf16_f32 v222, v216, v217
  v_lshlrev_b32 v216, 16, v222
  v_and_b32 v217, 0xffff0000, v222
  v_cvt_pk_bf16_f32 v223, v218, v219
  v_lshlrev_b32 v218, 16, v223
  v_and_b32 v219, 0xffff0000, v223
  v_pk_add_f32 v[204:205], v[204:205], v[188:189]
  v_pk_add_f32 v[206:207], v[206:207], v[190:191]
  v_pk_add_f32 v[208:209], v[208:209], v[192:193]
  v_pk_add_f32 v[210:211], v[210:211], v[194:195]
  v_pk_add_f32 v[212:213], v[212:213], v[196:197]
  v_pk_add_f32 v[214:215], v[214:215], v[198:199]
  v_pk_add_f32 v[216:217], v[216:217], v[200:201]
  v_pk_add_f32 v[218:219], v[218:219], v[202:203]
  v_cvt_pk_bf16_f32 v240, v204, v205
  v_cvt_pk_bf16_f32 v241, v206, v207
  v_cvt_pk_bf16_f32 v242, v208, v209
  v_cvt_pk_bf16_f32 v243, v210, v211
  v_cvt_pk_bf16_f32 v244, v212, v213
  v_cvt_pk_bf16_f32 v245, v214, v215
  v_cvt_pk_bf16_f32 v246, v216, v217
  v_cvt_pk_bf16_f32 v247, v218, v219
  buffer_store_dwordx4 v[240:243], v229, s[8:11], s60 offen offset:0 sc1
  buffer_store_dwordx4 v[244:247], v229, s[8:11], s60 offen offset:512 sc1
  v_lshlrev_b32 v204, 16, v248
  v_and_b32 v205, 0xffff0000, v248
  v_lshlrev_b32 v206, 16, v249
  v_and_b32 v207, 0xffff0000, v249
  v_lshlrev_b32 v208, 16, v250
  v_and_b32 v209, 0xffff0000, v250
  v_lshlrev_b32 v210, 16, v251
  v_and_b32 v211, 0xffff0000, v251
  v_lshlrev_b32 v212, 16, v252
  v_and_b32 v213, 0xffff0000, v252
  v_lshlrev_b32 v214, 16, v253
  v_and_b32 v215, 0xffff0000, v253
  v_lshlrev_b32 v216, 16, v254
  v_and_b32 v217, 0xffff0000, v254
  v_lshlrev_b32 v218, 16, v255
  v_and_b32 v219, 0xffff0000, v255
  v_pk_mul_f32 v[204:205], v[204:205], v[172:173]
  v_pk_mul_f32 v[206:207], v[206:207], v[174:175]
  v_pk_mul_f32 v[208:209], v[208:209], v[176:177]
  v_pk_mul_f32 v[210:211], v[210:211], v[178:179]
  v_pk_mul_f32 v[212:213], v[212:213], v[180:181]
  v_pk_mul_f32 v[214:215], v[214:215], v[182:183]
  v_pk_mul_f32 v[216:217], v[216:217], v[184:185]
  v_pk_mul_f32 v[218:219], v[218:219], v[186:187]
  v_cvt_pk_bf16_f32 v220, v204, v205
  v_lshlrev_b32 v204, 16, v220
  v_and_b32 v205, 0xffff0000, v220
  v_cvt_pk_bf16_f32 v221, v206, v207
  v_lshlrev_b32 v206, 16, v221
  v_and_b32 v207, 0xffff0000, v221
  v_cvt_pk_bf16_f32 v222, v208, v209
  v_lshlrev_b32 v208, 16, v222
  v_and_b32 v209, 0xffff0000, v222
  v_cvt_pk_bf16_f32 v223, v210, v211
  v_lshlrev_b32 v210, 16, v223
  v_and_b32 v211, 0xffff0000, v223
  v_cvt_pk_bf16_f32 v220, v212, v213
  v_lshlrev_b32 v212, 16, v220
  v_and_b32 v213, 0xffff0000, v220
  v_cvt_pk_bf16_f32 v221, v214, v215
  v_lshlrev_b32 v214, 16, v221
  v_and_b32 v215, 0xffff0000, v221
  v_cvt_pk_bf16_f32 v222, v216, v217
  v_lshlrev_b32 v216, 16, v222
  v_and_b32 v217, 0xffff0000, v222
  v_cvt_pk_bf16_f32 v223, v218, v219
  v_lshlrev_b32 v218, 16, v223
  v_and_b32 v219, 0xffff0000, v223
  v_pk_add_f32 v[204:205], v[204:205], v[188:189]
  v_pk_add_f32 v[206:207], v[206:207], v[190:191]
  v_pk_add_f32 v[208:209], v[208:209], v[192:193]
  v_pk_add_f32 v[210:211], v[210:211], v[194:195]
  v_pk_add_f32 v[212:213], v[212:213], v[196:197]
  v_pk_add_f32 v[214:215], v[214:215], v[198:199]
  v_pk_add_f32 v[216:217], v[216:217], v[200:201]
  v_pk_add_f32 v[218:219], v[218:219], v[202:203]
  v_cvt_pk_bf16_f32 v248, v204, v205
  v_cvt_pk_bf16_f32 v249, v206, v207
  v_cvt_pk_bf16_f32 v250, v208, v209
  v_cvt_pk_bf16_f32 v251, v210, v211
  v_cvt_pk_bf16_f32 v252, v212, v213
  v_cvt_pk_bf16_f32 v253, v214, v215
  v_cvt_pk_bf16_f32 v254, v216, v217
  v_cvt_pk_bf16_f32 v255, v218, v219
  buffer_store_dwordx4 v[248:251], v229, s[8:11], s60 offen offset:64 sc1
  buffer_store_dwordx4 v[252:255], v229, s[8:11], s60 offen offset:576 sc1
  s_lshl_b32 s60, s101, 4
  s_lshl_b32 s61, s54, 2
  s_add_u32 s60, s60, s61
  s_add_u32 s60, s60, 2342912
  v_mov_b32 v221, 0
  v_mov_b32 v220, 0x7ff00000
  v_cmp_eq_u32 vcc, 0, v0
  s_nop 1
  v_cndmask_b32 v220, v220, v221, vcc
  v_mov_b32 v221, 1
  s_waitcnt vmcnt(0)
  buffer_store_dword v221, v220, s[8:11], s60 offen sc1
  s_cmp_eq_u32 s72, 0
  s_cbranch_scc1 MAIN
  s_lshr_b32 s55, s2, 5
  s_and_b32 s56, s2, 31
  s_waitcnt vmcnt(0)
  s_barrier
  s_branch ROLE0
HOOK2:
  v_and_b32 v231, 7, v0
  v_lshlrev_b32 v231, 2, v231
wa_39:
  buffer_load_dword v230, v231, s[20:23], 0 offen offset:160 sc1
  s_waitcnt vmcnt(0)
  v_and_b32 v232, 0xffff, v230
  v_cmp_ne_u32 vcc, 32, v232
  s_cbranch_vccz waok_40
  s_sub_u32 s57, s57, 1
  s_cbranch_scc0 wa_39
  s_branch ABORT
waok_40:
  v_cmp_ne_u32 vcc, 32, v230
MAIN:
  s_cmp_eq_u32 s87, 1
  s_cbranch_scc1 JOB
MAIN2:
  s_cmp_eq_u32 s78, 0
  s_cbranch_scc1 M_KQ
  s_cmp_eq_u32 s78, 1
  s_cbranch_scc1 M_V
  s_cmp_eq_u32 s78, 5
  s_cbranch_scc0 ABORT
  s_cmp_eq_u32 s72, 0
  s_cbranch_scc0 M_CS
  s_mov_b32 s58, 0
  s_and_b32 s59, s58, 3
  s_lshl_b32 s64, s59, 14
  s_add_u32 s67, s64, 262144
  s_mul_i32 s66, s59, 40960
  s_add_u32 s66, s66, 524288
  s_lshl_b32 s68, s59, 17
  s_add_u32 s68, s68, 1572864
  s_add_u32 s65, s64, 16384
  s_and_b32 s65, s65, 0xffff
  v_mov_b32 v44, 0
  v_mov_b32 v45, 0
  v_mov_b32 v46, 0
  v_mov_b32 v47, 0
  v_mov_b32 v48, 0
  v_mov_b32 v49, 0
  v_mov_b32 v50, 0
  v_mov_b32 v51, 0
  v_mov_b32 v52, 0
  v_mov_b32 v53, 0
  v_mov_b32 v54, 0
  v_mov_b32 v55, 0
  v_mov_b32 v56, 0
  v_mov_b32 v57, 0
  v_mov_b32 v58, 0
  v_mov_b32 v59, 0
  v_mov_b32 v60, 0
  v_mov_b32 v61, 0
  v_mov_b32 v62, 0
  v_mov_b32 v63, 0
  v_mov_b32 v64, 0
  v_mov_b32 v65, 0
  v_mov_b32 v66, 0
  v_mov_b32 v67, 0
  s_cmp_eq_u32 s54, 0
  s_cbranch_scc1 lead_41
  s_lshl_b32 s59, s55, 5
  s_add_u32 s59, s59, s56
  s_lshl_b32 s60, s59, 11
  v_lshl_add_u32 v162, v0, 4, s60
  s_lshl_b32 s60, s59, 2
  v_and_b32 v163, 1, v0
  v_lshl_add_u32 v163, v163, 9, s60
  s_lshl_b32 s60, s59, 9
  v_lshlrev_b32 v23, 7, v2
  v_lshl_add_u32 v23, v1, 4, v23
  v_subrev_u32 v23, 128, v23
  v_add_u32 v23, s60, v23
  v_mov_b32 v155, 0x7ff00000
  v_cmp_gt_u32 vcc, 8, v1
  s_nop 1
  v_cndmask_b32 v23, v23, v155, vcc
  v_lshl_add_u32 v165, v0, 3, s60
  v_and_b32 v9, 31, v0
  v_lshlrev_b32 v9, 5, v9
  v_lshrrev_b32 v155, 5, v0
  v_lshl_add_u32 v9, v155, 4, v9
  s_lshl_b32 s60, s59, 2
  v_mov_b32 v166, s60
  v_mov_b32 v167, 1
  v_lshlrev_b32 v159, 4, v0
  s_mov_b32 s69, 0
  s_cmp_lg_u32 s54, 2
  s_cbranch_scc1 h0_42
  s_mul_i32 s59, s69, 1536
  s_add_u32 s59, s59, 2097152
kf_43:
  buffer_load_dword v164, v163, s[8:11], s59 offen sc1
  s_waitcnt vmcnt(0)
  v_cmp_ne_u32 vcc, 1, v164
  s_cbranch_vccz kok_44
  s_sub_u32 s57, s57, 1
  s_cbranch_scc0 kf_43
  s_branch ABORT
kok_44:
  s_and_b32 s60, s69, 1
  s_lshl_b32 s60, s60, 12
  s_lshl_b32 s59, s69, 18
  s_add_u32 m0, s60, 24576
  s_add_u32 s61, s59, 16777216
  buffer_load_dwordx4 v162, s[8:11], s61 offen sc1 lds
  buffer_load_dwordx4 v162, s[8:11], s61 offen offset:1024 sc1 lds
  s_add_u32 m0, s60, 26624
  s_add_u32 s61, s59, 33554432
  buffer_load_dwordx4 v162, s[8:11], s61 offen sc1 lds
  buffer_load_dwordx4 v162, s[8:11], s61 offen offset:1024 sc1 lds
  s_mul_i32 s59, s58, 1536
  s_add_u32 s59, s59, 2098688
  buffer_load_dword v164, v163, s[8:11], s59 offen sc1
h0_42:
hl_45:
  buffer_load_dwordx4 v[28:31], v4, s[8:11], s64 offen offset:0 sc1
  buffer_load_dwordx4 v[32:35], v4, s[8:11], s64 offen offset:1024 sc1
  buffer_load_dwordx4 v[36:39], v4, s[8:11], s64 offen offset:2048 sc1
  buffer_load_dwordx4 v[40:43], v4, s[8:11], s64 offen offset:3072 sc1
gc_46:
  s_waitcnt vmcnt(3)
  v_max_u32 v152, v28, v30
  v_cmp_eq_u32 vcc, -1, v152
  s_cbranch_vccnz gr_50
  v_smfmac_f32_16x16x64_bf16 v[44:47], v[28:31], a[0:7], v5
  v_smfmac_f32_16x16x64_bf16 v[48:51], v[28:31], a[32:39], v5
  v_smfmac_f32_16x16x64_bf16 v[52:55], v[28:31], a[64:71], v5
  v_smfmac_f32_16x16x64_bf16 v[56:59], v[28:31], a[96:103], v5
gc_47:
  s_waitcnt vmcnt(2)
  v_max_u32 v152, v32, v34
  v_cmp_eq_u32 vcc, -1, v152
  s_cbranch_vccnz gr_51
  v_smfmac_f32_16x16x64_bf16 v[44:47], v[32:35], a[8:15], v5
  v_smfmac_f32_16x16x64_bf16 v[48:51], v[32:35], a[40:47], v5
  v_smfmac_f32_16x16x64_bf16 v[52:55], v[32:35], a[72:79], v5
  v_smfmac_f32_16x16x64_bf16 v[56:59], v[32:35], a[104:111], v5
gc_48:
  s_waitcnt vmcnt(1)
  v_max_u32 v152, v36, v38
  v_cmp_eq_u32 vcc, -1, v152
  s_cbranch_vccnz gr_52
  v_smfmac_f32_16x16x64_bf16 v[44:47], v[36:39], a[16:23], v5
  v_smfmac_f32_16x16x64_bf16 v[48:51], v[36:39], a[48:55], v5
  v_smfmac_f32_16x16x64_bf16 v[52:55], v[36:39], a[80:87], v5
  v_smfmac_f32_16x16x64_bf16 v[56:59], v[36:39], a[112:119], v5
gc_49:
  s_waitcnt vmcnt(0)
  v_max_u32 v152, v40, v42
  v_cmp_eq_u32 vcc, -1, v152
  s_cbranch_vccnz gr_53
  v_smfmac_f32_16x16x64_bf16 v[44:47], v[40:43], a[24:31], v5
  v_smfmac_f32_16x16x64_bf16 v[48:51], v[40:43], a[56:63], v5
  v_smfmac_f32_16x16x64_bf16 v[52:55], v[40:43], a[88:95], v5
  v_smfmac_f32_16x16x64_bf16 v[56:59], v[40:43], a[120:127], v5
  s_nop 5
  v_permlane32_swap_b32 v44, v48
  v_permlane32_swap_b32 v45, v49
  v_permlane32_swap_b32 v46, v50
  v_permlane32_swap_b32 v47, v51
  v_pk_add_f32 v[44:45], v[44:45], v[48:49]
  v_pk_add_f32 v[46:47], v[46:47], v[50:51]
  ds_write_b32 v6, v44 offset:0
  ds_write_b32 v6, v45 offset:144
  ds_write_b32 v6, v46 offset:288
  ds_write_b32 v6, v47 offset:432
  v_permlane32_swap_b32 v52, v56
  v_permlane32_swap_b32 v53, v57
  v_permlane32_swap_b32 v54, v58
  v_permlane32_swap_b32 v55, v59
  v_pk_add_f32 v[52:53], v[52:53], v[56:57]
  v_pk_add_f32 v[54:55], v[54:55], v[58:59]
  ds_write_b32 v6, v52 offset:1152
  ds_write_b32 v6, v53 offset:1296
  ds_write_b32 v6, v54 offset:1440
  ds_write_b32 v6, v55 offset:1584
  s_waitcnt lgkmcnt(0)
  s_barrier
  v_smfmac_f32_16x16x64_bf16 v[60:63], v[28:31], a[128:135], v5
  v_smfmac_f32_16x16x64_bf16 v[64:67], v[28:31], a[160:167], v5
  v_smfmac_f32_16x16x64_bf16 v[60:63], v[32:35], a[136:143], v5
  v_smfmac_f32_16x16x64_bf16 v[64:67], v[32:35], a[168:175], v5
  v_smfmac_f32_16x16x64_bf16 v[60:63], v[36:39], a[144:151], v5
  v_smfmac_f32_16x16x64_bf16 v[64:67], v[36:39], a[176:183], v5
  v_smfmac_f32_16x16x64_bf16 v[60:63], v[40:43], a[152:159], v5
  v_smfmac_f32_16x16x64_bf16 v[64:67], v[40:43], a[184:191], v5
  s_nop 7
  v_permlane32_swap_b32 v60, v64
  v_permlane32_swap_b32 v61, v65
  v_permlane32_swap_b32 v62, v66
  v_permlane32_swap_b32 v63, v67
  v_pk_add_f32 v[60:61], v[60:61], v[64:65]
  v_pk_add_f32 v[62:63], v[62:63], v[66:67]
  ds_write_b128 v7, v[60:63] offset:18432
  s_waitcnt lgkmcnt(0)
  s_barrier
  s_cmp_lg_u32 s54, 1
  s_cbranch_scc1 b_54
  ds_read_b128 v[172:175], v8 offset:0
  ds_read_b128 v[176:179], v8 offset:32
  ds_read_b128 v[180:183], v8 offset:2304
  ds_read_b128 v[184:187], v8 offset:2336
  ds_read_b128 v[188:191], v8 offset:4608
  ds_read_b128 v[192:195], v8 offset:4640
  ds_read_b128 v[196:199], v8 offset:6912
  ds_read_b128 v[200:203], v8 offset:6944
  ds_read_b128 v[204:207], v9 offset:18432
  ds_read_b128 v[208:211], v9 offset:19456
  ds_read_b128 v[212:215], v9 offset:20480
  ds_read_b128 v[216:219], v9 offset:21504
  s_waitcnt lgkmcnt(0)
  v_pk_add_f32 v[172:173], v[172:173], v[180:181]
  v_pk_add_f32 v[174:175], v[174:175], v[182:183]
  v_pk_add_f32 v[176:177], v[176:177], v[184:185]
  v_pk_add_f32 v[178:179], v[178:179], v[186:187]
  v_pk_add_f32 v[188:189], v[188:189], v[196:197]
  v_pk_add_f32 v[190:191], v[190:191], v[198:199]
  v_pk_add_f32 v[192:193], v[192:193], v[200:201]
  v_pk_add_f32 v[194:195], v[194:195], v[202:203]
  v_pk_add_f32 v[172:173], v[172:173], v[188:189]
  v_pk_add_f32 v[174:175], v[174:175], v[190:191]
  v_pk_add_f32 v[176:177], v[176:177], v[192:193]
  v_pk_add_f32 v[178:179], v[178:179], v[194:195]
  v_pk_add_f32 v[204:205], v[204:205], v[208:209]
  v_pk_add_f32 v[206:207], v[206:207], v[210:211]
  v_pk_add_f32 v[212:213], v[212:213], v[216:217]
  v_pk_add_f32 v[214:215], v[214:215], v[218:219]
  v_pk_add_f32 v[204:205], v[204:205], v[212:213]
  v_pk_add_f32 v[206:207], v[206:207], v[214:215]
  v_cvt_pk_bf16_f32 v76, v172, v173
  v_cvt_pk_bf16_f32 v77, v174, v175
  v_cvt_pk_bf16_f32 v78, v176, v177
  v_cvt_pk_bf16_f32 v79, v178, v179
  v_cvt_pk_bf16_f32 v132, v204, v205
  v_cvt_pk_bf16_f32 v133, v206, v207
  s_cmp_lt_u32 s58, 63
  s_cbranch_scc1 c_55
  s_lshl_b32 s59, s58, 16
  s_add_u32 s60, s59, 54525952
  s_add_u32 s59, s59, 50331648
  buffer_store_dwordx4 v[76:79], v23, s[8:11], s59 offen sc1
  buffer_store_dwordx2 v[132:133], v165, s[8:11], s60 offen sc1
  s_waitcnt vmcnt(0)
  s_lshl_b32 s59, s58, 9
  s_add_u32 s59, s59, 2195456
  buffer_store_dword v167, v166, s[8:11], s59 offen sc1
  s_branch JR2
b_54:
  s_cmp_lt_u32 s58, 63
  s_cbranch_scc0 JR2
c_55:
  v_mov_b32 v44, 0
  v_mov_b32 v45, 0
  v_mov_b32 v46, 0
  v_mov_b32 v47, 0
  v_mov_b32 v48, 0
  v_mov_b32 v49, 0
  v_mov_b32 v50, 0
  v_mov_b32 v51, 0
  s_barrier
  buffer_load_dwordx4 v[28:31], v4, s[8:11], s67 offen offset:0 sc1
  buffer_load_dwordx4 v[32:35], v4, s[8:11], s67 offen offset:1024 sc1
  buffer_load_dwordx4 v[36:39], v4, s[8:11], s67 offen offset:2048 sc1
  buffer_load_dwordx4 v[40:43], v4, s[8:11], s67 offen offset:3072 sc1
gc_57:
  s_waitcnt vmcnt(3)
  v_max_u32 v152, v28, v30
  v_cmp_eq_u32 vcc, -1, v152
  s_cbranch_vccnz gr_61
  v_smfmac_f32_16x16x64_bf16 v[44:47], v[28:31], a[192:199], v5
  v_smfmac_f32_16x16x64_bf16 v[48:51], v[28:31], a[224:231], v5
gc_58:
  s_waitcnt vmcnt(2)
  v_max_u32 v152, v32, v34
  v_cmp_eq_u32 vcc, -1, v152
  s_cbranch_vccnz gr_62
  v_smfmac_f32_16x16x64_bf16 v[44:47], v[32:35], a[200:207], v5
  v_smfmac_f32_16x16x64_bf16 v[48:51], v[32:35], a[232:239], v5
gc_59:
  s_waitcnt vmcnt(1)
  v_max_u32 v152, v36, v38
  v_cmp_eq_u32 vcc, -1, v152
  s_cbranch_vccnz gr_63
  v_smfmac_f32_16x16x64_bf16 v[44:47], v[36:39], a[208:215], v5
  v_smfmac_f32_16x16x64_bf16 v[48:51], v[36:39], a[240:247], v5
gc_60:
  s_waitcnt vmcnt(0)
  v_max_u32 v152, v40, v42
  v_cmp_eq_u32 vcc, -1, v152
  s_cbranch_vccnz gr_64
  v_smfmac_f32_16x16x64_bf16 v[44:47], v[40:43], a[216:223], v5
  v_smfmac_f32_16x16x64_bf16 v[48:51], v[40:43], a[248:255], v5
  s_nop 7
  v_permlane32_swap_b32 v44, v48
  v_permlane32_swap_b32 v45, v49
  v_permlane32_swap_b32 v46, v50
  v_permlane32_swap_b32 v47, v51
  v_pk_add_f32 v[44:45], v[44:45], v[48:49]
  v_pk_add_f32 v[46:47], v[46:47], v[50:51]
  ds_write_b32 v6, v44 offset:9216
  ds_write_b32 v6, v45 offset:9360
  ds_write_b32 v6, v46 offset:9504
  ds_write_b32 v6, v47 offset:9648
  s_waitcnt lgkmcnt(0)
  s_barrier
  s_cmp_lg_u32 s54, 1
  s_cbranch_scc1 f_65
  s_lshl_b32 s59, s58, 16
  s_add_u32 s60, s59, 54525952
  s_add_u32 s59, s59, 50331648
  buffer_store_dwordx4 v[76:79], v23, s[8:11], s59 offen sc1
  buffer_store_dwordx2 v[132:133], v165, s[8:11], s60 offen sc1
  s_add_u32 s63, s58, 2
  s_and_b32 s63, s63, 3
  s_lshl_b32 s59, s63, 14
  s_add_u32 s60, s59, 262144
  buffer_store_dwordx2 v[24:25], v20, s[8:11], s59 offen
  buffer_store_dwordx2 v[24:25], v20, s[8:11], s60 offen
  s_mul_i32 s59, s63, 40960
  s_add_u32 s59, s59, 524288
  s_lshl_b32 s60, s63, 17
  s_add_u32 s60, s60, 1572864
  buffer_store_dwordx4 v[24:27], v160, s[8:11], s59 offen
  buffer_store_dword v24, v161, s[8:11], s59 offen
  buffer_store_dwordx4 v[24:27], v18, s[8:11], s60 offen sc1
  s_barrier
  s_waitcnt vmcnt(5)
  s_lshl_b32 s59, s58, 9
  s_add_u32 s59, s59, 2195456
  buffer_store_dword v167, v166, s[8:11], s59 offen sc1
  s_branch g_66
f_65:
  s_cmp_lg_u32 s54, 2
  s_cbranch_scc1 f3_67
  s_add_u32 s69, s58, 1
  v_cmp_ne_u32 vcc, 1, v164
  s_cbranch_vccz kok_72
  s_mul_i32 s59, s69, 1536
  s_add_u32 s59, s59, 2097152
kf_71:
  buffer_load_dword v164, v163, s[8:11], s59 offen sc1
  s_waitcnt vmcnt(0)
  v_cmp_ne_u32 vcc, 1, v164
  s_cbranch_vccz kok_72
  s_sub_u32 s57, s57, 1
  s_cbranch_scc0 kf_71
  s_branch ABORT
kok_72:
  s_and_b32 s60, s69, 1
  s_lshl_b32 s60, s60, 12
  s_lshl_b32 s59, s69, 18
  s_add_u32 m0, s60, 24576
  s_add_u32 s61, s59, 16777216
  buffer_load_dwordx4 v162, s[8:11], s61 offen sc1 lds
  buffer_load_dwordx4 v162, s[8:11], s61 offen offset:1024 sc1 lds
  s_add_u32 m0, s60, 26624
  s_add_u32 s61, s59, 33554432
  buffer_load_dwordx4 v162, s[8:11], s61 offen sc1 lds
  buffer_load_dwordx4 v162, s[8:11], s61 offen offset:1024 sc1 lds
  s_mul_i32 s59, s58, 1536
  s_add_u32 s59, s59, 2100224
  buffer_load_dword v164, v163, s[8:11], s59 offen sc1
  s_barrier
  s_branch g_66
f3_67:
  s_barrier
  v_mov_b32 v44, 0
  v_mov_b32 v45, 0
  v_mov_b32 v46, 0
  v_mov_b32 v47, 0
  v_mov_b32 v48, 0
  v_mov_b32 v49, 0
  v_mov_b32 v50, 0
  v_mov_b32 v51, 0
  v_mov_b32 v52, 0
  v_mov_b32 v53, 0
  v_mov_b32 v54, 0
  v_mov_b32 v55, 0
  v_mov_b32 v56, 0
  v_mov_b32 v57, 0
  v_mov_b32 v58, 0
  v_mov_b32 v59, 0
  v_mov_b32 v60, 0
  v_mov_b32 v61, 0
  v_mov_b32 v62, 0
  v_mov_b32 v63, 0
  v_mov_b32 v64, 0
  v_mov_b32 v65, 0
  v_mov_b32 v66, 0
  v_mov_b32 v67, 0
  s_mov_b32 s69, s68
  s_mov_b32 s70, s65
  s_add_u32 s58, s58, 1
  s_and_b32 s59, s58, 3
  s_lshl_b32 s64, s59, 14
  s_add_u32 s67, s64, 262144
  s_mul_i32 s66, s59, 40960
  s_add_u32 s66, s66, 524288
  s_lshl_b32 s68, s59, 17
  s_add_u32 s68, s68, 1572864
  s_add_u32 s65, s64, 16384
  s_and_b32 s65, s65, 0xffff
pp_69:
  buffer_load_dwordx4 v[108:111], v19, s[8:11], s69 offen offset:0 sc1
  buffer_load_dwordx4 v[112:115], v19, s[8:11], s69 offen offset:1024 sc1
  buffer_load_dwordx4 v[116:119], v19, s[8:11], s69 offen offset:2048 sc1
  buffer_load_dwordx4 v[120:123], v19, s[8:11], s69 offen offset:3072 sc1
pp_69_c:
  s_waitcnt vmcnt(2)
  v_pk_add_f32 v[108:109], v[108:109], v[112:113]
  v_pk_add_f32 v[110:111], v[110:111], v[114:115]
  s_waitcnt vmcnt(0)
  v_pk_add_f32 v[116:117], v[116:117], v[120:121]
  v_pk_add_f32 v[118:119], v[118:119], v[122:123]
  v_pk_add_f32 v[108:109], v[108:109], v[116:117]
  v_pk_add_f32 v[110:111], v[110:111], v[118:119]
  v_cmp_u_f32 vcc, v108, v108
  v_cvt_pk_bf16_f32 v112, v108, v109
  v_cvt_pk_bf16_f32 v113, v110, v111
  s_cbranch_vccz ppok_70
  s_sub_u32 s57, s57, 1
  s_cbranch_scc0 pp_69
  s_branch ABORT
ppok_70:
  buffer_store_dwordx2 v[112:113], v20, s[8:11], s70 offen
  s_barrier
  s_branch hl_45
g_66:
  s_add_u32 s58, s58, 1
  s_and_b32 s59, s58, 3
  s_lshl_b32 s64, s59, 14
  s_add_u32 s67, s64, 262144
  s_mul_i32 s66, s59, 40960
  s_add_u32 s66, s66, 524288
  s_lshl_b32 s68, s59, 17
  s_add_u32 s68, s68, 1572864
  s_add_u32 s65, s64, 16384
  s_and_b32 s65, s65, 0xffff
  v_mov_b32 v44, 0
  v_mov_b32 v45, 0
  v_mov_b32 v46, 0
  v_mov_b32 v47, 0
  v_mov_b32 v48, 0
  v_mov_b32 v49, 0
  v_mov_b32 v50, 0
  v_mov_b32 v51, 0
  v_mov_b32 v52, 0
  v_mov_b32 v53, 0
  v_mov_b32 v54, 0
  v_mov_b32 v55, 0
  v_mov_b32 v56, 0
  v_mov_b32 v57, 0
  v_mov_b32 v58, 0
  v_mov_b32 v59, 0
  v_mov_b32 v60, 0
  v_mov_b32 v61, 0
  v_mov_b32 v62, 0
  v_mov_b32 v63, 0
  v_mov_b32 v64, 0
  v_mov_b32 v65, 0
  v_mov_b32 v66, 0
  v_mov_b32 v67, 0
  s_barrier
  s_branch hl_45
gr_50:
  buffer_load_dwordx4 v[28:31], v4, s[8:11], s64 offen offset:0 sc1
  buffer_load_dwordx4 v[32:35], v4, s[8:11], s64 offen offset:1024 sc1
  buffer_load_dwordx4 v[36:39], v4, s[8:11], s64 offen offset:2048 sc1
  buffer_load_dwordx4 v[40:43], v4, s[8:11], s64 offen offset:3072 sc1
  s_sub_u32 s57, s57, 1
  s_cbranch_scc0 gc_46
  s_branch ABORT
gr_51:
  buffer_load_dwordx4 v[32:35], v4, s[8:11], s64 offen offset:1024 sc1
  buffer_load_dwordx4 v[36:39], v4, s[8:11], s64 offen offset:2048 sc1
  buffer_load_dwordx4 v[40:43], v4, s[8:11], s64 offen offset:3072 sc1
  s_sub_u32 s57, s57, 1
  s_cbranch_scc0 gc_47
  s_branch ABORT
gr_52:
  buffer_load_dwordx4 v[36:39], v4, s[8:11], s64 offen offset:2048 sc1
  buffer_load_dwordx4 v[40:43], v4, s[8:11], s64 offen offset:3072 sc1
  s_sub_u32 s57, s57, 1
  s_cbranch_scc0 gc_48
  s_branch ABORT
gr_53:
  buffer_load_dwordx4 v[40:43], v4, s[8:11], s64 offen offset:3072 sc1
  s_sub_u32 s57, s57, 1
  s_cbranch_scc0 gc_49
  s_branch ABORT
gr_61:
  buffer_load_dwordx4 v[28:31], v4, s[8:11], s67 offen offset:0 sc1
  buffer_load_dwordx4 v[32:35], v4, s[8:11], s67 offen offset:1024 sc1
  buffer_load_dwordx4 v[36:39], v4, s[8:11], s67 offen offset:2048 sc1
  buffer_load_dwordx4 v[40:43], v4, s[8:11], s67 offen offset:3072 sc1
  s_sub_u32 s57, s57, 1
  s_cbranch_scc0 gc_57
  s_branch ABORT
gr_62:
  buffer_load_dwordx4 v[32:35], v4, s[8:11], s67 offen offset:1024 sc1
  buffer_load_dwordx4 v[36:39], v4, s[8:11], s67 offen offset:2048 sc1
  buffer_load_dwordx4 v[40:43], v4, s[8:11], s67 offen offset:3072 sc1
  s_sub_u32 s57, s57, 1
  s_cbranch_scc0 gc_58
  s_branch ABORT
gr_63:
  buffer_load_dwordx4 v[36:39], v4, s[8:11], s67 offen offset:2048 sc1
  buffer_load_dwordx4 v[40:43], v4, s[8:11], s67 offen offset:3072 sc1
  s_sub_u32 s57, s57, 1
  s_cbranch_scc0 gc_59
  s_branch ABORT
gr_64:
  buffer_load_dwordx4 v[40:43], v4, s[8:11], s67 offen offset:3072 sc1
  s_sub_u32 s57, s57, 1
  s_cbranch_scc0 gc_60
  s_branch ABORT
lead_41:
ll_73:
  buffer_load_dwordx4 v[28:31], v4, s[8:11], s64 offen offset:0 sc1
  buffer_load_dwordx4 v[32:35], v4, s[8:11], s64 offen offset:1024 sc1
  buffer_load_dwordx4 v[36:39], v4, s[8:11], s64 offen offset:2048 sc1
  buffer_load_dwordx4 v[40:43], v4, s[8:11], s64 offen offset:3072 sc1
gc_74:
  s_waitcnt vmcnt(3)
  v_max_u32 v152, v28, v30
  v_cmp_eq_u32 vcc, -1, v152
  s_cbranch_vccnz gr_78
  v_smfmac_f32_16x16x64_bf16 v[44:47], v[28:31], a[0:7], v5
  v_smfmac_f32_16x16x64_bf16 v[48:51], v[28:31], a[32:39], v5
  v_smfmac_f32_16x16x64_bf16 v[52:55], v[28:31], a[64:71], v5
  v_smfmac_f32_16x16x64_bf16 v[56:59], v[28:31], a[96:103], v5
gc_75:
  s_waitcnt vmcnt(2)
  v_max_u32 v152, v32, v34
  v_cmp_eq_u32 vcc, -1, v152
  s_cbranch_vccnz gr_79
  v_smfmac_f32_16x16x64_bf16 v[44:47], v[32:35], a[8:15], v5
  v_smfmac_f32_16x16x64_bf16 v[48:51], v[32:35], a[40:47], v5
  v_smfmac_f32_16x16x64_bf16 v[52:55], v[32:35], a[72:79], v5
  v_smfmac_f32_16x16x64_bf16 v[56:59], v[32:35], a[104:111], v5
gc_76:
  s_waitcnt vmcnt(1)
  v_max_u32 v152, v36, v38
  v_cmp_eq_u32 vcc, -1, v152
  s_cbranch_vccnz gr_80
  v_smfmac_f32_16x16x64_bf16 v[44:47], v[36:39], a[16:23], v5
  v_smfmac_f32_16x16x64_bf16 v[48:51], v[36:39], a[48:55], v5
  v_smfmac_f32_16x16x64_bf16 v[52:55], v[36:39], a[80:87], v5
  v_smfmac_f32_16x16x64_bf16 v[56:59], v[36:39], a[112:119], v5
gc_77:
  s_waitcnt vmcnt(0)
  v_max_u32 v152, v40, v42
  v_cmp_eq_u32 vcc, -1, v152
  s_cbranch_vccnz gr_81
  v_smfmac_f32_16x16x64_bf16 v[44:47], v[40:43], a[24:31], v5
  v_smfmac_f32_16x16x64_bf16 v[48:51], v[40:43], a[56:63], v5
  v_smfmac_f32_16x16x64_bf16 v[52:55], v[40:43], a[88:95], v5
  v_smfmac_f32_16x16x64_bf16 v[56:59], v[40:43], a[120:127], v5
  s_nop 5
  v_permlane32_swap_b32 v44, v48
  v_permlane32_swap_b32 v45, v49
  v_permlane32_swap_b32 v46, v50
  v_permlane32_swap_b32 v47, v51
  v_pk_add_f32 v[44:45], v[44:45], v[48:49]
  v_pk_add_f32 v[46:47], v[46:47], v[50:51]
  ds_write_b32 v6, v44 offset:0
  ds_write_b32 v6, v45 offset:144
  ds_write_b32 v6, v46 offset:288
  ds_write_b32 v6, v47 offset:432
  v_permlane32_swap_b32 v52, v56
  v_permlane32_swap_b32 v53, v57
  v_permlane32_swap_b32 v54, v58
  v_permlane32_swap_b32 v55, v59
  v_pk_add_f32 v[52:53], v[52:53], v[56:57]
  v_pk_add_f32 v[54:55], v[54:55], v[58:59]
  ds_write_b32 v6, v52 offset:1152
  ds_write_b32 v6, v53 offset:1296
  ds_write_b32 v6, v54 offset:1440
  ds_write_b32 v6, v55 offset:1584
  s_waitcnt lgkmcnt(0)
  s_barrier
  ds_read_b128 v[172:175], v8 offset:0
  ds_read_b128 v[176:179], v8 offset:32
  ds_read_b128 v[180:183], v8 offset:2304
  ds_read_b128 v[184:187], v8 offset:2336
  ds_read_b128 v[188:191], v8 offset:4608
  ds_read_b128 v[192:195], v8 offset:4640
  ds_read_b128 v[196:199], v8 offset:6912
  ds_read_b128 v[200:203], v8 offset:6944
  ds_read_b128 v[80:83], v11
  ds_read_b128 v[84:87], v11 offset:128
  s_waitcnt lgkmcnt(6)
  v_pk_add_f32 v[172:173], v[172:173], v[180:181]
  v_pk_add_f32 v[174:175], v[174:175], v[182:183]
  v_pk_add_f32 v[176:177], v[176:177], v[184:185]
  v_pk_add_f32 v[178:179], v[178:179], v[186:187]
  s_waitcnt lgkmcnt(2)
  v_pk_add_f32 v[188:189], v[188:189], v[196:197]
  v_pk_add_f32 v[190:191], v[190:191], v[198:199]
  v_pk_add_f32 v[192:193], v[192:193], v[200:201]
  v_pk_add_f32 v[194:195], v[194:195], v[202:203]
  v_pk_add_f32 v[172:173], v[172:173], v[188:189]
  v_pk_add_f32 v[174:175], v[174:175], v[190:191]
  v_pk_add_f32 v[176:177], v[176:177], v[192:193]
  v_pk_add_f32 v[178:179], v[178:179], v[194:195]
  v_cvt_pk_bf16_f32 v76, v172, v173
  v_cvt_pk_bf16_f32 v77, v174, v175
  v_cvt_pk_bf16_f32 v78, v176, v177
  v_cvt_pk_bf16_f32 v79, v178, v179
  s_nop 1
  v_mfma_f32_16x16x32_bf16 v[96:99], v[76:79], v[76:79], 0
  s_waitcnt lgkmcnt(0)
  v_mfma_f32_16x16x32_bf16 v[100:103], v[80:83], v[76:79], 0
  v_mfma_f32_16x16x32_bf16 v[104:107], v[84:87], v[76:79], 0
  ds_read_b128 v[88:91], v12 offset:2048
  ds_read_b128 v[92:95], v12 offset:2304
  v_xor_b32 v11, 4096, v11
  v_xor_b32 v12, 4096, v12
  s_nop 0
  buffer_store_dwordx4 v[96:99], v14, s[8:11], s66 offen
  s_nop 0
  buffer_store_dwordx4 v[100:103], v13, s[8:11], s66 offen
  buffer_store_dwordx4 v[104:107], v13, s[8:11], s66 offen offset:512
  v_smfmac_f32_16x16x64_bf16 v[60:63], v[28:31], a[128:135], v5
  v_smfmac_f32_16x16x64_bf16 v[64:67], v[28:31], a[160:167], v5
  v_smfmac_f32_16x16x64_bf16 v[60:63], v[32:35], a[136:143], v5
  v_smfmac_f32_16x16x64_bf16 v[64:67], v[32:35], a[168:175], v5
  v_smfmac_f32_16x16x64_bf16 v[60:63], v[36:39], a[144:151], v5
  v_smfmac_f32_16x16x64_bf16 v[64:67], v[36:39], a[176:183], v5
  v_smfmac_f32_16x16x64_bf16 v[60:63], v[40:43], a[152:159], v5
  v_smfmac_f32_16x16x64_bf16 v[64:67], v[40:43], a[184:191], v5
  s_nop 7
  v_permlane32_swap_b32 v60, v64
  v_permlane32_swap_b32 v61, v65
  v_permlane32_swap_b32 v62, v66
  v_permlane32_swap_b32 v63, v67
  v_pk_add_f32 v[60:61], v[60:61], v[64:65]
  v_pk_add_f32 v[62:63], v[62:63], v[66:67]
  ds_write_b128 v7, v[60:63] offset:18432
  buffer_load_dwordx4 v[108:111], v15, s[8:11], s66 offen offset:0 sc1
  buffer_load_dword v124, v16, s[8:11], s66 offen offset:0 sc1
  buffer_load_dwordx4 v[112:115], v15, s[8:11], s66 offen offset:1280 sc1
  buffer_load_dword v125, v16, s[8:11], s66 offen offset:1280 sc1
  buffer_load_dwordx4 v[116:119], v15, s[8:11], s66 offen offset:2560 sc1
  buffer_load_dword v126, v16, s[8:11], s66 offen offset:2560 sc1
  buffer_load_dwordx4 v[120:123], v15, s[8:11], s66 offen offset:3840 sc1
  buffer_load_dword v127, v16, s[8:11], s66 offen offset:3840 sc1
  s_waitcnt lgkmcnt(0)
  s_barrier
  s_cmp_lt_u32 s58, 63
  s_cbranch_scc0 LEADEND_ll_73
  ds_read_b64 v[204:205], v9 offset:18432
  ds_read_b64 v[206:207], v9 offset:18944
  ds_read_b64 v[208:209], v9 offset:19456
  ds_read_b64 v[210:211], v9 offset:19968
  ds_read_b64 v[212:213], v9 offset:20480
  ds_read_b64 v[214:215], v9 offset:20992
  ds_read_b64 v[216:217], v9 offset:21504
  ds_read_b64 v[218:219], v9 offset:22016
  v_mov_b32 v52, 0
  v_mov_b32 v53, 0
  v_mov_b32 v54, 0
  v_mov_b32 v55, 0
  v_mov_b32 v56, 0
  v_mov_b32 v57, 0
  v_mov_b32 v58, 0
  v_mov_b32 v59, 0
  v_mov_b32 v60, 0
  v_mov_b32 v61, 0
  v_mov_b32 v62, 0
  v_mov_b32 v63, 0
  v_mov_b32 v64, 0
  v_mov_b32 v65, 0
  v_mov_b32 v66, 0
  v_mov_b32 v67, 0
  s_waitcnt lgkmcnt(0)
  v_pk_add_f32 v[204:205], v[204:205], v[208:209]
  v_pk_add_f32 v[206:207], v[206:207], v[210:211]
  v_pk_add_f32 v[212:213], v[212:213], v[216:217]
  v_pk_add_f32 v[214:215], v[214:215], v[218:219]
  v_pk_add_f32 v[204:205], v[204:205], v[212:213]
  v_pk_add_f32 v[206:207], v[206:207], v[214:215]
  v_cvt_pk_bf16_f32 v132, v204, v205
  v_cvt_pk_bf16_f32 v134, v206, v207
  s_branch sk_84
sc_82:
  buffer_load_dwordx4 v[108:111], v15, s[8:11], s66 offen offset:0 sc1
  buffer_load_dword v124, v16, s[8:11], s66 offen offset:0 sc1
  buffer_load_dwordx4 v[112:115], v15, s[8:11], s66 offen offset:1280 sc1
  buffer_load_dword v125, v16, s[8:11], s66 offen offset:1280 sc1
  buffer_load_dwordx4 v[116:119], v15, s[8:11], s66 offen offset:2560 sc1
  buffer_load_dword v126, v16, s[8:11], s66 offen offset:2560 sc1
  buffer_load_dwordx4 v[120:123], v15, s[8:11], s66 offen offset:3840 sc1
  buffer_load_dword v127, v16, s[8:11], s66 offen offset:3840 sc1
sk_84:
  s_waitcnt vmcnt(0)
  v_pk_add_f32 v[108:109], v[108:109], v[112:113]
  v_pk_add_f32 v[116:117], v[116:117], v[120:121]
  v_pk_add_f32 v[124:125], v[124:125], v[126:127]
  v_pk_add_f32 v[110:111], v[110:111], v[114:115]
  v_pk_add_f32 v[118:119], v[118:119], v[122:123]
  v_pk_add_f32 v[108:109], v[108:109], v[116:117]
  v_add_f32 v112, v124, v125
  v_pk_add_f32 v[110:111], v[110:111], v[118:119]
  v_cmp_u_f32 vcc, v108, v112
  v_max3_f32 v152, v108, v109, v112
  s_cbranch_vccz scok_83
  s_sub_u32 s57, s57, 1
  s_cbranch_scc0 sc_82
  s_branch ABORT
scok_83:
  v_max3_f32 v152, v152, v110, v111
  s_nop 1
  v_max_f32_dpp v152, v152, v152 row_ror:8 row_mask:0xf bank_mask:0xf
  v_mov_b32 v153, v152
  s_nop 1
  v_permlane16_swap_b32 v153, v152
  v_max_f32 v152, v152, v153
  v_mov_b32 v153, v152
  s_nop 1
  v_permlane32_swap_b32 v153, v152
  v_max_f32 v152, v152, v153
  v_mul_f32 v152, s71, v152
  v_fma_f32 v112, v112, s71, -v152
  v_fma_f32 v108, v108, s71, -v152
  v_fma_f32 v109, v109, s71, -v152
  v_fma_f32 v110, v110, s71, -v152
  v_fma_f32 v111, v111, s71, -v152
  v_exp_f32 v112, v112
  v_exp_f32 v108, v108
  v_exp_f32 v109, v109
  v_exp_f32 v110, v110
  v_exp_f32 v111, v111
  v_mov_b32_dpp v153, v112 row_ror:8 row_mask:0xf bank_mask:0xf
  v_cvt_pk_bf16_f32 v136, v108, v109
  v_cvt_pk_bf16_f32 v137, v110, v111
  v_cvt_pk_bf16_f32 v140, v112, v153
  v_mov_b32_dpp v138, v136 row_ror:8 row_mask:0xf bank_mask:0xf
  v_mov_b32_dpp v139, v137 row_ror:8 row_mask:0xf bank_mask:0xf
  v_mfma_f32_16x16x16_bf16 v[144:147], v[132:133], v[140:141], 0
  v_pk_add_f32 v[108:109], v[108:109], v[110:111]
  v_add_f32 v152, v108, v112
  v_mfma_f32_16x16x16_bf16 v[148:151], v[134:135], v[140:141], 0
  v_add_f32 v152, v152, v109
  s_nop 1
  v_mfma_f32_16x16x32_bf16 v[144:147], v[88:91], v[136:139], v[144:147]
  v_add_f32_dpp v152, v152, v152 row_ror:8 row_mask:0xf bank_mask:0xf
  v_mov_b32 v153, v152
  v_mfma_f32_16x16x32_bf16 v[148:151], v[92:95], v[136:139], v[148:151]
  s_nop 0
  v_permlane16_swap_b32 v153, v152
  v_add_f32 v152, v152, v153
  v_mov_b32 v153, v152
  s_nop 1
  v_permlane32_swap_b32 v153, v152
  v_add_f32 v152, v152, v153
  v_rcp_f32 v152, v152
  s_nop 0
  v_mul_f32 v144, v144, v152
  v_mul_f32 v145, v145, v152
  v_mul_f32 v146, v146, v152
  v_mul_f32 v147, v147, v152
  v_mul_f32 v148, v148, v152
  v_mul_f32 v149, v149, v152
  v_mul_f32 v150, v150, v152
  v_mul_f32 v151, v151, v152
  v_cvt_pk_bf16_f32 v144, v144, v145
  v_cvt_pk_bf16_f32 v145, v146, v147
  v_cvt_pk_bf16_f32 v146, v148, v149
  v_cvt_pk_bf16_f32 v147, v150, v151
  buffer_store_dwordx4 v[144:147], v17, s[8:11], s67 offen
  s_barrier
  v_mov_b32 v44, 0
  v_mov_b32 v45, 0
  v_mov_b32 v46, 0
  v_mov_b32 v47, 0
  v_mov_b32 v48, 0
  v_mov_b32 v49, 0
  v_mov_b32 v50, 0
  v_mov_b32 v51, 0
  buffer_load_dwordx4 v[28:31], v4, s[8:11], s67 offen offset:0 sc1
  buffer_load_dwordx4 v[32:35], v4, s[8:11], s67 offen offset:1024 sc1
  buffer_load_dwordx4 v[36:39], v4, s[8:11], s67 offen offset:2048 sc1
  buffer_load_dwordx4 v[40:43], v4, s[8:11], s67 offen offset:3072 sc1
gc_85:
  s_waitcnt vmcnt(3)
  v_max_u32 v152, v28, v30
  v_cmp_eq_u32 vcc, -1, v152
  s_cbranch_vccnz gr_89
  v_smfmac_f32_16x16x64_bf16 v[44:47], v[28:31], a[192:199], v5
  v_smfmac_f32_16x16x64_bf16 v[48:51], v[28:31], a[224:231], v5
gc_86:
  s_waitcnt vmcnt(2)
  v_max_u32 v152, v32, v34
  v_cmp_eq_u32 vcc, -1, v152
  s_cbranch_vccnz gr_90
  v_smfmac_f32_16x16x64_bf16 v[44:47], v[32:35], a[200:207], v5
  v_smfmac_f32_16x16x64_bf16 v[48:51], v[32:35], a[232:239], v5
gc_87:
  s_waitcnt vmcnt(1)
  v_max_u32 v152, v36, v38
  v_cmp_eq_u32 vcc, -1, v152
  s_cbranch_vccnz gr_91
  v_smfmac_f32_16x16x64_bf16 v[44:47], v[36:39], a[208:215], v5
  v_smfmac_f32_16x16x64_bf16 v[48:51], v[36:39], a[240:247], v5
gc_88:
  s_waitcnt vmcnt(0)
  v_max_u32 v152, v40, v42
  v_cmp_eq_u32 vcc, -1, v152
  s_cbranch_vccnz gr_92
  v_smfmac_f32_16x16x64_bf16 v[44:47], v[40:43], a[216:223], v5
  v_smfmac_f32_16x16x64_bf16 v[48:51], v[40:43], a[248:255], v5
  s_nop 7
  v_permlane32_swap_b32 v44, v48
  v_permlane32_swap_b32 v45, v49
  v_permlane32_swap_b32 v46, v50
  v_permlane32_swap_b32 v47, v51
  v_pk_add_f32 v[44:45], v[44:45], v[48:49]
  v_pk_add_f32 v[46:47], v[46:47], v[50:51]
  ds_write_b32 v6, v44 offset:9216
  ds_write_b32 v6, v45 offset:9360
  ds_write_b32 v6, v46 offset:9504
  ds_write_b32 v6, v47 offset:9648
  s_waitcnt lgkmcnt(0)
  s_barrier
  ds_read_b128 v[172:175], v10 offset:9216
  ds_read_b128 v[176:179], v10 offset:11520
  ds_read_b128 v[180:183], v10 offset:13824
  ds_read_b128 v[184:187], v10 offset:16128
  s_waitcnt lgkmcnt(2)
  v_pk_add_f32 v[172:173], v[172:173], v[176:177]
  v_pk_add_f32 v[174:175], v[174:175], v[178:179]
  s_waitcnt lgkmcnt(0)
  v_pk_add_f32 v[180:181], v[180:181], v[184:185]
  v_pk_add_f32 v[182:183], v[182:183], v[186:187]
  v_pk_add_f32 v[172:173], v[172:173], v[180:181]
  v_pk_add_f32 v[174:175], v[174:175], v[182:183]
  buffer_store_dwordx4 v[172:175], v18, s[8:11], s68 offen sc1
  s_barrier
  s_add_u32 s58, s58, 1
  s_and_b32 s59, s58, 3
  s_lshl_b32 s64, s59, 14
  s_add_u32 s67, s64, 262144
  s_mul_i32 s66, s59, 40960
  s_add_u32 s66, s66, 524288
  s_lshl_b32 s68, s59, 17
  s_add_u32 s68, s68, 1572864
  s_add_u32 s65, s64, 16384
  s_and_b32 s65, s65, 0xffff
  v_mov_b32 v44, 0
  v_mov_b32 v45, 0
  v_mov_b32 v46, 0
  v_mov_b32 v47, 0
  v_mov_b32 v48, 0
  v_mov_b32 v49, 0
  v_mov_b32 v50, 0
  v_mov_b32 v51, 0
  s_barrier
  s_branch ll_73
gr_78:
  buffer_load_dwordx4 v[28:31], v4, s[8:11], s64 offen offset:0 sc1
  buffer_load_dwordx4 v[32:35], v4, s[8:11], s64 offen offset:1024 sc1
  buffer_load_dwordx4 v[36:39], v4, s[8:11], s64 offen offset:2048 sc1
  buffer_load_dwordx4 v[40:43], v4, s[8:11], s64 offen offset:3072 sc1
  s_sub_u32 s57, s57, 1
  s_cbranch_scc0 gc_74
  s_branch ABORT
gr_79:
  buffer_load_dwordx4 v[32:35], v4, s[8:11], s64 offen offset:1024 sc1
  buffer_load_dwordx4 v[36:39], v4, s[8:11], s64 offen offset:2048 sc1
  buffer_load_dwordx4 v[40:43], v4, s[8:11], s64 offen offset:3072 sc1
  s_sub_u32 s57, s57, 1
  s_cbranch_scc0 gc_75
  s_branch ABORT
gr_80:
  buffer_load_dwordx4 v[36:39], v4, s[8:11], s64 offen offset:2048 sc1
  buffer_load_dwordx4 v[40:43], v4, s[8:11], s64 offen offset:3072 sc1
  s_sub_u32 s57, s57, 1
  s_cbranch_scc0 gc_76
  s_branch ABORT
gr_81:
  buffer_load_dwordx4 v[40:43], v4, s[8:11], s64 offen offset:3072 sc1
  s_sub_u32 s57, s57, 1
  s_cbranch_scc0 gc_77
  s_branch ABORT
gr_89:
  buffer_load_dwordx4 v[28:31], v4, s[8:11], s67 offen offset:0 sc1
  buffer_load_dwordx4 v[32:35], v4, s[8:11], s67 offen offset:1024 sc1
  buffer_load_dwordx4 v[36:39], v4, s[8:11], s67 offen offset:2048 sc1
  buffer_load_dwordx4 v[40:43], v4, s[8:11], s67 offen offset:3072 sc1
  s_sub_u32 s57, s57, 1
  s_cbranch_scc0 gc_85
  s_branch ABORT
gr_90:
  buffer_load_dwordx4 v[32:35], v4, s[8:11], s67 offen offset:1024 sc1
  buffer_load_dwordx4 v[36:39], v4, s[8:11], s67 offen offset:2048 sc1
  buffer_load_dwordx4 v[40:43], v4, s[8:11], s67 offen offset:3072 sc1
  s_sub_u32 s57, s57, 1
  s_cbranch_scc0 gc_86
  s_branch ABORT
gr_91:
  buffer_load_dwordx4 v[36:39], v4, s[8:11], s67 offen offset:2048 sc1
  buffer_load_dwordx4 v[40:43], v4, s[8:11], s67 offen offset:3072 sc1
  s_sub_u32 s57, s57, 1
  s_cbranch_scc0 gc_87
  s_branch ABORT
gr_92:
  buffer_load_dwordx4 v[40:43], v4, s[8:11], s67 offen offset:3072 sc1
  s_sub_u32 s57, s57, 1
  s_cbranch_scc0 gc_88
  s_branch ABORT
LEADEND_ll_73:
  s_branch JR2
M_CS:
  s_mov_b32 s58, 0
  s_and_b32 s59, s58, 3
  s_lshl_b32 s64, s59, 14
  s_add_u32 s67, s64, 262144
  s_mul_i32 s66, s59, 40960
  s_add_u32 s66, s66, 524288
  s_lshl_b32 s68, s59, 17
  s_add_u32 s68, s68, 1572864
  s_add_u32 s65, s64, 16384
  s_and_b32 s65, s65, 0xffff
  v_mov_b32 v44, 0
  v_mov_b32 v45, 0
  v_mov_b32 v46, 0
  v_mov_b32 v47, 0
  v_mov_b32 v48, 0
  v_mov_b32 v49, 0
  v_mov_b32 v50, 0
  v_mov_b32 v51, 0
  v_mov_b32 v52, 0
  v_mov_b32 v53, 0
  v_mov_b32 v54, 0
  v_mov_b32 v55, 0
  v_mov_b32 v56, 0
  v_mov_b32 v57, 0
  v_mov_b32 v58, 0
  v_mov_b32 v59, 0
  v_mov_b32 v60, 0
  v_mov_b32 v61, 0
  v_mov_b32 v62, 0
  v_mov_b32 v63, 0
  v_mov_b32 v64, 0
  v_mov_b32 v65, 0
  v_mov_b32 v66, 0
  v_mov_b32 v67, 0
  s_cmp_eq_u32 s54, 0
  s_cbranch_scc1 lead_95
  s_lshl_b32 s59, s55, 5
  s_add_u32 s59, s59, s56
  s_lshl_b32 s60, s59, 11
  v_lshl_add_u32 v162, v0, 4, s60
  s_lshl_b32 s60, s59, 2
  v_and_b32 v163, 1, v0
  v_lshl_add_u32 v163, v163, 9, s60
  s_lshl_b32 s60, s59, 9
  v_lshlrev_b32 v23, 7, v2
  v_lshl_add_u32 v23, v1, 4, v23
  v_subrev_u32 v23, 128, v23
  v_add_u32 v23, s60, v23
  v_mov_b32 v155, 0x7ff00000
  v_cmp_gt_u32 vcc, 8, v1
  s_nop 1
  v_cndmask_b32 v23, v23, v155, vcc
  v_lshl_add_u32 v165, v0, 3, s60
  v_and_b32 v9, 31, v0
  v_lshlrev_b32 v9, 5, v9
  v_lshrrev_b32 v155, 5, v0
  v_lshl_add_u32 v9, v155, 4, v9
  s_lshl_b32 s60, s59, 2
  v_mov_b32 v166, s60
  v_mov_b32 v167, 1
  v_lshlrev_b32 v159, 4, v0
  s_mov_b32 s69, 0
  s_cmp_lg_u32 s54, 2
  s_cbranch_scc1 h0_96
  s_mul_i32 s59, s69, 1536
  s_add_u32 s59, s59, 2097152
kf_97:
  buffer_load_dword v164, v163, s[8:11], s59 offen sc1
  s_waitcnt vmcnt(0)
  v_cmp_ne_u32 vcc, 1, v164
  s_cbranch_vccz kok_98
  s_sub_u32 s57, s57, 1
  s_cbranch_scc0 kf_97
  s_branch ABORT
kok_98:
  s_and_b32 s60, s69, 1
  s_lshl_b32 s60, s60, 12
  s_lshl_b32 s59, s69, 18
  s_add_u32 m0, s60, 24576
  s_add_u32 s61, s59, 16777216
  buffer_load_dwordx4 v162, s[8:11], s61 offen sc1 lds
  buffer_load_dwordx4 v162, s[8:11], s61 offen offset:1024 sc1 lds
  s_add_u32 m0, s60, 26624
  s_add_u32 s61, s59, 33554432
  buffer_load_dwordx4 v162, s[8:11], s61 offen sc1 lds
  buffer_load_dwordx4 v162, s[8:11], s61 offen offset:1024 sc1 lds
  s_mul_i32 s59, s58, 1536
  s_add_u32 s59, s59, 2098688
  buffer_load_dword v164, v163, s[8:11], s59 offen sc1
h0_96:
hl_99:
  buffer_load_dwordx4 v[28:31], v4, s[8:11], s64 offen offset:0 sc1
  buffer_load_dwordx4 v[32:35], v4, s[8:11], s64 offen offset:1024 sc1
  buffer_load_dwordx4 v[36:39], v4, s[8:11], s64 offen offset:2048 sc1
  buffer_load_dwordx4 v[40:43], v4, s[8:11], s64 offen offset:3072 sc1
gc_100:
  s_waitcnt vmcnt(3)
  v_max_u32 v152, v28, v30
  v_cmp_eq_u32 vcc, -1, v152
  s_cbranch_vccnz gr_104
  v_smfmac_f32_16x16x64_bf16 v[44:47], v[28:31], a[0:7], v5
  v_smfmac_f32_16x16x64_bf16 v[48:51], v[28:31], a[32:39], v5
  v_smfmac_f32_16x16x64_bf16 v[52:55], v[28:31], a[64:71], v5
  v_smfmac_f32_16x16x64_bf16 v[56:59], v[28:31], a[96:103], v5
gc_101:
  s_waitcnt vmcnt(2)
  v_max_u32 v152, v32, v34
  v_cmp_eq_u32 vcc, -1, v152
  s_cbranch_vccnz gr_105
  v_smfmac_f32_16x16x64_bf16 v[44:47], v[32:35], a[8:15], v5
  v_smfmac_f32_16x16x64_bf16 v[48:51], v[32:35], a[40:47], v5
  v_smfmac_f32_16x16x64_bf16 v[52:55], v[32:35], a[72:79], v5
  v_smfmac_f32_16x16x64_bf16 v[56:59], v[32:35], a[104:111], v5
gc_102:
  s_waitcnt vmcnt(1)
  v_max_u32 v152, v36, v38
  v_cmp_eq_u32 vcc, -1, v152
  s_cbranch_vccnz gr_106
  v_smfmac_f32_16x16x64_bf16 v[44:47], v[36:39], a[16:23], v5
  v_smfmac_f32_16x16x64_bf16 v[48:51], v[36:39], a[48:55], v5
  v_smfmac_f32_16x16x64_bf16 v[52:55], v[36:39], a[80:87], v5
  v_smfmac_f32_16x16x64_bf16 v[56:59], v[36:39], a[112:119], v5
gc_103:
  s_waitcnt vmcnt(0)
  v_max_u32 v152, v40, v42
  v_cmp_eq_u32 vcc, -1, v152
  s_cbranch_vccnz gr_107
  v_smfmac_f32_16x16x64_bf16 v[44:47], v[40:43], a[24:31], v5
  v_smfmac_f32_16x16x64_bf16 v[48:51], v[40:43], a[56:63], v5
  v_smfmac_f32_16x16x64_bf16 v[52:55], v[40:43], a[88:95], v5
  v_smfmac_f32_16x16x64_bf16 v[56:59], v[40:43], a[120:127], v5
  s_nop 5
  v_permlane32_swap_b32 v44, v48
  v_permlane32_swap_b32 v45, v49
  v_permlane32_swap_b32 v46, v50
  v_permlane32_swap_b32 v47, v51
  v_pk_add_f32 v[44:45], v[44:45], v[48:49]
  v_pk_add_f32 v[46:47], v[46:47], v[50:51]
  ds_write_b32 v6, v44 offset:0
  ds_write_b32 v6, v45 offset:144
  ds_write_b32 v6, v46 offset:288
  ds_write_b32 v6, v47 offset:432
  v_permlane32_swap_b32 v52, v56
  v_permlane32_swap_b32 v53, v57
  v_permlane32_swap_b32 v54, v58
  v_permlane32_swap_b32 v55, v59
  v_pk_add_f32 v[52:53], v[52:53], v[56:57]
  v_pk_add_f32 v[54:55], v[54:55], v[58:59]
  ds_write_b32 v6, v52 offset:1152
  ds_write_b32 v6, v53 offset:1296
  ds_write_b32 v6, v54 offset:1440
  ds_write_b32 v6, v55 offset:1584
  s_waitcnt lgkmcnt(0)
  s_barrier
  v_smfmac_f32_16x16x64_bf16 v[60:63], v[28:31], a[128:135], v5
  v_smfmac_f32_16x16x64_bf16 v[64:67], v[28:31], a[160:167], v5
  v_smfmac_f32_16x16x64_bf16 v[60:63], v[32:35], a[136:143], v5
  v_smfmac_f32_16x16x64_bf16 v[64:67], v[32:35], a[168:175], v5
  v_smfmac_f32_16x16x64_bf16 v[60:63], v[36:39], a[144:151], v5
  v_smfmac_f32_16x16x64_bf16 v[64:67], v[36:39], a[176:183], v5
  v_smfmac_f32_16x16x64_bf16 v[60:63], v[40:43], a[152:159], v5
  v_smfmac_f32_16x16x64_bf16 v[64:67], v[40:43], a[184:191], v5
  s_nop 7
  v_permlane32_swap_b32 v60, v64
  v_permlane32_swap_b32 v61, v65
  v_permlane32_swap_b32 v62, v66
  v_permlane32_swap_b32 v63, v67
  v_pk_add_f32 v[60:61], v[60:61], v[64:65]
  v_pk_add_f32 v[62:63], v[62:63], v[66:67]
  ds_write_b128 v7, v[60:63] offset:18432
  s_waitcnt lgkmcnt(0)
  s_barrier
  s_cmp_lg_u32 s54, 1
  s_cbranch_scc1 b_108
  ds_read_b128 v[172:175], v8 offset:0
  ds_read_b128 v[176:179], v8 offset:32
  ds_read_b128 v[180:183], v8 offset:2304
  ds_read_b128 v[184:187], v8 offset:2336
  ds_read_b128 v[188:191], v8 offset:4608
  ds_read_b128 v[192:195], v8 offset:4640
  ds_read_b128 v[196:199], v8 offset:6912
  ds_read_b128 v[200:203], v8 offset:6944
  ds_read_b128 v[204:207], v9 offset:18432
  ds_read_b128 v[208:211], v9 offset:19456
  ds_read_b128 v[212:215], v9 offset:20480
  ds_read_b128 v[216:219], v9 offset:21504
  s_waitcnt lgkmcnt(0)
  v_pk_add_f32 v[172:173], v[172:173], v[180:181]
  v_pk_add_f32 v[174:175], v[174:175], v[182:183]
  v_pk_add_f32 v[176:177], v[176:177], v[184:185]
  v_pk_add_f32 v[178:179], v[178:179], v[186:187]
  v_pk_add_f32 v[188:189], v[188:189], v[196:197]
  v_pk_add_f32 v[190:191], v[190:191], v[198:199]
  v_pk_add_f32 v[192:193], v[192:193], v[200:201]
  v_pk_add_f32 v[194:195], v[194:195], v[202:203]
  v_pk_add_f32 v[172:173], v[172:173], v[188:189]
  v_pk_add_f32 v[174:175], v[174:175], v[190:191]
  v_pk_add_f32 v[176:177], v[176:177], v[192:193]
  v_pk_add_f32 v[178:179], v[178:179], v[194:195]
  v_pk_add_f32 v[204:205], v[204:205], v[208:209]
  v_pk_add_f32 v[206:207], v[206:207], v[210:211]
  v_pk_add_f32 v[212:213], v[212:213], v[216:217]
  v_pk_add_f32 v[214:215], v[214:215], v[218:219]
  v_pk_add_f32 v[204:205], v[204:205], v[212:213]
  v_pk_add_f32 v[206:207], v[206:207], v[214:215]
  v_cvt_pk_bf16_f32 v76, v172, v173
  v_cvt_pk_bf16_f32 v77, v174, v175
  v_cvt_pk_bf16_f32 v78, v176, v177
  v_cvt_pk_bf16_f32 v79, v178, v179
  v_cvt_pk_bf16_f32 v132, v204, v205
  v_cvt_pk_bf16_f32 v133, v206, v207
  s_cmp_lt_u32 s58, 63
  s_cbranch_scc1 c_109
  s_lshl_b32 s59, s58, 16
  s_add_u32 s60, s59, 54525952
  s_add_u32 s59, s59, 50331648
  buffer_store_dwordx4 v[76:79], v23, s[8:11], s59 offen sc1
  buffer_store_dwordx2 v[132:133], v165, s[8:11], s60 offen sc1
  s_waitcnt vmcnt(0)
  s_lshl_b32 s59, s58, 9
  s_add_u32 s59, s59, 2195456
  buffer_store_dword v167, v166, s[8:11], s59 offen sc1
  s_branch JR2
b_108:
  s_cmp_lt_u32 s58, 63
  s_cbranch_scc0 JR2
c_109:
  v_mov_b32 v44, 0
  v_mov_b32 v45, 0
  v_mov_b32 v46, 0
  v_mov_b32 v47, 0
  v_mov_b32 v48, 0
  v_mov_b32 v49, 0
  v_mov_b32 v50, 0
  v_mov_b32 v51, 0
  s_barrier
  buffer_load_dwordx4 v[28:31], v4, s[8:11], s67 offen offset:0 sc1
  buffer_load_dwordx4 v[32:35], v4, s[8:11], s67 offen offset:1024 sc1
  buffer_load_dwordx4 v[36:39], v4, s[8:11], s67 offen offset:2048 sc1
  buffer_load_dwordx4 v[40:43], v4, s[8:11], s67 offen offset:3072 sc1
gc_111:
  s_waitcnt vmcnt(3)
  v_max_u32 v152, v28, v30
  v_cmp_eq_u32 vcc, -1, v152
  s_cbranch_vccnz gr_115
  v_smfmac_f32_16x16x64_bf16 v[44:47], v[28:31], a[192:199], v5
  v_smfmac_f32_16x16x64_bf16 v[48:51], v[28:31], a[224:231], v5
gc_112:
  s_waitcnt vmcnt(2)
  v_max_u32 v152, v32, v34
  v_cmp_eq_u32 vcc, -1, v152
  s_cbranch_vccnz gr_116
  v_smfmac_f32_16x16x64_bf16 v[44:47], v[32:35], a[200:207], v5
  v_smfmac_f32_16x16x64_bf16 v[48:51], v[32:35], a[232:239], v5
gc_113:
  s_waitcnt vmcnt(1)
  v_max_u32 v152, v36, v38
  v_cmp_eq_u32 vcc, -1, v152
  s_cbranch_vccnz gr_117
  v_smfmac_f32_16x16x64_bf16 v[44:47], v[36:39], a[208:215], v5
  v_smfmac_f32_16x16x64_bf16 v[48:51], v[36:39], a[240:247], v5
gc_114:
  s_waitcnt vmcnt(0)
  v_max_u32 v152, v40, v42
  v_cmp_eq_u32 vcc, -1, v152
  s_cbranch_vccnz gr_118
  v_smfmac_f32_16x16x64_bf16 v[44:47], v[40:43], a[216:223], v5
  v_smfmac_f32_16x16x64_bf16 v[48:51], v[40:43], a[248:255], v5
  s_nop 7
  v_permlane32_swap_b32 v44, v48
  v_permlane32_swap_b32 v45, v49
  v_permlane32_swap_b32 v46, v50
  v_permlane32_swap_b32 v47, v51
  v_pk_add_f32 v[44:45], v[44:45], v[48:49]
  v_pk_add_f32 v[46:47], v[46:47], v[50:51]
  ds_write_b32 v6, v44 offset:9216
  ds_write_b32 v6, v45 offset:9360
  ds_write_b32 v6, v46 offset:9504
  ds_write_b32 v6, v47 offset:9648
  s_waitcnt lgkmcnt(0)
  s_barrier
  s_cmp_lg_u32 s54, 1
  s_cbranch_scc1 f_119
  s_lshl_b32 s59, s58, 16
  s_add_u32 s60, s59, 54525952
  s_add_u32 s59, s59, 50331648
  buffer_store_dwordx4 v[76:79], v23, s[8:11], s59 offen sc1
  buffer_store_dwordx2 v[132:133], v165, s[8:11], s60 offen sc1
  s_add_u32 s63, s58, 2
  s_and_b32 s63, s63, 3
  s_lshl_b32 s59, s63, 14
  s_add_u32 s60, s59, 262144
  buffer_store_dwordx2 v[24:25], v20, s[8:11], s59 offen sc1
  buffer_store_dwordx2 v[24:25], v20, s[8:11], s60 offen sc1
  s_mul_i32 s59, s63, 40960
  s_add_u32 s59, s59, 524288
  s_lshl_b32 s60, s63, 17
  s_add_u32 s60, s60, 1572864
  buffer_store_dwordx4 v[24:27], v160, s[8:11], s59 offen sc1
  buffer_store_dword v24, v161, s[8:11], s59 offen sc1
  buffer_store_dwordx4 v[24:27], v18, s[8:11], s60 offen sc1
  s_barrier
  s_waitcnt vmcnt(5)
  s_lshl_b32 s59, s58, 9
  s_add_u32 s59, s59, 2195456
  buffer_store_dword v167, v166, s[8:11], s59 offen sc1
  s_branch g_120
f_119:
  s_cmp_lg_u32 s54, 2
  s_cbranch_scc1 f3_121
  s_add_u32 s69, s58, 1
  v_cmp_ne_u32 vcc, 1, v164
  s_cbranch_vccz kok_126
  s_mul_i32 s59, s69, 1536
  s_add_u32 s59, s59, 2097152
kf_125:
  buffer_load_dword v164, v163, s[8:11], s59 offen sc1
  s_waitcnt vmcnt(0)
  v_cmp_ne_u32 vcc, 1, v164
  s_cbranch_vccz kok_126
  s_sub_u32 s57, s57, 1
  s_cbranch_scc0 kf_125
  s_branch ABORT
kok_126:
  s_and_b32 s60, s69, 1
  s_lshl_b32 s60, s60, 12
  s_lshl_b32 s59, s69, 18
  s_add_u32 m0, s60, 24576
  s_add_u32 s61, s59, 16777216
  buffer_load_dwordx4 v162, s[8:11], s61 offen sc1 lds
  buffer_load_dwordx4 v162, s[8:11], s61 offen offset:1024 sc1 lds
  s_add_u32 m0, s60, 26624
  s_add_u32 s61, s59, 33554432
  buffer_load_dwordx4 v162, s[8:11], s61 offen sc1 lds
  buffer_load_dwordx4 v162, s[8:11], s61 offen offset:1024 sc1 lds
  s_mul_i32 s59, s58, 1536
  s_add_u32 s59, s59, 2100224
  buffer_load_dword v164, v163, s[8:11], s59 offen sc1
  s_barrier
  s_branch g_120
f3_121:
  s_barrier
  v_mov_b32 v44, 0
  v_mov_b32 v45, 0
  v_mov_b32 v46, 0
  v_mov_b32 v47, 0
  v_mov_b32 v48, 0
  v_mov_b32 v49, 0
  v_mov_b32 v50, 0
  v_mov_b32 v51, 0
  v_mov_b32 v52, 0
  v_mov_b32 v53, 0
  v_mov_b32 v54, 0
  v_mov_b32 v55, 0
  v_mov_b32 v56, 0
  v_mov_b32 v57, 0
  v_mov_b32 v58, 0
  v_mov_b32 v59, 0
  v_mov_b32 v60, 0
  v_mov_b32 v61, 0
  v_mov_b32 v62, 0
  v_mov_b32 v63, 0
  v_mov_b32 v64, 0
  v_mov_b32 v65, 0
  v_mov_b32 v66, 0
  v_mov_b32 v67, 0
  s_mov_b32 s69, s68
  s_mov_b32 s70, s65
  s_add_u32 s58, s58, 1
  s_and_b32 s59, s58, 3
  s_lshl_b32 s64, s59, 14
  s_add_u32 s67, s64, 262144
  s_mul_i32 s66, s59, 40960
  s_add_u32 s66, s66, 524288
  s_lshl_b32 s68, s59, 17
  s_add_u32 s68, s68, 1572864
  s_add_u32 s65, s64, 16384
  s_and_b32 s65, s65, 0xffff
pp_123:
  buffer_load_dwordx4 v[108:111], v19, s[8:11], s69 offen offset:0 sc1
  buffer_load_dwordx4 v[112:115], v19, s[8:11], s69 offen offset:1024 sc1
  buffer_load_dwordx4 v[116:119], v19, s[8:11], s69 offen offset:2048 sc1
  buffer_load_dwordx4 v[120:123], v19, s[8:11], s69 offen offset:3072 sc1
pp_123_c:
  s_waitcnt vmcnt(2)
  v_pk_add_f32 v[108:109], v[108:109], v[112:113]
  v_pk_add_f32 v[110:111], v[110:111], v[114:115]
  s_waitcnt vmcnt(0)
  v_pk_add_f32 v[116:117], v[116:117], v[120:121]
  v_pk_add_f32 v[118:119], v[118:119], v[122:123]
  v_pk_add_f32 v[108:109], v[108:109], v[116:117]
  v_pk_add_f32 v[110:111], v[110:111], v[118:119]
  v_cmp_u_f32 vcc, v108, v108
  v_cvt_pk_bf16_f32 v112, v108, v109
  v_cvt_pk_bf16_f32 v113, v110, v111
  s_cbranch_vccz ppok_124
  s_sub_u32 s57, s57, 1
  s_cbranch_scc0 pp_123
  s_branch ABORT
ppok_124:
  buffer_store_dwordx2 v[112:113], v20, s[8:11], s70 offen sc1
  s_barrier
  s_branch hl_99
g_120:
  s_add_u32 s58, s58, 1
  s_and_b32 s59, s58, 3
  s_lshl_b32 s64, s59, 14
  s_add_u32 s67, s64, 262144
  s_mul_i32 s66, s59, 40960
  s_add_u32 s66, s66, 524288
  s_lshl_b32 s68, s59, 17
  s_add_u32 s68, s68, 1572864
  s_add_u32 s65, s64, 16384
  s_and_b32 s65, s65, 0xffff
  v_mov_b32 v44, 0
  v_mov_b32 v45, 0
  v_mov_b32 v46, 0
  v_mov_b32 v47, 0
  v_mov_b32 v48, 0
  v_mov_b32 v49, 0
  v_mov_b32 v50, 0
  v_mov_b32 v51, 0
  v_mov_b32 v52, 0
  v_mov_b32 v53, 0
  v_mov_b32 v54, 0
  v_mov_b32 v55, 0
  v_mov_b32 v56, 0
  v_mov_b32 v57, 0
  v_mov_b32 v58, 0
  v_mov_b32 v59, 0
  v_mov_b32 v60, 0
  v_mov_b32 v61, 0
  v_mov_b32 v62, 0
  v_mov_b32 v63, 0
  v_mov_b32 v64, 0
  v_mov_b32 v65, 0
  v_mov_b32 v66, 0
  v_mov_b32 v67, 0
  s_barrier
  s_branch hl_99
gr_104:
  buffer_load_dwordx4 v[28:31], v4, s[8:11], s64 offen offset:0 sc1
  buffer_load_dwordx4 v[32:35], v4, s[8:11], s64 offen offset:1024 sc1
  buffer_load_dwordx4 v[36:39], v4, s[8:11], s64 offen offset:2048 sc1
  buffer_load_dwordx4 v[40:43], v4, s[8:11], s64 offen offset:3072 sc1
  s_sub_u32 s57, s57, 1
  s_cbranch_scc0 gc_100
  s_branch ABORT
gr_105:
  buffer_load_dwordx4 v[32:35], v4, s[8:11], s64 offen offset:1024 sc1
  buffer_load_dwordx4 v[36:39], v4, s[8:11], s64 offen offset:2048 sc1
  buffer_load_dwordx4 v[40:43], v4, s[8:11], s64 offen offset:3072 sc1
  s_sub_u32 s57, s57, 1
  s_cbranch_scc0 gc_101
  s_branch ABORT
gr_106:
  buffer_load_dwordx4 v[36:39], v4, s[8:11], s64 offen offset:2048 sc1
  buffer_load_dwordx4 v[40:43], v4, s[8:11], s64 offen offset:3072 sc1
  s_sub_u32 s57, s57, 1
  s_cbranch_scc0 gc_102
  s_branch ABORT
gr_107:
  buffer_load_dwordx4 v[40:43], v4, s[8:11], s64 offen offset:3072 sc1
  s_sub_u32 s57, s57, 1
  s_cbranch_scc0 gc_103
  s_branch ABORT
gr_115:
  buffer_load_dwordx4 v[28:31], v4, s[8:11], s67 offen offset:0 sc1
  buffer_load_dwordx4 v[32:35], v4, s[8:11], s67 offen offset:1024 sc1
  buffer_load_dwordx4 v[36:39], v4, s[8:11], s67 offen offset:2048 sc1
  buffer_load_dwordx4 v[40:43], v4, s[8:11], s67 offen offset:3072 sc1
  s_sub_u32 s57, s57, 1
  s_cbranch_scc0 gc_111
  s_branch ABORT
gr_116:
  buffer_load_dwordx4 v[32:35], v4, s[8:11], s67 offen offset:1024 sc1
  buffer_load_dwordx4 v[36:39], v4, s[8:11], s67 offen offset:2048 sc1
  buffer_load_dwordx4 v[40:43], v4, s[8:11], s67 offen offset:3072 sc1
  s_sub_u32 s57, s57, 1
  s_cbranch_scc0 gc_112
  s_branch ABORT
gr_117:
  buffer_load_dwordx4 v[36:39], v4, s[8:11], s67 offen offset:2048 sc1
  buffer_load_dwordx4 v[40:43], v4, s[8:11], s67 offen offset:3072 sc1
  s_sub_u32 s57, s57, 1
  s_cbranch_scc0 gc_113
  s_branch ABORT
gr_118:
  buffer_load_dwordx4 v[40:43], v4, s[8:11], s67 offen offset:3072 sc1
  s_sub_u32 s57, s57, 1
  s_cbranch_scc0 gc_114
  s_branch ABORT
lead_95:
ll_127:
  buffer_load_dwordx4 v[28:31], v4, s[8:11], s64 offen offset:0 sc1
  buffer_load_dwordx4 v[32:35], v4, s[8:11], s64 offen offset:1024 sc1
  buffer_load_dwordx4 v[36:39], v4, s[8:11], s64 offen offset:2048 sc1
  buffer_load_dwordx4 v[40:43], v4, s[8:11], s64 offen offset:3072 sc1
gc_128:
  s_waitcnt vmcnt(3)
  v_max_u32 v152, v28, v30
  v_cmp_eq_u32 vcc, -1, v152
  s_cbranch_vccnz gr_132
  v_smfmac_f32_16x16x64_bf16 v[44:47], v[28:31], a[0:7], v5
  v_smfmac_f32_16x16x64_bf16 v[48:51], v[28:31], a[32:39], v5
  v_smfmac_f32_16x16x64_bf16 v[52:55], v[28:31], a[64:71], v5
  v_smfmac_f32_16x16x64_bf16 v[56:59], v[28:31], a[96:103], v5
gc_129:
  s_waitcnt vmcnt(2)
  v_max_u32 v152, v32, v34
  v_cmp_eq_u32 vcc, -1, v152
  s_cbranch_vccnz gr_133
  v_smfmac_f32_16x16x64_bf16 v[44:47], v[32:35], a[8:15], v5
  v_smfmac_f32_16x16x64_bf16 v[48:51], v[32:35], a[40:47], v5
  v_smfmac_f32_16x16x64_bf16 v[52:55], v[32:35], a[72:79], v5
  v_smfmac_f32_16x16x64_bf16 v[56:59], v[32:35], a[104:111], v5
gc_130:
  s_waitcnt vmcnt(1)
  v_max_u32 v152, v36, v38
  v_cmp_eq_u32 vcc, -1, v152
  s_cbranch_vccnz gr_134
  v_smfmac_f32_16x16x64_bf16 v[44:47], v[36:39], a[16:23], v5
  v_smfmac_f32_16x16x64_bf16 v[48:51], v[36:39], a[48:55], v5
  v_smfmac_f32_16x16x64_bf16 v[52:55], v[36:39], a[80:87], v5
  v_smfmac_f32_16x16x64_bf16 v[56:59], v[36:39], a[112:119], v5
gc_131:
  s_waitcnt vmcnt(0)
  v_max_u32 v152, v40, v42
  v_cmp_eq_u32 vcc, -1, v152
  s_cbranch_vccnz gr_135
  v_smfmac_f32_16x16x64_bf16 v[44:47], v[40:43], a[24:31], v5
  v_smfmac_f32_16x16x64_bf16 v[48:51], v[40:43], a[56:63], v5
  v_smfmac_f32_16x16x64_bf16 v[52:55], v[40:43], a[88:95], v5
  v_smfmac_f32_16x16x64_bf16 v[56:59], v[40:43], a[120:127], v5
  s_nop 5
  v_permlane32_swap_b32 v44, v48
  v_permlane32_swap_b32 v45, v49
  v_permlane32_swap_b32 v46, v50
  v_permlane32_swap_b32 v47, v51
  v_pk_add_f32 v[44:45], v[44:45], v[48:49]
  v_pk_add_f32 v[46:47], v[46:47], v[50:51]
  ds_write_b32 v6, v44 offset:0
  ds_write_b32 v6, v45 offset:144
  ds_write_b32 v6, v46 offset:288
  ds_write_b32 v6, v47 offset:432
  v_permlane32_swap_b32 v52, v56
  v_permlane32_swap_b32 v53, v57
  v_permlane32_swap_b32 v54, v58
  v_permlane32_swap_b32 v55, v59
  v_pk_add_f32 v[52:53], v[52:53], v[56:57]
  v_pk_add_f32 v[54:55], v[54:55], v[58:59]
  ds_write_b32 v6, v52 offset:1152
  ds_write_b32 v6, v53 offset:1296
  ds_write_b32 v6, v54 offset:1440
  ds_write_b32 v6, v55 offset:1584
  s_waitcnt lgkmcnt(0)
  s_barrier
  ds_read_b128 v[172:175], v8 offset:0
  ds_read_b128 v[176:179], v8 offset:32
  ds_read_b128 v[180:183], v8 offset:2304
  ds_read_b128 v[184:187], v8 offset:2336
  ds_read_b128 v[188:191], v8 offset:4608
  ds_read_b128 v[192:195], v8 offset:4640
  ds_read_b128 v[196:199], v8 offset:6912
  ds_read_b128 v[200:203], v8 offset:6944
  ds_read_b128 v[80:83], v11
  ds_read_b128 v[84:87], v11 offset:128
  s_waitcnt lgkmcnt(6)
  v_pk_add_f32 v[172:173], v[172:173], v[180:181]
  v_pk_add_f32 v[174:175], v[174:175], v[182:183]
  v_pk_add_f32 v[176:177], v[176:177], v[184:185]
  v_pk_add_f32 v[178:179], v[178:179], v[186:187]
  s_waitcnt lgkmcnt(2)
  v_pk_add_f32 v[188:189], v[188:189], v[196:197]
  v_pk_add_f32 v[190:191], v[190:191], v[198:199]
  v_pk_add_f32 v[192:193], v[192:193], v[200:201]
  v_pk_add_f32 v[194:195], v[194:195], v[202:203]
  v_pk_add_f32 v[172:173], v[172:173], v[188:189]
  v_pk_add_f32 v[174:175], v[174:175], v[190:191]
  v_pk_add_f32 v[176:177], v[176:177], v[192:193]
  v_pk_add_f32 v[178:179], v[178:179], v[194:195]
  v_cvt_pk_bf16_f32 v76, v172, v173
  v_cvt_pk_bf16_f32 v77, v174, v175
  v_cvt_pk_bf16_f32 v78, v176, v177
  v_cvt_pk_bf16_f32 v79, v178, v179
  s_nop 1
  v_mfma_f32_16x16x32_bf16 v[96:99], v[76:79], v[76:79], 0
  s_waitcnt lgkmcnt(0)
  v_mfma_f32_16x16x32_bf16 v[100:103], v[80:83], v[76:79], 0
  v_mfma_f32_16x16x32_bf16 v[104:107], v[84:87], v[76:79], 0
  ds_read_b128 v[88:91], v12 offset:2048
  ds_read_b128 v[92:95], v12 offset:2304
  v_xor_b32 v11, 4096, v11
  v_xor_b32 v12, 4096, v12
  s_nop 0
  buffer_store_dwordx4 v[96:99], v14, s[8:11], s66 offen sc1
  s_nop 0
  buffer_store_dwordx4 v[100:103], v13, s[8:11], s66 offen sc1
  buffer_store_dwordx4 v[104:107], v13, s[8:11], s66 offen offset:512 sc1
  v_smfmac_f32_16x16x64_bf16 v[60:63], v[28:31], a[128:135], v5
  v_smfmac_f32_16x16x64_bf16 v[64:67], v[28:31], a[160:167], v5
  v_smfmac_f32_16x16x64_bf16 v[60:63], v[32:35], a[136:143], v5
  v_smfmac_f32_16x16x64_bf16 v[64:67], v[32:35], a[168:175], v5
  v_smfmac_f32_16x16x64_bf16 v[60:63], v[36:39], a[144:151], v5
  v_smfmac_f32_16x16x64_bf16 v[64:67], v[36:39], a[176:183], v5
  v_smfmac_f32_16x16x64_bf16 v[60:63], v[40:43], a[152:159], v5
  v_smfmac_f32_16x16x64_bf16 v[64:67], v[40:43], a[184:191], v5
  s_nop 7
  v_permlane32_swap_b32 v60, v64
  v_permlane32_swap_b32 v61, v65
  v_permlane32_swap_b32 v62, v66
  v_permlane32_swap_b32 v63, v67
  v_pk_add_f32 v[60:61], v[60:61], v[64:65]
  v_pk_add_f32 v[62:63], v[62:63], v[66:67]
  ds_write_b128 v7, v[60:63] offset:18432
  buffer_load_dwordx4 v[108:111], v15, s[8:11], s66 offen offset:0 sc1
  buffer_load_dword v124, v16, s[8:11], s66 offen offset:0 sc1
  buffer_load_dwordx4 v[112:115], v15, s[8:11], s66 offen offset:1280 sc1
  buffer_load_dword v125, v16, s[8:11], s66 offen offset:1280 sc1
  buffer_load_dwordx4 v[116:119], v15, s[8:11], s66 offen offset:2560 sc1
  buffer_load_dword v126, v16, s[8:11], s66 offen offset:2560 sc1
  buffer_load_dwordx4 v[120:123], v15, s[8:11], s66 offen offset:3840 sc1
  buffer_load_dword v127, v16, s[8:11], s66 offen offset:3840 sc1
  s_waitcnt lgkmcnt(0)
  s_barrier
  s_cmp_lt_u32 s58, 63
  s_cbranch_scc0 LEADEND_ll_127
  ds_read_b64 v[204:205], v9 offset:18432
  ds_read_b64 v[206:207], v9 offset:18944
  ds_read_b64 v[208:209], v9 offset:19456
  ds_read_b64 v[210:211], v9 offset:19968
  ds_read_b64 v[212:213], v9 offset:20480
  ds_read_b64 v[214:215], v9 offset:20992
  ds_read_b64 v[216:217], v9 offset:21504
  ds_read_b64 v[218:219], v9 offset:22016
  v_mov_b32 v52, 0
  v_mov_b32 v53, 0
  v_mov_b32 v54, 0
  v_mov_b32 v55, 0
  v_mov_b32 v56, 0
  v_mov_b32 v57, 0
  v_mov_b32 v58, 0
  v_mov_b32 v59, 0
  v_mov_b32 v60, 0
  v_mov_b32 v61, 0
  v_mov_b32 v62, 0
  v_mov_b32 v63, 0
  v_mov_b32 v64, 0
  v_mov_b32 v65, 0
  v_mov_b32 v66, 0
  v_mov_b32 v67, 0
  s_waitcnt lgkmcnt(0)
  v_pk_add_f32 v[204:205], v[204:205], v[208:209]
  v_pk_add_f32 v[206:207], v[206:207], v[210:211]
  v_pk_add_f32 v[212:213], v[212:213], v[216:217]
  v_pk_add_f32 v[214:215], v[214:215], v[218:219]
  v_pk_add_f32 v[204:205], v[204:205], v[212:213]
  v_pk_add_f32 v[206:207], v[206:207], v[214:215]
  v_cvt_pk_bf16_f32 v132, v204, v205
  v_cvt_pk_bf16_f32 v134, v206, v207
  s_branch sk_138
sc_136:
  buffer_load_dwordx4 v[108:111], v15, s[8:11], s66 offen offset:0 sc1
  buffer_load_dword v124, v16, s[8:11], s66 offen offset:0 sc1
  buffer_load_dwordx4 v[112:115], v15, s[8:11], s66 offen offset:1280 sc1
  buffer_load_dword v125, v16, s[8:11], s66 offen offset:1280 sc1
  buffer_load_dwordx4 v[116:119], v15, s[8:11], s66 offen offset:2560 sc1
  buffer_load_dword v126, v16, s[8:11], s66 offen offset:2560 sc1
  buffer_load_dwordx4 v[120:123], v15, s[8:11], s66 offen offset:3840 sc1
  buffer_load_dword v127, v16, s[8:11], s66 offen offset:3840 sc1
sk_138:
  s_waitcnt vmcnt(0)
  v_pk_add_f32 v[108:109], v[108:109], v[112:113]
  v_pk_add_f32 v[116:117], v[116:117], v[120:121]
  v_pk_add_f32 v[124:125], v[124:125], v[126:127]
  v_pk_add_f32 v[110:111], v[110:111], v[114:115]
  v_pk_add_f32 v[118:119], v[118:119], v[122:123]
  v_pk_add_f32 v[108:109], v[108:109], v[116:117]
  v_add_f32 v112, v124, v125
  v_pk_add_f32 v[110:111], v[110:111], v[118:119]
  v_cmp_u_f32 vcc, v108, v112
  v_max3_f32 v152, v108, v109, v112
  s_cbranch_vccz scok_137
  s_sub_u32 s57, s57, 1
  s_cbranch_scc0 sc_136
  s_branch ABORT
scok_137:
  v_max3_f32 v152, v152, v110, v111
  s_nop 1
  v_max_f32_dpp v152, v152, v152 row_ror:8 row_mask:0xf bank_mask:0xf
  v_mov_b32 v153, v152
  s_nop 1
  v_permlane16_swap_b32 v153, v152
  v_max_f32 v152, v152, v153
  v_mov_b32 v153, v152
  s_nop 1
  v_permlane32_swap_b32 v153, v152
  v_max_f32 v152, v152, v153
  v_mul_f32 v152, s71, v152
  v_fma_f32 v112, v112, s71, -v152
  v_fma_f32 v108, v108, s71, -v152
  v_fma_f32 v109, v109, s71, -v152
  v_fma_f32 v110, v110, s71, -v152
  v_fma_f32 v111, v111, s71, -v152
  v_exp_f32 v112, v112
  v_exp_f32 v108, v108
  v_exp_f32 v109, v109
  v_exp_f32 v110, v110
  v_exp_f32 v111, v111
  v_mov_b32_dpp v153, v112 row_ror:8 row_mask:0xf bank_mask:0xf
  v_cvt_pk_bf16_f32 v136, v108, v109
  v_cvt_pk_bf16_f32 v137, v110, v111
  v_cvt_pk_bf16_f32 v140, v112, v153
  v_mov_b32_dpp v138, v136 row_ror:8 row_mask:0xf bank_mask:0xf
  v_mov_b32_dpp v139, v137 row_ror:8 row_mask:0xf bank_mask:0xf
  v_mfma_f32_16x16x16_bf16 v[144:147], v[132:133], v[140:141], 0
  v_pk_add_f32 v[108:109], v[108:109], v[110:111]
  v_add_f32 v152, v108, v112
  v_mfma_f32_16x16x16_bf16 v[148:151], v[134:135], v[140:141], 0
  v_add_f32 v152, v152, v109
  s_nop 1
  v_mfma_f32_16x16x32_bf16 v[144:147], v[88:91], v[136:139], v[144:147]
  v_add_f32_dpp v152, v152, v152 row_ror:8 row_mask:0xf bank_mask:0xf
  v_mov_b32 v153, v152
  v_mfma_f32_16x16x32_bf16 v[148:151], v[92:95], v[136:139], v[148:151]
  s_nop 0
  v_permlane16_swap_b32 v153, v152
  v_add_f32 v152, v152, v153
  v_mov_b32 v153, v152
  s_nop 1
  v_permlane32_swap_b32 v153, v152
  v_add_f32 v152, v152, v153
  v_rcp_f32 v152, v152
  s_nop 0
  v_mul_f32 v144, v144, v152
  v_mul_f32 v145, v145, v152
  v_mul_f32 v146, v146, v152
  v_mul_f32 v147, v147, v152
  v_mul_f32 v148, v148, v152
  v_mul_f32 v149, v149, v152
  v_mul_f32 v150, v150, v152
  v_mul_f32 v151, v151, v152
  v_cvt_pk_bf16_f32 v144, v144, v145
  v_cvt_pk_bf16_f32 v145, v146, v147
  v_cvt_pk_bf16_f32 v146, v148, v149
  v_cvt_pk_bf16_f32 v147, v150, v151
  buffer_store_dwordx4 v[144:147], v17, s[8:11], s67 offen sc1
  s_barrier
  v_mov_b32 v44, 0
  v_mov_b32 v45, 0
  v_mov_b32 v46, 0
  v_mov_b32 v47, 0
  v_mov_b32 v48, 0
  v_mov_b32 v49, 0
  v_mov_b32 v50, 0
  v_mov_b32 v51, 0
  buffer_load_dwordx4 v[28:31], v4, s[8:11], s67 offen offset:0 sc1
  buffer_load_dwordx4 v[32:35], v4, s[8:11], s67 offen offset:1024 sc1
  buffer_load_dwordx4 v[36:39], v4, s[8:11], s67 offen offset:2048 sc1
  buffer_load_dwordx4 v[40:43], v4, s[8:11], s67 offen offset:3072 sc1
gc_139:
  s_waitcnt vmcnt(3)
  v_max_u32 v152, v28, v30
  v_cmp_eq_u32 vcc, -1, v152
  s_cbranch_vccnz gr_143
  v_smfmac_f32_16x16x64_bf16 v[44:47], v[28:31], a[192:199], v5
  v_smfmac_f32_16x16x64_bf16 v[48:51], v[28:31], a[224:231], v5
gc_140:
  s_waitcnt vmcnt(2)
  v_max_u32 v152, v32, v34
  v_cmp_eq_u32 vcc, -1, v152
  s_cbranch_vccnz gr_144
  v_smfmac_f32_16x16x64_bf16 v[44:47], v[32:35], a[200:207], v5
  v_smfmac_f32_16x16x64_bf16 v[48:51], v[32:35], a[232:239], v5
gc_141:
  s_waitcnt vmcnt(1)
  v_max_u32 v152, v36, v38
  v_cmp_eq_u32 vcc, -1, v152
  s_cbranch_vccnz gr_145
  v_smfmac_f32_16x16x64_bf16 v[44:47], v[36:39], a[208:215], v5
  v_smfmac_f32_16x16x64_bf16 v[48:51], v[36:39], a[240:247], v5
gc_142:
  s_waitcnt vmcnt(0)
  v_max_u32 v152, v40, v42
  v_cmp_eq_u32 vcc, -1, v152
  s_cbranch_vccnz gr_146
  v_smfmac_f32_16x16x64_bf16 v[44:47], v[40:43], a[216:223], v5
  v_smfmac_f32_16x16x64_bf16 v[48:51], v[40:43], a[248:255], v5
  s_nop 7
  v_permlane32_swap_b32 v44, v48
  v_permlane32_swap_b32 v45, v49
  v_permlane32_swap_b32 v46, v50
  v_permlane32_swap_b32 v47, v51
  v_pk_add_f32 v[44:45], v[44:45], v[48:49]
  v_pk_add_f32 v[46:47], v[46:47], v[50:51]
  ds_write_b32 v6, v44 offset:9216
  ds_write_b32 v6, v45 offset:9360
  ds_write_b32 v6, v46 offset:9504
  ds_write_b32 v6, v47 offset:9648
  s_waitcnt lgkmcnt(0)
  s_barrier
  ds_read_b128 v[172:175], v10 offset:9216
  ds_read_b128 v[176:179], v10 offset:11520
  ds_read_b128 v[180:183], v10 offset:13824
  ds_read_b128 v[184:187], v10 offset:16128
  s_waitcnt lgkmcnt(2)
  v_pk_add_f32 v[172:173], v[172:173], v[176:177]
  v_pk_add_f32 v[174:175], v[174:175], v[178:179]
  s_waitcnt lgkmcnt(0)
  v_pk_add_f32 v[180:181], v[180:181], v[184:185]
  v_pk_add_f32 v[182:183], v[182:183], v[186:187]
  v_pk_add_f32 v[172:173], v[172:173], v[180:181]
  v_pk_add_f32 v[174:175], v[174:175], v[182:183]
  buffer_store_dwordx4 v[172:175], v18, s[8:11], s68 offen sc1
  s_barrier
  s_add_u32 s58, s58, 1
  s_and_b32 s59, s58, 3
  s_lshl_b32 s64, s59, 14
  s_add_u32 s67, s64, 262144
  s_mul_i32 s66, s59, 40960
  s_add_u32 s66, s66, 524288
  s_lshl_b32 s68, s59, 17
  s_add_u32 s68, s68, 1572864
  s_add_u32 s65, s64, 16384
  s_and_b32 s65, s65, 0xffff
  v_mov_b32 v44, 0
  v_mov_b32 v45, 0
  v_mov_b32 v46, 0
  v_mov_b32 v47, 0
  v_mov_b32 v48, 0
  v_mov_b32 v49, 0
  v_mov_b32 v50, 0
  v_mov_b32 v51, 0
  s_barrier
  s_branch ll_127
gr_132:
  buffer_load_dwordx4 v[28:31], v4, s[8:11], s64 offen offset:0 sc1
  buffer_load_dwordx4 v[32:35], v4, s[8:11], s64 offen offset:1024 sc1
  buffer_load_dwordx4 v[36:39], v4, s[8:11], s64 offen offset:2048 sc1
  buffer_load_dwordx4 v[40:43], v4, s[8:11], s64 offen offset:3072 sc1
  s_sub_u32 s57, s57, 1
  s_cbranch_scc0 gc_128
  s_branch ABORT
gr_133:
  buffer_load_dwordx4 v[32:35], v4, s[8:11], s64 offen offset:1024 sc1
  buffer_load_dwordx4 v[36:39], v4, s[8:11], s64 offen offset:2048 sc1
  buffer_load_dwordx4 v[40:43], v4, s[8:11], s64 offen offset:3072 sc1
  s_sub_u32 s57, s57, 1
  s_cbranch_scc0 gc_129
  s_branch ABORT
gr_134:
  buffer_load_dwordx4 v[36:39], v4, s[8:11], s64 offen offset:2048 sc1
  buffer_load_dwordx4 v[40:43], v4, s[8:11], s64 offen offset:3072 sc1
  s_sub_u32 s57, s57, 1
  s_cbranch_scc0 gc_130
  s_branch ABORT
gr_135:
  buffer_load_dwordx4 v[40:43], v4, s[8:11], s64 offen offset:3072 sc1
  s_sub_u32 s57, s57, 1
  s_cbranch_scc0 gc_131
  s_branch ABORT
gr_143:
  buffer_load_dwordx4 v[28:31], v4, s[8:11], s67 offen offset:0 sc1
  buffer_load_dwordx4 v[32:35], v4, s[8:11], s67 offen offset:1024 sc1
  buffer_load_dwordx4 v[36:39], v4, s[8:11], s67 offen offset:2048 sc1
  buffer_load_dwordx4 v[40:43], v4, s[8:11], s67 offen offset:3072 sc1
  s_sub_u32 s57, s57, 1
  s_cbranch_scc0 gc_139
  s_branch ABORT
gr_144:
  buffer_load_dwordx4 v[32:35], v4, s[8:11], s67 offen offset:1024 sc1
  buffer_load_dwordx4 v[36:39], v4, s[8:11], s67 offen offset:2048 sc1
  buffer_load_dwordx4 v[40:43], v4, s[8:11], s67 offen offset:3072 sc1
  s_sub_u32 s57, s57, 1
  s_cbranch_scc0 gc_140
  s_branch ABORT
gr_145:
  buffer_load_dwordx4 v[36:39], v4, s[8:11], s67 offen offset:2048 sc1
  buffer_load_dwordx4 v[40:43], v4, s[8:11], s67 offen offset:3072 sc1
  s_sub_u32 s57, s57, 1
  s_cbranch_scc0 gc_141
  s_branch ABORT
gr_146:
  buffer_load_dwordx4 v[40:43], v4, s[8:11], s67 offen offset:3072 sc1
  s_sub_u32 s57, s57, 1
  s_cbranch_scc0 gc_142
  s_branch ABORT
LEADEND_ll_127:
  s_branch JR2
M_KQ:
  v_lshlrev_b32 v1, 4, v0
  v_lshrrev_b32 v8, 4, v0
  v_and_b32 v9, 15, v0
  v_lshlrev_b32 v10, 4, v9
  v_lshl_add_u32 v10, v8, 9, v10
  v_mov_b32 v20, v10
  v_add_u32 v21, 256, v10
  v_add_u32 v22, 0x10000, v20
  v_add_u32 v23, 0x10000, v21
  s_lshl_b32 s70, s54, 10
  v_add_u32 v2, s70, v1
  v_and_b32 v3, 31, v0
  v_min_u32 v3, s81, v3
  v_lshlrev_b32 v3, 4, v3
  v_lshrrev_b32 v24, 5, v0
  v_mul_u32_u24 v24, 64, v24
  v_add_u32 v3, v3, v24
  s_and_b32 s59, s56, 7
  s_lshl_b32 s59, s59, 2
  s_add_u32 s59, s59, s54
  s_mul_i32 s59, s59, 16
  v_add_u32 v24, s59, v0
  v_min_u32 v24, 511, v24
  v_lshlrev_b32 v24, 7, v24
  v_mov_b32 v25, 0x7ff00000
  v_mov_b32 v29, 0x7ff00000
  v_cmp_gt_u32 vcc, 16, v0
  s_nop 1
  v_cndmask_b32 v24, v25, v24, vcc
  v_mov_b32 v6, 0
  v_mov_b32 v5, 0x7ff00000
  v_cmp_eq_u32 vcc, 0, v0
  s_nop 1
  v_cndmask_b32 v5, v5, v6, vcc
  v_mov_b32 v6, 1
  s_lshl_b32 s59, s54, 11
  v_add_u32 v4, s59, v10
  s_mov_b32 s80, s64
  s_barrier
  s_branch gf_151
gl_149:
  s_mov_b32 s64, s80
  s_add_u32 s80, s64, 1
  ds_read_b128 v[88:91], v20 offset:6144
  s_waitcnt lgkmcnt(6)
  v_mfma_f32_16x16x32_bf16 v[32:35], a[0:3], v[64:67], 0
  v_mfma_f32_16x16x32_bf16 v[36:39], a[4:7], v[64:67], 0
  v_and_b32 v16, v16, v17
  v_and_b32 v18, v18, v19
  s_lshl_b32 s74, s80, 16
  s_add_u32 s74, s74, s66
  ds_read_b128 v[92:95], v21 offset:6144
  s_waitcnt lgkmcnt(6)
  v_mfma_f32_16x16x32_bf16 v[40:43], a[0:3], v[68:71], 0
  v_mfma_f32_16x16x32_bf16 v[44:47], a[4:7], v[68:71], 0
  v_and_b32 v16, v16, v18
  v_cmp_ne_u32 vcc, 1, v16
  s_cmp_lt_u32 s80, s65
  s_cselect_b32 vcc_lo, vcc_lo, -1
  s_cmp_eq_u32 vcc_lo, 0
  s_cselect_b32 s59, 0, 0x7ff00000
  v_add_u32 v7, s59, v2
  ds_read_b128 v[64:67], v20 offset:8192
  s_waitcnt lgkmcnt(6)
  v_mfma_f32_16x16x32_bf16 v[32:35], a[8:11], v[72:75], v[32:35]
  v_mfma_f32_16x16x32_bf16 v[36:39], a[12:15], v[72:75], v[36:39]
  s_add_u32 s59, s80, 1
  s_cmp_lt_u32 s59, s65
  s_cselect_b32 vcc_hi, vcc_hi, -1
  s_cmp_eq_u32 vcc_hi, 0
  s_cselect_b32 s59, 0, 0x7ff00000
  s_mov_b32 vcc_hi, 0
  v_add_u32 v25, s59, v24
  s_add_u32 m0, s70, 65536
  s_add_u32 s62, s74, 0
  buffer_load_dwordx4 v7, s[8:11], s62 offen sc1 lds
  ds_read_b128 v[68:71], v21 offset:8192
  s_waitcnt lgkmcnt(6)
  v_mfma_f32_16x16x32_bf16 v[40:43], a[8:11], v[76:79], v[40:43]
  v_mfma_f32_16x16x32_bf16 v[44:47], a[12:15], v[76:79], v[44:47]
  v_add_u32 v27, s73, v4
  v_add_u32 v28, s71, v5
  v_cvt_pk_bf16_f32 v96, v104, v105
  v_cvt_pk_bf16_f32 v97, v106, v107
  v_cvt_pk_bf16_f32 v98, v108, v109
  v_cvt_pk_bf16_f32 v99, v110, v111
  ds_read_b128 v[72:75], v20 offset:10240
  s_waitcnt lgkmcnt(6)
  v_mfma_f32_16x16x32_bf16 v[32:35], a[16:19], v[80:83], v[32:35]
  v_mfma_f32_16x16x32_bf16 v[36:39], a[20:23], v[80:83], v[36:39]
  v_cvt_pk_bf16_f32 v100, v112, v113
  v_cvt_pk_bf16_f32 v101, v114, v115
  v_cvt_pk_bf16_f32 v102, v116, v117
  v_cvt_pk_bf16_f32 v103, v118, v119
  ds_read_b128 v[76:79], v21 offset:10240
  s_waitcnt lgkmcnt(6)
  v_mfma_f32_16x16x32_bf16 v[40:43], a[16:19], v[84:87], v[40:43]
  v_mfma_f32_16x16x32_bf16 v[44:47], a[20:23], v[84:87], v[44:47]
  ds_read_b128 v[80:83], v20 offset:12288
  s_waitcnt lgkmcnt(6)
  v_mfma_f32_16x16x32_bf16 v[32:35], a[24:27], v[88:91], v[32:35]
  v_mfma_f32_16x16x32_bf16 v[36:39], a[28:31], v[88:91], v[36:39]
  s_add_u32 m0, s70, 69632
  s_add_u32 s62, s74, 4096
  buffer_load_dwordx4 v7, s[8:11], s62 offen sc1 lds
  ds_read_b128 v[84:87], v21 offset:12288
  s_waitcnt lgkmcnt(6)
  v_mfma_f32_16x16x32_bf16 v[40:43], a[24:27], v[92:95], v[40:43]
  v_mfma_f32_16x16x32_bf16 v[44:47], a[28:31], v[92:95], v[44:47]
  ds_read_b128 v[88:91], v20 offset:14336
  s_waitcnt lgkmcnt(6)
  v_mfma_f32_16x16x32_bf16 v[32:35], a[32:35], v[64:67], v[32:35]
  v_mfma_f32_16x16x32_bf16 v[36:39], a[36:39], v[64:67], v[36:39]
  s_lshl_b32 s61, s64, 18
  s_add_u32 s61, s61, s68
  s_sub_u32 s61, s61, 262144
  buffer_store_dwordx4 v[96:99], v27, s[8:11], s61 offen offset:0 sc1
  ds_read_b128 v[92:95], v21 offset:14336
  s_waitcnt lgkmcnt(6)
  v_mfma_f32_16x16x32_bf16 v[40:43], a[32:35], v[68:71], v[40:43]
  v_mfma_f32_16x16x32_bf16 v[44:47], a[36:39], v[68:71], v[44:47]
  s_waitcnt vmcnt(14)
  s_barrier
  ds_read_b128 v[64:67], v20 offset:16384
  s_waitcnt lgkmcnt(6)
  v_mfma_f32_16x16x32_bf16 v[32:35], a[40:43], v[72:75], v[32:35]
  v_mfma_f32_16x16x32_bf16 v[36:39], a[44:47], v[72:75], v[36:39]
  s_add_u32 m0, s70, 73728
  s_add_u32 s62, s74, 8192
  buffer_load_dwordx4 v7, s[8:11], s62 offen sc1 lds
  ds_read_b128 v[68:71], v21 offset:16384
  s_waitcnt lgkmcnt(6)
  v_mfma_f32_16x16x32_bf16 v[40:43], a[40:43], v[76:79], v[40:43]
  v_mfma_f32_16x16x32_bf16 v[44:47], a[44:47], v[76:79], v[44:47]
  ds_read_b128 v[72:75], v20 offset:18432
  s_waitcnt lgkmcnt(6)
  v_mfma_f32_16x16x32_bf16 v[32:35], a[48:51], v[80:83], v[32:35]
  v_mfma_f32_16x16x32_bf16 v[36:39], a[52:55], v[80:83], v[36:39]
  buffer_store_dwordx4 v[100:103], v27, s[8:11], s61 offen offset:256 sc1
  ds_read_b128 v[76:79], v21 offset:18432
  s_waitcnt lgkmcnt(6)
  v_mfma_f32_16x16x32_bf16 v[40:43], a[48:51], v[84:87], v[40:43]
  v_mfma_f32_16x16x32_bf16 v[44:47], a[52:55], v[84:87], v[44:47]
  ds_read_b128 v[80:83], v20 offset:20480
  s_waitcnt lgkmcnt(6)
  v_mfma_f32_16x16x32_bf16 v[32:35], a[56:59], v[88:91], v[32:35]
  v_mfma_f32_16x16x32_bf16 v[36:39], a[60:63], v[88:91], v[36:39]
  s_add_u32 m0, s70, 77824
  s_add_u32 s62, s74, 12288
  buffer_load_dwordx4 v7, s[8:11], s62 offen sc1 lds
  ds_read_b128 v[84:87], v21 offset:20480
  s_waitcnt lgkmcnt(6)
  v_mfma_f32_16x16x32_bf16 v[40:43], a[56:59], v[92:95], v[40:43]
  v_mfma_f32_16x16x32_bf16 v[44:47], a[60:63], v[92:95], v[44:47]
  ds_read_b128 v[88:91], v20 offset:22528
  s_waitcnt lgkmcnt(6)
  v_mfma_f32_16x16x32_bf16 v[32:35], a[64:67], v[64:67], v[32:35]
  v_mfma_f32_16x16x32_bf16 v[36:39], a[68:71], v[64:67], v[36:39]
  ds_read_b128 v[92:95], v21 offset:22528
  s_waitcnt lgkmcnt(6)
  v_mfma_f32_16x16x32_bf16 v[40:43], a[64:67], v[68:71], v[40:43]
  v_mfma_f32_16x16x32_bf16 v[44:47], a[68:71], v[68:71], v[44:47]
  ds_read_b128 v[64:67], v20 offset:24576
  s_waitcnt lgkmcnt(6)
  v_mfma_f32_16x16x32_bf16 v[32:35], a[72:75], v[72:75], v[32:35]
  v_mfma_f32_16x16x32_bf16 v[36:39], a[76:79], v[72:75], v[36:39]
  s_add_u32 m0, s70, 81920
  s_add_u32 s62, s74, 16384
  buffer_load_dwordx4 v7, s[8:11], s62 offen sc1 lds
  ds_read_b128 v[68:71], v21 offset:24576
  s_waitcnt lgkmcnt(6)
  v_mfma_f32_16x16x32_bf16 v[40:43], a[72:75], v[76:79], v[40:43]
  v_mfma_f32_16x16x32_bf16 v[44:47], a[76:79], v[76:79], v[44:47]
  ds_read_b128 v[72:75], v20 offset:26624
  s_waitcnt lgkmcnt(6)
  v_mfma_f32_16x16x32_bf16 v[32:35], a[80:83], v[80:83], v[32:35]
  v_mfma_f32_16x16x32_bf16 v[36:39], a[84:87], v[80:83], v[36:39]
  ds_read_b128 v[76:79], v21 offset:26624
  s_waitcnt lgkmcnt(6)
  v_mfma_f32_16x16x32_bf16 v[40:43], a[80:83], v[84:87], v[40:43]
  v_mfma_f32_16x16x32_bf16 v[44:47], a[84:87], v[84:87], v[44:47]
  ds_read_b128 v[80:83], v20 offset:28672
  s_waitcnt lgkmcnt(6)
  v_mfma_f32_16x16x32_bf16 v[32:35], a[88:91], v[88:91], v[32:35]
  v_mfma_f32_16x16x32_bf16 v[36:39], a[92:95], v[88:91], v[36:39]
  s_add_u32 m0, s70, 86016
  s_add_u32 s62, s74, 20480
  buffer_load_dwordx4 v7, s[8:11], s62 offen sc1 lds
  ds_read_b128 v[84:87], v21 offset:28672
  s_waitcnt lgkmcnt(6)
  v_mfma_f32_16x16x32_bf16 v[40:43], a[88:91], v[92:95], v[40:43]
  v_mfma_f32_16x16x32_bf16 v[44:47], a[92:95], v[92:95], v[44:47]
  ds_read_b128 v[88:91], v20 offset:30720
  s_waitcnt lgkmcnt(6)
  v_mfma_f32_16x16x32_bf16 v[32:35], a[96:99], v[64:67], v[32:35]
  v_mfma_f32_16x16x32_bf16 v[36:39], a[100:103], v[64:67], v[36:39]
  ds_read_b128 v[92:95], v21 offset:30720
  s_waitcnt lgkmcnt(6)
  v_mfma_f32_16x16x32_bf16 v[40:43], a[96:99], v[68:71], v[40:43]
  v_mfma_f32_16x16x32_bf16 v[44:47], a[100:103], v[68:71], v[44:47]
  s_waitcnt vmcnt(12)
  s_barrier
  ds_read_b128 v[64:67], v20 offset:32768
  s_waitcnt lgkmcnt(6)
  v_mfma_f32_16x16x32_bf16 v[32:35], a[104:107], v[72:75], v[32:35]
  v_mfma_f32_16x16x32_bf16 v[36:39], a[108:111], v[72:75], v[36:39]
  s_add_u32 m0, s70, 90112
  s_add_u32 s62, s74, 24576
  buffer_load_dwordx4 v7, s[8:11], s62 offen sc1 lds
  ds_read_b128 v[68:71], v21 offset:32768
  s_waitcnt lgkmcnt(6)
  v_mfma_f32_16x16x32_bf16 v[40:43], a[104:107], v[76:79], v[40:43]
  v_mfma_f32_16x16x32_bf16 v[44:47], a[108:111], v[76:79], v[44:47]
  ds_read_b128 v[72:75], v20 offset:34816
  s_waitcnt lgkmcnt(6)
  v_mfma_f32_16x16x32_bf16 v[32:35], a[112:115], v[80:83], v[32:35]
  v_mfma_f32_16x16x32_bf16 v[36:39], a[116:119], v[80:83], v[36:39]
  ds_read_b128 v[76:79], v21 offset:34816
  s_waitcnt lgkmcnt(6)
  v_mfma_f32_16x16x32_bf16 v[40:43], a[112:115], v[84:87], v[40:43]
  v_mfma_f32_16x16x32_bf16 v[44:47], a[116:119], v[84:87], v[44:47]
  ds_read_b128 v[80:83], v20 offset:36864
  s_waitcnt lgkmcnt(6)
  v_mfma_f32_16x16x32_bf16 v[32:35], a[120:123], v[88:91], v[32:35]
  v_mfma_f32_16x16x32_bf16 v[36:39], a[124:127], v[88:91], v[36:39]
  s_add_u32 m0, s70, 94208
  s_add_u32 s62, s74, 28672
  buffer_load_dwordx4 v7, s[8:11], s62 offen sc1 lds
  ds_read_b128 v[84:87], v21 offset:36864
  s_waitcnt lgkmcnt(6)
  v_mfma_f32_16x16x32_bf16 v[40:43], a[120:123], v[92:95], v[40:43]
  v_mfma_f32_16x16x32_bf16 v[44:47], a[124:127], v[92:95], v[44:47]
  ds_read_b128 v[88:91], v20 offset:38912
  s_waitcnt lgkmcnt(6)
  v_mfma_f32_16x16x32_bf16 v[32:35], a[128:131], v[64:67], v[32:35]
  v_mfma_f32_16x16x32_bf16 v[36:39], a[132:135], v[64:67], v[36:39]
  s_mul_i32 s60, s80, 64
  s_add_u32 s60, s60, s67
  s_add_u32 s60, s60, 64
  buffer_load_dwordx4 v[16:19], v3, s[8:11], s60 offen sc1
  ds_read_b128 v[92:95], v21 offset:38912
  s_waitcnt lgkmcnt(6)
  v_mfma_f32_16x16x32_bf16 v[40:43], a[128:131], v[68:71], v[40:43]
  v_mfma_f32_16x16x32_bf16 v[44:47], a[132:135], v[68:71], v[44:47]
  ds_read_b128 v[64:67], v20 offset:40960
  s_waitcnt lgkmcnt(6)
  v_mfma_f32_16x16x32_bf16 v[32:35], a[136:139], v[72:75], v[32:35]
  v_mfma_f32_16x16x32_bf16 v[36:39], a[140:143], v[72:75], v[36:39]
  s_add_u32 m0, s70, 98304
  s_add_u32 s62, s74, 32768
  buffer_load_dwordx4 v7, s[8:11], s62 offen sc1 lds
  ds_read_b128 v[68:71], v21 offset:40960
  s_waitcnt lgkmcnt(6)
  v_mfma_f32_16x16x32_bf16 v[40:43], a[136:139], v[76:79], v[40:43]
  v_mfma_f32_16x16x32_bf16 v[44:47], a[140:143], v[76:79], v[44:47]
  ds_read_b128 v[72:75], v20 offset:43008
  s_waitcnt lgkmcnt(6)
  v_mfma_f32_16x16x32_bf16 v[32:35], a[144:147], v[80:83], v[32:35]
  v_mfma_f32_16x16x32_bf16 v[36:39], a[148:151], v[80:83], v[36:39]
  s_add_u32 s59, s74, 65536
  buffer_load_dword v26, v25, s[8:11], s59 offen sc1
  ds_read_b128 v[76:79], v21 offset:43008
  s_waitcnt lgkmcnt(6)
  v_mfma_f32_16x16x32_bf16 v[40:43], a[144:147], v[84:87], v[40:43]
  v_mfma_f32_16x16x32_bf16 v[44:47], a[148:151], v[84:87], v[44:47]
  ds_read_b128 v[80:83], v20 offset:45056
  s_waitcnt lgkmcnt(6)
  v_mfma_f32_16x16x32_bf16 v[32:35], a[152:155], v[88:91], v[32:35]
  v_mfma_f32_16x16x32_bf16 v[36:39], a[156:159], v[88:91], v[36:39]
  s_add_u32 m0, s70, 102400
  s_add_u32 s62, s74, 36864
  buffer_load_dwordx4 v7, s[8:11], s62 offen sc1 lds
  ds_read_b128 v[84:87], v21 offset:45056
  s_waitcnt lgkmcnt(6)
  v_mfma_f32_16x16x32_bf16 v[40:43], a[152:155], v[92:95], v[40:43]
  v_mfma_f32_16x16x32_bf16 v[44:47], a[156:159], v[92:95], v[44:47]
  ds_read_b128 v[88:91], v20 offset:47104
  s_waitcnt lgkmcnt(6)
  v_mfma_f32_16x16x32_bf16 v[32:35], a[160:163], v[64:67], v[32:35]
  v_mfma_f32_16x16x32_bf16 v[36:39], a[164:167], v[64:67], v[36:39]
  ds_read_b128 v[92:95], v21 offset:47104
  s_waitcnt lgkmcnt(6)
  v_mfma_f32_16x16x32_bf16 v[40:43], a[160:163], v[68:71], v[40:43]
  v_mfma_f32_16x16x32_bf16 v[44:47], a[164:167], v[68:71], v[44:47]
  s_waitcnt vmcnt(14)
  s_barrier
  ds_read_b128 v[64:67], v20 offset:49152
  s_waitcnt lgkmcnt(6)
  v_mfma_f32_16x16x32_bf16 v[32:35], a[168:171], v[72:75], v[32:35]
  v_mfma_f32_16x16x32_bf16 v[36:39], a[172:175], v[72:75], v[36:39]
  s_add_u32 m0, s70, 106496
  s_add_u32 s62, s74, 40960
  buffer_load_dwordx4 v7, s[8:11], s62 offen sc1 lds
  ds_read_b128 v[68:71], v21 offset:49152
  s_waitcnt lgkmcnt(6)
  v_mfma_f32_16x16x32_bf16 v[40:43], a[168:171], v[76:79], v[40:43]
  v_mfma_f32_16x16x32_bf16 v[44:47], a[172:175], v[76:79], v[44:47]
  ds_read_b128 v[72:75], v20 offset:51200
  s_waitcnt lgkmcnt(6)
  v_mfma_f32_16x16x32_bf16 v[32:35], a[176:179], v[80:83], v[32:35]
  v_mfma_f32_16x16x32_bf16 v[36:39], a[180:183], v[80:83], v[36:39]
  s_waitcnt vmcnt(10)
  s_mul_i32 s76, s64, 1536
  s_add_u32 s76, s76, s69
  s_sub_u32 s76, s76, 1536
  buffer_store_dword v6, v28, s[8:11], s76 offen sc1
  ds_read_b128 v[76:79], v21 offset:51200
  s_waitcnt lgkmcnt(6)
  v_mfma_f32_16x16x32_bf16 v[40:43], a[176:179], v[84:87], v[40:43]
  v_mfma_f32_16x16x32_bf16 v[44:47], a[180:183], v[84:87], v[44:47]
  ds_read_b128 v[80:83], v20 offset:53248
  s_waitcnt lgkmcnt(6)
  v_mfma_f32_16x16x32_bf16 v[32:35], a[184:187], v[88:91], v[32:35]
  v_mfma_f32_16x16x32_bf16 v[36:39], a[188:191], v[88:91], v[36:39]
  s_add_u32 m0, s70, 110592
  s_add_u32 s62, s74, 45056
  buffer_load_dwordx4 v7, s[8:11], s62 offen sc1 lds
  ds_read_b128 v[84:87], v21 offset:53248
  s_waitcnt lgkmcnt(6)
  v_mfma_f32_16x16x32_bf16 v[40:43], a[184:187], v[92:95], v[40:43]
  v_mfma_f32_16x16x32_bf16 v[44:47], a[188:191], v[92:95], v[44:47]
  ds_read_b128 v[88:91], v20 offset:55296
  s_waitcnt lgkmcnt(6)
  v_mfma_f32_16x16x32_bf16 v[32:35], a[192:195], v[64:67], v[32:35]
  v_mfma_f32_16x16x32_bf16 v[36:39], a[196:199], v[64:67], v[36:39]
  ds_read_b128 v[92:95], v21 offset:55296
  s_waitcnt lgkmcnt(6)
  v_mfma_f32_16x16x32_bf16 v[40:43], a[192:195], v[68:71], v[40:43]
  v_mfma_f32_16x16x32_bf16 v[44:47], a[196:199], v[68:71], v[44:47]
  ds_read_b128 v[64:67], v20 offset:57344
  s_waitcnt lgkmcnt(6)
  v_mfma_f32_16x16x32_bf16 v[32:35], a[200:203], v[72:75], v[32:35]
  v_mfma_f32_16x16x32_bf16 v[36:39], a[204:207], v[72:75], v[36:39]
  s_add_u32 m0, s70, 114688
  s_add_u32 s62, s74, 49152
  buffer_load_dwordx4 v7, s[8:11], s62 offen sc1 lds
  ds_read_b128 v[68:71], v21 offset:57344
  s_waitcnt lgkmcnt(6)
  v_mfma_f32_16x16x32_bf16 v[40:43], a[200:203], v[76:79], v[40:43]
  v_mfma_f32_16x16x32_bf16 v[44:47], a[204:207], v[76:79], v[44:47]
  ds_read_b128 v[72:75], v20 offset:59392
  s_waitcnt lgkmcnt(6)
  v_mfma_f32_16x16x32_bf16 v[32:35], a[208:211], v[80:83], v[32:35]
  v_mfma_f32_16x16x32_bf16 v[36:39], a[212:215], v[80:83], v[36:39]
  ds_read_b128 v[76:79], v21 offset:59392
  s_waitcnt lgkmcnt(6)
  v_mfma_f32_16x16x32_bf16 v[40:43], a[208:211], v[84:87], v[40:43]
  v_mfma_f32_16x16x32_bf16 v[44:47], a[212:215], v[84:87], v[44:47]
  ds_read_b128 v[80:83], v20 offset:61440
  s_waitcnt lgkmcnt(6)
  v_mfma_f32_16x16x32_bf16 v[32:35], a[216:219], v[88:91], v[32:35]
  v_mfma_f32_16x16x32_bf16 v[36:39], a[220:223], v[88:91], v[36:39]
  s_add_u32 m0, s70, 118784
  s_add_u32 s62, s74, 53248
  buffer_load_dwordx4 v7, s[8:11], s62 offen sc1 lds
  ds_read_b128 v[84:87], v21 offset:61440
  s_waitcnt lgkmcnt(6)
  v_mfma_f32_16x16x32_bf16 v[40:43], a[216:219], v[92:95], v[40:43]
  v_mfma_f32_16x16x32_bf16 v[44:47], a[220:223], v[92:95], v[44:47]
  ds_read_b128 v[88:91], v20 offset:63488
  s_waitcnt lgkmcnt(6)
  v_mfma_f32_16x16x32_bf16 v[32:35], a[224:227], v[64:67], v[32:35]
  v_mfma_f32_16x16x32_bf16 v[36:39], a[228:231], v[64:67], v[36:39]
  ds_read_b128 v[92:95], v21 offset:63488
  s_waitcnt lgkmcnt(6)
  v_mfma_f32_16x16x32_bf16 v[40:43], a[224:227], v[68:71], v[40:43]
  v_mfma_f32_16x16x32_bf16 v[44:47], a[228:231], v[68:71], v[44:47]
  s_cbranch_vccnz gt_153
  s_waitcnt vmcnt(13)
  s_barrier
  ds_read_b128 v[64:67], v22 offset:0
  s_waitcnt lgkmcnt(6)
  v_mfma_f32_16x16x32_bf16 v[32:35], a[232:235], v[72:75], v[32:35]
  v_mfma_f32_16x16x32_bf16 v[36:39], a[236:239], v[72:75], v[36:39]
  s_add_u32 m0, s70, 122880
  s_add_u32 s62, s74, 57344
  buffer_load_dwordx4 v7, s[8:11], s62 offen sc1 lds
  ds_read_b128 v[68:71], v23 offset:0
  s_waitcnt lgkmcnt(6)
  v_mfma_f32_16x16x32_bf16 v[40:43], a[232:235], v[76:79], v[40:43]
  v_mfma_f32_16x16x32_bf16 v[44:47], a[236:239], v[76:79], v[44:47]
  ds_read_b128 v[72:75], v22 offset:2048
  s_waitcnt lgkmcnt(6)
  v_mfma_f32_16x16x32_bf16 v[32:35], a[240:243], v[80:83], v[32:35]
  v_mfma_f32_16x16x32_bf16 v[36:39], a[244:247], v[80:83], v[36:39]
  ds_read_b128 v[76:79], v23 offset:2048
  s_waitcnt lgkmcnt(6)
  v_mfma_f32_16x16x32_bf16 v[40:43], a[240:243], v[84:87], v[40:43]
  v_mfma_f32_16x16x32_bf16 v[44:47], a[244:247], v[84:87], v[44:47]
  ds_read_b128 v[80:83], v22 offset:4096
  s_waitcnt lgkmcnt(6)
  v_mfma_f32_16x16x32_bf16 v[32:35], a[248:251], v[88:91], v[32:35]
  v_mfma_f32_16x16x32_bf16 v[36:39], a[252:255], v[88:91], v[36:39]
  s_add_u32 m0, s70, 126976
  s_add_u32 s62, s74, 61440
  buffer_load_dwordx4 v7, s[8:11], s62 offen sc1 lds
  ds_read_b128 v[84:87], v23 offset:4096
  s_waitcnt lgkmcnt(6)
  v_mfma_f32_16x16x32_bf16 v[40:43], a[248:251], v[92:95], v[40:43]
  v_mfma_f32_16x16x32_bf16 v[44:47], a[252:255], v[92:95], v[44:47]
  s_mov_b32 s73, 0
  s_mov_b32 s71, 0
  s_waitcnt vmcnt(10)
gl_150:
  s_mov_b32 s64, s80
  s_add_u32 s80, s64, 1
  ds_read_b128 v[88:91], v22 offset:6144
  s_waitcnt lgkmcnt(6)
  v_mfma_f32_16x16x32_bf16 v[104:107], a[0:3], v[64:67], 0
  v_mfma_f32_16x16x32_bf16 v[108:111], a[4:7], v[64:67], 0
  v_and_b32 v16, v16, v17
  v_and_b32 v18, v18, v19
  s_lshl_b32 s74, s80, 16
  s_add_u32 s74, s74, s66
  ds_read_b128 v[92:95], v23 offset:6144
  s_waitcnt lgkmcnt(6)
  v_mfma_f32_16x16x32_bf16 v[112:115], a[0:3], v[68:71], 0
  v_mfma_f32_16x16x32_bf16 v[116:119], a[4:7], v[68:71], 0
  v_and_b32 v16, v16, v18
  v_cmp_ne_u32 vcc, 1, v16
  s_cmp_lt_u32 s80, s65
  s_cselect_b32 vcc_lo, vcc_lo, -1
  s_cmp_eq_u32 vcc_lo, 0
  s_cselect_b32 s59, 0, 0x7ff00000
  v_add_u32 v7, s59, v2
  ds_read_b128 v[64:67], v22 offset:8192
  s_waitcnt lgkmcnt(6)
  v_mfma_f32_16x16x32_bf16 v[104:107], a[8:11], v[72:75], v[104:107]
  v_mfma_f32_16x16x32_bf16 v[108:111], a[12:15], v[72:75], v[108:111]
  s_add_u32 s59, s80, 1
  s_cmp_lt_u32 s59, s65
  s_cselect_b32 vcc_hi, vcc_hi, -1
  s_cmp_eq_u32 vcc_hi, 0
  s_cselect_b32 s59, 0, 0x7ff00000
  s_mov_b32 vcc_hi, 0
  v_add_u32 v25, s59, v24
  s_add_u32 m0, s70, 0
  s_add_u32 s62, s74, 0
  buffer_load_dwordx4 v7, s[8:11], s62 offen sc1 lds
  ds_read_b128 v[68:71], v23 offset:8192
  s_waitcnt lgkmcnt(6)
  v_mfma_f32_16x16x32_bf16 v[112:115], a[8:11], v[76:79], v[112:115]
  v_mfma_f32_16x16x32_bf16 v[116:119], a[12:15], v[76:79], v[116:119]
  v_add_u32 v27, s73, v4
  v_add_u32 v28, s71, v5
  v_cvt_pk_bf16_f32 v96, v32, v33
  v_cvt_pk_bf16_f32 v97, v34, v35
  v_cvt_pk_bf16_f32 v98, v36, v37
  v_cvt_pk_bf16_f32 v99, v38, v39
  ds_read_b128 v[72:75], v22 offset:10240
  s_waitcnt lgkmcnt(6)
  v_mfma_f32_16x16x32_bf16 v[104:107], a[16:19], v[80:83], v[104:107]
  v_mfma_f32_16x16x32_bf16 v[108:111], a[20:23], v[80:83], v[108:111]
  v_cvt_pk_bf16_f32 v100, v40, v41
  v_cvt_pk_bf16_f32 v101, v42, v43
  v_cvt_pk_bf16_f32 v102, v44, v45
  v_cvt_pk_bf16_f32 v103, v46, v47
  ds_read_b128 v[76:79], v23 offset:10240
  s_waitcnt lgkmcnt(6)
  v_mfma_f32_16x16x32_bf16 v[112:115], a[16:19], v[84:87], v[112:115]
  v_mfma_f32_16x16x32_bf16 v[116:119], a[20:23], v[84:87], v[116:119]
  ds_read_b128 v[80:83], v22 offset:12288
  s_waitcnt lgkmcnt(6)
  v_mfma_f32_16x16x32_bf16 v[104:107], a[24:27], v[88:91], v[104:107]
  v_mfma_f32_16x16x32_bf16 v[108:111], a[28:31], v[88:91], v[108:111]
  s_add_u32 m0, s70, 4096
  s_add_u32 s62, s74, 4096
  buffer_load_dwordx4 v7, s[8:11], s62 offen sc1 lds
  ds_read_b128 v[84:87], v23 offset:12288
  s_waitcnt lgkmcnt(6)
  v_mfma_f32_16x16x32_bf16 v[112:115], a[24:27], v[92:95], v[112:115]
  v_mfma_f32_16x16x32_bf16 v[116:119], a[28:31], v[92:95], v[116:119]
  ds_read_b128 v[88:91], v22 offset:14336
  s_waitcnt lgkmcnt(6)
  v_mfma_f32_16x16x32_bf16 v[104:107], a[32:35], v[64:67], v[104:107]
  v_mfma_f32_16x16x32_bf16 v[108:111], a[36:39], v[64:67], v[108:111]
  s_lshl_b32 s61, s64, 18
  s_add_u32 s61, s61, s68
  s_sub_u32 s61, s61, 262144
  buffer_store_dwordx4 v[96:99], v27, s[8:11], s61 offen offset:0 sc1
  ds_read_b128 v[92:95], v23 offset:14336
  s_waitcnt lgkmcnt(6)
  v_mfma_f32_16x16x32_bf16 v[112:115], a[32:35], v[68:71], v[112:115]
  v_mfma_f32_16x16x32_bf16 v[116:119], a[36:39], v[68:71], v[116:119]
  s_waitcnt vmcnt(14)
  s_barrier
  ds_read_b128 v[64:67], v22 offset:16384
  s_waitcnt lgkmcnt(6)
  v_mfma_f32_16x16x32_bf16 v[104:107], a[40:43], v[72:75], v[104:107]
  v_mfma_f32_16x16x32_bf16 v[108:111], a[44:47], v[72:75], v[108:111]
  s_add_u32 m0, s70, 8192
  s_add_u32 s62, s74, 8192
  buffer_load_dwordx4 v7, s[8:11], s62 offen sc1 lds
  ds_read_b128 v[68:71], v23 offset:16384
  s_waitcnt lgkmcnt(6)
  v_mfma_f32_16x16x32_bf16 v[112:115], a[40:43], v[76:79], v[112:115]
  v_mfma_f32_16x16x32_bf16 v[116:119], a[44:47], v[76:79], v[116:119]
  ds_read_b128 v[72:75], v22 offset:18432
  s_waitcnt lgkmcnt(6)
  v_mfma_f32_16x16x32_bf16 v[104:107], a[48:51], v[80:83], v[104:107]
  v_mfma_f32_16x16x32_bf16 v[108:111], a[52:55], v[80:83], v[108:111]
  buffer_store_dwordx4 v[100:103], v27, s[8:11], s61 offen offset:256 sc1
  ds_read_b128 v[76:79], v23 offset:18432
  s_waitcnt lgkmcnt(6)
  v_mfma_f32_16x16x32_bf16 v[112:115], a[48:51], v[84:87], v[112:115]
  v_mfma_f32_16x16x32_bf16 v[116:119], a[52:55], v[84:87], v[116:119]
  ds_read_b128 v[80:83], v22 offset:20480
  s_waitcnt lgkmcnt(6)
  v_mfma_f32_16x16x32_bf16 v[104:107], a[56:59], v[88:91], v[104:107]
  v_mfma_f32_16x16x32_bf16 v[108:111], a[60:63], v[88:91], v[108:111]
  s_add_u32 m0, s70, 12288
  s_add_u32 s62, s74, 12288
  buffer_load_dwordx4 v7, s[8:11], s62 offen sc1 lds
  ds_read_b128 v[84:87], v23 offset:20480
  s_waitcnt lgkmcnt(6)
  v_mfma_f32_16x16x32_bf16 v[112:115], a[56:59], v[92:95], v[112:115]
  v_mfma_f32_16x16x32_bf16 v[116:119], a[60:63], v[92:95], v[116:119]
  ds_read_b128 v[88:91], v22 offset:22528
  s_waitcnt lgkmcnt(6)
  v_mfma_f32_16x16x32_bf16 v[104:107], a[64:67], v[64:67], v[104:107]
  v_mfma_f32_16x16x32_bf16 v[108:111], a[68:71], v[64:67], v[108:111]
  ds_read_b128 v[92:95], v23 offset:22528
  s_waitcnt lgkmcnt(6)
  v_mfma_f32_16x16x32_bf16 v[112:115], a[64:67], v[68:71], v[112:115]
  v_mfma_f32_16x16x32_bf16 v[116:119], a[68:71], v[68:71], v[116:119]
  ds_read_b128 v[64:67], v22 offset:24576
  s_waitcnt lgkmcnt(6)
  v_mfma_f32_16x16x32_bf16 v[104:107], a[72:75], v[72:75], v[104:107]
  v_mfma_f32_16x16x32_bf16 v[108:111], a[76:79], v[72:75], v[108:111]
  s_add_u32 m0, s70, 16384
  s_add_u32 s62, s74, 16384
  buffer_load_dwordx4 v7, s[8:11], s62 offen sc1 lds
  ds_read_b128 v[68:71], v23 offset:24576
  s_waitcnt lgkmcnt(6)
  v_mfma_f32_16x16x32_bf16 v[112:115], a[72:75], v[76:79], v[112:115]
  v_mfma_f32_16x16x32_bf16 v[116:119], a[76:79], v[76:79], v[116:119]
  ds_read_b128 v[72:75], v22 offset:26624
  s_waitcnt lgkmcnt(6)
  v_mfma_f32_16x16x32_bf16 v[104:107], a[80:83], v[80:83], v[104:107]
  v_mfma_f32_16x16x32_bf16 v[108:111], a[84:87], v[80:83], v[108:111]
  ds_read_b128 v[76:79], v23 offset:26624
  s_waitcnt lgkmcnt(6)
  v_mfma_f32_16x16x32_bf16 v[112:115], a[80:83], v[84:87], v[112:115]
  v_mfma_f32_16x16x32_bf16 v[116:119], a[84:87], v[84:87], v[116:119]
  ds_read_b128 v[80:83], v22 offset:28672
  s_waitcnt lgkmcnt(6)
  v_mfma_f32_16x16x32_bf16 v[104:107], a[88:91], v[88:91], v[104:107]
  v_mfma_f32_16x16x32_bf16 v[108:111], a[92:95], v[88:91], v[108:111]
  s_add_u32 m0, s70, 20480
  s_add_u32 s62, s74, 20480
  buffer_load_dwordx4 v7, s[8:11], s62 offen sc1 lds
  ds_read_b128 v[84:87], v23 offset:28672
  s_waitcnt lgkmcnt(6)
  v_mfma_f32_16x16x32_bf16 v[112:115], a[88:91], v[92:95], v[112:115]
  v_mfma_f32_16x16x32_bf16 v[116:119], a[92:95], v[92:95], v[116:119]
  ds_read_b128 v[88:91], v22 offset:30720
  s_waitcnt lgkmcnt(6)
  v_mfma_f32_16x16x32_bf16 v[104:107], a[96:99], v[64:67], v[104:107]
  v_mfma_f32_16x16x32_bf16 v[108:111], a[100:103], v[64:67], v[108:111]
  ds_read_b128 v[92:95], v23 offset:30720
  s_waitcnt lgkmcnt(6)
  v_mfma_f32_16x16x32_bf16 v[112:115], a[96:99], v[68:71], v[112:115]
  v_mfma_f32_16x16x32_bf16 v[116:119], a[100:103], v[68:71], v[116:119]
  s_waitcnt vmcnt(12)
  s_barrier
  ds_read_b128 v[64:67], v22 offset:32768
  s_waitcnt lgkmcnt(6)
  v_mfma_f32_16x16x32_bf16 v[104:107], a[104:107], v[72:75], v[104:107]
  v_mfma_f32_16x16x32_bf16 v[108:111], a[108:111], v[72:75], v[108:111]
  s_add_u32 m0, s70, 24576
  s_add_u32 s62, s74, 24576
  buffer_load_dwordx4 v7, s[8:11], s62 offen sc1 lds
  ds_read_b128 v[68:71], v23 offset:32768
  s_waitcnt lgkmcnt(6)
  v_mfma_f32_16x16x32_bf16 v[112:115], a[104:107], v[76:79], v[112:115]
  v_mfma_f32_16x16x32_bf16 v[116:119], a[108:111], v[76:79], v[116:119]
  ds_read_b128 v[72:75], v22 offset:34816
  s_waitcnt lgkmcnt(6)
  v_mfma_f32_16x16x32_bf16 v[104:107], a[112:115], v[80:83], v[104:107]
  v_mfma_f32_16x16x32_bf16 v[108:111], a[116:119], v[80:83], v[108:111]
  ds_read_b128 v[76:79], v23 offset:34816
  s_waitcnt lgkmcnt(6)
  v_mfma_f32_16x16x32_bf16 v[112:115], a[112:115], v[84:87], v[112:115]
  v_mfma_f32_16x16x32_bf16 v[116:119], a[116:119], v[84:87], v[116:119]
  ds_read_b128 v[80:83], v22 offset:36864
  s_waitcnt lgkmcnt(6)
  v_mfma_f32_16x16x32_bf16 v[104:107], a[120:123], v[88:91], v[104:107]
  v_mfma_f32_16x16x32_bf16 v[108:111], a[124:127], v[88:91], v[108:111]
  s_add_u32 m0, s70, 28672
  s_add_u32 s62, s74, 28672
  buffer_load_dwordx4 v7, s[8:11], s62 offen sc1 lds
  ds_read_b128 v[84:87], v23 offset:36864
  s_waitcnt lgkmcnt(6)
  v_mfma_f32_16x16x32_bf16 v[112:115], a[120:123], v[92:95], v[112:115]
  v_mfma_f32_16x16x32_bf16 v[116:119], a[124:127], v[92:95], v[116:119]
  ds_read_b128 v[88:91], v22 offset:38912
  s_waitcnt lgkmcnt(6)
  v_mfma_f32_16x16x32_bf16 v[104:107], a[128:131], v[64:67], v[104:107]
  v_mfma_f32_16x16x32_bf16 v[108:111], a[132:135], v[64:67], v[108:111]
  s_mul_i32 s60, s80, 64
  s_add_u32 s60, s60, s67
  s_add_u32 s60, s60, 64
  buffer_load_dwordx4 v[16:19], v3, s[8:11], s60 offen sc1
  ds_read_b128 v[92:95], v23 offset:38912
  s_waitcnt lgkmcnt(6)
  v_mfma_f32_16x16x32_bf16 v[112:115], a[128:131], v[68:71], v[112:115]
  v_mfma_f32_16x16x32_bf16 v[116:119], a[132:135], v[68:71], v[116:119]
  ds_read_b128 v[64:67], v22 offset:40960
  s_waitcnt lgkmcnt(6)
  v_mfma_f32_16x16x32_bf16 v[104:107], a[136:139], v[72:75], v[104:107]
  v_mfma_f32_16x16x32_bf16 v[108:111], a[140:143], v[72:75], v[108:111]
  s_add_u32 m0, s70, 32768
  s_add_u32 s62, s74, 32768
  buffer_load_dwordx4 v7, s[8:11], s62 offen sc1 lds
  ds_read_b128 v[68:71], v23 offset:40960
  s_waitcnt lgkmcnt(6)
  v_mfma_f32_16x16x32_bf16 v[112:115], a[136:139], v[76:79], v[112:115]
  v_mfma_f32_16x16x32_bf16 v[116:119], a[140:143], v[76:79], v[116:119]
  ds_read_b128 v[72:75], v22 offset:43008
  s_waitcnt lgkmcnt(6)
  v_mfma_f32_16x16x32_bf16 v[104:107], a[144:147], v[80:83], v[104:107]
  v_mfma_f32_16x16x32_bf16 v[108:111], a[148:151], v[80:83], v[108:111]
  s_add_u32 s59, s74, 65536
  buffer_load_dword v26, v25, s[8:11], s59 offen sc1
  ds_read_b128 v[76:79], v23 offset:43008
  s_waitcnt lgkmcnt(6)
  v_mfma_f32_16x16x32_bf16 v[112:115], a[144:147], v[84:87], v[112:115]
  v_mfma_f32_16x16x32_bf16 v[116:119], a[148:151], v[84:87], v[116:119]
  ds_read_b128 v[80:83], v22 offset:45056
  s_waitcnt lgkmcnt(6)
  v_mfma_f32_16x16x32_bf16 v[104:107], a[152:155], v[88:91], v[104:107]
  v_mfma_f32_16x16x32_bf16 v[108:111], a[156:159], v[88:91], v[108:111]
  s_add_u32 m0, s70, 36864
  s_add_u32 s62, s74, 36864
  buffer_load_dwordx4 v7, s[8:11], s62 offen sc1 lds
  ds_read_b128 v[84:87], v23 offset:45056
  s_waitcnt lgkmcnt(6)
  v_mfma_f32_16x16x32_bf16 v[112:115], a[152:155], v[92:95], v[112:115]
  v_mfma_f32_16x16x32_bf16 v[116:119], a[156:159], v[92:95], v[116:119]
  ds_read_b128 v[88:91], v22 offset:47104
  s_waitcnt lgkmcnt(6)
  v_mfma_f32_16x16x32_bf16 v[104:107], a[160:163], v[64:67], v[104:107]
  v_mfma_f32_16x16x32_bf16 v[108:111], a[164:167], v[64:67], v[108:111]
  ds_read_b128 v[92:95], v23 offset:47104
  s_waitcnt lgkmcnt(6)
  v_mfma_f32_16x16x32_bf16 v[112:115], a[160:163], v[68:71], v[112:115]
  v_mfma_f32_16x16x32_bf16 v[116:119], a[164:167], v[68:71], v[116:119]
  s_waitcnt vmcnt(14)
  s_barrier
  ds_read_b128 v[64:67], v22 offset:49152
  s_waitcnt lgkmcnt(6)
  v_mfma_f32_16x16x32_bf16 v[104:107], a[168:171], v[72:75], v[104:107]
  v_mfma_f32_16x16x32_bf16 v[108:111], a[172:175], v[72:75], v[108:111]
  s_add_u32 m0, s70, 40960
  s_add_u32 s62, s74, 40960
  buffer_load_dwordx4 v7, s[8:11], s62 offen sc1 lds
  ds_read_b128 v[68:71], v23 offset:49152
  s_waitcnt lgkmcnt(6)
  v_mfma_f32_16x16x32_bf16 v[112:115], a[168:171], v[76:79], v[112:115]
  v_mfma_f32_16x16x32_bf16 v[116:119], a[172:175], v[76:79], v[116:119]
  ds_read_b128 v[72:75], v22 offset:51200
  s_waitcnt lgkmcnt(6)
  v_mfma_f32_16x16x32_bf16 v[104:107], a[176:179], v[80:83], v[104:107]
  v_mfma_f32_16x16x32_bf16 v[108:111], a[180:183], v[80:83], v[108:111]
  s_waitcnt vmcnt(10)
  s_mul_i32 s76, s64, 1536
  s_add_u32 s76, s76, s69
  s_sub_u32 s76, s76, 1536
  buffer_store_dword v6, v28, s[8:11], s76 offen sc1
  ds_read_b128 v[76:79], v23 offset:51200
  s_waitcnt lgkmcnt(6)
  v_mfma_f32_16x16x32_bf16 v[112:115], a[176:179], v[84:87], v[112:115]
  v_mfma_f32_16x16x32_bf16 v[116:119], a[180:183], v[84:87], v[116:119]
  ds_read_b128 v[80:83], v22 offset:53248
  s_waitcnt lgkmcnt(6)
  v_mfma_f32_16x16x32_bf16 v[104:107], a[184:187], v[88:91], v[104:107]
  v_mfma_f32_16x16x32_bf16 v[108:111], a[188:191], v[88:91], v[108:111]
  s_add_u32 m0, s70, 45056
  s_add_u32 s62, s74, 45056
  buffer_load_dwordx4 v7, s[8:11], s62 offen sc1 lds
  ds_read_b128 v[84:87], v23 offset:53248
  s_waitcnt lgkmcnt(6)
  v_mfma_f32_16x16x32_bf16 v[112:115], a[184:187], v[92:95], v[112:115]
  v_mfma_f32_16x16x32_bf16 v[116:119], a[188:191], v[92:95], v[116:119]
  ds_read_b128 v[88:91], v22 offset:55296
  s_waitcnt lgkmcnt(6)
  v_mfma_f32_16x16x32_bf16 v[104:107], a[192:195], v[64:67], v[104:107]
  v_mfma_f32_16x16x32_bf16 v[108:111], a[196:199], v[64:67], v[108:111]
  ds_read_b128 v[92:95], v23 offset:55296
  s_waitcnt lgkmcnt(6)
  v_mfma_f32_16x16x32_bf16 v[112:115], a[192:195], v[68:71], v[112:115]
  v_mfma_f32_16x16x32_bf16 v[116:119], a[196:199], v[68:71], v[116:119]
  ds_read_b128 v[64:67], v22 offset:57344
  s_waitcnt lgkmcnt(6)
  v_mfma_f32_16x16x32_bf16 v[104:107], a[200:203], v[72:75], v[104:107]
  v_mfma_f32_16x16x32_bf16 v[108:111], a[204:207], v[72:75], v[108:111]
  s_add_u32 m0, s70, 49152
  s_add_u32 s62, s74, 49152
  buffer_load_dwordx4 v7, s[8:11], s62 offen sc1 lds
  ds_read_b128 v[68:71], v23 offset:57344
  s_waitcnt lgkmcnt(6)
  v_mfma_f32_16x16x32_bf16 v[112:115], a[200:203], v[76:79], v[112:115]
  v_mfma_f32_16x16x32_bf16 v[116:119], a[204:207], v[76:79], v[116:119]
  ds_read_b128 v[72:75], v22 offset:59392
  s_waitcnt lgkmcnt(6)
  v_mfma_f32_16x16x32_bf16 v[104:107], a[208:211], v[80:83], v[104:107]
  v_mfma_f32_16x16x32_bf16 v[108:111], a[212:215], v[80:83], v[108:111]
  ds_read_b128 v[76:79], v23 offset:59392
  s_waitcnt lgkmcnt(6)
  v_mfma_f32_16x16x32_bf16 v[112:115], a[208:211], v[84:87], v[112:115]
  v_mfma_f32_16x16x32_bf16 v[116:119], a[212:215], v[84:87], v[116:119]
  ds_read_b128 v[80:83], v22 offset:61440
  s_waitcnt lgkmcnt(6)
  v_mfma_f32_16x16x32_bf16 v[104:107], a[216:219], v[88:91], v[104:107]
  v_mfma_f32_16x16x32_bf16 v[108:111], a[220:223], v[88:91], v[108:111]
  s_add_u32 m0, s70, 53248
  s_add_u32 s62, s74, 53248
  buffer_load_dwordx4 v7, s[8:11], s62 offen sc1 lds
  ds_read_b128 v[84:87], v23 offset:61440
  s_waitcnt lgkmcnt(6)
  v_mfma_f32_16x16x32_bf16 v[112:115], a[216:219], v[92:95], v[112:115]
  v_mfma_f32_16x16x32_bf16 v[116:119], a[220:223], v[92:95], v[116:119]
  ds_read_b128 v[88:91], v22 offset:63488
  s_waitcnt lgkmcnt(6)
  v_mfma_f32_16x16x32_bf16 v[104:107], a[224:227], v[64:67], v[104:107]
  v_mfma_f32_16x16x32_bf16 v[108:111], a[228:231], v[64:67], v[108:111]
  ds_read_b128 v[92:95], v23 offset:63488
  s_waitcnt lgkmcnt(6)
  v_mfma_f32_16x16x32_bf16 v[112:115], a[224:227], v[68:71], v[112:115]
  v_mfma_f32_16x16x32_bf16 v[116:119], a[228:231], v[68:71], v[116:119]
  s_cbranch_vccnz gt_154
  s_waitcnt vmcnt(13)
  s_barrier
  ds_read_b128 v[64:67], v20 offset:0
  s_waitcnt lgkmcnt(6)
  v_mfma_f32_16x16x32_bf16 v[104:107], a[232:235], v[72:75], v[104:107]
  v_mfma_f32_16x16x32_bf16 v[108:111], a[236:239], v[72:75], v[108:111]
  s_add_u32 m0, s70, 57344
  s_add_u32 s62, s74, 57344
  buffer_load_dwordx4 v7, s[8:11], s62 offen sc1 lds
  ds_read_b128 v[68:71], v21 offset:0
  s_waitcnt lgkmcnt(6)
  v_mfma_f32_16x16x32_bf16 v[112:115], a[232:235], v[76:79], v[112:115]
  v_mfma_f32_16x16x32_bf16 v[116:119], a[236:239], v[76:79], v[116:119]
  ds_read_b128 v[72:75], v20 offset:2048
  s_waitcnt lgkmcnt(6)
  v_mfma_f32_16x16x32_bf16 v[104:107], a[240:243], v[80:83], v[104:107]
  v_mfma_f32_16x16x32_bf16 v[108:111], a[244:247], v[80:83], v[108:111]
  ds_read_b128 v[76:79], v21 offset:2048
  s_waitcnt lgkmcnt(6)
  v_mfma_f32_16x16x32_bf16 v[112:115], a[240:243], v[84:87], v[112:115]
  v_mfma_f32_16x16x32_bf16 v[116:119], a[244:247], v[84:87], v[116:119]
  ds_read_b128 v[80:83], v20 offset:4096
  s_waitcnt lgkmcnt(6)
  v_mfma_f32_16x16x32_bf16 v[104:107], a[248:251], v[88:91], v[104:107]
  v_mfma_f32_16x16x32_bf16 v[108:111], a[252:255], v[88:91], v[108:111]
  s_add_u32 m0, s70, 61440
  s_add_u32 s62, s74, 61440
  buffer_load_dwordx4 v7, s[8:11], s62 offen sc1 lds
  ds_read_b128 v[84:87], v21 offset:4096
  s_waitcnt lgkmcnt(6)
  v_mfma_f32_16x16x32_bf16 v[112:115], a[248:251], v[92:95], v[112:115]
  v_mfma_f32_16x16x32_bf16 v[116:119], a[252:255], v[92:95], v[116:119]
  s_mov_b32 s73, 0
  s_mov_b32 s71, 0
  s_waitcnt vmcnt(10)
  s_branch gl_149
gt_153:
  s_mul_i32 s60, s80, 64
  s_add_u32 s60, s60, s67
  buffer_load_dwordx4 v[16:19], v3, s[8:11], s60 offen sc1
  s_waitcnt lgkmcnt(5)
  v_mfma_f32_16x16x32_bf16 v[32:35], a[232:235], v[72:75], v[32:35]
  v_mfma_f32_16x16x32_bf16 v[36:39], a[236:239], v[72:75], v[36:39]
  s_waitcnt lgkmcnt(4)
  v_mfma_f32_16x16x32_bf16 v[40:43], a[232:235], v[76:79], v[40:43]
  v_mfma_f32_16x16x32_bf16 v[44:47], a[236:239], v[76:79], v[44:47]
  s_waitcnt lgkmcnt(3)
  v_mfma_f32_16x16x32_bf16 v[32:35], a[240:243], v[80:83], v[32:35]
  v_mfma_f32_16x16x32_bf16 v[36:39], a[244:247], v[80:83], v[36:39]
  s_waitcnt lgkmcnt(2)
  v_mfma_f32_16x16x32_bf16 v[40:43], a[240:243], v[84:87], v[40:43]
  v_mfma_f32_16x16x32_bf16 v[44:47], a[244:247], v[84:87], v[44:47]
  s_waitcnt lgkmcnt(1)
  v_mfma_f32_16x16x32_bf16 v[32:35], a[248:251], v[88:91], v[32:35]
  v_mfma_f32_16x16x32_bf16 v[36:39], a[252:255], v[88:91], v[36:39]
  s_waitcnt lgkmcnt(0)
  v_mfma_f32_16x16x32_bf16 v[40:43], a[248:251], v[92:95], v[40:43]
  v_mfma_f32_16x16x32_bf16 v[44:47], a[252:255], v[92:95], v[44:47]
  s_nop 3
  v_cvt_pk_bf16_f32 v96, v32, v33
  v_cvt_pk_bf16_f32 v97, v34, v35
  v_cvt_pk_bf16_f32 v98, v36, v37
  v_cvt_pk_bf16_f32 v99, v38, v39
  v_cvt_pk_bf16_f32 v100, v40, v41
  v_cvt_pk_bf16_f32 v101, v42, v43
  v_cvt_pk_bf16_f32 v102, v44, v45
  v_cvt_pk_bf16_f32 v103, v46, v47
  s_lshl_b32 s61, s64, 18
  s_add_u32 s61, s61, s68
  buffer_store_dwordx4 v[96:99], v4, s[8:11], s61 offen offset:0 sc1
  buffer_store_dwordx4 v[100:103], v4, s[8:11], s61 offen offset:256 sc1
  v_mov_b32 v28, v5
  s_cmp_lt_u32 s80, s65
  s_cbranch_scc0 gl_149_y
  s_waitcnt vmcnt(2)
  v_and_b32 v16, v16, v17
  v_and_b32 v18, v18, v19
  v_and_b32 v16, v16, v18
  v_cmp_ne_u32 vcc, 1, v16
  s_nop 0
  s_cmp_eq_u32 vcc_lo, 0
  s_cbranch_scc1 fs_155
  buffer_load_dwordx4 v[16:19], v3, s[8:11], s60 offen sc1
  s_waitcnt vmcnt(1)
  s_mul_i32 s76, s64, 1536
  s_add_u32 s76, s76, s69
  buffer_store_dword v6, v5, s[8:11], s76 offen sc1
  s_waitcnt vmcnt(1)
  v_and_b32 v16, v16, v17
  v_and_b32 v18, v18, v19
  v_and_b32 v16, v16, v18
  v_cmp_ne_u32 vcc, 1, v16
  s_nop 0
  s_cmp_eq_u32 vcc_lo, 0
  s_cbranch_scc1 fq_156
gf_152:
  s_mul_i32 s60, s80, 64
  s_add_u32 s60, s60, s67
pl_157:
  buffer_load_dwordx4 v[16:19], v3, s[8:11], s60 offen sc1
  s_waitcnt vmcnt(0)
  v_and_b32 v16, v16, v17
  v_and_b32 v18, v18, v19
  v_and_b32 v16, v16, v18
  v_cmp_ne_u32 vcc, 1, v16
  s_nop 0
  s_cmp_eq_u32 vcc_lo, 0
  s_cbranch_scc1 pk_158
  s_sub_u32 s57, s57, 1
  s_cbranch_scc0 pl_157
  s_branch ABORT
pk_158:
fq_156:
  v_mov_b32 v28, v29
fs_155:
  s_lshl_b32 s74, s80, 16
  s_add_u32 s74, s74, s66
  s_add_u32 s60, s60, 64
  buffer_load_dwordx4 v[16:19], v3, s[8:11], s60 offen sc1
  s_add_u32 m0, s70, 65536
  s_add_u32 s62, s74, 0
  buffer_load_dwordx4 v2, s[8:11], s62 offen sc1 lds
  s_add_u32 m0, s70, 69632
  s_add_u32 s62, s74, 4096
  buffer_load_dwordx4 v2, s[8:11], s62 offen sc1 lds
  s_add_u32 m0, s70, 73728
  s_add_u32 s62, s74, 8192
  buffer_load_dwordx4 v2, s[8:11], s62 offen sc1 lds
  s_add_u32 m0, s70, 77824
  s_add_u32 s62, s74, 12288
  buffer_load_dwordx4 v2, s[8:11], s62 offen sc1 lds
  s_add_u32 m0, s70, 81920
  s_add_u32 s62, s74, 16384
  buffer_load_dwordx4 v2, s[8:11], s62 offen sc1 lds
  s_add_u32 m0, s70, 86016
  s_add_u32 s62, s74, 20480
  buffer_load_dwordx4 v2, s[8:11], s62 offen sc1 lds
  s_add_u32 m0, s70, 90112
  s_add_u32 s62, s74, 24576
  buffer_load_dwordx4 v2, s[8:11], s62 offen sc1 lds
  s_add_u32 m0, s70, 94208
  s_add_u32 s62, s74, 28672
  buffer_load_dwordx4 v2, s[8:11], s62 offen sc1 lds
  buffer_load_dword v26, v29, s[8:11], 0 offen
  s_add_u32 m0, s70, 98304
  s_add_u32 s62, s74, 32768
  buffer_load_dwordx4 v2, s[8:11], s62 offen sc1 lds
  buffer_load_dword v26, v29, s[8:11], 0 offen
  s_add_u32 m0, s70, 102400
  s_add_u32 s62, s74, 36864
  buffer_load_dwordx4 v2, s[8:11], s62 offen sc1 lds
  s_add_u32 m0, s70, 106496
  s_add_u32 s62, s74, 40960
  buffer_load_dwordx4 v2, s[8:11], s62 offen sc1 lds
  s_add_u32 m0, s70, 110592
  s_add_u32 s62, s74, 45056
  buffer_load_dwordx4 v2, s[8:11], s62 offen sc1 lds
  s_add_u32 m0, s70, 114688
  s_add_u32 s62, s74, 49152
  buffer_load_dwordx4 v2, s[8:11], s62 offen sc1 lds
  s_add_u32 m0, s70, 118784
  s_add_u32 s62, s74, 53248
  buffer_load_dwordx4 v2, s[8:11], s62 offen sc1 lds
  s_add_u32 m0, s70, 122880
  s_add_u32 s62, s74, 57344
  buffer_load_dwordx4 v2, s[8:11], s62 offen sc1 lds
  s_add_u32 m0, s70, 126976
  s_add_u32 s62, s74, 61440
  buffer_load_dwordx4 v2, s[8:11], s62 offen sc1 lds
  s_mov_b32 s73, 0x7ff00000
  s_mov_b32 s71, 0x7ff00000
  s_waitcnt vmcnt(14)
  s_mul_i32 s76, s64, 1536
  s_add_u32 s76, s76, s69
  buffer_store_dword v6, v28, s[8:11], s76 offen sc1
  s_barrier
  ds_read_b128 v[64:67], v22 offset:0
  ds_read_b128 v[68:71], v23 offset:0
  ds_read_b128 v[72:75], v22 offset:2048
  ds_read_b128 v[76:79], v23 offset:2048
  ds_read_b128 v[80:83], v22 offset:4096
  ds_read_b128 v[84:87], v23 offset:4096
  s_branch gl_150
gt_154:
  s_mul_i32 s60, s80, 64
  s_add_u32 s60, s60, s67
  buffer_load_dwordx4 v[16:19], v3, s[8:11], s60 offen sc1
  s_waitcnt lgkmcnt(5)
  v_mfma_f32_16x16x32_bf16 v[104:107], a[232:235], v[72:75], v[104:107]
  v_mfma_f32_16x16x32_bf16 v[108:111], a[236:239], v[72:75], v[108:111]
  s_waitcnt lgkmcnt(4)
  v_mfma_f32_16x16x32_bf16 v[112:115], a[232:235], v[76:79], v[112:115]
  v_mfma_f32_16x16x32_bf16 v[116:119], a[236:239], v[76:79], v[116:119]
  s_waitcnt lgkmcnt(3)
  v_mfma_f32_16x16x32_bf16 v[104:107], a[240:243], v[80:83], v[104:107]
  v_mfma_f32_16x16x32_bf16 v[108:111], a[244:247], v[80:83], v[108:111]
  s_waitcnt lgkmcnt(2)
  v_mfma_f32_16x16x32_bf16 v[112:115], a[240:243], v[84:87], v[112:115]
  v_mfma_f32_16x16x32_bf16 v[116:119], a[244:247], v[84:87], v[116:119]
  s_waitcnt lgkmcnt(1)
  v_mfma_f32_16x16x32_bf16 v[104:107], a[248:251], v[88:91], v[104:107]
  v_mfma_f32_16x16x32_bf16 v[108:111], a[252:255], v[88:91], v[108:111]
  s_waitcnt lgkmcnt(0)
  v_mfma_f32_16x16x32_bf16 v[112:115], a[248:251], v[92:95], v[112:115]
  v_mfma_f32_16x16x32_bf16 v[116:119], a[252:255], v[92:95], v[116:119]
  s_nop 3
  v_cvt_pk_bf16_f32 v96, v104, v105
  v_cvt_pk_bf16_f32 v97, v106, v107
  v_cvt_pk_bf16_f32 v98, v108, v109
  v_cvt_pk_bf16_f32 v99, v110, v111
  v_cvt_pk_bf16_f32 v100, v112, v113
  v_cvt_pk_bf16_f32 v101, v114, v115
  v_cvt_pk_bf16_f32 v102, v116, v117
  v_cvt_pk_bf16_f32 v103, v118, v119
  s_lshl_b32 s61, s64, 18
  s_add_u32 s61, s61, s68
  buffer_store_dwordx4 v[96:99], v4, s[8:11], s61 offen offset:0 sc1
  buffer_store_dwordx4 v[100:103], v4, s[8:11], s61 offen offset:256 sc1
  v_mov_b32 v28, v5
  s_cmp_lt_u32 s80, s65
  s_cbranch_scc0 gl_149_y
  s_waitcnt vmcnt(2)
  v_and_b32 v16, v16, v17
  v_and_b32 v18, v18, v19
  v_and_b32 v16, v16, v18
  v_cmp_ne_u32 vcc, 1, v16
  s_nop 0
  s_cmp_eq_u32 vcc_lo, 0
  s_cbranch_scc1 fs_159
  buffer_load_dwordx4 v[16:19], v3, s[8:11], s60 offen sc1
  s_waitcnt vmcnt(1)
  s_mul_i32 s76, s64, 1536
  s_add_u32 s76, s76, s69
  buffer_store_dword v6, v5, s[8:11], s76 offen sc1
  s_waitcnt vmcnt(1)
  v_and_b32 v16, v16, v17
  v_and_b32 v18, v18, v19
  v_and_b32 v16, v16, v18
  v_cmp_ne_u32 vcc, 1, v16
  s_nop 0
  s_cmp_eq_u32 vcc_lo, 0
  s_cbranch_scc1 fq_160
gf_151:
  s_mul_i32 s60, s80, 64
  s_add_u32 s60, s60, s67
pl_161:
  buffer_load_dwordx4 v[16:19], v3, s[8:11], s60 offen sc1
  s_waitcnt vmcnt(0)
  v_and_b32 v16, v16, v17
  v_and_b32 v18, v18, v19
  v_and_b32 v16, v16, v18
  v_cmp_ne_u32 vcc, 1, v16
  s_nop 0
  s_cmp_eq_u32 vcc_lo, 0
  s_cbranch_scc1 pk_162
  s_sub_u32 s57, s57, 1
  s_cbranch_scc0 pl_161
  s_branch ABORT
pk_162:
fq_160:
  v_mov_b32 v28, v29
fs_159:
  s_lshl_b32 s74, s80, 16
  s_add_u32 s74, s74, s66
  s_add_u32 s60, s60, 64
  buffer_load_dwordx4 v[16:19], v3, s[8:11], s60 offen sc1
  s_add_u32 m0, s70, 0
  s_add_u32 s62, s74, 0
  buffer_load_dwordx4 v2, s[8:11], s62 offen sc1 lds
  s_add_u32 m0, s70, 4096
  s_add_u32 s62, s74, 4096
  buffer_load_dwordx4 v2, s[8:11], s62 offen sc1 lds
  s_add_u32 m0, s70, 8192
  s_add_u32 s62, s74, 8192
  buffer_load_dwordx4 v2, s[8:11], s62 offen sc1 lds
  s_add_u32 m0, s70, 12288
  s_add_u32 s62, s74, 12288
  buffer_load_dwordx4 v2, s[8:11], s62 offen sc1 lds
  s_add_u32 m0, s70, 16384
  s_add_u32 s62, s74, 16384
  buffer_load_dwordx4 v2, s[8:11], s62 offen sc1 lds
  s_add_u32 m0, s70, 20480
  s_add_u32 s62, s74, 20480
  buffer_load_dwordx4 v2, s[8:11], s62 offen sc1 lds
  s_add_u32 m0, s70, 24576
  s_add_u32 s62, s74, 24576
  buffer_load_dwordx4 v2, s[8:11], s62 offen sc1 lds
  s_add_u32 m0, s70, 28672
  s_add_u32 s62, s74, 28672
  buffer_load_dwordx4 v2, s[8:11], s62 offen sc1 lds
  buffer_load_dword v26, v29, s[8:11], 0 offen
  s_add_u32 m0, s70, 32768
  s_add_u32 s62, s74, 32768
  buffer_load_dwordx4 v2, s[8:11], s62 offen sc1 lds
  buffer_load_dword v26, v29, s[8:11], 0 offen
  s_add_u32 m0, s70, 36864
  s_add_u32 s62, s74, 36864
  buffer_load_dwordx4 v2, s[8:11], s62 offen sc1 lds
  s_add_u32 m0, s70, 40960
  s_add_u32 s62, s74, 40960
  buffer_load_dwordx4 v2, s[8:11], s62 offen sc1 lds
  s_add_u32 m0, s70, 45056
  s_add_u32 s62, s74, 45056
  buffer_load_dwordx4 v2, s[8:11], s62 offen sc1 lds
  s_add_u32 m0, s70, 49152
  s_add_u32 s62, s74, 49152
  buffer_load_dwordx4 v2, s[8:11], s62 offen sc1 lds
  s_add_u32 m0, s70, 53248
  s_add_u32 s62, s74, 53248
  buffer_load_dwordx4 v2, s[8:11], s62 offen sc1 lds
  s_add_u32 m0, s70, 57344
  s_add_u32 s62, s74, 57344
  buffer_load_dwordx4 v2, s[8:11], s62 offen sc1 lds
  s_add_u32 m0, s70, 61440
  s_add_u32 s62, s74, 61440
  buffer_load_dwordx4 v2, s[8:11], s62 offen sc1 lds
  s_mov_b32 s73, 0x7ff00000
  s_mov_b32 s71, 0x7ff00000
  s_waitcnt vmcnt(14)
  s_mul_i32 s76, s64, 1536
  s_add_u32 s76, s76, s69
  buffer_store_dword v6, v28, s[8:11], s76 offen sc1
  s_barrier
  ds_read_b128 v[64:67], v20 offset:0
  ds_read_b128 v[68:71], v21 offset:0
  ds_read_b128 v[72:75], v20 offset:2048
  ds_read_b128 v[76:79], v21 offset:2048
  ds_read_b128 v[80:83], v20 offset:4096
  ds_read_b128 v[84:87], v21 offset:4096
  s_branch gl_149
gl_149_y:
  s_waitcnt vmcnt(0)
  s_mul_i32 s76, s64, 1536
  s_add_u32 s76, s76, s69
  buffer_store_dword v6, v5, s[8:11], s76 offen sc1
gl_149_x:
  s_barrier
  s_branch NEXT
M_V:
  v_lshlrev_b32 v1, 4, v0
  v_lshrrev_b32 v8, 4, v0
  v_and_b32 v9, 15, v0
  v_lshlrev_b32 v10, 4, v9
  v_lshl_add_u32 v10, v8, 9, v10
  v_and_b32 v11, 8, v9
  v_add_u32 v11, v11, v9
  v_and_b32 v9, 1, v8
  v_lshl_add_u32 v11, v9, 3, v11
  v_lshlrev_b32 v11, 4, v11
  v_lshl_add_u32 v20, v8, 9, v11
  v_xor_b32 v21, 128, v20
  v_lshrrev_b32 v11, 5, v0
  v_lshlrev_b32 v11, 7, v11
  v_xor_b32 v1, v11, v1
  v_add_u32 v22, 0x10000, v20
  v_add_u32 v23, 0x10000, v21
  s_lshl_b32 s70, s54, 10
  v_add_u32 v2, s70, v1
  v_and_b32 v3, 31, v0
  v_min_u32 v3, s81, v3
  v_lshlrev_b32 v3, 4, v3
  v_lshrrev_b32 v24, 5, v0
  v_mul_u32_u24 v24, 64, v24
  v_add_u32 v3, v3, v24
  s_and_b32 s59, s56, 7
  s_lshl_b32 s59, s59, 2
  s_add_u32 s59, s59, s54
  s_mul_i32 s59, s59, 16
  v_add_u32 v24, s59, v0
  v_min_u32 v24, 511, v24
  v_lshlrev_b32 v24, 7, v24
  v_mov_b32 v25, 0x7ff00000
  v_mov_b32 v29, 0x7ff00000
  v_cmp_gt_u32 vcc, 16, v0
  s_nop 1
  v_cndmask_b32 v24, v25, v24, vcc
  v_mov_b32 v6, 0
  v_mov_b32 v5, 0x7ff00000
  v_cmp_eq_u32 vcc, 0, v0
  s_nop 1
  v_cndmask_b32 v5, v5, v6, vcc
  v_mov_b32 v6, 1
  s_lshl_b32 s59, s54, 11
  v_add_u32 v4, s59, v10
  s_mov_b32 s80, s64
  s_barrier
  s_branch gf_165
gl_163:
  s_mov_b32 s64, s80
  s_add_u32 s80, s64, 1
  ds_read_b128 v[88:91], v20 offset:6144
  s_waitcnt lgkmcnt(6)
  v_mfma_f32_16x16x32_bf16 v[32:35], v[64:67], a[0:3], 0
  v_mfma_f32_16x16x32_bf16 v[40:43], v[64:67], a[4:7], 0
  v_and_b32 v16, v16, v17
  v_and_b32 v18, v18, v19
  s_lshl_b32 s74, s80, 16
  s_add_u32 s74, s74, s66
  ds_read_b128 v[92:95], v21 offset:6144
  s_waitcnt lgkmcnt(6)
  v_mfma_f32_16x16x32_bf16 v[36:39], v[68:71], a[0:3], 0
  v_mfma_f32_16x16x32_bf16 v[44:47], v[68:71], a[4:7], 0
  v_and_b32 v16, v16, v18
  v_cmp_ne_u32 vcc, 1, v16
  s_cmp_lt_u32 s80, s65
  s_cselect_b32 vcc_lo, vcc_lo, -1
  s_cmp_eq_u32 vcc_lo, 0
  s_cselect_b32 s59, 0, 0x7ff00000
  v_add_u32 v7, s59, v2
  ds_read_b128 v[64:67], v20 offset:8192
  s_waitcnt lgkmcnt(6)
  v_mfma_f32_16x16x32_bf16 v[32:35], v[72:75], a[8:11], v[32:35]
  v_mfma_f32_16x16x32_bf16 v[40:43], v[72:75], a[12:15], v[40:43]
  s_add_u32 s59, s80, 1
  s_cmp_lt_u32 s59, s65
  s_cselect_b32 vcc_hi, vcc_hi, -1
  s_cmp_eq_u32 vcc_hi, 0
  s_cselect_b32 s59, 0, 0x7ff00000
  s_mov_b32 vcc_hi, 0
  v_add_u32 v25, s59, v24
  s_add_u32 m0, s70, 65536
  s_add_u32 s62, s74, 0
  buffer_load_dwordx4 v7, s[8:11], s62 offen sc1 lds
  ds_read_b128 v[68:71], v21 offset:8192
  s_waitcnt lgkmcnt(6)
  v_mfma_f32_16x16x32_bf16 v[36:39], v[76:79], a[8:11], v[36:39]
  v_mfma_f32_16x16x32_bf16 v[44:47], v[76:79], a[12:15], v[44:47]
  v_add_u32 v27, s73, v4
  v_add_u32 v28, s71, v5
  v_cvt_pk_bf16_f32 v96, v104, v105
  v_cvt_pk_bf16_f32 v97, v106, v107
  v_cvt_pk_bf16_f32 v98, v108, v109
  v_cvt_pk_bf16_f32 v99, v110, v111
  ds_read_b128 v[72:75], v20 offset:10240
  s_waitcnt lgkmcnt(6)
  v_mfma_f32_16x16x32_bf16 v[32:35], v[80:83], a[16:19], v[32:35]
  v_mfma_f32_16x16x32_bf16 v[40:43], v[80:83], a[20:23], v[40:43]
  v_cvt_pk_bf16_f32 v100, v112, v113
  v_cvt_pk_bf16_f32 v101, v114, v115
  v_cvt_pk_bf16_f32 v102, v116, v117
  v_cvt_pk_bf16_f32 v103, v118, v119
  ds_read_b128 v[76:79], v21 offset:10240
  s_waitcnt lgkmcnt(6)
  v_mfma_f32_16x16x32_bf16 v[36:39], v[84:87], a[16:19], v[36:39]
  v_mfma_f32_16x16x32_bf16 v[44:47], v[84:87], a[20:23], v[44:47]
  ds_read_b128 v[80:83], v20 offset:12288
  s_waitcnt lgkmcnt(6)
  v_mfma_f32_16x16x32_bf16 v[32:35], v[88:91], a[24:27], v[32:35]
  v_mfma_f32_16x16x32_bf16 v[40:43], v[88:91], a[28:31], v[40:43]
  s_add_u32 m0, s70, 69632
  s_add_u32 s62, s74, 4096
  buffer_load_dwordx4 v7, s[8:11], s62 offen sc1 lds
  ds_read_b128 v[84:87], v21 offset:12288
  s_waitcnt lgkmcnt(6)
  v_mfma_f32_16x16x32_bf16 v[36:39], v[92:95], a[24:27], v[36:39]
  v_mfma_f32_16x16x32_bf16 v[44:47], v[92:95], a[28:31], v[44:47]
  ds_read_b128 v[88:91], v20 offset:14336
  s_waitcnt lgkmcnt(6)
  v_mfma_f32_16x16x32_bf16 v[32:35], v[64:67], a[32:35], v[32:35]
  v_mfma_f32_16x16x32_bf16 v[40:43], v[64:67], a[36:39], v[40:43]
  s_lshl_b32 s61, s64, 18
  s_add_u32 s61, s61, s68
  s_sub_u32 s61, s61, 262144
  buffer_store_dwordx4 v[96:99], v27, s[8:11], s61 offen offset:0 sc1
  ds_read_b128 v[92:95], v21 offset:14336
  s_waitcnt lgkmcnt(6)
  v_mfma_f32_16x16x32_bf16 v[36:39], v[68:71], a[32:35], v[36:39]
  v_mfma_f32_16x16x32_bf16 v[44:47], v[68:71], a[36:39], v[44:47]
  s_waitcnt vmcnt(14)
  s_barrier
  ds_read_b128 v[64:67], v20 offset:16384
  s_waitcnt lgkmcnt(6)
  v_mfma_f32_16x16x32_bf16 v[32:35], v[72:75], a[40:43], v[32:35]
  v_mfma_f32_16x16x32_bf16 v[40:43], v[72:75], a[44:47], v[40:43]
  s_add_u32 m0, s70, 73728
  s_add_u32 s62, s74, 8192
  buffer_load_dwordx4 v7, s[8:11], s62 offen sc1 lds
  ds_read_b128 v[68:71], v21 offset:16384
  s_waitcnt lgkmcnt(6)
  v_mfma_f32_16x16x32_bf16 v[36:39], v[76:79], a[40:43], v[36:39]
  v_mfma_f32_16x16x32_bf16 v[44:47], v[76:79], a[44:47], v[44:47]
  ds_read_b128 v[72:75], v20 offset:18432
  s_waitcnt lgkmcnt(6)
  v_mfma_f32_16x16x32_bf16 v[32:35], v[80:83], a[48:51], v[32:35]
  v_mfma_f32_16x16x32_bf16 v[40:43], v[80:83], a[52:55], v[40:43]
  buffer_store_dwordx4 v[100:103], v27, s[8:11], s61 offen offset:256 sc1
  ds_read_b128 v[76:79], v21 offset:18432
  s_waitcnt lgkmcnt(6)
  v_mfma_f32_16x16x32_bf16 v[36:39], v[84:87], a[48:51], v[36:39]
  v_mfma_f32_16x16x32_bf16 v[44:47], v[84:87], a[52:55], v[44:47]
  ds_read_b128 v[80:83], v20 offset:20480
  s_waitcnt lgkmcnt(6)
  v_mfma_f32_16x16x32_bf16 v[32:35], v[88:91], a[56:59], v[32:35]
  v_mfma_f32_16x16x32_bf16 v[40:43], v[88:91], a[60:63], v[40:43]
  s_add_u32 m0, s70, 77824
  s_add_u32 s62, s74, 12288
  buffer_load_dwordx4 v7, s[8:11], s62 offen sc1 lds
  ds_read_b128 v[84:87], v21 offset:20480
  s_waitcnt lgkmcnt(6)
  v_mfma_f32_16x16x32_bf16 v[36:39], v[92:95], a[56:59], v[36:39]
  v_mfma_f32_16x16x32_bf16 v[44:47], v[92:95], a[60:63], v[44:47]
  ds_read_b128 v[88:91], v20 offset:22528
  s_waitcnt lgkmcnt(6)
  v_mfma_f32_16x16x32_bf16 v[32:35], v[64:67], a[64:67], v[32:35]
  v_mfma_f32_16x16x32_bf16 v[40:43], v[64:67], a[68:71], v[40:43]
  ds_read_b128 v[92:95], v21 offset:22528
  s_waitcnt lgkmcnt(6)
  v_mfma_f32_16x16x32_bf16 v[36:39], v[68:71], a[64:67], v[36:39]
  v_mfma_f32_16x16x32_bf16 v[44:47], v[68:71], a[68:71], v[44:47]
  ds_read_b128 v[64:67], v20 offset:24576
  s_waitcnt lgkmcnt(6)
  v_mfma_f32_16x16x32_bf16 v[32:35], v[72:75], a[72:75], v[32:35]
  v_mfma_f32_16x16x32_bf16 v[40:43], v[72:75], a[76:79], v[40:43]
  s_add_u32 m0, s70, 81920
  s_add_u32 s62, s74, 16384
  buffer_load_dwordx4 v7, s[8:11], s62 offen sc1 lds
  ds_read_b128 v[68:71], v21 offset:24576
  s_waitcnt lgkmcnt(6)
  v_mfma_f32_16x16x32_bf16 v[36:39], v[76:79], a[72:75], v[36:39]
  v_mfma_f32_16x16x32_bf16 v[44:47], v[76:79], a[76:79], v[44:47]
  ds_read_b128 v[72:75], v20 offset:26624
  s_waitcnt lgkmcnt(6)
  v_mfma_f32_16x16x32_bf16 v[32:35], v[80:83], a[80:83], v[32:35]
  v_mfma_f32_16x16x32_bf16 v[40:43], v[80:83], a[84:87], v[40:43]
  ds_read_b128 v[76:79], v21 offset:26624
  s_waitcnt lgkmcnt(6)
  v_mfma_f32_16x16x32_bf16 v[36:39], v[84:87], a[80:83], v[36:39]
  v_mfma_f32_16x16x32_bf16 v[44:47], v[84:87], a[84:87], v[44:47]
  ds_read_b128 v[80:83], v20 offset:28672
  s_waitcnt lgkmcnt(6)
  v_mfma_f32_16x16x32_bf16 v[32:35], v[88:91], a[88:91], v[32:35]
  v_mfma_f32_16x16x32_bf16 v[40:43], v[88:91], a[92:95], v[40:43]
  s_add_u32 m0, s70, 86016
  s_add_u32 s62, s74, 20480
  buffer_load_dwordx4 v7, s[8:11], s62 offen sc1 lds
  ds_read_b128 v[84:87], v21 offset:28672
  s_waitcnt lgkmcnt(6)
  v_mfma_f32_16x16x32_bf16 v[36:39], v[92:95], a[88:91], v[36:39]
  v_mfma_f32_16x16x32_bf16 v[44:47], v[92:95], a[92:95], v[44:47]
  ds_read_b128 v[88:91], v20 offset:30720
  s_waitcnt lgkmcnt(6)
  v_mfma_f32_16x16x32_bf16 v[32:35], v[64:67], a[96:99], v[32:35]
  v_mfma_f32_16x16x32_bf16 v[40:43], v[64:67], a[100:103], v[40:43]
  ds_read_b128 v[92:95], v21 offset:30720
  s_waitcnt lgkmcnt(6)
  v_mfma_f32_16x16x32_bf16 v[36:39], v[68:71], a[96:99], v[36:39]
  v_mfma_f32_16x16x32_bf16 v[44:47], v[68:71], a[100:103], v[44:47]
  s_waitcnt vmcnt(12)
  s_barrier
  ds_read_b128 v[64:67], v20 offset:32768
  s_waitcnt lgkmcnt(6)
  v_mfma_f32_16x16x32_bf16 v[32:35], v[72:75], a[104:107], v[32:35]
  v_mfma_f32_16x16x32_bf16 v[40:43], v[72:75], a[108:111], v[40:43]
  s_add_u32 m0, s70, 90112
  s_add_u32 s62, s74, 24576
  buffer_load_dwordx4 v7, s[8:11], s62 offen sc1 lds
  ds_read_b128 v[68:71], v21 offset:32768
  s_waitcnt lgkmcnt(6)
  v_mfma_f32_16x16x32_bf16 v[36:39], v[76:79], a[104:107], v[36:39]
  v_mfma_f32_16x16x32_bf16 v[44:47], v[76:79], a[108:111], v[44:47]
  ds_read_b128 v[72:75], v20 offset:34816
  s_waitcnt lgkmcnt(6)
  v_mfma_f32_16x16x32_bf16 v[32:35], v[80:83], a[112:115], v[32:35]
  v_mfma_f32_16x16x32_bf16 v[40:43], v[80:83], a[116:119], v[40:43]
  ds_read_b128 v[76:79], v21 offset:34816
  s_waitcnt lgkmcnt(6)
  v_mfma_f32_16x16x32_bf16 v[36:39], v[84:87], a[112:115], v[36:39]
  v_mfma_f32_16x16x32_bf16 v[44:47], v[84:87], a[116:119], v[44:47]
  ds_read_b128 v[80:83], v20 offset:36864
  s_waitcnt lgkmcnt(6)
  v_mfma_f32_16x16x32_bf16 v[32:35], v[88:91], a[120:123], v[32:35]
  v_mfma_f32_16x16x32_bf16 v[40:43], v[88:91], a[124:127], v[40:43]
  s_add_u32 m0, s70, 94208
  s_add_u32 s62, s74, 28672
  buffer_load_dwordx4 v7, s[8:11], s62 offen sc1 lds
  ds_read_b128 v[84:87], v21 offset:36864
  s_waitcnt lgkmcnt(6)
  v_mfma_f32_16x16x32_bf16 v[36:39], v[92:95], a[120:123], v[36:39]
  v_mfma_f32_16x16x32_bf16 v[44:47], v[92:95], a[124:127], v[44:47]
  ds_read_b128 v[88:91], v20 offset:38912
  s_waitcnt lgkmcnt(6)
  v_mfma_f32_16x16x32_bf16 v[32:35], v[64:67], a[128:131], v[32:35]
  v_mfma_f32_16x16x32_bf16 v[40:43], v[64:67], a[132:135], v[40:43]
  s_mul_i32 s60, s80, 64
  s_add_u32 s60, s60, s67
  s_add_u32 s60, s60, 64
  buffer_load_dwordx4 v[16:19], v3, s[8:11], s60 offen sc1
  ds_read_b128 v[92:95], v21 offset:38912
  s_waitcnt lgkmcnt(6)
  v_mfma_f32_16x16x32_bf16 v[36:39], v[68:71], a[128:131], v[36:39]
  v_mfma_f32_16x16x32_bf16 v[44:47], v[68:71], a[132:135], v[44:47]
  ds_read_b128 v[64:67], v20 offset:40960
  s_waitcnt lgkmcnt(6)
  v_mfma_f32_16x16x32_bf16 v[32:35], v[72:75], a[136:139], v[32:35]
  v_mfma_f32_16x16x32_bf16 v[40:43], v[72:75], a[140:143], v[40:43]
  s_add_u32 m0, s70, 98304
  s_add_u32 s62, s74, 32768
  buffer_load_dwordx4 v7, s[8:11], s62 offen sc1 lds
  ds_read_b128 v[68:71], v21 offset:40960
  s_waitcnt lgkmcnt(6)
  v_mfma_f32_16x16x32_bf16 v[36:39], v[76:79], a[136:139], v[36:39]
  v_mfma_f32_16x16x32_bf16 v[44:47], v[76:79], a[140:143], v[44:47]
  ds_read_b128 v[72:75], v20 offset:43008
  s_waitcnt lgkmcnt(6)
  v_mfma_f32_16x16x32_bf16 v[32:35], v[80:83], a[144:147], v[32:35]
  v_mfma_f32_16x16x32_bf16 v[40:43], v[80:83], a[148:151], v[40:43]
  s_add_u32 s59, s74, 65536
  buffer_load_dword v26, v25, s[8:11], s59 offen sc1
  ds_read_b128 v[76:79], v21 offset:43008
  s_waitcnt lgkmcnt(6)
  v_mfma_f32_16x16x32_bf16 v[36:39], v[84:87], a[144:147], v[36:39]
  v_mfma_f32_16x16x32_bf16 v[44:47], v[84:87], a[148:151], v[44:47]
  ds_read_b128 v[80:83], v20 offset:45056
  s_waitcnt lgkmcnt(6)
  v_mfma_f32_16x16x32_bf16 v[32:35], v[88:91], a[152:155], v[32:35]
  v_mfma_f32_16x16x32_bf16 v[40:43], v[88:91], a[156:159], v[40:43]
  s_add_u32 m0, s70, 102400
  s_add_u32 s62, s74, 36864
  buffer_load_dwordx4 v7, s[8:11], s62 offen sc1 lds
  ds_read_b128 v[84:87], v21 offset:45056
  s_waitcnt lgkmcnt(6)
  v_mfma_f32_16x16x32_bf16 v[36:39], v[92:95], a[152:155], v[36:39]
  v_mfma_f32_16x16x32_bf16 v[44:47], v[92:95], a[156:159], v[44:47]
  ds_read_b128 v[88:91], v20 offset:47104
  s_waitcnt lgkmcnt(6)
  v_mfma_f32_16x16x32_bf16 v[32:35], v[64:67], a[160:163], v[32:35]
  v_mfma_f32_16x16x32_bf16 v[40:43], v[64:67], a[164:167], v[40:43]
  ds_read_b128 v[92:95], v21 offset:47104
  s_waitcnt lgkmcnt(6)
  v_mfma_f32_16x16x32_bf16 v[36:39], v[68:71], a[160:163], v[36:39]
  v_mfma_f32_16x16x32_bf16 v[44:47], v[68:71], a[164:167], v[44:47]
  s_waitcnt vmcnt(14)
  s_barrier
  ds_read_b128 v[64:67], v20 offset:49152
  s_waitcnt lgkmcnt(6)
  v_mfma_f32_16x16x32_bf16 v[32:35], v[72:75], a[168:171], v[32:35]
  v_mfma_f32_16x16x32_bf16 v[40:43], v[72:75], a[172:175], v[40:43]
  s_add_u32 m0, s70, 106496
  s_add_u32 s62, s74, 40960
  buffer_load_dwordx4 v7, s[8:11], s62 offen sc1 lds
  ds_read_b128 v[68:71], v21 offset:49152
  s_waitcnt lgkmcnt(6)
  v_mfma_f32_16x16x32_bf16 v[36:39], v[76:79], a[168:171], v[36:39]
  v_mfma_f32_16x16x32_bf16 v[44:47], v[76:79], a[172:175], v[44:47]
  ds_read_b128 v[72:75], v20 offset:51200
  s_waitcnt lgkmcnt(6)
  v_mfma_f32_16x16x32_bf16 v[32:35], v[80:83], a[176:179], v[32:35]
  v_mfma_f32_16x16x32_bf16 v[40:43], v[80:83], a[180:183], v[40:43]
  s_waitcnt vmcnt(10)
  s_mul_i32 s76, s64, 1536
  s_add_u32 s76, s76, s69
  s_sub_u32 s76, s76, 1536
  buffer_store_dword v6, v28, s[8:11], s76 offen sc1
  ds_read_b128 v[76:79], v21 offset:51200
  s_waitcnt lgkmcnt(6)
  v_mfma_f32_16x16x32_bf16 v[36:39], v[84:87], a[176:179], v[36:39]
  v_mfma_f32_16x16x32_bf16 v[44:47], v[84:87], a[180:183], v[44:47]
  ds_read_b128 v[80:83], v20 offset:53248
  s_waitcnt lgkmcnt(6)
  v_mfma_f32_16x16x32_bf16 v[32:35], v[88:91], a[184:187], v[32:35]
  v_mfma_f32_16x16x32_bf16 v[40:43], v[88:91], a[188:191], v[40:43]
  s_add_u32 m0, s70, 110592
  s_add_u32 s62, s74, 45056
  buffer_load_dwordx4 v7, s[8:11], s62 offen sc1 lds
  ds_read_b128 v[84:87], v21 offset:53248
  s_waitcnt lgkmcnt(6)
  v_mfma_f32_16x16x32_bf16 v[36:39], v[92:95], a[184:187], v[36:39]
  v_mfma_f32_16x16x32_bf16 v[44:47], v[92:95], a[188:191], v[44:47]
  ds_read_b128 v[88:91], v20 offset:55296
  s_waitcnt lgkmcnt(6)
  v_mfma_f32_16x16x32_bf16 v[32:35], v[64:67], a[192:195], v[32:35]
  v_mfma_f32_16x16x32_bf16 v[40:43], v[64:67], a[196:199], v[40:43]
  ds_read_b128 v[92:95], v21 offset:55296
  s_waitcnt lgkmcnt(6)
  v_mfma_f32_16x16x32_bf16 v[36:39], v[68:71], a[192:195], v[36:39]
  v_mfma_f32_16x16x32_bf16 v[44:47], v[68:71], a[196:199], v[44:47]
  ds_read_b128 v[64:67], v20 offset:57344
  s_waitcnt lgkmcnt(6)
  v_mfma_f32_16x16x32_bf16 v[32:35], v[72:75], a[200:203], v[32:35]
  v_mfma_f32_16x16x32_bf16 v[40:43], v[72:75], a[204:207], v[40:43]
  s_add_u32 m0, s70, 114688
  s_add_u32 s62, s74, 49152
  buffer_load_dwordx4 v7, s[8:11], s62 offen sc1 lds
  ds_read_b128 v[68:71], v21 offset:57344
  s_waitcnt lgkmcnt(6)
  v_mfma_f32_16x16x32_bf16 v[36:39], v[76:79], a[200:203], v[36:39]
  v_mfma_f32_16x16x32_bf16 v[44:47], v[76:79], a[204:207], v[44:47]
  ds_read_b128 v[72:75], v20 offset:59392
  s_waitcnt lgkmcnt(6)
  v_mfma_f32_16x16x32_bf16 v[32:35], v[80:83], a[208:211], v[32:35]
  v_mfma_f32_16x16x32_bf16 v[40:43], v[80:83], a[212:215], v[40:43]
  ds_read_b128 v[76:79], v21 offset:59392
  s_waitcnt lgkmcnt(6)
  v_mfma_f32_16x16x32_bf16 v[36:39], v[84:87], a[208:211], v[36:39]
  v_mfma_f32_16x16x32_bf16 v[44:47], v[84:87], a[212:215], v[44:47]
  ds_read_b128 v[80:83], v20 offset:61440
  s_waitcnt lgkmcnt(6)
  v_mfma_f32_16x16x32_bf16 v[32:35], v[88:91], a[216:219], v[32:35]
  v_mfma_f32_16x16x32_bf16 v[40:43], v[88:91], a[220:223], v[40:43]
  s_add_u32 m0, s70, 118784
  s_add_u32 s62, s74, 53248
  buffer_load_dwordx4 v7, s[8:11], s62 offen sc1 lds
  ds_read_b128 v[84:87], v21 offset:61440
  s_waitcnt lgkmcnt(6)
  v_mfma_f32_16x16x32_bf16 v[36:39], v[92:95], a[216:219], v[36:39]
  v_mfma_f32_16x16x32_bf16 v[44:47], v[92:95], a[220:223], v[44:47]
  ds_read_b128 v[88:91], v20 offset:63488
  s_waitcnt lgkmcnt(6)
  v_mfma_f32_16x16x32_bf16 v[32:35], v[64:67], a[224:227], v[32:35]
  v_mfma_f32_16x16x32_bf16 v[40:43], v[64:67], a[228:231], v[40:43]
  ds_read_b128 v[92:95], v21 offset:63488
  s_waitcnt lgkmcnt(6)
  v_mfma_f32_16x16x32_bf16 v[36:39], v[68:71], a[224:227], v[36:39]
  v_mfma_f32_16x16x32_bf16 v[44:47], v[68:71], a[228:231], v[44:47]
  s_cbranch_vccnz gt_167
  s_waitcnt vmcnt(13)
  s_barrier
  ds_read_b128 v[64:67], v22 offset:0
  s_waitcnt lgkmcnt(6)
  v_mfma_f32_16x16x32_bf16 v[32:35], v[72:75], a[232:235], v[32:35]
  v_mfma_f32_16x16x32_bf16 v[40:43], v[72:75], a[236:239], v[40:43]
  s_add_u32 m0, s70, 122880
  s_add_u32 s62, s74, 57344
  buffer_load_dwordx4 v7, s[8:11], s62 offen sc1 lds
  ds_read_b128 v[68:71], v23 offset:0
  s_waitcnt lgkmcnt(6)
  v_mfma_f32_16x16x32_bf16 v[36:39], v[76:79], a[232:235], v[36:39]
  v_mfma_f32_16x16x32_bf16 v[44:47], v[76:79], a[236:239], v[44:47]
  ds_read_b128 v[72:75], v22 offset:2048
  s_waitcnt lgkmcnt(6)
  v_mfma_f32_16x16x32_bf16 v[32:35], v[80:83], a[240:243], v[32:35]
  v_mfma_f32_16x16x32_bf16 v[40:43], v[80:83], a[244:247], v[40:43]
  ds_read_b128 v[76:79], v23 offset:2048
  s_waitcnt lgkmcnt(6)
  v_mfma_f32_16x16x32_bf16 v[36:39], v[84:87], a[240:243], v[36:39]
  v_mfma_f32_16x16x32_bf16 v[44:47], v[84:87], a[244:247], v[44:47]
  ds_read_b128 v[80:83], v22 offset:4096
  s_waitcnt lgkmcnt(6)
  v_mfma_f32_16x16x32_bf16 v[32:35], v[88:91], a[248:251], v[32:35]
  v_mfma_f32_16x16x32_bf16 v[40:43], v[88:91], a[252:255], v[40:43]
  s_add_u32 m0, s70, 126976
  s_add_u32 s62, s74, 61440
  buffer_load_dwordx4 v7, s[8:11], s62 offen sc1 lds
  ds_read_b128 v[84:87], v23 offset:4096
  s_waitcnt lgkmcnt(6)
  v_mfma_f32_16x16x32_bf16 v[36:39], v[92:95], a[248:251], v[36:39]
  v_mfma_f32_16x16x32_bf16 v[44:47], v[92:95], a[252:255], v[44:47]
  s_mov_b32 s73, 0
  s_mov_b32 s71, 0
  s_waitcnt vmcnt(10)
gl_164:
  s_mov_b32 s64, s80
  s_add_u32 s80, s64, 1
  ds_read_b128 v[88:91], v22 offset:6144
  s_waitcnt lgkmcnt(6)
  v_mfma_f32_16x16x32_bf16 v[104:107], v[64:67], a[0:3], 0
  v_mfma_f32_16x16x32_bf16 v[112:115], v[64:67], a[4:7], 0
  v_and_b32 v16, v16, v17
  v_and_b32 v18, v18, v19
  s_lshl_b32 s74, s80, 16
  s_add_u32 s74, s74, s66
  ds_read_b128 v[92:95], v23 offset:6144
  s_waitcnt lgkmcnt(6)
  v_mfma_f32_16x16x32_bf16 v[108:111], v[68:71], a[0:3], 0
  v_mfma_f32_16x16x32_bf16 v[116:119], v[68:71], a[4:7], 0
  v_and_b32 v16, v16, v18
  v_cmp_ne_u32 vcc, 1, v16
  s_cmp_lt_u32 s80, s65
  s_cselect_b32 vcc_lo, vcc_lo, -1
  s_cmp_eq_u32 vcc_lo, 0
  s_cselect_b32 s59, 0, 0x7ff00000
  v_add_u32 v7, s59, v2
  ds_read_b128 v[64:67], v22 offset:8192
  s_waitcnt lgkmcnt(6)
  v_mfma_f32_16x16x32_bf16 v[104:107], v[72:75], a[8:11], v[104:107]
  v_mfma_f32_16x16x32_bf16 v[112:115], v[72:75], a[12:15], v[112:115]
  s_add_u32 s59, s80, 1
  s_cmp_lt_u32 s59, s65
  s_cselect_b32 vcc_hi, vcc_hi, -1
  s_cmp_eq_u32 vcc_hi, 0
  s_cselect_b32 s59, 0, 0x7ff00000
  s_mov_b32 vcc_hi, 0
  v_add_u32 v25, s59, v24
  s_add_u32 m0, s70, 0
  s_add_u32 s62, s74, 0
  buffer_load_dwordx4 v7, s[8:11], s62 offen sc1 lds
  ds_read_b128 v[68:71], v23 offset:8192
  s_waitcnt lgkmcnt(6)
  v_mfma_f32_16x16x32_bf16 v[108:111], v[76:79], a[8:11], v[108:111]
  v_mfma_f32_16x16x32_bf16 v[116:119], v[76:79], a[12:15], v[116:119]
  v_add_u32 v27, s73, v4
  v_add_u32 v28, s71, v5
  v_cvt_pk_bf16_f32 v96, v32, v33
  v_cvt_pk_bf16_f32 v97, v34, v35
  v_cvt_pk_bf16_f32 v98, v36, v37
  v_cvt_pk_bf16_f32 v99, v38, v39
  ds_read_b128 v[72:75], v22 offset:10240
  s_waitcnt lgkmcnt(6)
  v_mfma_f32_16x16x32_bf16 v[104:107], v[80:83], a[16:19], v[104:107]
  v_mfma_f32_16x16x32_bf16 v[112:115], v[80:83], a[20:23], v[112:115]
  v_cvt_pk_bf16_f32 v100, v40, v41
  v_cvt_pk_bf16_f32 v101, v42, v43
  v_cvt_pk_bf16_f32 v102, v44, v45
  v_cvt_pk_bf16_f32 v103, v46, v47
  ds_read_b128 v[76:79], v23 offset:10240
  s_waitcnt lgkmcnt(6)
  v_mfma_f32_16x16x32_bf16 v[108:111], v[84:87], a[16:19], v[108:111]
  v_mfma_f32_16x16x32_bf16 v[116:119], v[84:87], a[20:23], v[116:119]
  ds_read_b128 v[80:83], v22 offset:12288
  s_waitcnt lgkmcnt(6)
  v_mfma_f32_16x16x32_bf16 v[104:107], v[88:91], a[24:27], v[104:107]
  v_mfma_f32_16x16x32_bf16 v[112:115], v[88:91], a[28:31], v[112:115]
  s_add_u32 m0, s70, 4096
  s_add_u32 s62, s74, 4096
  buffer_load_dwordx4 v7, s[8:11], s62 offen sc1 lds
  ds_read_b128 v[84:87], v23 offset:12288
  s_waitcnt lgkmcnt(6)
  v_mfma_f32_16x16x32_bf16 v[108:111], v[92:95], a[24:27], v[108:111]
  v_mfma_f32_16x16x32_bf16 v[116:119], v[92:95], a[28:31], v[116:119]
  ds_read_b128 v[88:91], v22 offset:14336
  s_waitcnt lgkmcnt(6)
  v_mfma_f32_16x16x32_bf16 v[104:107], v[64:67], a[32:35], v[104:107]
  v_mfma_f32_16x16x32_bf16 v[112:115], v[64:67], a[36:39], v[112:115]
  s_lshl_b32 s61, s64, 18
  s_add_u32 s61, s61, s68
  s_sub_u32 s61, s61, 262144
  buffer_store_dwordx4 v[96:99], v27, s[8:11], s61 offen offset:0 sc1
  ds_read_b128 v[92:95], v23 offset:14336
  s_waitcnt lgkmcnt(6)
  v_mfma_f32_16x16x32_bf16 v[108:111], v[68:71], a[32:35], v[108:111]
  v_mfma_f32_16x16x32_bf16 v[116:119], v[68:71], a[36:39], v[116:119]
  s_waitcnt vmcnt(14)
  s_barrier
  ds_read_b128 v[64:67], v22 offset:16384
  s_waitcnt lgkmcnt(6)
  v_mfma_f32_16x16x32_bf16 v[104:107], v[72:75], a[40:43], v[104:107]
  v_mfma_f32_16x16x32_bf16 v[112:115], v[72:75], a[44:47], v[112:115]
  s_add_u32 m0, s70, 8192
  s_add_u32 s62, s74, 8192
  buffer_load_dwordx4 v7, s[8:11], s62 offen sc1 lds
  ds_read_b128 v[68:71], v23 offset:16384
  s_waitcnt lgkmcnt(6)
  v_mfma_f32_16x16x32_bf16 v[108:111], v[76:79], a[40:43], v[108:111]
  v_mfma_f32_16x16x32_bf16 v[116:119], v[76:79], a[44:47], v[116:119]
  ds_read_b128 v[72:75], v22 offset:18432
  s_waitcnt lgkmcnt(6)
  v_mfma_f32_16x16x32_bf16 v[104:107], v[80:83], a[48:51], v[104:107]
  v_mfma_f32_16x16x32_bf16 v[112:115], v[80:83], a[52:55], v[112:115]
  buffer_store_dwordx4 v[100:103], v27, s[8:11], s61 offen offset:256 sc1
  ds_read_b128 v[76:79], v23 offset:18432
  s_waitcnt lgkmcnt(6)
  v_mfma_f32_16x16x32_bf16 v[108:111], v[84:87], a[48:51], v[108:111]
  v_mfma_f32_16x16x32_bf16 v[116:119], v[84:87], a[52:55], v[116:119]
  ds_read_b128 v[80:83], v22 offset:20480
  s_waitcnt lgkmcnt(6)
  v_mfma_f32_16x16x32_bf16 v[104:107], v[88:91], a[56:59], v[104:107]
  v_mfma_f32_16x16x32_bf16 v[112:115], v[88:91], a[60:63], v[112:115]
  s_add_u32 m0, s70, 12288
  s_add_u32 s62, s74, 12288
  buffer_load_dwordx4 v7, s[8:11], s62 offen sc1 lds
  ds_read_b128 v[84:87], v23 offset:20480
  s_waitcnt lgkmcnt(6)
  v_mfma_f32_16x16x32_bf16 v[108:111], v[92:95], a[56:59], v[108:111]
  v_mfma_f32_16x16x32_bf16 v[116:119], v[92:95], a[60:63], v[116:119]
  ds_read_b128 v[88:91], v22 offset:22528
  s_waitcnt lgkmcnt(6)
  v_mfma_f32_16x16x32_bf16 v[104:107], v[64:67], a[64:67], v[104:107]
  v_mfma_f32_16x16x32_bf16 v[112:115], v[64:67], a[68:71], v[112:115]
  ds_read_b128 v[92:95], v23 offset:22528
  s_waitcnt lgkmcnt(6)
  v_mfma_f32_16x16x32_bf16 v[108:111], v[68:71], a[64:67], v[108:111]
  v_mfma_f32_16x16x32_bf16 v[116:119], v[68:71], a[68:71], v[116:119]
  ds_read_b128 v[64:67], v22 offset:24576
  s_waitcnt lgkmcnt(6)
  v_mfma_f32_16x16x32_bf16 v[104:107], v[72:75], a[72:75], v[104:107]
  v_mfma_f32_16x16x32_bf16 v[112:115], v[72:75], a[76:79], v[112:115]
  s_add_u32 m0, s70, 16384
  s_add_u32 s62, s74, 16384
  buffer_load_dwordx4 v7, s[8:11], s62 offen sc1 lds
  ds_read_b128 v[68:71], v23 offset:24576
  s_waitcnt lgkmcnt(6)
  v_mfma_f32_16x16x32_bf16 v[108:111], v[76:79], a[72:75], v[108:111]
  v_mfma_f32_16x16x32_bf16 v[116:119], v[76:79], a[76:79], v[116:119]
  ds_read_b128 v[72:75], v22 offset:26624
  s_waitcnt lgkmcnt(6)
  v_mfma_f32_16x16x32_bf16 v[104:107], v[80:83], a[80:83], v[104:107]
  v_mfma_f32_16x16x32_bf16 v[112:115], v[80:83], a[84:87], v[112:115]
  ds_read_b128 v[76:79], v23 offset:26624
  s_waitcnt lgkmcnt(6)
  v_mfma_f32_16x16x32_bf16 v[108:111], v[84:87], a[80:83], v[108:111]
  v_mfma_f32_16x16x32_bf16 v[116:119], v[84:87], a[84:87], v[116:119]
  ds_read_b128 v[80:83], v22 offset:28672
  s_waitcnt lgkmcnt(6)
  v_mfma_f32_16x16x32_bf16 v[104:107], v[88:91], a[88:91], v[104:107]
  v_mfma_f32_16x16x32_bf16 v[112:115], v[88:91], a[92:95], v[112:115]
  s_add_u32 m0, s70, 20480
  s_add_u32 s62, s74, 20480
  buffer_load_dwordx4 v7, s[8:11], s62 offen sc1 lds
  ds_read_b128 v[84:87], v23 offset:28672
  s_waitcnt lgkmcnt(6)
  v_mfma_f32_16x16x32_bf16 v[108:111], v[92:95], a[88:91], v[108:111]
  v_mfma_f32_16x16x32_bf16 v[116:119], v[92:95], a[92:95], v[116:119]
  ds_read_b128 v[88:91], v22 offset:30720
  s_waitcnt lgkmcnt(6)
  v_mfma_f32_16x16x32_bf16 v[104:107], v[64:67], a[96:99], v[104:107]
  v_mfma_f32_16x16x32_bf16 v[112:115], v[64:67], a[100:103], v[112:115]
  ds_read_b128 v[92:95], v23 offset:30720
  s_waitcnt lgkmcnt(6)
  v_mfma_f32_16x16x32_bf16 v[108:111], v[68:71], a[96:99], v[108:111]
  v_mfma_f32_16x16x32_bf16 v[116:119], v[68:71], a[100:103], v[116:119]
  s_waitcnt vmcnt(12)
  s_barrier
  ds_read_b128 v[64:67], v22 offset:32768
  s_waitcnt lgkmcnt(6)
  v_mfma_f32_16x16x32_bf16 v[104:107], v[72:75], a[104:107], v[104:107]
  v_mfma_f32_16x16x32_bf16 v[112:115], v[72:75], a[108:111], v[112:115]
  s_add_u32 m0, s70, 24576
  s_add_u32 s62, s74, 24576
  buffer_load_dwordx4 v7, s[8:11], s62 offen sc1 lds
  ds_read_b128 v[68:71], v23 offset:32768
  s_waitcnt lgkmcnt(6)
  v_mfma_f32_16x16x32_bf16 v[108:111], v[76:79], a[104:107], v[108:111]
  v_mfma_f32_16x16x32_bf16 v[116:119], v[76:79], a[108:111], v[116:119]
  ds_read_b128 v[72:75], v22 offset:34816
  s_waitcnt lgkmcnt(6)
  v_mfma_f32_16x16x32_bf16 v[104:107], v[80:83], a[112:115], v[104:107]
  v_mfma_f32_16x16x32_bf16 v[112:115], v[80:83], a[116:119], v[112:115]
  ds_read_b128 v[76:79], v23 offset:34816
  s_waitcnt lgkmcnt(6)
  v_mfma_f32_16x16x32_bf16 v[108:111], v[84:87], a[112:115], v[108:111]
  v_mfma_f32_16x16x32_bf16 v[116:119], v[84:87], a[116:119], v[116:119]
  ds_read_b128 v[80:83], v22 offset:36864
  s_waitcnt lgkmcnt(6)
  v_mfma_f32_16x16x32_bf16 v[104:107], v[88:91], a[120:123], v[104:107]
  v_mfma_f32_16x16x32_bf16 v[112:115], v[88:91], a[124:127], v[112:115]
  s_add_u32 m0, s70, 28672
  s_add_u32 s62, s74, 28672
  buffer_load_dwordx4 v7, s[8:11], s62 offen sc1 lds
  ds_read_b128 v[84:87], v23 offset:36864
  s_waitcnt lgkmcnt(6)
  v_mfma_f32_16x16x32_bf16 v[108:111], v[92:95], a[120:123], v[108:111]
  v_mfma_f32_16x16x32_bf16 v[116:119], v[92:95], a[124:127], v[116:119]
  ds_read_b128 v[88:91], v22 offset:38912
  s_waitcnt lgkmcnt(6)
  v_mfma_f32_16x16x32_bf16 v[104:107], v[64:67], a[128:131], v[104:107]
  v_mfma_f32_16x16x32_bf16 v[112:115], v[64:67], a[132:135], v[112:115]
  s_mul_i32 s60, s80, 64
  s_add_u32 s60, s60, s67
  s_add_u32 s60, s60, 64
  buffer_load_dwordx4 v[16:19], v3, s[8:11], s60 offen sc1
  ds_read_b128 v[92:95], v23 offset:38912
  s_waitcnt lgkmcnt(6)
  v_mfma_f32_16x16x32_bf16 v[108:111], v[68:71], a[128:131], v[108:111]
  v_mfma_f32_16x16x32_bf16 v[116:119], v[68:71], a[132:135], v[116:119]
  ds_read_b128 v[64:67], v22 offset:40960
  s_waitcnt lgkmcnt(6)
  v_mfma_f32_16x16x32_bf16 v[104:107], v[72:75], a[136:139], v[104:107]
  v_mfma_f32_16x16x32_bf16 v[112:115], v[72:75], a[140:143], v[112:115]
  s_add_u32 m0, s70, 32768
  s_add_u32 s62, s74, 32768
  buffer_load_dwordx4 v7, s[8:11], s62 offen sc1 lds
  ds_read_b128 v[68:71], v23 offset:40960
  s_waitcnt lgkmcnt(6)
  v_mfma_f32_16x16x32_bf16 v[108:111], v[76:79], a[136:139], v[108:111]
  v_mfma_f32_16x16x32_bf16 v[116:119], v[76:79], a[140:143], v[116:119]
  ds_read_b128 v[72:75], v22 offset:43008
  s_waitcnt lgkmcnt(6)
  v_mfma_f32_16x16x32_bf16 v[104:107], v[80:83], a[144:147], v[104:107]
  v_mfma_f32_16x16x32_bf16 v[112:115], v[80:83], a[148:151], v[112:115]
  s_add_u32 s59, s74, 65536
  buffer_load_dword v26, v25, s[8:11], s59 offen sc1
  ds_read_b128 v[76:79], v23 offset:43008
  s_waitcnt lgkmcnt(6)
  v_mfma_f32_16x16x32_bf16 v[108:111], v[84:87], a[144:147], v[108:111]
  v_mfma_f32_16x16x32_bf16 v[116:119], v[84:87], a[148:151], v[116:119]
  ds_read_b128 v[80:83], v22 offset:45056
  s_waitcnt lgkmcnt(6)
  v_mfma_f32_16x16x32_bf16 v[104:107], v[88:91], a[152:155], v[104:107]
  v_mfma_f32_16x16x32_bf16 v[112:115], v[88:91], a[156:159], v[112:115]
  s_add_u32 m0, s70, 36864
  s_add_u32 s62, s74, 36864
  buffer_load_dwordx4 v7, s[8:11], s62 offen sc1 lds
  ds_read_b128 v[84:87], v23 offset:45056
  s_waitcnt lgkmcnt(6)
  v_mfma_f32_16x16x32_bf16 v[108:111], v[92:95], a[152:155], v[108:111]
  v_mfma_f32_16x16x32_bf16 v[116:119], v[92:95], a[156:159], v[116:119]
  ds_read_b128 v[88:91], v22 offset:47104
  s_waitcnt lgkmcnt(6)
  v_mfma_f32_16x16x32_bf16 v[104:107], v[64:67], a[160:163], v[104:107]
  v_mfma_f32_16x16x32_bf16 v[112:115], v[64:67], a[164:167], v[112:115]
  ds_read_b128 v[92:95], v23 offset:47104
  s_waitcnt lgkmcnt(6)
  v_mfma_f32_16x16x32_bf16 v[108:111], v[68:71], a[160:163], v[108:111]
  v_mfma_f32_16x16x32_bf16 v[116:119], v[68:71], a[164:167], v[116:119]
  s_waitcnt vmcnt(14)
  s_barrier
  ds_read_b128 v[64:67], v22 offset:49152
  s_waitcnt lgkmcnt(6)
  v_mfma_f32_16x16x32_bf16 v[104:107], v[72:75], a[168:171], v[104:107]
  v_mfma_f32_16x16x32_bf16 v[112:115], v[72:75], a[172:175], v[112:115]
  s_add_u32 m0, s70, 40960
  s_add_u32 s62, s74, 40960
  buffer_load_dwordx4 v7, s[8:11], s62 offen sc1 lds
  ds_read_b128 v[68:71], v23 offset:49152
  s_waitcnt lgkmcnt(6)
  v_mfma_f32_16x16x32_bf16 v[108:111], v[76:79], a[168:171], v[108:111]
  v_mfma_f32_16x16x32_bf16 v[116:119], v[76:79], a[172:175], v[116:119]
  ds_read_b128 v[72:75], v22 offset:51200
  s_waitcnt lgkmcnt(6)
  v_mfma_f32_16x16x32_bf16 v[104:107], v[80:83], a[176:179], v[104:107]
  v_mfma_f32_16x16x32_bf16 v[112:115], v[80:83], a[180:183], v[112:115]
  s_waitcnt vmcnt(10)
  s_mul_i32 s76, s64, 1536
  s_add_u32 s76, s76, s69
  s_sub_u32 s76, s76, 1536
  buffer_store_dword v6, v28, s[8:11], s76 offen sc1
  ds_read_b128 v[76:79], v23 offset:51200
  s_waitcnt lgkmcnt(6)
  v_mfma_f32_16x16x32_bf16 v[108:111], v[84:87], a[176:179], v[108:111]
  v_mfma_f32_16x16x32_bf16 v[116:119], v[84:87], a[180:183], v[116:119]
  ds_read_b128 v[80:83], v22 offset:53248
  s_waitcnt lgkmcnt(6)
  v_mfma_f32_16x16x32_bf16 v[104:107], v[88:91], a[184:187], v[104:107]
  v_mfma_f32_16x16x32_bf16 v[112:115], v[88:91], a[188:191], v[112:115]
  s_add_u32 m0, s70, 45056
  s_add_u32 s62, s74, 45056
  buffer_load_dwordx4 v7, s[8:11], s62 offen sc1 lds
  ds_read_b128 v[84:87], v23 offset:53248
  s_waitcnt lgkmcnt(6)
  v_mfma_f32_16x16x32_bf16 v[108:111], v[92:95], a[184:187], v[108:111]
  v_mfma_f32_16x16x32_bf16 v[116:119], v[92:95], a[188:191], v[116:119]
  ds_read_b128 v[88:91], v22 offset:55296
  s_waitcnt lgkmcnt(6)
  v_mfma_f32_16x16x32_bf16 v[104:107], v[64:67], a[192:195], v[104:107]
  v_mfma_f32_16x16x32_bf16 v[112:115], v[64:67], a[196:199], v[112:115]
  ds_read_b128 v[92:95], v23 offset:55296
  s_waitcnt lgkmcnt(6)
  v_mfma_f32_16x16x32_bf16 v[108:111], v[68:71], a[192:195], v[108:111]
  v_mfma_f32_16x16x32_bf16 v[116:119], v[68:71], a[196:199], v[116:119]
  ds_read_b128 v[64:67], v22 offset:57344
  s_waitcnt lgkmcnt(6)
  v_mfma_f32_16x16x32_bf16 v[104:107], v[72:75], a[200:203], v[104:107]
  v_mfma_f32_16x16x32_bf16 v[112:115], v[72:75], a[204:207], v[112:115]
  s_add_u32 m0, s70, 49152
  s_add_u32 s62, s74, 49152
  buffer_load_dwordx4 v7, s[8:11], s62 offen sc1 lds
  ds_read_b128 v[68:71], v23 offset:57344
  s_waitcnt lgkmcnt(6)
  v_mfma_f32_16x16x32_bf16 v[108:111], v[76:79], a[200:203], v[108:111]
  v_mfma_f32_16x16x32_bf16 v[116:119], v[76:79], a[204:207], v[116:119]
  ds_read_b128 v[72:75], v22 offset:59392
  s_waitcnt lgkmcnt(6)
  v_mfma_f32_16x16x32_bf16 v[104:107], v[80:83], a[208:211], v[104:107]
  v_mfma_f32_16x16x32_bf16 v[112:115], v[80:83], a[212:215], v[112:115]
  ds_read_b128 v[76:79], v23 offset:59392
  s_waitcnt lgkmcnt(6)
  v_mfma_f32_16x16x32_bf16 v[108:111], v[84:87], a[208:211], v[108:111]
  v_mfma_f32_16x16x32_bf16 v[116:119], v[84:87], a[212:215], v[116:119]
  ds_read_b128 v[80:83], v22 offset:61440
  s_waitcnt lgkmcnt(6)
  v_mfma_f32_16x16x32_bf16 v[104:107], v[88:91], a[216:219], v[104:107]
  v_mfma_f32_16x16x32_bf16 v[112:115], v[88:91], a[220:223], v[112:115]
  s_add_u32 m0, s70, 53248
  s_add_u32 s62, s74, 53248
  buffer_load_dwordx4 v7, s[8:11], s62 offen sc1 lds
  ds_read_b128 v[84:87], v23 offset:61440
  s_waitcnt lgkmcnt(6)
  v_mfma_f32_16x16x32_bf16 v[108:111], v[92:95], a[216:219], v[108:111]
  v_mfma_f32_16x16x32_bf16 v[116:119], v[92:95], a[220:223], v[116:119]
  ds_read_b128 v[88:91], v22 offset:63488
  s_waitcnt lgkmcnt(6)
  v_mfma_f32_16x16x32_bf16 v[104:107], v[64:67], a[224:227], v[104:107]
  v_mfma_f32_16x16x32_bf16 v[112:115], v[64:67], a[228:231], v[112:115]
  ds_read_b128 v[92:95], v23 offset:63488
  s_waitcnt lgkmcnt(6)
  v_mfma_f32_16x16x32_bf16 v[108:111], v[68:71], a[224:227], v[108:111]
  v_mfma_f32_16x16x32_bf16 v[116:119], v[68:71], a[228:231], v[116:119]
  s_cbranch_vccnz gt_168
  s_waitcnt vmcnt(13)
  s_barrier
  ds_read_b128 v[64:67], v20 offset:0
  s_waitcnt lgkmcnt(6)
  v_mfma_f32_16x16x32_bf16 v[104:107], v[72:75], a[232:235], v[104:107]
  v_mfma_f32_16x16x32_bf16 v[112:115], v[72:75], a[236:239], v[112:115]
  s_add_u32 m0, s70, 57344
  s_add_u32 s62, s74, 57344
  buffer_load_dwordx4 v7, s[8:11], s62 offen sc1 lds
  ds_read_b128 v[68:71], v21 offset:0
  s_waitcnt lgkmcnt(6)
  v_mfma_f32_16x16x32_bf16 v[108:111], v[76:79], a[232:235], v[108:111]
  v_mfma_f32_16x16x32_bf16 v[116:119], v[76:79], a[236:239], v[116:119]
  ds_read_b128 v[72:75], v20 offset:2048
  s_waitcnt lgkmcnt(6)
  v_mfma_f32_16x16x32_bf16 v[104:107], v[80:83], a[240:243], v[104:107]
  v_mfma_f32_16x16x32_bf16 v[112:115], v[80:83], a[244:247], v[112:115]
  ds_read_b128 v[76:79], v21 offset:2048
  s_waitcnt lgkmcnt(6)
  v_mfma_f32_16x16x32_bf16 v[108:111], v[84:87], a[240:243], v[108:111]
  v_mfma_f32_16x16x32_bf16 v[116:119], v[84:87], a[244:247], v[116:119]
  ds_read_b128 v[80:83], v20 offset:4096
  s_waitcnt lgkmcnt(6)
  v_mfma_f32_16x16x32_bf16 v[104:107], v[88:91], a[248:251], v[104:107]
  v_mfma_f32_16x16x32_bf16 v[112:115], v[88:91], a[252:255], v[112:115]
  s_add_u32 m0, s70, 61440
  s_add_u32 s62, s74, 61440
  buffer_load_dwordx4 v7, s[8:11], s62 offen sc1 lds
  ds_read_b128 v[84:87], v21 offset:4096
  s_waitcnt lgkmcnt(6)
  v_mfma_f32_16x16x32_bf16 v[108:111], v[92:95], a[248:251], v[108:111]
  v_mfma_f32_16x16x32_bf16 v[116:119], v[92:95], a[252:255], v[116:119]
  s_mov_b32 s73, 0
  s_mov_b32 s71, 0
  s_waitcnt vmcnt(10)
  s_branch gl_163
gt_167:
  s_mul_i32 s60, s80, 64
  s_add_u32 s60, s60, s67
  buffer_load_dwordx4 v[16:19], v3, s[8:11], s60 offen sc1
  s_waitcnt lgkmcnt(5)
  v_mfma_f32_16x16x32_bf16 v[32:35], v[72:75], a[232:235], v[32:35]
  v_mfma_f32_16x16x32_bf16 v[40:43], v[72:75], a[236:239], v[40:43]
  s_waitcnt lgkmcnt(4)
  v_mfma_f32_16x16x32_bf16 v[36:39], v[76:79], a[232:235], v[36:39]
  v_mfma_f32_16x16x32_bf16 v[44:47], v[76:79], a[236:239], v[44:47]
  s_waitcnt lgkmcnt(3)
  v_mfma_f32_16x16x32_bf16 v[32:35], v[80:83], a[240:243], v[32:35]
  v_mfma_f32_16x16x32_bf16 v[40:43], v[80:83], a[244:247], v[40:43]
  s_waitcnt lgkmcnt(2)
  v_mfma_f32_16x16x32_bf16 v[36:39], v[84:87], a[240:243], v[36:39]
  v_mfma_f32_16x16x32_bf16 v[44:47], v[84:87], a[244:247], v[44:47]
  s_waitcnt lgkmcnt(1)
  v_mfma_f32_16x16x32_bf16 v[32:35], v[88:91], a[248:251], v[32:35]
  v_mfma_f32_16x16x32_bf16 v[40:43], v[88:91], a[252:255], v[40:43]
  s_waitcnt lgkmcnt(0)
  v_mfma_f32_16x16x32_bf16 v[36:39], v[92:95], a[248:251], v[36:39]
  v_mfma_f32_16x16x32_bf16 v[44:47], v[92:95], a[252:255], v[44:47]
  s_nop 3
  v_cvt_pk_bf16_f32 v96, v32, v33
  v_cvt_pk_bf16_f32 v97, v34, v35
  s_nop 0
  v_cvt_pk_bf16_f32 v98, v36, v37
  v_cvt_pk_bf16_f32 v99, v38, v39
  v_cvt_pk_bf16_f32 v100, v40, v41
  v_cvt_pk_bf16_f32 v101, v42, v43
  v_cvt_pk_bf16_f32 v102, v44, v45
  v_cvt_pk_bf16_f32 v103, v46, v47
  s_lshl_b32 s61, s64, 18
  s_add_u32 s61, s61, s68
  buffer_store_dwordx4 v[96:99], v4, s[8:11], s61 offen offset:0 sc1
  buffer_store_dwordx4 v[100:103], v4, s[8:11], s61 offen offset:256 sc1
  v_mov_b32 v28, v5
  s_cmp_lt_u32 s80, s65
  s_cbranch_scc0 gl_163_y
  s_waitcnt vmcnt(2)
  v_and_b32 v16, v16, v17
  v_and_b32 v18, v18, v19
  v_and_b32 v16, v16, v18
  v_cmp_ne_u32 vcc, 1, v16
  s_nop 0
  s_cmp_eq_u32 vcc_lo, 0
  s_cbranch_scc1 fs_169
  buffer_load_dwordx4 v[16:19], v3, s[8:11], s60 offen sc1
  s_waitcnt vmcnt(1)
  s_mul_i32 s76, s64, 1536
  s_add_u32 s76, s76, s69
  buffer_store_dword v6, v5, s[8:11], s76 offen sc1
  s_waitcnt vmcnt(1)
  v_and_b32 v16, v16, v17
  v_and_b32 v18, v18, v19
  v_and_b32 v16, v16, v18
  v_cmp_ne_u32 vcc, 1, v16
  s_nop 0
  s_cmp_eq_u32 vcc_lo, 0
  s_cbranch_scc1 fq_170
gf_166:
  s_mul_i32 s60, s80, 64
  s_add_u32 s60, s60, s67
pl_171:
  buffer_load_dwordx4 v[16:19], v3, s[8:11], s60 offen sc1
  s_waitcnt vmcnt(0)
  v_and_b32 v16, v16, v17
  v_and_b32 v18, v18, v19
  v_and_b32 v16, v16, v18
  v_cmp_ne_u32 vcc, 1, v16
  s_nop 0
  s_cmp_eq_u32 vcc_lo, 0
  s_cbranch_scc1 pk_172
  s_sub_u32 s57, s57, 1
  s_cbranch_scc0 pl_171
  s_branch ABORT
pk_172:
fq_170:
  v_mov_b32 v28, v29
fs_169:
  s_lshl_b32 s74, s80, 16
  s_add_u32 s74, s74, s66
  s_add_u32 s60, s60, 64
  buffer_load_dwordx4 v[16:19], v3, s[8:11], s60 offen sc1
  s_add_u32 m0, s70, 65536
  s_add_u32 s62, s74, 0
  buffer_load_dwordx4 v2, s[8:11], s62 offen sc1 lds
  s_add_u32 m0, s70, 69632
  s_add_u32 s62, s74, 4096
  buffer_load_dwordx4 v2, s[8:11], s62 offen sc1 lds
  s_add_u32 m0, s70, 73728
  s_add_u32 s62, s74, 8192
  buffer_load_dwordx4 v2, s[8:11], s62 offen sc1 lds
  s_add_u32 m0, s70, 77824
  s_add_u32 s62, s74, 12288
  buffer_load_dwordx4 v2, s[8:11], s62 offen sc1 lds
  s_add_u32 m0, s70, 81920
  s_add_u32 s62, s74, 16384
  buffer_load_dwordx4 v2, s[8:11], s62 offen sc1 lds
  s_add_u32 m0, s70, 86016
  s_add_u32 s62, s74, 20480
  buffer_load_dwordx4 v2, s[8:11], s62 offen sc1 lds
  s_add_u32 m0, s70, 90112
  s_add_u32 s62, s74, 24576
  buffer_load_dwordx4 v2, s[8:11], s62 offen sc1 lds
  s_add_u32 m0, s70, 94208
  s_add_u32 s62, s74, 28672
  buffer_load_dwordx4 v2, s[8:11], s62 offen sc1 lds
  buffer_load_dword v26, v29, s[8:11], 0 offen
  s_add_u32 m0, s70, 98304
  s_add_u32 s62, s74, 32768
  buffer_load_dwordx4 v2, s[8:11], s62 offen sc1 lds
  buffer_load_dword v26, v29, s[8:11], 0 offen
  s_add_u32 m0, s70, 102400
  s_add_u32 s62, s74, 36864
  buffer_load_dwordx4 v2, s[8:11], s62 offen sc1 lds
  s_add_u32 m0, s70, 106496
  s_add_u32 s62, s74, 40960
  buffer_load_dwordx4 v2, s[8:11], s62 offen sc1 lds
  s_add_u32 m0, s70, 110592
  s_add_u32 s62, s74, 45056
  buffer_load_dwordx4 v2, s[8:11], s62 offen sc1 lds
  s_add_u32 m0, s70, 114688
  s_add_u32 s62, s74, 49152
  buffer_load_dwordx4 v2, s[8:11], s62 offen sc1 lds
  s_add_u32 m0, s70, 118784
  s_add_u32 s62, s74, 53248
  buffer_load_dwordx4 v2, s[8:11], s62 offen sc1 lds
  s_add_u32 m0, s70, 122880
  s_add_u32 s62, s74, 57344
  buffer_load_dwordx4 v2, s[8:11], s62 offen sc1 lds
  s_add_u32 m0, s70, 126976
  s_add_u32 s62, s74, 61440
  buffer_load_dwordx4 v2, s[8:11], s62 offen sc1 lds
  s_mov_b32 s73, 0x7ff00000
  s_mov_b32 s71, 0x7ff00000
  s_waitcnt vmcnt(14)
  s_mul_i32 s76, s64, 1536
  s_add_u32 s76, s76, s69
  buffer_store_dword v6, v28, s[8:11], s76 offen sc1
  s_barrier
  ds_read_b128 v[64:67], v22 offset:0
  ds_read_b128 v[68:71], v23 offset:0
  ds_read_b128 v[72:75], v22 offset:2048
  ds_read_b128 v[76:79], v23 offset:2048
  ds_read_b128 v[80:83], v22 offset:4096
  ds_read_b128 v[84:87], v23 offset:4096
  s_branch gl_164
gt_168:
  s_mul_i32 s60, s80, 64
  s_add_u32 s60, s60, s67
  buffer_load_dwordx4 v[16:19], v3, s[8:11], s60 offen sc1
  s_waitcnt lgkmcnt(5)
  v_mfma_f32_16x16x32_bf16 v[104:107], v[72:75], a[232:235], v[104:107]
  v_mfma_f32_16x16x32_bf16 v[112:115], v[72:75], a[236:239], v[112:115]
  s_waitcnt lgkmcnt(4)
  v_mfma_f32_16x16x32_bf16 v[108:111], v[76:79], a[232:235], v[108:111]
  v_mfma_f32_16x16x32_bf16 v[116:119], v[76:79], a[236:239], v[116:119]
  s_waitcnt lgkmcnt(3)
  v_mfma_f32_16x16x32_bf16 v[104:107], v[80:83], a[240:243], v[104:107]
  v_mfma_f32_16x16x32_bf16 v[112:115], v[80:83], a[244:247], v[112:115]
  s_waitcnt lgkmcnt(2)
  v_mfma_f32_16x16x32_bf16 v[108:111], v[84:87], a[240:243], v[108:111]
  v_mfma_f32_16x16x32_bf16 v[116:119], v[84:87], a[244:247], v[116:119]
  s_waitcnt lgkmcnt(1)
  v_mfma_f32_16x16x32_bf16 v[104:107], v[88:91], a[248:251], v[104:107]
  v_mfma_f32_16x16x32_bf16 v[112:115], v[88:91], a[252:255], v[112:115]
  s_waitcnt lgkmcnt(0)
  v_mfma_f32_16x16x32_bf16 v[108:111], v[92:95], a[248:251], v[108:111]
  v_mfma_f32_16x16x32_bf16 v[116:119], v[92:95], a[252:255], v[116:119]
  s_nop 3
  v_cvt_pk_bf16_f32 v96, v104, v105
  v_cvt_pk_bf16_f32 v97, v106, v107
  s_nop 0
  v_cvt_pk_bf16_f32 v98, v108, v109
  v_cvt_pk_bf16_f32 v99, v110, v111
  v_cvt_pk_bf16_f32 v100, v112, v113
  v_cvt_pk_bf16_f32 v101, v114, v115
  v_cvt_pk_bf16_f32 v102, v116, v117
  v_cvt_pk_bf16_f32 v103, v118, v119
  s_lshl_b32 s61, s64, 18
  s_add_u32 s61, s61, s68
  buffer_store_dwordx4 v[96:99], v4, s[8:11], s61 offen offset:0 sc1
  buffer_store_dwordx4 v[100:103], v4, s[8:11], s61 offen offset:256 sc1
  v_mov_b32 v28, v5
  s_cmp_lt_u32 s80, s65
  s_cbranch_scc0 gl_163_y
  s_waitcnt vmcnt(2)
  v_and_b32 v16, v16, v17
  v_and_b32 v18, v18, v19
  v_and_b32 v16, v16, v18
  v_cmp_ne_u32 vcc, 1, v16
  s_nop 0
  s_cmp_eq_u32 vcc_lo, 0
  s_cbranch_scc1 fs_173
  buffer_load_dwordx4 v[16:19], v3, s[8:11], s60 offen sc1
  s_waitcnt vmcnt(1)
  s_mul_i32 s76, s64, 1536
  s_add_u32 s76, s76, s69
  buffer_store_dword v6, v5, s[8:11], s76 offen sc1
  s_waitcnt vmcnt(1)
  v_and_b32 v16, v16, v17
  v_and_b32 v18, v18, v19
  v_and_b32 v16, v16, v18
  v_cmp_ne_u32 vcc, 1, v16
  s_nop 0
  s_cmp_eq_u32 vcc_lo, 0
  s_cbranch_scc1 fq_174
gf_165:
  s_mul_i32 s60, s80, 64
  s_add_u32 s60, s60, s67
pl_175:
  buffer_load_dwordx4 v[16:19], v3, s[8:11], s60 offen sc1
  s_waitcnt vmcnt(0)
  v_and_b32 v16, v16, v17
  v_and_b32 v18, v18, v19
  v_and_b32 v16, v16, v18
  v_cmp_ne_u32 vcc, 1, v16
  s_nop 0
  s_cmp_eq_u32 vcc_lo, 0
  s_cbranch_scc1 pk_176
  s_sub_u32 s57, s57, 1
  s_cbranch_scc0 pl_175
  s_branch ABORT
pk_176:
fq_174:
  v_mov_b32 v28, v29
fs_173:
  s_lshl_b32 s74, s80, 16
  s_add_u32 s74, s74, s66
  s_add_u32 s60, s60, 64
  buffer_load_dwordx4 v[16:19], v3, s[8:11], s60 offen sc1
  s_add_u32 m0, s70, 0
  s_add_u32 s62, s74, 0
  buffer_load_dwordx4 v2, s[8:11], s62 offen sc1 lds
  s_add_u32 m0, s70, 4096
  s_add_u32 s62, s74, 4096
  buffer_load_dwordx4 v2, s[8:11], s62 offen sc1 lds
  s_add_u32 m0, s70, 8192
  s_add_u32 s62, s74, 8192
  buffer_load_dwordx4 v2, s[8:11], s62 offen sc1 lds
  s_add_u32 m0, s70, 12288
  s_add_u32 s62, s74, 12288
  buffer_load_dwordx4 v2, s[8:11], s62 offen sc1 lds
  s_add_u32 m0, s70, 16384
  s_add_u32 s62, s74, 16384
  buffer_load_dwordx4 v2, s[8:11], s62 offen sc1 lds
  s_add_u32 m0, s70, 20480
  s_add_u32 s62, s74, 20480
  buffer_load_dwordx4 v2, s[8:11], s62 offen sc1 lds
  s_add_u32 m0, s70, 24576
  s_add_u32 s62, s74, 24576
  buffer_load_dwordx4 v2, s[8:11], s62 offen sc1 lds
  s_add_u32 m0, s70, 28672
  s_add_u32 s62, s74, 28672
  buffer_load_dwordx4 v2, s[8:11], s62 offen sc1 lds
  buffer_load_dword v26, v29, s[8:11], 0 offen
  s_add_u32 m0, s70, 32768
  s_add_u32 s62, s74, 32768
  buffer_load_dwordx4 v2, s[8:11], s62 offen sc1 lds
  buffer_load_dword v26, v29, s[8:11], 0 offen
  s_add_u32 m0, s70, 36864
  s_add_u32 s62, s74, 36864
  buffer_load_dwordx4 v2, s[8:11], s62 offen sc1 lds
  s_add_u32 m0, s70, 40960
  s_add_u32 s62, s74, 40960
  buffer_load_dwordx4 v2, s[8:11], s62 offen sc1 lds
  s_add_u32 m0, s70, 45056
  s_add_u32 s62, s74, 45056
  buffer_load_dwordx4 v2, s[8:11], s62 offen sc1 lds
  s_add_u32 m0, s70, 49152
  s_add_u32 s62, s74, 49152
  buffer_load_dwordx4 v2, s[8:11], s62 offen sc1 lds
  s_add_u32 m0, s70, 53248
  s_add_u32 s62, s74, 53248
  buffer_load_dwordx4 v2, s[8:11], s62 offen sc1 lds
  s_add_u32 m0, s70, 57344
  s_add_u32 s62, s74, 57344
  buffer_load_dwordx4 v2, s[8:11], s62 offen sc1 lds
  s_add_u32 m0, s70, 61440
  s_add_u32 s62, s74, 61440
  buffer_load_dwordx4 v2, s[8:11], s62 offen sc1 lds
  s_mov_b32 s73, 0x7ff00000
  s_mov_b32 s71, 0x7ff00000
  s_waitcnt vmcnt(14)
  s_mul_i32 s76, s64, 1536
  s_add_u32 s76, s76, s69
  buffer_store_dword v6, v28, s[8:11], s76 offen sc1
  s_barrier
  ds_read_b128 v[64:67], v20 offset:0
  ds_read_b128 v[68:71], v21 offset:0
  ds_read_b128 v[72:75], v20 offset:2048
  ds_read_b128 v[76:79], v21 offset:2048
  ds_read_b128 v[80:83], v20 offset:4096
  ds_read_b128 v[84:87], v21 offset:4096
  s_branch gl_163
gl_163_y:
  s_waitcnt vmcnt(0)
  s_mul_i32 s76, s64, 1536
  s_add_u32 s76, s76, s69
  buffer_store_dword v6, v5, s[8:11], s76 offen sc1
gl_163_x:
  s_barrier
  s_branch NEXT
JB:
  s_mov_b32 s78, 0
  s_mov_b32 s65, 64
  s_lshl_b32 s61, s79, 3
  s_add_u32 s61, s61, s60
  s_lshl_b32 s69, s61, 4
  s_lshl_b32 s61, s54, 2
  s_add_u32 s69, s69, s61
  s_lshl_b32 s66, s79, 16
  s_lshl_b32 s77, s60, 8
  s_lshl_b32 s68, s60, 11
  s_lshl_b32 s61, s79, 14
  s_add_u32 s68, s68, s61
  s_cmp_eq_u32 s59, 1
  s_cbranch_scc1 JF1
  s_cmp_eq_u32 s59, 2
  s_cbranch_scc1 JF2
  s_add_u32 s69, s69, 2228224
  s_add_u32 s66, s66, 67108864
  s_add_u32 s68, s68, 83886080
  s_lshl_b32 s61, s79, 21
  s_add_u32 s77, s77, s61
  s_lshl_b32 s67, s79, 11
  s_add_u32 s67, s67, 2326528
  s_mov_b32 s81, 1
  s_mov_b32 s12, s34
  s_mov_b32 s13, s35
  s_mov_b32 s14, 0x800000
  s_mov_b32 s15, 0x00020000
  v_lshrrev_b32 v10, 2, v0
  s_mov_b32 s59, 2048
  v_mul_lo_u32 v8, v10, s59
  v_and_b32 v11, 3, v0
  v_lshl_add_u32 v8, v11, 4, v8
  s_lshl_b32 s59, s54, 6
  s_add_u32 s59, s59, s77
  v_add_u32 v8, s59, v8
  s_lshl_b32 s63, s54, 15
  v_and_b32 v10, 3, v10
  v_mov_b32 v9, 0
  v_bfe_u32 v9, v0, 4, 1
  v_lshl_add_u32 v10, v9, 2, v10
  v_lshrrev_b32 v9, 5, v0
  v_lshl_add_u32 v10, v9, 4, v10
  v_lshlrev_b32 v9, 6, v10
  v_add_u32 v9, s63, v9
  v_lshlrev_b32 v10, 3, v11
  v_and_b32 v12, 2, v11
  v_lshl_add_u32 v12, v12, 3, v10
  s_cmp_eq_u32 s78, 1
  s_cselect_b64 vcc, -1, 0
  s_cselect_b32 s59, 32, 16
  v_cndmask_b32 v10, v12, v10, vcc
  v_add_u32 v9, v9, v10
  v_add_u32 v12, s59, v9
  s_add_u32 m0, s63, 0
  s_mov_b32 s59, 0
  buffer_load_dwordx4 v8, s[12:15], s59 offen lds
  s_add_u32 m0, s63, 1024
  s_mov_b32 s59, 32768
  buffer_load_dwordx4 v8, s[12:15], s59 offen lds
  s_add_u32 m0, s63, 2048
  s_mov_b32 s59, 65536
  buffer_load_dwordx4 v8, s[12:15], s59 offen lds
  s_add_u32 m0, s63, 3072
  s_mov_b32 s59, 98304
  buffer_load_dwordx4 v8, s[12:15], s59 offen lds
  s_add_u32 m0, s63, 4096
  s_mov_b32 s59, 131072
  buffer_load_dwordx4 v8, s[12:15], s59 offen lds
  s_add_u32 m0, s63, 5120
  s_mov_b32 s59, 163840
  buffer_load_dwordx4 v8, s[12:15], s59 offen lds
  s_add_u32 m0, s63, 6144
  s_mov_b32 s59, 196608
  buffer_load_dwordx4 v8, s[12:15], s59 offen lds
  s_add_u32 m0, s63, 7168
  s_mov_b32 s59, 229376
  buffer_load_dwordx4 v8, s[12:15], s59 offen lds
  s_add_u32 m0, s63, 8192
  s_mov_b32 s59, 262144
  buffer_load_dwordx4 v8, s[12:15], s59 offen lds
  s_add_u32 m0, s63, 9216
  s_mov_b32 s59, 294912
  buffer_load_dwordx4 v8, s[12:15], s59 offen lds
  s_add_u32 m0, s63, 10240
  s_mov_b32 s59, 327680
  buffer_load_dwordx4 v8, s[12:15], s59 offen lds
  s_add_u32 m0, s63, 11264
  s_mov_b32 s59, 360448
  buffer_load_dwordx4 v8, s[12:15], s59 offen lds
  s_add_u32 m0, s63, 12288
  s_mov_b32 s59, 393216
  buffer_load_dwordx4 v8, s[12:15], s59 offen lds
  s_add_u32 m0, s63, 13312
  s_mov_b32 s59, 425984
  buffer_load_dwordx4 v8, s[12:15], s59 offen lds
  s_add_u32 m0, s63, 14336
  s_mov_b32 s59, 458752
  buffer_load_dwordx4 v8, s[12:15], s59 offen lds
  s_add_u32 m0, s63, 15360
  s_mov_b32 s59, 491520
  buffer_load_dwordx4 v8, s[12:15], s59 offen lds
  s_add_u32 m0, s63, 16384
  s_mov_b32 s59, 524288
  buffer_load_dwordx4 v8, s[12:15], s59 offen lds
  s_add_u32 m0, s63, 17408
  s_mov_b32 s59, 557056
  buffer_load_dwordx4 v8, s[12:15], s59 offen lds
  s_add_u32 m0, s63, 18432
  s_mov_b32 s59, 589824
  buffer_load_dwordx4 v8, s[12:15], s59 offen lds
  s_add_u32 m0, s63, 19456
  s_mov_b32 s59, 622592
  buffer_load_dwordx4 v8, s[12:15], s59 offen lds
  s_add_u32 m0, s63, 20480
  s_mov_b32 s59, 655360
  buffer_load_dwordx4 v8, s[12:15], s59 offen lds
  s_add_u32 m0, s63, 21504
  s_mov_b32 s59, 688128
  buffer_load_dwordx4 v8, s[12:15], s59 offen lds
  s_add_u32 m0, s63, 22528
  s_mov_b32 s59, 720896
  buffer_load_dwordx4 v8, s[12:15], s59 offen lds
  s_add_u32 m0, s63, 23552
  s_mov_b32 s59, 753664
  buffer_load_dwordx4 v8, s[12:15], s59 offen lds
  s_add_u32 m0, s63, 24576
  s_mov_b32 s59, 786432
  buffer_load_dwordx4 v8, s[12:15], s59 offen lds
  s_add_u32 m0, s63, 25600
  s_mov_b32 s59, 819200
  buffer_load_dwordx4 v8, s[12:15], s59 offen lds
  s_add_u32 m0, s63, 26624
  s_mov_b32 s59, 851968
  buffer_load_dwordx4 v8, s[12:15], s59 offen lds
  s_add_u32 m0, s63, 27648
  s_mov_b32 s59, 884736
  buffer_load_dwordx4 v8, s[12:15], s59 offen lds
  s_add_u32 m0, s63, 28672
  s_mov_b32 s59, 917504
  buffer_load_dwordx4 v8, s[12:15], s59 offen lds
  s_add_u32 m0, s63, 29696
  s_mov_b32 s59, 950272
  buffer_load_dwordx4 v8, s[12:15], s59 offen lds
  s_add_u32 m0, s63, 30720
  s_mov_b32 s59, 983040
  buffer_load_dwordx4 v8, s[12:15], s59 offen lds
  s_add_u32 m0, s63, 31744
  s_mov_b32 s59, 1015808
  buffer_load_dwordx4 v8, s[12:15], s59 offen lds
  s_waitcnt vmcnt(16)
  ds_read_b64_tr_b16 a[0:1], v9 offset:0
  ds_read_b64_tr_b16 a[2:3], v9 offset:512
  ds_read_b64_tr_b16 a[4:5], v12 offset:0
  ds_read_b64_tr_b16 a[6:7], v12 offset:512
  ds_read_b64_tr_b16 a[8:9], v9 offset:2048
  ds_read_b64_tr_b16 a[10:11], v9 offset:2560
  ds_read_b64_tr_b16 a[12:13], v12 offset:2048
  ds_read_b64_tr_b16 a[14:15], v12 offset:2560
  ds_read_b64_tr_b16 a[16:17], v9 offset:4096
  ds_read_b64_tr_b16 a[18:19], v9 offset:4608
  ds_read_b64_tr_b16 a[20:21], v12 offset:4096
  ds_read_b64_tr_b16 a[22:23], v12 offset:4608
  ds_read_b64_tr_b16 a[24:25], v9 offset:6144
  ds_read_b64_tr_b16 a[26:27], v9 offset:6656
  ds_read_b64_tr_b16 a[28:29], v12 offset:6144
  ds_read_b64_tr_b16 a[30:31], v12 offset:6656
  ds_read_b64_tr_b16 a[32:33], v9 offset:8192
  ds_read_b64_tr_b16 a[34:35], v9 offset:8704
  ds_read_b64_tr_b16 a[36:37], v12 offset:8192
  ds_read_b64_tr_b16 a[38:39], v12 offset:8704
  ds_read_b64_tr_b16 a[40:41], v9 offset:10240
  ds_read_b64_tr_b16 a[42:43], v9 offset:10752
  ds_read_b64_tr_b16 a[44:45], v12 offset:10240
  ds_read_b64_tr_b16 a[46:47], v12 offset:10752
  ds_read_b64_tr_b16 a[48:49], v9 offset:12288
  ds_read_b64_tr_b16 a[50:51], v9 offset:12800
  ds_read_b64_tr_b16 a[52:53], v12 offset:12288
  ds_read_b64_tr_b16 a[54:55], v12 offset:12800
  ds_read_b64_tr_b16 a[56:57], v9 offset:14336
  ds_read_b64_tr_b16 a[58:59], v9 offset:14848
  ds_read_b64_tr_b16 a[60:61], v12 offset:14336
  ds_read_b64_tr_b16 a[62:63], v12 offset:14848
  s_waitcnt lgkmcnt(0)
  s_add_u32 m0, s63, 0
  s_mov_b32 s59, 1048576
  buffer_load_dwordx4 v8, s[12:15], s59 offen lds
  s_add_u32 m0, s63, 1024
  s_mov_b32 s59, 1081344
  buffer_load_dwordx4 v8, s[12:15], s59 offen lds
  s_add_u32 m0, s63, 2048
  s_mov_b32 s59, 1114112
  buffer_load_dwordx4 v8, s[12:15], s59 offen lds
  s_add_u32 m0, s63, 3072
  s_mov_b32 s59, 1146880
  buffer_load_dwordx4 v8, s[12:15], s59 offen lds
  s_add_u32 m0, s63, 4096
  s_mov_b32 s59, 1179648
  buffer_load_dwordx4 v8, s[12:15], s59 offen lds
  s_add_u32 m0, s63, 5120
  s_mov_b32 s59, 1212416
  buffer_load_dwordx4 v8, s[12:15], s59 offen lds
  s_add_u32 m0, s63, 6144
  s_mov_b32 s59, 1245184
  buffer_load_dwordx4 v8, s[12:15], s59 offen lds
  s_add_u32 m0, s63, 7168
  s_mov_b32 s59, 1277952
  buffer_load_dwordx4 v8, s[12:15], s59 offen lds
  s_add_u32 m0, s63, 8192
  s_mov_b32 s59, 1310720
  buffer_load_dwordx4 v8, s[12:15], s59 offen lds
  s_add_u32 m0, s63, 9216
  s_mov_b32 s59, 1343488
  buffer_load_dwordx4 v8, s[12:15], s59 offen lds
  s_add_u32 m0, s63, 10240
  s_mov_b32 s59, 1376256
  buffer_load_dwordx4 v8, s[12:15], s59 offen lds
  s_add_u32 m0, s63, 11264
  s_mov_b32 s59, 1409024
  buffer_load_dwordx4 v8, s[12:15], s59 offen lds
  s_add_u32 m0, s63, 12288
  s_mov_b32 s59, 1441792
  buffer_load_dwordx4 v8, s[12:15], s59 offen lds
  s_add_u32 m0, s63, 13312
  s_mov_b32 s59, 1474560
  buffer_load_dwordx4 v8, s[12:15], s59 offen lds
  s_add_u32 m0, s63, 14336
  s_mov_b32 s59, 1507328
  buffer_load_dwordx4 v8, s[12:15], s59 offen lds
  s_add_u32 m0, s63, 15360
  s_mov_b32 s59, 1540096
  buffer_load_dwordx4 v8, s[12:15], s59 offen lds
  s_waitcnt vmcnt(16)
  ds_read_b64_tr_b16 a[64:65], v9 offset:16384
  ds_read_b64_tr_b16 a[66:67], v9 offset:16896
  ds_read_b64_tr_b16 a[68:69], v12 offset:16384
  ds_read_b64_tr_b16 a[70:71], v12 offset:16896
  ds_read_b64_tr_b16 a[72:73], v9 offset:18432
  ds_read_b64_tr_b16 a[74:75], v9 offset:18944
  ds_read_b64_tr_b16 a[76:77], v12 offset:18432
  ds_read_b64_tr_b16 a[78:79], v12 offset:18944
  ds_read_b64_tr_b16 a[80:81], v9 offset:20480
  ds_read_b64_tr_b16 a[82:83], v9 offset:20992
  ds_read_b64_tr_b16 a[84:85], v12 offset:20480
  ds_read_b64_tr_b16 a[86:87], v12 offset:20992
  ds_read_b64_tr_b16 a[88:89], v9 offset:22528
  ds_read_b64_tr_b16 a[90:91], v9 offset:23040
  ds_read_b64_tr_b16 a[92:93], v12 offset:22528
  ds_read_b64_tr_b16 a[94:95], v12 offset:23040
  ds_read_b64_tr_b16 a[96:97], v9 offset:24576
  ds_read_b64_tr_b16 a[98:99], v9 offset:25088
  ds_read_b64_tr_b16 a[100:101], v12 offset:24576
  ds_read_b64_tr_b16 a[102:103], v12 offset:25088
  ds_read_b64_tr_b16 a[104:105], v9 offset:26624
  ds_read_b64_tr_b16 a[106:107], v9 offset:27136
  ds_read_b64_tr_b16 a[108:109], v12 offset:26624
  ds_read_b64_tr_b16 a[110:111], v12 offset:27136
  ds_read_b64_tr_b16 a[112:113], v9 offset:28672
  ds_read_b64_tr_b16 a[114:115], v9 offset:29184
  ds_read_b64_tr_b16 a[116:117], v12 offset:28672
  ds_read_b64_tr_b16 a[118:119], v12 offset:29184
  ds_read_b64_tr_b16 a[120:121], v9 offset:30720
  ds_read_b64_tr_b16 a[122:123], v9 offset:31232
  ds_read_b64_tr_b16 a[124:125], v12 offset:30720
  ds_read_b64_tr_b16 a[126:127], v12 offset:31232
  s_waitcnt lgkmcnt(0)
  s_add_u32 m0, s63, 16384
  s_mov_b32 s59, 1572864
  buffer_load_dwordx4 v8, s[12:15], s59 offen lds
  s_add_u32 m0, s63, 17408
  s_mov_b32 s59, 1605632
  buffer_load_dwordx4 v8, s[12:15], s59 offen lds
  s_add_u32 m0, s63, 18432
  s_mov_b32 s59, 1638400
  buffer_load_dwordx4 v8, s[12:15], s59 offen lds
  s_add_u32 m0, s63, 19456
  s_mov_b32 s59, 1671168
  buffer_load_dwordx4 v8, s[12:15], s59 offen lds
  s_add_u32 m0, s63, 20480
  s_mov_b32 s59, 1703936
  buffer_load_dwordx4 v8, s[12:15], s59 offen lds
  s_add_u32 m0, s63, 21504
  s_mov_b32 s59, 1736704
  buffer_load_dwordx4 v8, s[12:15], s59 offen lds
  s_add_u32 m0, s63, 22528
  s_mov_b32 s59, 1769472
  buffer_load_dwordx4 v8, s[12:15], s59 offen lds
  s_add_u32 m0, s63, 23552
  s_mov_b32 s59, 1802240
  buffer_load_dwordx4 v8, s[12:15], s59 offen lds
  s_add_u32 m0, s63, 24576
  s_mov_b32 s59, 1835008
  buffer_load_dwordx4 v8, s[12:15], s59 offen lds
  s_add_u32 m0, s63, 25600
  s_mov_b32 s59, 1867776
  buffer_load_dwordx4 v8, s[12:15], s59 offen lds
  s_add_u32 m0, s63, 26624
  s_mov_b32 s59, 1900544
  buffer_load_dwordx4 v8, s[12:15], s59 offen lds
  s_add_u32 m0, s63, 27648
  s_mov_b32 s59, 1933312
  buffer_load_dwordx4 v8, s[12:15], s59 offen lds
  s_add_u32 m0, s63, 28672
  s_mov_b32 s59, 1966080
  buffer_load_dwordx4 v8, s[12:15], s59 offen lds
  s_add_u32 m0, s63, 29696
  s_mov_b32 s59, 1998848
  buffer_load_dwordx4 v8, s[12:15], s59 offen lds
  s_add_u32 m0, s63, 30720
  s_mov_b32 s59, 2031616
  buffer_load_dwordx4 v8, s[12:15], s59 offen lds
  s_add_u32 m0, s63, 31744
  s_mov_b32 s59, 2064384
  buffer_load_dwordx4 v8, s[12:15], s59 offen lds
  s_waitcnt vmcnt(16)
  ds_read_b64_tr_b16 a[128:129], v9 offset:0
  ds_read_b64_tr_b16 a[130:131], v9 offset:512
  ds_read_b64_tr_b16 a[132:133], v12 offset:0
  ds_read_b64_tr_b16 a[134:135], v12 offset:512
  ds_read_b64_tr_b16 a[136:137], v9 offset:2048
  ds_read_b64_tr_b16 a[138:139], v9 offset:2560
  ds_read_b64_tr_b16 a[140:141], v12 offset:2048
  ds_read_b64_tr_b16 a[142:143], v12 offset:2560
  ds_read_b64_tr_b16 a[144:145], v9 offset:4096
  ds_read_b64_tr_b16 a[146:147], v9 offset:4608
  ds_read_b64_tr_b16 a[148:149], v12 offset:4096
  ds_read_b64_tr_b16 a[150:151], v12 offset:4608
  ds_read_b64_tr_b16 a[152:153], v9 offset:6144
  ds_read_b64_tr_b16 a[154:155], v9 offset:6656
  ds_read_b64_tr_b16 a[156:157], v12 offset:6144
  ds_read_b64_tr_b16 a[158:159], v12 offset:6656
  ds_read_b64_tr_b16 a[160:161], v9 offset:8192
  ds_read_b64_tr_b16 a[162:163], v9 offset:8704
  ds_read_b64_tr_b16 a[164:165], v12 offset:8192
  ds_read_b64_tr_b16 a[166:167], v12 offset:8704
  ds_read_b64_tr_b16 a[168:169], v9 offset:10240
  ds_read_b64_tr_b16 a[170:171], v9 offset:10752
  ds_read_b64_tr_b16 a[172:173], v12 offset:10240
  ds_read_b64_tr_b16 a[174:175], v12 offset:10752
  ds_read_b64_tr_b16 a[176:177], v9 offset:12288
  ds_read_b64_tr_b16 a[178:179], v9 offset:12800
  ds_read_b64_tr_b16 a[180:181], v12 offset:12288
  ds_read_b64_tr_b16 a[182:183], v12 offset:12800
  ds_read_b64_tr_b16 a[184:185], v9 offset:14336
  ds_read_b64_tr_b16 a[186:187], v9 offset:14848
  ds_read_b64_tr_b16 a[188:189], v12 offset:14336
  ds_read_b64_tr_b16 a[190:191], v12 offset:14848
  s_waitcnt lgkmcnt(0)
  s_waitcnt vmcnt(0)
  ds_read_b64_tr_b16 a[192:193], v9 offset:16384
  ds_read_b64_tr_b16 a[194:195], v9 offset:16896
  ds_read_b64_tr_b16 a[196:197], v12 offset:16384
  ds_read_b64_tr_b16 a[198:199], v12 offset:16896
  ds_read_b64_tr_b16 a[200:201], v9 offset:18432
  ds_read_b64_tr_b16 a[202:203], v9 offset:18944
  ds_read_b64_tr_b16 a[204:205], v12 offset:18432
  ds_read_b64_tr_b16 a[206:207], v12 offset:18944
  ds_read_b64_tr_b16 a[208:209], v9 offset:20480
  ds_read_b64_tr_b16 a[210:211], v9 offset:20992
  ds_read_b64_tr_b16 a[212:213], v12 offset:20480
  ds_read_b64_tr_b16 a[214:215], v12 offset:20992
  ds_read_b64_tr_b16 a[216:217], v9 offset:22528
  ds_read_b64_tr_b16 a[218:219], v9 offset:23040
  ds_read_b64_tr_b16 a[220:221], v12 offset:22528
  ds_read_b64_tr_b16 a[222:223], v12 offset:23040
  ds_read_b64_tr_b16 a[224:225], v9 offset:24576
  ds_read_b64_tr_b16 a[226:227], v9 offset:25088
  ds_read_b64_tr_b16 a[228:229], v12 offset:24576
  ds_read_b64_tr_b16 a[230:231], v12 offset:25088
  ds_read_b64_tr_b16 a[232:233], v9 offset:26624
  ds_read_b64_tr_b16 a[234:235], v9 offset:27136
  ds_read_b64_tr_b16 a[236:237], v12 offset:26624
  ds_read_b64_tr_b16 a[238:239], v12 offset:27136
  ds_read_b64_tr_b16 a[240:241], v9 offset:28672
  ds_read_b64_tr_b16 a[242:243], v9 offset:29184
  ds_read_b64_tr_b16 a[244:245], v12 offset:28672
  ds_read_b64_tr_b16 a[246:247], v12 offset:29184
  ds_read_b64_tr_b16 a[248:249], v9 offset:30720
  ds_read_b64_tr_b16 a[250:251], v9 offset:31232
  ds_read_b64_tr_b16 a[252:253], v12 offset:30720
  ds_read_b64_tr_b16 a[254:255], v12 offset:31232
  s_waitcnt lgkmcnt(0)
  v_lshlrev_b32 v1, 4, v0
  v_lshrrev_b32 v8, 4, v0
  v_and_b32 v9, 15, v0
  v_lshlrev_b32 v10, 4, v9
  v_lshl_add_u32 v10, v8, 9, v10
  v_mov_b32 v20, v10
  v_add_u32 v21, 256, v10
  v_add_u32 v22, 0x10000, v20
  v_add_u32 v23, 0x10000, v21
  s_lshl_b32 s70, s54, 10
  v_add_u32 v2, s70, v1
  v_and_b32 v3, 31, v0
  v_min_u32 v3, s81, v3
  v_lshlrev_b32 v3, 4, v3
  v_lshrrev_b32 v24, 5, v0
  v_mul_u32_u24 v24, 32, v24
  v_add_u32 v3, v3, v24
  s_and_b32 s59, s56, 7
  s_lshl_b32 s59, s59, 2
  s_add_u32 s59, s59, s54
  s_mul_i32 s59, s59, 16
  v_add_u32 v24, s59, v0
  v_min_u32 v24, 511, v24
  v_lshlrev_b32 v24, 7, v24
  v_mov_b32 v25, 0x7ff00000
  v_mov_b32 v29, 0x7ff00000
  v_cmp_gt_u32 vcc, 16, v0
  s_nop 1
  v_cndmask_b32 v24, v25, v24, vcc
  v_mov_b32 v6, 0
  v_mov_b32 v5, 0x7ff00000
  v_cmp_eq_u32 vcc, 0, v0
  s_nop 1
  v_cndmask_b32 v5, v5, v6, vcc
  v_mov_b32 v6, 1
  v_bfe_u32 v11, v0, 2, 2
  v_lshlrev_b32 v4, 16, v11
  v_and_b32 v11, 3, v0
  v_lshl_add_u32 v4, v11, 4, v4
  v_lshrrev_b32 v11, 5, v0
  v_lshl_add_u32 v4, v11, 8, v4
  s_lshl_b32 s59, s54, 9
  v_add_u32 v4, s59, v4
  v_bfe_u32 v11, v0, 4, 1
  v_lshl_add_u32 v4, v11, 6, v4
  s_mov_b32 s80, s64
  s_barrier
  s_branch gf_179
gl_177:
  s_mov_b32 s64, s80
  s_add_u32 s80, s64, 1
  ds_read_b128 v[88:91], v20 offset:6144
  s_waitcnt lgkmcnt(6)
  v_mfma_f32_16x16x32_bf16 v[32:35], a[0:3], v[64:67], 0
  v_mfma_f32_16x16x32_bf16 v[36:39], a[4:7], v[64:67], 0
  v_and_b32 v16, v16, v17
  v_and_b32 v18, v18, v19
  s_lshl_b32 s74, s80, 18
  s_add_u32 s74, s74, s66
  ds_read_b128 v[92:95], v21 offset:6144
  s_waitcnt lgkmcnt(6)
  v_mfma_f32_16x16x32_bf16 v[40:43], a[0:3], v[68:71], 0
  v_mfma_f32_16x16x32_bf16 v[44:47], a[4:7], v[68:71], 0
  v_and_b32 v16, v16, v18
  v_cmp_ne_u32 vcc, 1, v16
  s_cmp_lt_u32 s80, s65
  s_cselect_b32 vcc_lo, vcc_lo, -1
  s_cmp_eq_u32 vcc_lo, 0
  s_cselect_b32 s59, 0, 0x7ff00000
  v_add_u32 v7, s59, v2
  ds_read_b128 v[64:67], v20 offset:8192
  s_waitcnt lgkmcnt(6)
  v_mfma_f32_16x16x32_bf16 v[32:35], a[8:11], v[72:75], v[32:35]
  v_mfma_f32_16x16x32_bf16 v[36:39], a[12:15], v[72:75], v[36:39]
  s_add_u32 s59, s80, 1
  s_cmp_lt_u32 s59, s65
  s_cselect_b32 vcc_hi, vcc_hi, -1
  s_cmp_eq_u32 vcc_hi, 0
  s_cselect_b32 s59, 0, 0x7ff00000
  s_mov_b32 vcc_hi, 0
  v_add_u32 v25, s59, v24
  s_add_u32 m0, s70, 65536
  s_add_u32 s62, s74, 0
  buffer_load_dwordx4 v7, s[8:11], s62 offen sc1 lds
  ds_read_b128 v[68:71], v21 offset:8192
  s_waitcnt lgkmcnt(6)
  v_mfma_f32_16x16x32_bf16 v[40:43], a[8:11], v[76:79], v[40:43]
  v_mfma_f32_16x16x32_bf16 v[44:47], a[12:15], v[76:79], v[44:47]
  v_add_u32 v27, s73, v4
  v_add_u32 v28, s71, v5
  ds_read_b128 v[72:75], v20 offset:10240
  s_waitcnt lgkmcnt(6)
  v_mfma_f32_16x16x32_bf16 v[32:35], a[16:19], v[80:83], v[32:35]
  v_mfma_f32_16x16x32_bf16 v[36:39], a[20:23], v[80:83], v[36:39]
  s_lshl_b32 s61, s64, 19
  s_add_u32 s61, s61, s68
  s_sub_u32 s61, s61, 524288
  s_add_u32 s63, s61, 262144
  buffer_store_dwordx4 v[104:107], v27, s[8:11], s61 offen offset:0 sc1
  ds_read_b128 v[76:79], v21 offset:10240
  s_waitcnt lgkmcnt(6)
  v_mfma_f32_16x16x32_bf16 v[40:43], a[16:19], v[84:87], v[40:43]
  v_mfma_f32_16x16x32_bf16 v[44:47], a[20:23], v[84:87], v[44:47]
  ds_read_b128 v[80:83], v20 offset:12288
  s_waitcnt lgkmcnt(6)
  v_mfma_f32_16x16x32_bf16 v[32:35], a[24:27], v[88:91], v[32:35]
  v_mfma_f32_16x16x32_bf16 v[36:39], a[28:31], v[88:91], v[36:39]
  s_add_u32 m0, s70, 69632
  s_add_u32 s62, s74, 4096
  buffer_load_dwordx4 v7, s[8:11], s62 offen sc1 lds
  ds_read_b128 v[84:87], v21 offset:12288
  s_waitcnt lgkmcnt(6)
  v_mfma_f32_16x16x32_bf16 v[40:43], a[24:27], v[92:95], v[40:43]
  v_mfma_f32_16x16x32_bf16 v[44:47], a[28:31], v[92:95], v[44:47]
  ds_read_b128 v[88:91], v20 offset:14336
  s_waitcnt lgkmcnt(6)
  v_mfma_f32_16x16x32_bf16 v[32:35], a[32:35], v[64:67], v[32:35]
  v_mfma_f32_16x16x32_bf16 v[36:39], a[36:39], v[64:67], v[36:39]
  buffer_store_dwordx4 v[108:111], v27, s[8:11], s61 offen offset:128 sc1
  ds_read_b128 v[92:95], v21 offset:14336
  s_waitcnt lgkmcnt(6)
  v_mfma_f32_16x16x32_bf16 v[40:43], a[32:35], v[68:71], v[40:43]
  v_mfma_f32_16x16x32_bf16 v[44:47], a[36:39], v[68:71], v[44:47]
  s_waitcnt vmcnt(15)
  s_barrier
  ds_read_b128 v[64:67], v20 offset:16384
  s_waitcnt lgkmcnt(6)
  v_mfma_f32_16x16x32_bf16 v[32:35], a[40:43], v[72:75], v[32:35]
  v_mfma_f32_16x16x32_bf16 v[36:39], a[44:47], v[72:75], v[36:39]
  s_add_u32 m0, s70, 73728
  s_add_u32 s62, s74, 8192
  buffer_load_dwordx4 v7, s[8:11], s62 offen sc1 lds
  ds_read_b128 v[68:71], v21 offset:16384
  s_waitcnt lgkmcnt(6)
  v_mfma_f32_16x16x32_bf16 v[40:43], a[40:43], v[76:79], v[40:43]
  v_mfma_f32_16x16x32_bf16 v[44:47], a[44:47], v[76:79], v[44:47]
  ds_read_b128 v[72:75], v20 offset:18432
  s_waitcnt lgkmcnt(6)
  v_mfma_f32_16x16x32_bf16 v[32:35], a[48:51], v[80:83], v[32:35]
  v_mfma_f32_16x16x32_bf16 v[36:39], a[52:55], v[80:83], v[36:39]
  buffer_store_dwordx4 v[112:115], v27, s[8:11], s63 offen offset:0 sc1
  ds_read_b128 v[76:79], v21 offset:18432
  s_waitcnt lgkmcnt(6)
  v_mfma_f32_16x16x32_bf16 v[40:43], a[48:51], v[84:87], v[40:43]
  v_mfma_f32_16x16x32_bf16 v[44:47], a[52:55], v[84:87], v[44:47]
  ds_read_b128 v[80:83], v20 offset:20480
  s_waitcnt lgkmcnt(6)
  v_mfma_f32_16x16x32_bf16 v[32:35], a[56:59], v[88:91], v[32:35]
  v_mfma_f32_16x16x32_bf16 v[36:39], a[60:63], v[88:91], v[36:39]
  s_add_u32 m0, s70, 77824
  s_add_u32 s62, s74, 12288
  buffer_load_dwordx4 v7, s[8:11], s62 offen sc1 lds
  ds_read_b128 v[84:87], v21 offset:20480
  s_waitcnt lgkmcnt(6)
  v_mfma_f32_16x16x32_bf16 v[40:43], a[56:59], v[92:95], v[40:43]
  v_mfma_f32_16x16x32_bf16 v[44:47], a[60:63], v[92:95], v[44:47]
  ds_read_b128 v[88:91], v20 offset:22528
  s_waitcnt lgkmcnt(6)
  v_mfma_f32_16x16x32_bf16 v[32:35], a[64:67], v[64:67], v[32:35]
  v_mfma_f32_16x16x32_bf16 v[36:39], a[68:71], v[64:67], v[36:39]
  buffer_store_dwordx4 v[116:119], v27, s[8:11], s63 offen offset:128 sc1
  ds_read_b128 v[92:95], v21 offset:22528
  s_waitcnt lgkmcnt(6)
  v_mfma_f32_16x16x32_bf16 v[40:43], a[64:67], v[68:71], v[40:43]
  v_mfma_f32_16x16x32_bf16 v[44:47], a[68:71], v[68:71], v[44:47]
  ds_read_b128 v[64:67], v20 offset:24576
  s_waitcnt lgkmcnt(6)
  v_mfma_f32_16x16x32_bf16 v[32:35], a[72:75], v[72:75], v[32:35]
  v_mfma_f32_16x16x32_bf16 v[36:39], a[76:79], v[72:75], v[36:39]
  s_add_u32 m0, s70, 81920
  s_add_u32 s62, s74, 16384
  buffer_load_dwordx4 v7, s[8:11], s62 offen sc1 lds
  ds_read_b128 v[68:71], v21 offset:24576
  s_waitcnt lgkmcnt(6)
  v_mfma_f32_16x16x32_bf16 v[40:43], a[72:75], v[76:79], v[40:43]
  v_mfma_f32_16x16x32_bf16 v[44:47], a[76:79], v[76:79], v[44:47]
  ds_read_b128 v[72:75], v20 offset:26624
  s_waitcnt lgkmcnt(6)
  v_mfma_f32_16x16x32_bf16 v[32:35], a[80:83], v[80:83], v[32:35]
  v_mfma_f32_16x16x32_bf16 v[36:39], a[84:87], v[80:83], v[36:39]
  ds_read_b128 v[76:79], v21 offset:26624
  s_waitcnt lgkmcnt(6)
  v_mfma_f32_16x16x32_bf16 v[40:43], a[80:83], v[84:87], v[40:43]
  v_mfma_f32_16x16x32_bf16 v[44:47], a[84:87], v[84:87], v[44:47]
  ds_read_b128 v[80:83], v20 offset:28672
  s_waitcnt lgkmcnt(6)
  v_mfma_f32_16x16x32_bf16 v[32:35], a[88:91], v[88:91], v[32:35]
  v_mfma_f32_16x16x32_bf16 v[36:39], a[92:95], v[88:91], v[36:39]
  s_add_u32 m0, s70, 86016
  s_add_u32 s62, s74, 20480
  buffer_load_dwordx4 v7, s[8:11], s62 offen sc1 lds
  ds_read_b128 v[84:87], v21 offset:28672
  s_waitcnt lgkmcnt(6)
  v_mfma_f32_16x16x32_bf16 v[40:43], a[88:91], v[92:95], v[40:43]
  v_mfma_f32_16x16x32_bf16 v[44:47], a[92:95], v[92:95], v[44:47]
  ds_read_b128 v[88:91], v20 offset:30720
  s_waitcnt lgkmcnt(6)
  v_mfma_f32_16x16x32_bf16 v[32:35], a[96:99], v[64:67], v[32:35]
  v_mfma_f32_16x16x32_bf16 v[36:39], a[100:103], v[64:67], v[36:39]
  ds_read_b128 v[92:95], v21 offset:30720
  s_waitcnt lgkmcnt(6)
  v_mfma_f32_16x16x32_bf16 v[40:43], a[96:99], v[68:71], v[40:43]
  v_mfma_f32_16x16x32_bf16 v[44:47], a[100:103], v[68:71], v[44:47]
  s_waitcnt vmcnt(14)
  s_barrier
  ds_read_b128 v[64:67], v20 offset:32768
  s_waitcnt lgkmcnt(6)
  v_mfma_f32_16x16x32_bf16 v[32:35], a[104:107], v[72:75], v[32:35]
  v_mfma_f32_16x16x32_bf16 v[36:39], a[108:111], v[72:75], v[36:39]
  s_add_u32 m0, s70, 90112
  s_add_u32 s62, s74, 24576
  buffer_load_dwordx4 v7, s[8:11], s62 offen sc1 lds
  ds_read_b128 v[68:71], v21 offset:32768
  s_waitcnt lgkmcnt(6)
  v_mfma_f32_16x16x32_bf16 v[40:43], a[104:107], v[76:79], v[40:43]
  v_mfma_f32_16x16x32_bf16 v[44:47], a[108:111], v[76:79], v[44:47]
  ds_read_b128 v[72:75], v20 offset:34816
  s_waitcnt lgkmcnt(6)
  v_mfma_f32_16x16x32_bf16 v[32:35], a[112:115], v[80:83], v[32:35]
  v_mfma_f32_16x16x32_bf16 v[36:39], a[116:119], v[80:83], v[36:39]
  ds_read_b128 v[76:79], v21 offset:34816
  s_waitcnt lgkmcnt(6)
  v_mfma_f32_16x16x32_bf16 v[40:43], a[112:115], v[84:87], v[40:43]
  v_mfma_f32_16x16x32_bf16 v[44:47], a[116:119], v[84:87], v[44:47]
  ds_read_b128 v[80:83], v20 offset:36864
  s_waitcnt lgkmcnt(6)
  v_mfma_f32_16x16x32_bf16 v[32:35], a[120:123], v[88:91], v[32:35]
  v_mfma_f32_16x16x32_bf16 v[36:39], a[124:127], v[88:91], v[36:39]
  s_add_u32 m0, s70, 94208
  s_add_u32 s62, s74, 28672
  buffer_load_dwordx4 v7, s[8:11], s62 offen sc1 lds
  ds_read_b128 v[84:87], v21 offset:36864
  s_waitcnt lgkmcnt(6)
  v_mfma_f32_16x16x32_bf16 v[40:43], a[120:123], v[92:95], v[40:43]
  v_mfma_f32_16x16x32_bf16 v[44:47], a[124:127], v[92:95], v[44:47]
  ds_read_b128 v[88:91], v20 offset:38912
  s_waitcnt lgkmcnt(6)
  v_mfma_f32_16x16x32_bf16 v[32:35], a[128:131], v[64:67], v[32:35]
  v_mfma_f32_16x16x32_bf16 v[36:39], a[132:135], v[64:67], v[36:39]
  s_mul_i32 s60, s80, 32
  s_add_u32 s60, s60, s67
  s_add_u32 s60, s60, 32
  buffer_load_dwordx4 v[16:19], v3, s[8:11], s60 offen sc1
  ds_read_b128 v[92:95], v21 offset:38912
  s_waitcnt lgkmcnt(6)
  v_mfma_f32_16x16x32_bf16 v[40:43], a[128:131], v[68:71], v[40:43]
  v_mfma_f32_16x16x32_bf16 v[44:47], a[132:135], v[68:71], v[44:47]
  ds_read_b128 v[64:67], v20 offset:40960
  s_waitcnt lgkmcnt(6)
  v_mfma_f32_16x16x32_bf16 v[32:35], a[136:139], v[72:75], v[32:35]
  v_mfma_f32_16x16x32_bf16 v[36:39], a[140:143], v[72:75], v[36:39]
  s_add_u32 m0, s70, 98304
  s_add_u32 s62, s74, 32768
  buffer_load_dwordx4 v7, s[8:11], s62 offen sc1 lds
  ds_read_b128 v[68:71], v21 offset:40960
  s_waitcnt lgkmcnt(6)
  v_mfma_f32_16x16x32_bf16 v[40:43], a[136:139], v[76:79], v[40:43]
  v_mfma_f32_16x16x32_bf16 v[44:47], a[140:143], v[76:79], v[44:47]
  ds_read_b128 v[72:75], v20 offset:43008
  s_waitcnt lgkmcnt(6)
  v_mfma_f32_16x16x32_bf16 v[32:35], a[144:147], v[80:83], v[32:35]
  v_mfma_f32_16x16x32_bf16 v[36:39], a[148:151], v[80:83], v[36:39]
  s_add_u32 s59, s74, 262144
  buffer_load_dword v26, v25, s[8:11], s59 offen sc1
  ds_read_b128 v[76:79], v21 offset:43008
  s_waitcnt lgkmcnt(6)
  v_mfma_f32_16x16x32_bf16 v[40:43], a[144:147], v[84:87], v[40:43]
  v_mfma_f32_16x16x32_bf16 v[44:47], a[148:151], v[84:87], v[44:47]
  ds_read_b128 v[80:83], v20 offset:45056
  s_waitcnt lgkmcnt(6)
  v_mfma_f32_16x16x32_bf16 v[32:35], a[152:155], v[88:91], v[32:35]
  v_mfma_f32_16x16x32_bf16 v[36:39], a[156:159], v[88:91], v[36:39]
  s_add_u32 m0, s70, 102400
  s_add_u32 s62, s74, 36864
  buffer_load_dwordx4 v7, s[8:11], s62 offen sc1 lds
  ds_read_b128 v[84:87], v21 offset:45056
  s_waitcnt lgkmcnt(6)
  v_mfma_f32_16x16x32_bf16 v[40:43], a[152:155], v[92:95], v[40:43]
  v_mfma_f32_16x16x32_bf16 v[44:47], a[156:159], v[92:95], v[44:47]
  ds_read_b128 v[88:91], v20 offset:47104
  s_waitcnt lgkmcnt(6)
  v_mfma_f32_16x16x32_bf16 v[32:35], a[160:163], v[64:67], v[32:35]
  v_mfma_f32_16x16x32_bf16 v[36:39], a[164:167], v[64:67], v[36:39]
  ds_read_b128 v[92:95], v21 offset:47104
  s_waitcnt lgkmcnt(6)
  v_mfma_f32_16x16x32_bf16 v[40:43], a[160:163], v[68:71], v[40:43]
  v_mfma_f32_16x16x32_bf16 v[44:47], a[164:167], v[68:71], v[44:47]
  s_waitcnt vmcnt(16)
  s_barrier
  ds_read_b128 v[64:67], v20 offset:49152
  s_waitcnt lgkmcnt(6)
  v_mfma_f32_16x16x32_bf16 v[32:35], a[168:171], v[72:75], v[32:35]
  v_mfma_f32_16x16x32_bf16 v[36:39], a[172:175], v[72:75], v[36:39]
  s_add_u32 m0, s70, 106496
  s_add_u32 s62, s74, 40960
  buffer_load_dwordx4 v7, s[8:11], s62 offen sc1 lds
  ds_read_b128 v[68:71], v21 offset:49152
  s_waitcnt lgkmcnt(6)
  v_mfma_f32_16x16x32_bf16 v[40:43], a[168:171], v[76:79], v[40:43]
  v_mfma_f32_16x16x32_bf16 v[44:47], a[172:175], v[76:79], v[44:47]
  ds_read_b128 v[72:75], v20 offset:51200
  s_waitcnt lgkmcnt(6)
  v_mfma_f32_16x16x32_bf16 v[32:35], a[176:179], v[80:83], v[32:35]
  v_mfma_f32_16x16x32_bf16 v[36:39], a[180:183], v[80:83], v[36:39]
  s_waitcnt vmcnt(9)
  s_mul_i32 s76, s64, 512
  s_add_u32 s76, s76, s69
  s_sub_u32 s76, s76, 512
  buffer_store_dword v6, v28, s[8:11], s76 offen sc1
  ds_read_b128 v[76:79], v21 offset:51200
  s_waitcnt lgkmcnt(6)
  v_mfma_f32_16x16x32_bf16 v[40:43], a[176:179], v[84:87], v[40:43]
  v_mfma_f32_16x16x32_bf16 v[44:47], a[180:183], v[84:87], v[44:47]
  ds_read_b128 v[80:83], v20 offset:53248
  s_waitcnt lgkmcnt(6)
  v_mfma_f32_16x16x32_bf16 v[32:35], a[184:187], v[88:91], v[32:35]
  v_mfma_f32_16x16x32_bf16 v[36:39], a[188:191], v[88:91], v[36:39]
  s_add_u32 m0, s70, 110592
  s_add_u32 s62, s74, 45056
  buffer_load_dwordx4 v7, s[8:11], s62 offen sc1 lds
  ds_read_b128 v[84:87], v21 offset:53248
  s_waitcnt lgkmcnt(6)
  v_mfma_f32_16x16x32_bf16 v[40:43], a[184:187], v[92:95], v[40:43]
  v_mfma_f32_16x16x32_bf16 v[44:47], a[188:191], v[92:95], v[44:47]
  ds_read_b128 v[88:91], v20 offset:55296
  s_waitcnt lgkmcnt(6)
  v_mfma_f32_16x16x32_bf16 v[32:35], a[192:195], v[64:67], v[32:35]
  v_mfma_f32_16x16x32_bf16 v[36:39], a[196:199], v[64:67], v[36:39]
  ds_read_b128 v[92:95], v21 offset:55296
  s_waitcnt lgkmcnt(6)
  v_mfma_f32_16x16x32_bf16 v[40:43], a[192:195], v[68:71], v[40:43]
  v_mfma_f32_16x16x32_bf16 v[44:47], a[196:199], v[68:71], v[44:47]
  ds_read_b128 v[64:67], v20 offset:57344
  s_waitcnt lgkmcnt(6)
  v_mfma_f32_16x16x32_bf16 v[32:35], a[200:203], v[72:75], v[32:35]
  v_mfma_f32_16x16x32_bf16 v[36:39], a[204:207], v[72:75], v[36:39]
  s_add_u32 m0, s70, 114688
  s_add_u32 s62, s74, 49152
  buffer_load_dwordx4 v7, s[8:11], s62 offen sc1 lds
  ds_read_b128 v[68:71], v21 offset:57344
  s_waitcnt lgkmcnt(6)
  v_mfma_f32_16x16x32_bf16 v[40:43], a[200:203], v[76:79], v[40:43]
  v_mfma_f32_16x16x32_bf16 v[44:47], a[204:207], v[76:79], v[44:47]
  ds_read_b128 v[72:75], v20 offset:59392
  s_waitcnt lgkmcnt(6)
  v_mfma_f32_16x16x32_bf16 v[32:35], a[208:211], v[80:83], v[32:35]
  v_mfma_f32_16x16x32_bf16 v[36:39], a[212:215], v[80:83], v[36:39]
  ds_read_b128 v[76:79], v21 offset:59392
  s_waitcnt lgkmcnt(6)
  v_mfma_f32_16x16x32_bf16 v[40:43], a[208:211], v[84:87], v[40:43]
  v_mfma_f32_16x16x32_bf16 v[44:47], a[212:215], v[84:87], v[44:47]
  ds_read_b128 v[80:83], v20 offset:61440
  s_waitcnt lgkmcnt(6)
  v_mfma_f32_16x16x32_bf16 v[32:35], a[216:219], v[88:91], v[32:35]
  v_mfma_f32_16x16x32_bf16 v[36:39], a[220:223], v[88:91], v[36:39]
  s_add_u32 m0, s70, 118784
  s_add_u32 s62, s74, 53248
  buffer_load_dwordx4 v7, s[8:11], s62 offen sc1 lds
  ds_read_b128 v[84:87], v21 offset:61440
  s_waitcnt lgkmcnt(6)
  v_mfma_f32_16x16x32_bf16 v[40:43], a[216:219], v[92:95], v[40:43]
  v_mfma_f32_16x16x32_bf16 v[44:47], a[220:223], v[92:95], v[44:47]
  ds_read_b128 v[88:91], v20 offset:63488
  s_waitcnt lgkmcnt(6)
  v_mfma_f32_16x16x32_bf16 v[32:35], a[224:227], v[64:67], v[32:35]
  v_mfma_f32_16x16x32_bf16 v[36:39], a[228:231], v[64:67], v[36:39]
  ds_read_b128 v[92:95], v21 offset:63488
  s_waitcnt lgkmcnt(6)
  v_mfma_f32_16x16x32_bf16 v[40:43], a[224:227], v[68:71], v[40:43]
  v_mfma_f32_16x16x32_bf16 v[44:47], a[228:231], v[68:71], v[44:47]
  s_cbranch_vccnz gt_181
  s_waitcnt vmcnt(14)
  s_barrier
  ds_read_b128 v[64:67], v22 offset:0
  s_waitcnt lgkmcnt(6)
  v_mfma_f32_16x16x32_bf16 v[32:35], a[232:235], v[72:75], v[32:35]
  v_mfma_f32_16x16x32_bf16 v[36:39], a[236:239], v[72:75], v[36:39]
  s_add_u32 m0, s70, 122880
  s_add_u32 s62, s74, 57344
  buffer_load_dwordx4 v7, s[8:11], s62 offen sc1 lds
  ds_read_b128 v[68:71], v23 offset:0
  s_waitcnt lgkmcnt(6)
  v_mfma_f32_16x16x32_bf16 v[40:43], a[232:235], v[76:79], v[40:43]
  v_mfma_f32_16x16x32_bf16 v[44:47], a[236:239], v[76:79], v[44:47]
  ds_read_b128 v[72:75], v22 offset:2048
  s_waitcnt lgkmcnt(6)
  v_mfma_f32_16x16x32_bf16 v[32:35], a[240:243], v[80:83], v[32:35]
  v_mfma_f32_16x16x32_bf16 v[36:39], a[244:247], v[80:83], v[36:39]
  ds_read_b128 v[76:79], v23 offset:2048
  s_waitcnt lgkmcnt(6)
  v_mfma_f32_16x16x32_bf16 v[40:43], a[240:243], v[84:87], v[40:43]
  v_mfma_f32_16x16x32_bf16 v[44:47], a[244:247], v[84:87], v[44:47]
  ds_read_b128 v[80:83], v22 offset:4096
  s_waitcnt lgkmcnt(6)
  v_mfma_f32_16x16x32_bf16 v[32:35], a[248:251], v[88:91], v[32:35]
  v_mfma_f32_16x16x32_bf16 v[36:39], a[252:255], v[88:91], v[36:39]
  s_add_u32 m0, s70, 126976
  s_add_u32 s62, s74, 61440
  buffer_load_dwordx4 v7, s[8:11], s62 offen sc1 lds
  ds_read_b128 v[84:87], v23 offset:4096
  s_waitcnt lgkmcnt(6)
  v_mfma_f32_16x16x32_bf16 v[40:43], a[248:251], v[92:95], v[40:43]
  v_mfma_f32_16x16x32_bf16 v[44:47], a[252:255], v[92:95], v[44:47]
  s_mov_b32 s73, 0
  s_mov_b32 s71, 0
  s_waitcnt vmcnt(10)
gl_178:
  s_mov_b32 s64, s80
  s_add_u32 s80, s64, 1
  ds_read_b128 v[88:91], v22 offset:6144
  s_waitcnt lgkmcnt(6)
  v_mfma_f32_16x16x32_bf16 v[104:107], a[0:3], v[64:67], 0
  v_mfma_f32_16x16x32_bf16 v[108:111], a[4:7], v[64:67], 0
  v_and_b32 v16, v16, v17
  v_and_b32 v18, v18, v19
  s_lshl_b32 s74, s80, 18
  s_add_u32 s74, s74, s66
  ds_read_b128 v[92:95], v23 offset:6144
  s_waitcnt lgkmcnt(6)
  v_mfma_f32_16x16x32_bf16 v[112:115], a[0:3], v[68:71], 0
  v_mfma_f32_16x16x32_bf16 v[116:119], a[4:7], v[68:71], 0
  v_and_b32 v16, v16, v18
  v_cmp_ne_u32 vcc, 1, v16
  s_cmp_lt_u32 s80, s65
  s_cselect_b32 vcc_lo, vcc_lo, -1
  s_cmp_eq_u32 vcc_lo, 0
  s_cselect_b32 s59, 0, 0x7ff00000
  v_add_u32 v7, s59, v2
  ds_read_b128 v[64:67], v22 offset:8192
  s_waitcnt lgkmcnt(6)
  v_mfma_f32_16x16x32_bf16 v[104:107], a[8:11], v[72:75], v[104:107]
  v_mfma_f32_16x16x32_bf16 v[108:111], a[12:15], v[72:75], v[108:111]
  s_add_u32 s59, s80, 1
  s_cmp_lt_u32 s59, s65
  s_cselect_b32 vcc_hi, vcc_hi, -1
  s_cmp_eq_u32 vcc_hi, 0
  s_cselect_b32 s59, 0, 0x7ff00000
  s_mov_b32 vcc_hi, 0
  v_add_u32 v25, s59, v24
  s_add_u32 m0, s70, 0
  s_add_u32 s62, s74, 0
  buffer_load_dwordx4 v7, s[8:11], s62 offen sc1 lds
  ds_read_b128 v[68:71], v23 offset:8192
  s_waitcnt lgkmcnt(6)
  v_mfma_f32_16x16x32_bf16 v[112:115], a[8:11], v[76:79], v[112:115]
  v_mfma_f32_16x16x32_bf16 v[116:119], a[12:15], v[76:79], v[116:119]
  v_add_u32 v27, s73, v4
  v_add_u32 v28, s71, v5
  ds_read_b128 v[72:75], v22 offset:10240
  s_waitcnt lgkmcnt(6)
  v_mfma_f32_16x16x32_bf16 v[104:107], a[16:19], v[80:83], v[104:107]
  v_mfma_f32_16x16x32_bf16 v[108:111], a[20:23], v[80:83], v[108:111]
  s_lshl_b32 s61, s64, 19
  s_add_u32 s61, s61, s68
  s_sub_u32 s61, s61, 524288
  s_add_u32 s63, s61, 262144
  buffer_store_dwordx4 v[32:35], v27, s[8:11], s61 offen offset:0 sc1
  ds_read_b128 v[76:79], v23 offset:10240
  s_waitcnt lgkmcnt(6)
  v_mfma_f32_16x16x32_bf16 v[112:115], a[16:19], v[84:87], v[112:115]
  v_mfma_f32_16x16x32_bf16 v[116:119], a[20:23], v[84:87], v[116:119]
  ds_read_b128 v[80:83], v22 offset:12288
  s_waitcnt lgkmcnt(6)
  v_mfma_f32_16x16x32_bf16 v[104:107], a[24:27], v[88:91], v[104:107]
  v_mfma_f32_16x16x32_bf16 v[108:111], a[28:31], v[88:91], v[108:111]
  s_add_u32 m0, s70, 4096
  s_add_u32 s62, s74, 4096
  buffer_load_dwordx4 v7, s[8:11], s62 offen sc1 lds
  ds_read_b128 v[84:87], v23 offset:12288
  s_waitcnt lgkmcnt(6)
  v_mfma_f32_16x16x32_bf16 v[112:115], a[24:27], v[92:95], v[112:115]
  v_mfma_f32_16x16x32_bf16 v[116:119], a[28:31], v[92:95], v[116:119]
  ds_read_b128 v[88:91], v22 offset:14336
  s_waitcnt lgkmcnt(6)
  v_mfma_f32_16x16x32_bf16 v[104:107], a[32:35], v[64:67], v[104:107]
  v_mfma_f32_16x16x32_bf16 v[108:111], a[36:39], v[64:67], v[108:111]
  buffer_store_dwordx4 v[36:39], v27, s[8:11], s61 offen offset:128 sc1
  ds_read_b128 v[92:95], v23 offset:14336
  s_waitcnt lgkmcnt(6)
  v_mfma_f32_16x16x32_bf16 v[112:115], a[32:35], v[68:71], v[112:115]
  v_mfma_f32_16x16x32_bf16 v[116:119], a[36:39], v[68:71], v[116:119]
  s_waitcnt vmcnt(15)
  s_barrier
  ds_read_b128 v[64:67], v22 offset:16384
  s_waitcnt lgkmcnt(6)
  v_mfma_f32_16x16x32_bf16 v[104:107], a[40:43], v[72:75], v[104:107]
  v_mfma_f32_16x16x32_bf16 v[108:111], a[44:47], v[72:75], v[108:111]
  s_add_u32 m0, s70, 8192
  s_add_u32 s62, s74, 8192
  buffer_load_dwordx4 v7, s[8:11], s62 offen sc1 lds
  ds_read_b128 v[68:71], v23 offset:16384
  s_waitcnt lgkmcnt(6)
  v_mfma_f32_16x16x32_bf16 v[112:115], a[40:43], v[76:79], v[112:115]
  v_mfma_f32_16x16x32_bf16 v[116:119], a[44:47], v[76:79], v[116:119]
  ds_read_b128 v[72:75], v22 offset:18432
  s_waitcnt lgkmcnt(6)
  v_mfma_f32_16x16x32_bf16 v[104:107], a[48:51], v[80:83], v[104:107]
  v_mfma_f32_16x16x32_bf16 v[108:111], a[52:55], v[80:83], v[108:111]
  buffer_store_dwordx4 v[40:43], v27, s[8:11], s63 offen offset:0 sc1
  ds_read_b128 v[76:79], v23 offset:18432
  s_waitcnt lgkmcnt(6)
  v_mfma_f32_16x16x32_bf16 v[112:115], a[48:51], v[84:87], v[112:115]
  v_mfma_f32_16x16x32_bf16 v[116:119], a[52:55], v[84:87], v[116:119]
  ds_read_b128 v[80:83], v22 offset:20480
  s_waitcnt lgkmcnt(6)
  v_mfma_f32_16x16x32_bf16 v[104:107], a[56:59], v[88:91], v[104:107]
  v_mfma_f32_16x16x32_bf16 v[108:111], a[60:63], v[88:91], v[108:111]
  s_add_u32 m0, s70, 12288
  s_add_u32 s62, s74, 12288
  buffer_load_dwordx4 v7, s[8:11], s62 offen sc1 lds
  ds_read_b128 v[84:87], v23 offset:20480
  s_waitcnt lgkmcnt(6)
  v_mfma_f32_16x16x32_bf16 v[112:115], a[56:59], v[92:95], v[112:115]
  v_mfma_f32_16x16x32_bf16 v[116:119], a[60:63], v[92:95], v[116:119]
  ds_read_b128 v[88:91], v22 offset:22528
  s_waitcnt lgkmcnt(6)
  v_mfma_f32_16x16x32_bf16 v[104:107], a[64:67], v[64:67], v[104:107]
  v_mfma_f32_16x16x32_bf16 v[108:111], a[68:71], v[64:67], v[108:111]
  buffer_store_dwordx4 v[44:47], v27, s[8:11], s63 offen offset:128 sc1
  ds_read_b128 v[92:95], v23 offset:22528
  s_waitcnt lgkmcnt(6)
  v_mfma_f32_16x16x32_bf16 v[112:115], a[64:67], v[68:71], v[112:115]
  v_mfma_f32_16x16x32_bf16 v[116:119], a[68:71], v[68:71], v[116:119]
  ds_read_b128 v[64:67], v22 offset:24576
  s_waitcnt lgkmcnt(6)
  v_mfma_f32_16x16x32_bf16 v[104:107], a[72:75], v[72:75], v[104:107]
  v_mfma_f32_16x16x32_bf16 v[108:111], a[76:79], v[72:75], v[108:111]
  s_add_u32 m0, s70, 16384
  s_add_u32 s62, s74, 16384
  buffer_load_dwordx4 v7, s[8:11], s62 offen sc1 lds
  ds_read_b128 v[68:71], v23 offset:24576
  s_waitcnt lgkmcnt(6)
  v_mfma_f32_16x16x32_bf16 v[112:115], a[72:75], v[76:79], v[112:115]
  v_mfma_f32_16x16x32_bf16 v[116:119], a[76:79], v[76:79], v[116:119]
  ds_read_b128 v[72:75], v22 offset:26624
  s_waitcnt lgkmcnt(6)
  v_mfma_f32_16x16x32_bf16 v[104:107], a[80:83], v[80:83], v[104:107]
  v_mfma_f32_16x16x32_bf16 v[108:111], a[84:87], v[80:83], v[108:111]
  ds_read_b128 v[76:79], v23 offset:26624
  s_waitcnt lgkmcnt(6)
  v_mfma_f32_16x16x32_bf16 v[112:115], a[80:83], v[84:87], v[112:115]
  v_mfma_f32_16x16x32_bf16 v[116:119], a[84:87], v[84:87], v[116:119]
  ds_read_b128 v[80:83], v22 offset:28672
  s_waitcnt lgkmcnt(6)
  v_mfma_f32_16x16x32_bf16 v[104:107], a[88:91], v[88:91], v[104:107]
  v_mfma_f32_16x16x32_bf16 v[108:111], a[92:95], v[88:91], v[108:111]
  s_add_u32 m0, s70, 20480
  s_add_u32 s62, s74, 20480
  buffer_load_dwordx4 v7, s[8:11], s62 offen sc1 lds
  ds_read_b128 v[84:87], v23 offset:28672
  s_waitcnt lgkmcnt(6)
  v_mfma_f32_16x16x32_bf16 v[112:115], a[88:91], v[92:95], v[112:115]
  v_mfma_f32_16x16x32_bf16 v[116:119], a[92:95], v[92:95], v[116:119]
  ds_read_b128 v[88:91], v22 offset:30720
  s_waitcnt lgkmcnt(6)
  v_mfma_f32_16x16x32_bf16 v[104:107], a[96:99], v[64:67], v[104:107]
  v_mfma_f32_16x16x32_bf16 v[108:111], a[100:103], v[64:67], v[108:111]
  ds_read_b128 v[92:95], v23 offset:30720
  s_waitcnt lgkmcnt(6)
  v_mfma_f32_16x16x32_bf16 v[112:115], a[96:99], v[68:71], v[112:115]
  v_mfma_f32_16x16x32_bf16 v[116:119], a[100:103], v[68:71], v[116:119]
  s_waitcnt vmcnt(14)
  s_barrier
  ds_read_b128 v[64:67], v22 offset:32768
  s_waitcnt lgkmcnt(6)
  v_mfma_f32_16x16x32_bf16 v[104:107], a[104:107], v[72:75], v[104:107]
  v_mfma_f32_16x16x32_bf16 v[108:111], a[108:111], v[72:75], v[108:111]
  s_add_u32 m0, s70, 24576
  s_add_u32 s62, s74, 24576
  buffer_load_dwordx4 v7, s[8:11], s62 offen sc1 lds
  ds_read_b128 v[68:71], v23 offset:32768
  s_waitcnt lgkmcnt(6)
  v_mfma_f32_16x16x32_bf16 v[112:115], a[104:107], v[76:79], v[112:115]
  v_mfma_f32_16x16x32_bf16 v[116:119], a[108:111], v[76:79], v[116:119]
  ds_read_b128 v[72:75], v22 offset:34816
  s_waitcnt lgkmcnt(6)
  v_mfma_f32_16x16x32_bf16 v[104:107], a[112:115], v[80:83], v[104:107]
  v_mfma_f32_16x16x32_bf16 v[108:111], a[116:119], v[80:83], v[108:111]
  ds_read_b128 v[76:79], v23 offset:34816
  s_waitcnt lgkmcnt(6)
  v_mfma_f32_16x16x32_bf16 v[112:115], a[112:115], v[84:87], v[112:115]
  v_mfma_f32_16x16x32_bf16 v[116:119], a[116:119], v[84:87], v[116:119]
  ds_read_b128 v[80:83], v22 offset:36864
  s_waitcnt lgkmcnt(6)
  v_mfma_f32_16x16x32_bf16 v[104:107], a[120:123], v[88:91], v[104:107]
  v_mfma_f32_16x16x32_bf16 v[108:111], a[124:127], v[88:91], v[108:111]
  s_add_u32 m0, s70, 28672
  s_add_u32 s62, s74, 28672
  buffer_load_dwordx4 v7, s[8:11], s62 offen sc1 lds
  ds_read_b128 v[84:87], v23 offset:36864
  s_waitcnt lgkmcnt(6)
  v_mfma_f32_16x16x32_bf16 v[112:115], a[120:123], v[92:95], v[112:115]
  v_mfma_f32_16x16x32_bf16 v[116:119], a[124:127], v[92:95], v[116:119]
  ds_read_b128 v[88:91], v22 offset:38912
  s_waitcnt lgkmcnt(6)
  v_mfma_f32_16x16x32_bf16 v[104:107], a[128:131], v[64:67], v[104:107]
  v_mfma_f32_16x16x32_bf16 v[108:111], a[132:135], v[64:67], v[108:111]
  s_mul_i32 s60, s80, 32
  s_add_u32 s60, s60, s67
  s_add_u32 s60, s60, 32
  buffer_load_dwordx4 v[16:19], v3, s[8:11], s60 offen sc1
  ds_read_b128 v[92:95], v23 offset:38912
  s_waitcnt lgkmcnt(6)
  v_mfma_f32_16x16x32_bf16 v[112:115], a[128:131], v[68:71], v[112:115]
  v_mfma_f32_16x16x32_bf16 v[116:119], a[132:135], v[68:71], v[116:119]
  ds_read_b128 v[64:67], v22 offset:40960
  s_waitcnt lgkmcnt(6)
  v_mfma_f32_16x16x32_bf16 v[104:107], a[136:139], v[72:75], v[104:107]
  v_mfma_f32_16x16x32_bf16 v[108:111], a[140:143], v[72:75], v[108:111]
  s_add_u32 m0, s70, 32768
  s_add_u32 s62, s74, 32768
  buffer_load_dwordx4 v7, s[8:11], s62 offen sc1 lds
  ds_read_b128 v[68:71], v23 offset:40960
  s_waitcnt lgkmcnt(6)
  v_mfma_f32_16x16x32_bf16 v[112:115], a[136:139], v[76:79], v[112:115]
  v_mfma_f32_16x16x32_bf16 v[116:119], a[140:143], v[76:79], v[116:119]
  ds_read_b128 v[72:75], v22 offset:43008
  s_waitcnt lgkmcnt(6)
  v_mfma_f32_16x16x32_bf16 v[104:107], a[144:147], v[80:83], v[104:107]
  v_mfma_f32_16x16x32_bf16 v[108:111], a[148:151], v[80:83], v[108:111]
  s_add_u32 s59, s74, 262144
  buffer_load_dword v26, v25, s[8:11], s59 offen sc1
  ds_read_b128 v[76:79], v23 offset:43008
  s_waitcnt lgkmcnt(6)
  v_mfma_f32_16x16x32_bf16 v[112:115], a[144:147], v[84:87], v[112:115]
  v_mfma_f32_16x16x32_bf16 v[116:119], a[148:151], v[84:87], v[116:119]
  ds_read_b128 v[80:83], v22 offset:45056
  s_waitcnt lgkmcnt(6)
  v_mfma_f32_16x16x32_bf16 v[104:107], a[152:155], v[88:91], v[104:107]
  v_mfma_f32_16x16x32_bf16 v[108:111], a[156:159], v[88:91], v[108:111]
  s_add_u32 m0, s70, 36864
  s_add_u32 s62, s74, 36864
  buffer_load_dwordx4 v7, s[8:11], s62 offen sc1 lds
  ds_read_b128 v[84:87], v23 offset:45056
  s_waitcnt lgkmcnt(6)
  v_mfma_f32_16x16x32_bf16 v[112:115], a[152:155], v[92:95], v[112:115]
  v_mfma_f32_16x16x32_bf16 v[116:119], a[156:159], v[92:95], v[116:119]
  ds_read_b128 v[88:91], v22 offset:47104
  s_waitcnt lgkmcnt(6)
  v_mfma_f32_16x16x32_bf16 v[104:107], a[160:163], v[64:67], v[104:107]
  v_mfma_f32_16x16x32_bf16 v[108:111], a[164:167], v[64:67], v[108:111]
  ds_read_b128 v[92:95], v23 offset:47104
  s_waitcnt lgkmcnt(6)
  v_mfma_f32_16x16x32_bf16 v[112:115], a[160:163], v[68:71], v[112:115]
  v_mfma_f32_16x16x32_bf16 v[116:119], a[164:167], v[68:71], v[116:119]
  s_waitcnt vmcnt(16)
  s_barrier
  ds_read_b128 v[64:67], v22 offset:49152
  s_waitcnt lgkmcnt(6)
  v_mfma_f32_16x16x32_bf16 v[104:107], a[168:171], v[72:75], v[104:107]
  v_mfma_f32_16x16x32_bf16 v[108:111], a[172:175], v[72:75], v[108:111]
  s_add_u32 m0, s70, 40960
  s_add_u32 s62, s74, 40960
  buffer_load_dwordx4 v7, s[8:11], s62 offen sc1 lds
  ds_read_b128 v[68:71], v23 offset:49152
  s_waitcnt lgkmcnt(6)
  v_mfma_f32_16x16x32_bf16 v[112:115], a[168:171], v[76:79], v[112:115]
  v_mfma_f32_16x16x32_bf16 v[116:119], a[172:175], v[76:79], v[116:119]
  ds_read_b128 v[72:75], v22 offset:51200
  s_waitcnt lgkmcnt(6)
  v_mfma_f32_16x16x32_bf16 v[104:107], a[176:179], v[80:83], v[104:107]
  v_mfma_f32_16x16x32_bf16 v[108:111], a[180:183], v[80:83], v[108:111]
  s_waitcnt vmcnt(9)
  s_mul_i32 s76, s64, 512
  s_add_u32 s76, s76, s69
  s_sub_u32 s76, s76, 512
  buffer_store_dword v6, v28, s[8:11], s76 offen sc1
  ds_read_b128 v[76:79], v23 offset:51200
  s_waitcnt lgkmcnt(6)
  v_mfma_f32_16x16x32_bf16 v[112:115], a[176:179], v[84:87], v[112:115]
  v_mfma_f32_16x16x32_bf16 v[116:119], a[180:183], v[84:87], v[116:119]
  ds_read_b128 v[80:83], v22 offset:53248
  s_waitcnt lgkmcnt(6)
  v_mfma_f32_16x16x32_bf16 v[104:107], a[184:187], v[88:91], v[104:107]
  v_mfma_f32_16x16x32_bf16 v[108:111], a[188:191], v[88:91], v[108:111]
  s_add_u32 m0, s70, 45056
  s_add_u32 s62, s74, 45056
  buffer_load_dwordx4 v7, s[8:11], s62 offen sc1 lds
  ds_read_b128 v[84:87], v23 offset:53248
  s_waitcnt lgkmcnt(6)
  v_mfma_f32_16x16x32_bf16 v[112:115], a[184:187], v[92:95], v[112:115]
  v_mfma_f32_16x16x32_bf16 v[116:119], a[188:191], v[92:95], v[116:119]
  ds_read_b128 v[88:91], v22 offset:55296
  s_waitcnt lgkmcnt(6)
  v_mfma_f32_16x16x32_bf16 v[104:107], a[192:195], v[64:67], v[104:107]
  v_mfma_f32_16x16x32_bf16 v[108:111], a[196:199], v[64:67], v[108:111]
  ds_read_b128 v[92:95], v23 offset:55296
  s_waitcnt lgkmcnt(6)
  v_mfma_f32_16x16x32_bf16 v[112:115], a[192:195], v[68:71], v[112:115]
  v_mfma_f32_16x16x32_bf16 v[116:119], a[196:199], v[68:71], v[116:119]
  ds_read_b128 v[64:67], v22 offset:57344
  s_waitcnt lgkmcnt(6)
  v_mfma_f32_16x16x32_bf16 v[104:107], a[200:203], v[72:75], v[104:107]
  v_mfma_f32_16x16x32_bf16 v[108:111], a[204:207], v[72:75], v[108:111]
  s_add_u32 m0, s70, 49152
  s_add_u32 s62, s74, 49152
  buffer_load_dwordx4 v7, s[8:11], s62 offen sc1 lds
  ds_read_b128 v[68:71], v23 offset:57344
  s_waitcnt lgkmcnt(6)
  v_mfma_f32_16x16x32_bf16 v[112:115], a[200:203], v[76:79], v[112:115]
  v_mfma_f32_16x16x32_bf16 v[116:119], a[204:207], v[76:79], v[116:119]
  ds_read_b128 v[72:75], v22 offset:59392
  s_waitcnt lgkmcnt(6)
  v_mfma_f32_16x16x32_bf16 v[104:107], a[208:211], v[80:83], v[104:107]
  v_mfma_f32_16x16x32_bf16 v[108:111], a[212:215], v[80:83], v[108:111]
  ds_read_b128 v[76:79], v23 offset:59392
  s_waitcnt lgkmcnt(6)
  v_mfma_f32_16x16x32_bf16 v[112:115], a[208:211], v[84:87], v[112:115]
  v_mfma_f32_16x16x32_bf16 v[116:119], a[212:215], v[84:87], v[116:119]
  ds_read_b128 v[80:83], v22 offset:61440
  s_waitcnt lgkmcnt(6)
  v_mfma_f32_16x16x32_bf16 v[104:107], a[216:219], v[88:91], v[104:107]
  v_mfma_f32_16x16x32_bf16 v[108:111], a[220:223], v[88:91], v[108:111]
  s_add_u32 m0, s70, 53248
  s_add_u32 s62, s74, 53248
  buffer_load_dwordx4 v7, s[8:11], s62 offen sc1 lds
  ds_read_b128 v[84:87], v23 offset:61440
  s_waitcnt lgkmcnt(6)
  v_mfma_f32_16x16x32_bf16 v[112:115], a[216:219], v[92:95], v[112:115]
  v_mfma_f32_16x16x32_bf16 v[116:119], a[220:223], v[92:95], v[116:119]
  ds_read_b128 v[88:91], v22 offset:63488
  s_waitcnt lgkmcnt(6)
  v_mfma_f32_16x16x32_bf16 v[104:107], a[224:227], v[64:67], v[104:107]
  v_mfma_f32_16x16x32_bf16 v[108:111], a[228:231], v[64:67], v[108:111]
  ds_read_b128 v[92:95], v23 offset:63488
  s_waitcnt lgkmcnt(6)
  v_mfma_f32_16x16x32_bf16 v[112:115], a[224:227], v[68:71], v[112:115]
  v_mfma_f32_16x16x32_bf16 v[116:119], a[228:231], v[68:71], v[116:119]
  s_cbranch_vccnz gt_182
  s_waitcnt vmcnt(14)
  s_barrier
  ds_read_b128 v[64:67], v20 offset:0
  s_waitcnt lgkmcnt(6)
  v_mfma_f32_16x16x32_bf16 v[104:107], a[232:235], v[72:75], v[104:107]
  v_mfma_f32_16x16x32_bf16 v[108:111], a[236:239], v[72:75], v[108:111]
  s_add_u32 m0, s70, 57344
  s_add_u32 s62, s74, 57344
  buffer_load_dwordx4 v7, s[8:11], s62 offen sc1 lds
  ds_read_b128 v[68:71], v21 offset:0
  s_waitcnt lgkmcnt(6)
  v_mfma_f32_16x16x32_bf16 v[112:115], a[232:235], v[76:79], v[112:115]
  v_mfma_f32_16x16x32_bf16 v[116:119], a[236:239], v[76:79], v[116:119]
  ds_read_b128 v[72:75], v20 offset:2048
  s_waitcnt lgkmcnt(6)
  v_mfma_f32_16x16x32_bf16 v[104:107], a[240:243], v[80:83], v[104:107]
  v_mfma_f32_16x16x32_bf16 v[108:111], a[244:247], v[80:83], v[108:111]
  ds_read_b128 v[76:79], v21 offset:2048
  s_waitcnt lgkmcnt(6)
  v_mfma_f32_16x16x32_bf16 v[112:115], a[240:243], v[84:87], v[112:115]
  v_mfma_f32_16x16x32_bf16 v[116:119], a[244:247], v[84:87], v[116:119]
  ds_read_b128 v[80:83], v20 offset:4096
  s_waitcnt lgkmcnt(6)
  v_mfma_f32_16x16x32_bf16 v[104:107], a[248:251], v[88:91], v[104:107]
  v_mfma_f32_16x16x32_bf16 v[108:111], a[252:255], v[88:91], v[108:111]
  s_add_u32 m0, s70, 61440
  s_add_u32 s62, s74, 61440
  buffer_load_dwordx4 v7, s[8:11], s62 offen sc1 lds
  ds_read_b128 v[84:87], v21 offset:4096
  s_waitcnt lgkmcnt(6)
  v_mfma_f32_16x16x32_bf16 v[112:115], a[248:251], v[92:95], v[112:115]
  v_mfma_f32_16x16x32_bf16 v[116:119], a[252:255], v[92:95], v[116:119]
  s_mov_b32 s73, 0
  s_mov_b32 s71, 0
  s_waitcnt vmcnt(10)
  s_branch gl_177
gt_181:
  s_mul_i32 s60, s80, 32
  s_add_u32 s60, s60, s67
  buffer_load_dwordx4 v[16:19], v3, s[8:11], s60 offen sc1
  s_waitcnt lgkmcnt(5)
  v_mfma_f32_16x16x32_bf16 v[32:35], a[232:235], v[72:75], v[32:35]
  v_mfma_f32_16x16x32_bf16 v[36:39], a[236:239], v[72:75], v[36:39]
  s_waitcnt lgkmcnt(4)
  v_mfma_f32_16x16x32_bf16 v[40:43], a[232:235], v[76:79], v[40:43]
  v_mfma_f32_16x16x32_bf16 v[44:47], a[236:239], v[76:79], v[44:47]
  s_waitcnt lgkmcnt(3)
  v_mfma_f32_16x16x32_bf16 v[32:35], a[240:243], v[80:83], v[32:35]
  v_mfma_f32_16x16x32_bf16 v[36:39], a[244:247], v[80:83], v[36:39]
  s_waitcnt lgkmcnt(2)
  v_mfma_f32_16x16x32_bf16 v[40:43], a[240:243], v[84:87], v[40:43]
  v_mfma_f32_16x16x32_bf16 v[44:47], a[244:247], v[84:87], v[44:47]
  s_waitcnt lgkmcnt(1)
  v_mfma_f32_16x16x32_bf16 v[32:35], a[248:251], v[88:91], v[32:35]
  v_mfma_f32_16x16x32_bf16 v[36:39], a[252:255], v[88:91], v[36:39]
  s_waitcnt lgkmcnt(0)
  v_mfma_f32_16x16x32_bf16 v[40:43], a[248:251], v[92:95], v[40:43]
  v_mfma_f32_16x16x32_bf16 v[44:47], a[252:255], v[92:95], v[44:47]
  s_lshl_b32 s61, s64, 19
  s_add_u32 s61, s61, s68
  s_add_u32 s63, s61, 262144
  s_nop 0
  buffer_store_dwordx4 v[32:35], v4, s[8:11], s61 offen offset:0 sc1
  buffer_store_dwordx4 v[36:39], v4, s[8:11], s61 offen offset:128 sc1
  s_nop 0
  buffer_store_dwordx4 v[40:43], v4, s[8:11], s63 offen offset:0 sc1
  buffer_store_dwordx4 v[44:47], v4, s[8:11], s63 offen offset:128 sc1
  v_mov_b32 v28, v5
  s_cmp_lt_u32 s80, s65
  s_cbranch_scc0 gl_177_y
  s_waitcnt vmcnt(4)
  v_and_b32 v16, v16, v17
  v_and_b32 v18, v18, v19
  v_and_b32 v16, v16, v18
  v_cmp_ne_u32 vcc, 1, v16
  s_nop 0
  s_cmp_eq_u32 vcc_lo, 0
  s_cbranch_scc1 fs_183
  buffer_load_dwordx4 v[16:19], v3, s[8:11], s60 offen sc1
  s_waitcnt vmcnt(1)
  s_mul_i32 s76, s64, 512
  s_add_u32 s76, s76, s69
  buffer_store_dword v6, v5, s[8:11], s76 offen sc1
  s_waitcnt vmcnt(1)
  v_and_b32 v16, v16, v17
  v_and_b32 v18, v18, v19
  v_and_b32 v16, v16, v18
  v_cmp_ne_u32 vcc, 1, v16
  s_nop 0
  s_cmp_eq_u32 vcc_lo, 0
  s_cbranch_scc1 fq_184
gf_180:
  s_mul_i32 s60, s80, 32
  s_add_u32 s60, s60, s67
pl_185:
  buffer_load_dwordx4 v[16:19], v3, s[8:11], s60 offen sc1
  s_waitcnt vmcnt(0)
  v_and_b32 v16, v16, v17
  v_and_b32 v18, v18, v19
  v_and_b32 v16, v16, v18
  v_cmp_ne_u32 vcc, 1, v16
  s_nop 0
  s_cmp_eq_u32 vcc_lo, 0
  s_cbranch_scc1 pk_186
  s_sub_u32 s57, s57, 1
  s_cbranch_scc0 pl_185
  s_branch ABORT
pk_186:
fq_184:
  v_mov_b32 v28, v29
fs_183:
  s_lshl_b32 s74, s80, 18
  s_add_u32 s74, s74, s66
  s_add_u32 s60, s60, 32
  buffer_load_dwordx4 v[16:19], v3, s[8:11], s60 offen sc1
  s_add_u32 m0, s70, 65536
  s_add_u32 s62, s74, 0
  buffer_load_dwordx4 v2, s[8:11], s62 offen sc1 lds
  s_add_u32 m0, s70, 69632
  s_add_u32 s62, s74, 4096
  buffer_load_dwordx4 v2, s[8:11], s62 offen sc1 lds
  s_add_u32 m0, s70, 73728
  s_add_u32 s62, s74, 8192
  buffer_load_dwordx4 v2, s[8:11], s62 offen sc1 lds
  s_add_u32 m0, s70, 77824
  s_add_u32 s62, s74, 12288
  buffer_load_dwordx4 v2, s[8:11], s62 offen sc1 lds
  s_add_u32 m0, s70, 81920
  s_add_u32 s62, s74, 16384
  buffer_load_dwordx4 v2, s[8:11], s62 offen sc1 lds
  s_add_u32 m0, s70, 86016
  s_add_u32 s62, s74, 20480
  buffer_load_dwordx4 v2, s[8:11], s62 offen sc1 lds
  s_add_u32 m0, s70, 90112
  s_add_u32 s62, s74, 24576
  buffer_load_dwordx4 v2, s[8:11], s62 offen sc1 lds
  s_add_u32 m0, s70, 94208
  s_add_u32 s62, s74, 28672
  buffer_load_dwordx4 v2, s[8:11], s62 offen sc1 lds
  buffer_load_dword v26, v29, s[8:11], 0 offen
  s_add_u32 m0, s70, 98304
  s_add_u32 s62, s74, 32768
  buffer_load_dwordx4 v2, s[8:11], s62 offen sc1 lds
  buffer_load_dword v26, v29, s[8:11], 0 offen
  s_add_u32 m0, s70, 102400
  s_add_u32 s62, s74, 36864
  buffer_load_dwordx4 v2, s[8:11], s62 offen sc1 lds
  s_add_u32 m0, s70, 106496
  s_add_u32 s62, s74, 40960
  buffer_load_dwordx4 v2, s[8:11], s62 offen sc1 lds
  s_add_u32 m0, s70, 110592
  s_add_u32 s62, s74, 45056
  buffer_load_dwordx4 v2, s[8:11], s62 offen sc1 lds
  s_add_u32 m0, s70, 114688
  s_add_u32 s62, s74, 49152
  buffer_load_dwordx4 v2, s[8:11], s62 offen sc1 lds
  s_add_u32 m0, s70, 118784
  s_add_u32 s62, s74, 53248
  buffer_load_dwordx4 v2, s[8:11], s62 offen sc1 lds
  s_add_u32 m0, s70, 122880
  s_add_u32 s62, s74, 57344
  buffer_load_dwordx4 v2, s[8:11], s62 offen sc1 lds
  s_add_u32 m0, s70, 126976
  s_add_u32 s62, s74, 61440
  buffer_load_dwordx4 v2, s[8:11], s62 offen sc1 lds
  s_mov_b32 s73, 0x7ff00000
  s_mov_b32 s71, 0x7ff00000
  s_waitcnt vmcnt(14)
  s_mul_i32 s76, s64, 512
  s_add_u32 s76, s76, s69
  buffer_store_dword v6, v28, s[8:11], s76 offen sc1
  s_barrier
  ds_read_b128 v[64:67], v22 offset:0
  ds_read_b128 v[68:71], v23 offset:0
  ds_read_b128 v[72:75], v22 offset:2048
  ds_read_b128 v[76:79], v23 offset:2048
  ds_read_b128 v[80:83], v22 offset:4096
  ds_read_b128 v[84:87], v23 offset:4096
  s_branch gl_178
gt_182:
  s_mul_i32 s60, s80, 32
  s_add_u32 s60, s60, s67
  buffer_load_dwordx4 v[16:19], v3, s[8:11], s60 offen sc1
  s_waitcnt lgkmcnt(5)
  v_mfma_f32_16x16x32_bf16 v[104:107], a[232:235], v[72:75], v[104:107]
  v_mfma_f32_16x16x32_bf16 v[108:111], a[236:239], v[72:75], v[108:111]
  s_waitcnt lgkmcnt(4)
  v_mfma_f32_16x16x32_bf16 v[112:115], a[232:235], v[76:79], v[112:115]
  v_mfma_f32_16x16x32_bf16 v[116:119], a[236:239], v[76:79], v[116:119]
  s_waitcnt lgkmcnt(3)
  v_mfma_f32_16x16x32_bf16 v[104:107], a[240:243], v[80:83], v[104:107]
  v_mfma_f32_16x16x32_bf16 v[108:111], a[244:247], v[80:83], v[108:111]
  s_waitcnt lgkmcnt(2)
  v_mfma_f32_16x16x32_bf16 v[112:115], a[240:243], v[84:87], v[112:115]
  v_mfma_f32_16x16x32_bf16 v[116:119], a[244:247], v[84:87], v[116:119]
  s_waitcnt lgkmcnt(1)
  v_mfma_f32_16x16x32_bf16 v[104:107], a[248:251], v[88:91], v[104:107]
  v_mfma_f32_16x16x32_bf16 v[108:111], a[252:255], v[88:91], v[108:111]
  s_waitcnt lgkmcnt(0)
  v_mfma_f32_16x16x32_bf16 v[112:115], a[248:251], v[92:95], v[112:115]
  v_mfma_f32_16x16x32_bf16 v[116:119], a[252:255], v[92:95], v[116:119]
  s_lshl_b32 s61, s64, 19
  s_add_u32 s61, s61, s68
  s_add_u32 s63, s61, 262144
  s_nop 0
  buffer_store_dwordx4 v[104:107], v4, s[8:11], s61 offen offset:0 sc1
  buffer_store_dwordx4 v[108:111], v4, s[8:11], s61 offen offset:128 sc1
  s_nop 0
  buffer_store_dwordx4 v[112:115], v4, s[8:11], s63 offen offset:0 sc1
  buffer_store_dwordx4 v[116:119], v4, s[8:11], s63 offen offset:128 sc1
  v_mov_b32 v28, v5
  s_cmp_lt_u32 s80, s65
  s_cbranch_scc0 gl_177_y
  s_waitcnt vmcnt(4)
  v_and_b32 v16, v16, v17
  v_and_b32 v18, v18, v19
  v_and_b32 v16, v16, v18
  v_cmp_ne_u32 vcc, 1, v16
  s_nop 0
  s_cmp_eq_u32 vcc_lo, 0
  s_cbranch_scc1 fs_187
  buffer_load_dwordx4 v[16:19], v3, s[8:11], s60 offen sc1
  s_waitcnt vmcnt(1)
  s_mul_i32 s76, s64, 512
  s_add_u32 s76, s76, s69
  buffer_store_dword v6, v5, s[8:11], s76 offen sc1
  s_waitcnt vmcnt(1)
  v_and_b32 v16, v16, v17
  v_and_b32 v18, v18, v19
  v_and_b32 v16, v16, v18
  v_cmp_ne_u32 vcc, 1, v16
  s_nop 0
  s_cmp_eq_u32 vcc_lo, 0
  s_cbranch_scc1 fq_188
gf_179:
  s_mul_i32 s60, s80, 32
  s_add_u32 s60, s60, s67
pl_189:
  buffer_load_dwordx4 v[16:19], v3, s[8:11], s60 offen sc1
  s_waitcnt vmcnt(0)
  v_and_b32 v16, v16, v17
  v_and_b32 v18, v18, v19
  v_and_b32 v16, v16, v18
  v_cmp_ne_u32 vcc, 1, v16
  s_nop 0
  s_cmp_eq_u32 vcc_lo, 0
  s_cbranch_scc1 pk_190
  s_sub_u32 s57, s57, 1
  s_cbranch_scc0 pl_189
  s_branch ABORT
pk_190:
fq_188:
  v_mov_b32 v28, v29
fs_187:
  s_lshl_b32 s74, s80, 18
  s_add_u32 s74, s74, s66
  s_add_u32 s60, s60, 32
  buffer_load_dwordx4 v[16:19], v3, s[8:11], s60 offen sc1
  s_add_u32 m0, s70, 0
  s_add_u32 s62, s74, 0
  buffer_load_dwordx4 v2, s[8:11], s62 offen sc1 lds
  s_add_u32 m0, s70, 4096
  s_add_u32 s62, s74, 4096
  buffer_load_dwordx4 v2, s[8:11], s62 offen sc1 lds
  s_add_u32 m0, s70, 8192
  s_add_u32 s62, s74, 8192
  buffer_load_dwordx4 v2, s[8:11], s62 offen sc1 lds
  s_add_u32 m0, s70, 12288
  s_add_u32 s62, s74, 12288
  buffer_load_dwordx4 v2, s[8:11], s62 offen sc1 lds
  s_add_u32 m0, s70, 16384
  s_add_u32 s62, s74, 16384
  buffer_load_dwordx4 v2, s[8:11], s62 offen sc1 lds
  s_add_u32 m0, s70, 20480
  s_add_u32 s62, s74, 20480
  buffer_load_dwordx4 v2, s[8:11], s62 offen sc1 lds
  s_add_u32 m0, s70, 24576
  s_add_u32 s62, s74, 24576
  buffer_load_dwordx4 v2, s[8:11], s62 offen sc1 lds
  s_add_u32 m0, s70, 28672
  s_add_u32 s62, s74, 28672
  buffer_load_dwordx4 v2, s[8:11], s62 offen sc1 lds
  buffer_load_dword v26, v29, s[8:11], 0 offen
  s_add_u32 m0, s70, 32768
  s_add_u32 s62, s74, 32768
  buffer_load_dwordx4 v2, s[8:11], s62 offen sc1 lds
  buffer_load_dword v26, v29, s[8:11], 0 offen
  s_add_u32 m0, s70, 36864
  s_add_u32 s62, s74, 36864
  buffer_load_dwordx4 v2, s[8:11], s62 offen sc1 lds
  s_add_u32 m0, s70, 40960
  s_add_u32 s62, s74, 40960
  buffer_load_dwordx4 v2, s[8:11], s62 offen sc1 lds
  s_add_u32 m0, s70, 45056
  s_add_u32 s62, s74, 45056
  buffer_load_dwordx4 v2, s[8:11], s62 offen sc1 lds
  s_add_u32 m0, s70, 49152
  s_add_u32 s62, s74, 49152
  buffer_load_dwordx4 v2, s[8:11], s62 offen sc1 lds
  s_add_u32 m0, s70, 53248
  s_add_u32 s62, s74, 53248
  buffer_load_dwordx4 v2, s[8:11], s62 offen sc1 lds
  s_add_u32 m0, s70, 57344
  s_add_u32 s62, s74, 57344
  buffer_load_dwordx4 v2, s[8:11], s62 offen sc1 lds
  s_add_u32 m0, s70, 61440
  s_add_u32 s62, s74, 61440
  buffer_load_dwordx4 v2, s[8:11], s62 offen sc1 lds
  s_mov_b32 s73, 0x7ff00000
  s_mov_b32 s71, 0x7ff00000
  s_waitcnt vmcnt(14)
  s_mul_i32 s76, s64, 512
  s_add_u32 s76, s76, s69
  buffer_store_dword v6, v28, s[8:11], s76 offen sc1
  s_barrier
  ds_read_b128 v[64:67], v20 offset:0
  ds_read_b128 v[68:71], v21 offset:0
  ds_read_b128 v[72:75], v20 offset:2048
  ds_read_b128 v[76:79], v21 offset:2048
  ds_read_b128 v[80:83], v20 offset:4096
  ds_read_b128 v[84:87], v21 offset:4096
  s_branch gl_177
gl_177_y:
  s_waitcnt vmcnt(0)
  s_mul_i32 s76, s64, 512
  s_add_u32 s76, s76, s69
  buffer_store_dword v6, v5, s[8:11], s76 offen sc1
gl_177_x:
  s_barrier
  s_branch DONE
JF2:
  s_add_u32 s69, s69, 2260992
  s_add_u32 s66, s66, 117440512
  s_add_u32 s68, s68, 134217728
  s_mul_i32 s61, s79, 1835008
  s_add_u32 s77, s77, s61
  s_lshl_b32 s67, s79, 7
  s_add_u32 s67, s67, 2293760
  s_mov_b32 s81, 6
  s_mov_b32 s12, s42
  s_mov_b32 s13, s43
  s_mov_b32 s14, 0x700000
  s_mov_b32 s15, 0x00020000
  v_lshrrev_b32 v10, 2, v0
  s_mov_b32 s59, 2048
  v_mul_lo_u32 v8, v10, s59
  v_and_b32 v11, 3, v0
  v_lshl_add_u32 v8, v11, 4, v8
  s_lshl_b32 s59, s54, 6
  s_add_u32 s59, s59, s77
  v_add_u32 v8, s59, v8
  s_lshl_b32 s63, s54, 15
  v_and_b32 v10, 3, v10
  v_mov_b32 v9, 0
  v_bfe_u32 v9, v0, 4, 1
  v_lshl_add_u32 v10, v9, 2, v10
  v_lshrrev_b32 v9, 5, v0
  v_lshl_add_u32 v10, v9, 4, v10
  v_lshlrev_b32 v9, 6, v10
  v_add_u32 v9, s63, v9
  v_lshlrev_b32 v10, 3, v11
  v_and_b32 v12, 2, v11
  v_lshl_add_u32 v12, v12, 3, v10
  s_cmp_eq_u32 s78, 1
  s_cselect_b64 vcc, -1, 0
  s_cselect_b32 s59, 32, 16
  v_cndmask_b32 v10, v12, v10, vcc
  v_add_u32 v9, v9, v10
  v_add_u32 v12, s59, v9
  s_add_u32 m0, s63, 0
  s_mov_b32 s59, 0
  buffer_load_dwordx4 v8, s[12:15], s59 offen lds
  s_add_u32 m0, s63, 1024
  s_mov_b32 s59, 32768
  buffer_load_dwordx4 v8, s[12:15], s59 offen lds
  s_add_u32 m0, s63, 2048
  s_mov_b32 s59, 65536
  buffer_load_dwordx4 v8, s[12:15], s59 offen lds
  s_add_u32 m0, s63, 3072
  s_mov_b32 s59, 98304
  buffer_load_dwordx4 v8, s[12:15], s59 offen lds
  s_add_u32 m0, s63, 4096
  s_mov_b32 s59, 131072
  buffer_load_dwordx4 v8, s[12:15], s59 offen lds
  s_add_u32 m0, s63, 5120
  s_mov_b32 s59, 163840
  buffer_load_dwordx4 v8, s[12:15], s59 offen lds
  s_add_u32 m0, s63, 6144
  s_mov_b32 s59, 196608
  buffer_load_dwordx4 v8, s[12:15], s59 offen lds
  s_add_u32 m0, s63, 7168
  s_mov_b32 s59, 229376
  buffer_load_dwordx4 v8, s[12:15], s59 offen lds
  s_add_u32 m0, s63, 8192
  s_mov_b32 s59, 262144
  buffer_load_dwordx4 v8, s[12:15], s59 offen lds
  s_add_u32 m0, s63, 9216
  s_mov_b32 s59, 294912
  buffer_load_dwordx4 v8, s[12:15], s59 offen lds
  s_add_u32 m0, s63, 10240
  s_mov_b32 s59, 327680
  buffer_load_dwordx4 v8, s[12:15], s59 offen lds
  s_add_u32 m0, s63, 11264
  s_mov_b32 s59, 360448
  buffer_load_dwordx4 v8, s[12:15], s59 offen lds
  s_add_u32 m0, s63, 12288
  s_mov_b32 s59, 393216
  buffer_load_dwordx4 v8, s[12:15], s59 offen lds
  s_add_u32 m0, s63, 13312
  s_mov_b32 s59, 425984
  buffer_load_dwordx4 v8, s[12:15], s59 offen lds
  s_add_u32 m0, s63, 14336
  s_mov_b32 s59, 458752
  buffer_load_dwordx4 v8, s[12:15], s59 offen lds
  s_add_u32 m0, s63, 15360
  s_mov_b32 s59, 491520
  buffer_load_dwordx4 v8, s[12:15], s59 offen lds
  s_add_u32 m0, s63, 16384
  s_mov_b32 s59, 524288
  buffer_load_dwordx4 v8, s[12:15], s59 offen lds
  s_add_u32 m0, s63, 17408
  s_mov_b32 s59, 557056
  buffer_load_dwordx4 v8, s[12:15], s59 offen lds
  s_add_u32 m0, s63, 18432
  s_mov_b32 s59, 589824
  buffer_load_dwordx4 v8, s[12:15], s59 offen lds
  s_add_u32 m0, s63, 19456
  s_mov_b32 s59, 622592
  buffer_load_dwordx4 v8, s[12:15], s59 offen lds
  s_add_u32 m0, s63, 20480
  s_mov_b32 s59, 655360
  buffer_load_dwordx4 v8, s[12:15], s59 offen lds
  s_add_u32 m0, s63, 21504
  s_mov_b32 s59, 688128
  buffer_load_dwordx4 v8, s[12:15], s59 offen lds
  s_add_u32 m0, s63, 22528
  s_mov_b32 s59, 720896
  buffer_load_dwordx4 v8, s[12:15], s59 offen lds
  s_add_u32 m0, s63, 23552
  s_mov_b32 s59, 753664
  buffer_load_dwordx4 v8, s[12:15], s59 offen lds
  s_add_u32 m0, s63, 24576
  s_mov_b32 s59, 786432
  buffer_load_dwordx4 v8, s[12:15], s59 offen lds
  s_add_u32 m0, s63, 25600
  s_mov_b32 s59, 819200
  buffer_load_dwordx4 v8, s[12:15], s59 offen lds
  s_add_u32 m0, s63, 26624
  s_mov_b32 s59, 851968
  buffer_load_dwordx4 v8, s[12:15], s59 offen lds
  s_add_u32 m0, s63, 27648
  s_mov_b32 s59, 884736
  buffer_load_dwordx4 v8, s[12:15], s59 offen lds
  s_add_u32 m0, s63, 28672
  s_mov_b32 s59, 917504
  buffer_load_dwordx4 v8, s[12:15], s59 offen lds
  s_add_u32 m0, s63, 29696
  s_mov_b32 s59, 950272
  buffer_load_dwordx4 v8, s[12:15], s59 offen lds
  s_add_u32 m0, s63, 30720
  s_mov_b32 s59, 983040
  buffer_load_dwordx4 v8, s[12:15], s59 offen lds
  s_add_u32 m0, s63, 31744
  s_mov_b32 s59, 1015808
  buffer_load_dwordx4 v8, s[12:15], s59 offen lds
  s_waitcnt vmcnt(16)
  ds_read_b64_tr_b16 a[0:1], v9 offset:0
  ds_read_b64_tr_b16 a[2:3], v9 offset:512
  ds_read_b64_tr_b16 a[4:5], v12 offset:0
  ds_read_b64_tr_b16 a[6:7], v12 offset:512
  ds_read_b64_tr_b16 a[8:9], v9 offset:2048
  ds_read_b64_tr_b16 a[10:11], v9 offset:2560
  ds_read_b64_tr_b16 a[12:13], v12 offset:2048
  ds_read_b64_tr_b16 a[14:15], v12 offset:2560
  ds_read_b64_tr_b16 a[16:17], v9 offset:4096
  ds_read_b64_tr_b16 a[18:19], v9 offset:4608
  ds_read_b64_tr_b16 a[20:21], v12 offset:4096
  ds_read_b64_tr_b16 a[22:23], v12 offset:4608
  ds_read_b64_tr_b16 a[24:25], v9 offset:6144
  ds_read_b64_tr_b16 a[26:27], v9 offset:6656
  ds_read_b64_tr_b16 a[28:29], v12 offset:6144
  ds_read_b64_tr_b16 a[30:31], v12 offset:6656
  ds_read_b64_tr_b16 a[32:33], v9 offset:8192
  ds_read_b64_tr_b16 a[34:35], v9 offset:8704
  ds_read_b64_tr_b16 a[36:37], v12 offset:8192
  ds_read_b64_tr_b16 a[38:39], v12 offset:8704
  ds_read_b64_tr_b16 a[40:41], v9 offset:10240
  ds_read_b64_tr_b16 a[42:43], v9 offset:10752
  ds_read_b64_tr_b16 a[44:45], v12 offset:10240
  ds_read_b64_tr_b16 a[46:47], v12 offset:10752
  ds_read_b64_tr_b16 a[48:49], v9 offset:12288
  ds_read_b64_tr_b16 a[50:51], v9 offset:12800
  ds_read_b64_tr_b16 a[52:53], v12 offset:12288
  ds_read_b64_tr_b16 a[54:55], v12 offset:12800
  ds_read_b64_tr_b16 a[56:57], v9 offset:14336
  ds_read_b64_tr_b16 a[58:59], v9 offset:14848
  ds_read_b64_tr_b16 a[60:61], v12 offset:14336
  ds_read_b64_tr_b16 a[62:63], v12 offset:14848
  s_waitcnt lgkmcnt(0)
  s_add_u32 m0, s63, 0
  s_mov_b32 s59, 1048576
  buffer_load_dwordx4 v8, s[12:15], s59 offen lds
  s_add_u32 m0, s63, 1024
  s_mov_b32 s59, 1081344
  buffer_load_dwordx4 v8, s[12:15], s59 offen lds
  s_add_u32 m0, s63, 2048
  s_mov_b32 s59, 1114112
  buffer_load_dwordx4 v8, s[12:15], s59 offen lds
  s_add_u32 m0, s63, 3072
  s_mov_b32 s59, 1146880
  buffer_load_dwordx4 v8, s[12:15], s59 offen lds
  s_add_u32 m0, s63, 4096
  s_mov_b32 s59, 1179648
  buffer_load_dwordx4 v8, s[12:15], s59 offen lds
  s_add_u32 m0, s63, 5120
  s_mov_b32 s59, 1212416
  buffer_load_dwordx4 v8, s[12:15], s59 offen lds
  s_add_u32 m0, s63, 6144
  s_mov_b32 s59, 1245184
  buffer_load_dwordx4 v8, s[12:15], s59 offen lds
  s_add_u32 m0, s63, 7168
  s_mov_b32 s59, 1277952
  buffer_load_dwordx4 v8, s[12:15], s59 offen lds
  s_add_u32 m0, s63, 8192
  s_mov_b32 s59, 1310720
  buffer_load_dwordx4 v8, s[12:15], s59 offen lds
  s_add_u32 m0, s63, 9216
  s_mov_b32 s59, 1343488
  buffer_load_dwordx4 v8, s[12:15], s59 offen lds
  s_add_u32 m0, s63, 10240
  s_mov_b32 s59, 1376256
  buffer_load_dwordx4 v8, s[12:15], s59 offen lds
  s_add_u32 m0, s63, 11264
  s_mov_b32 s59, 1409024
  buffer_load_dwordx4 v8, s[12:15], s59 offen lds
  s_add_u32 m0, s63, 12288
  s_mov_b32 s59, 1441792
  buffer_load_dwordx4 v8, s[12:15], s59 offen lds
  s_add_u32 m0, s63, 13312
  s_mov_b32 s59, 1474560
  buffer_load_dwordx4 v8, s[12:15], s59 offen lds
  s_add_u32 m0, s63, 14336
  s_mov_b32 s59, 1507328
  buffer_load_dwordx4 v8, s[12:15], s59 offen lds
  s_add_u32 m0, s63, 15360
  s_mov_b32 s59, 1540096
  buffer_load_dwordx4 v8, s[12:15], s59 offen lds
  s_waitcnt vmcnt(16)
  ds_read_b64_tr_b16 a[64:65], v9 offset:16384
  ds_read_b64_tr_b16 a[66:67], v9 offset:16896
  ds_read_b64_tr_b16 a[68:69], v12 offset:16384
  ds_read_b64_tr_b16 a[70:71], v12 offset:16896
  ds_read_b64_tr_b16 a[72:73], v9 offset:18432
  ds_read_b64_tr_b16 a[74:75], v9 offset:18944
  ds_read_b64_tr_b16 a[76:77], v12 offset:18432
  ds_read_b64_tr_b16 a[78:79], v12 offset:18944
  ds_read_b64_tr_b16 a[80:81], v9 offset:20480
  ds_read_b64_tr_b16 a[82:83], v9 offset:20992
  ds_read_b64_tr_b16 a[84:85], v12 offset:20480
  ds_read_b64_tr_b16 a[86:87], v12 offset:20992
  ds_read_b64_tr_b16 a[88:89], v9 offset:22528
  ds_read_b64_tr_b16 a[90:91], v9 offset:23040
  ds_read_b64_tr_b16 a[92:93], v12 offset:22528
  ds_read_b64_tr_b16 a[94:95], v12 offset:23040
  ds_read_b64_tr_b16 a[96:97], v9 offset:24576
  ds_read_b64_tr_b16 a[98:99], v9 offset:25088
  ds_read_b64_tr_b16 a[100:101], v12 offset:24576
  ds_read_b64_tr_b16 a[102:103], v12 offset:25088
  ds_read_b64_tr_b16 a[104:105], v9 offset:26624
  ds_read_b64_tr_b16 a[106:107], v9 offset:27136
  ds_read_b64_tr_b16 a[108:109], v12 offset:26624
  ds_read_b64_tr_b16 a[110:111], v12 offset:27136
  ds_read_b64_tr_b16 a[112:113], v9 offset:28672
  ds_read_b64_tr_b16 a[114:115], v9 offset:29184
  ds_read_b64_tr_b16 a[116:117], v12 offset:28672
  ds_read_b64_tr_b16 a[118:119], v12 offset:29184
  ds_read_b64_tr_b16 a[120:121], v9 offset:30720
  ds_read_b64_tr_b16 a[122:123], v9 offset:31232
  ds_read_b64_tr_b16 a[124:125], v12 offset:30720
  ds_read_b64_tr_b16 a[126:127], v12 offset:31232
  s_waitcnt lgkmcnt(0)
  s_add_u32 m0, s63, 16384
  s_mov_b32 s59, 1572864
  buffer_load_dwordx4 v8, s[12:15], s59 offen lds
  s_add_u32 m0, s63, 17408
  s_mov_b32 s59, 1605632
  buffer_load_dwordx4 v8, s[12:15], s59 offen lds
  s_add_u32 m0, s63, 18432
  s_mov_b32 s59, 1638400
  buffer_load_dwordx4 v8, s[12:15], s59 offen lds
  s_add_u32 m0, s63, 19456
  s_mov_b32 s59, 1671168
  buffer_load_dwordx4 v8, s[12:15], s59 offen lds
  s_add_u32 m0, s63, 20480
  s_mov_b32 s59, 1703936
  buffer_load_dwordx4 v8, s[12:15], s59 offen lds
  s_add_u32 m0, s63, 21504
  s_mov_b32 s59, 1736704
  buffer_load_dwordx4 v8, s[12:15], s59 offen lds
  s_add_u32 m0, s63, 22528
  s_mov_b32 s59, 1769472
  buffer_load_dwordx4 v8, s[12:15], s59 offen lds
  s_add_u32 m0, s63, 23552
  s_mov_b32 s59, 1802240
  buffer_load_dwordx4 v8, s[12:15], s59 offen lds
  s_waitcnt vmcnt(8)
  ds_read_b64_tr_b16 a[128:129], v9 offset:0
  ds_read_b64_tr_b16 a[130:131], v9 offset:512
  ds_read_b64_tr_b16 a[132:133], v12 offset:0
  ds_read_b64_tr_b16 a[134:135], v12 offset:512
  ds_read_b64_tr_b16 a[136:137], v9 offset:2048
  ds_read_b64_tr_b16 a[138:139], v9 offset:2560
  ds_read_b64_tr_b16 a[140:141], v12 offset:2048
  ds_read_b64_tr_b16 a[142:143], v12 offset:2560
  ds_read_b64_tr_b16 a[144:145], v9 offset:4096
  ds_read_b64_tr_b16 a[146:147], v9 offset:4608
  ds_read_b64_tr_b16 a[148:149], v12 offset:4096
  ds_read_b64_tr_b16 a[150:151], v12 offset:4608
  ds_read_b64_tr_b16 a[152:153], v9 offset:6144
  ds_read_b64_tr_b16 a[154:155], v9 offset:6656
  ds_read_b64_tr_b16 a[156:157], v12 offset:6144
  ds_read_b64_tr_b16 a[158:159], v12 offset:6656
  ds_read_b64_tr_b16 a[160:161], v9 offset:8192
  ds_read_b64_tr_b16 a[162:163], v9 offset:8704
  ds_read_b64_tr_b16 a[164:165], v12 offset:8192
  ds_read_b64_tr_b16 a[166:167], v12 offset:8704
  ds_read_b64_tr_b16 a[168:169], v9 offset:10240
  ds_read_b64_tr_b16 a[170:171], v9 offset:10752
  ds_read_b64_tr_b16 a[172:173], v12 offset:10240
  ds_read_b64_tr_b16 a[174:175], v12 offset:10752
  ds_read_b64_tr_b16 a[176:177], v9 offset:12288
  ds_read_b64_tr_b16 a[178:179], v9 offset:12800
  ds_read_b64_tr_b16 a[180:181], v12 offset:12288
  ds_read_b64_tr_b16 a[182:183], v12 offset:12800
  ds_read_b64_tr_b16 a[184:185], v9 offset:14336
  ds_read_b64_tr_b16 a[186:187], v9 offset:14848
  ds_read_b64_tr_b16 a[188:189], v12 offset:14336
  ds_read_b64_tr_b16 a[190:191], v12 offset:14848
  s_waitcnt lgkmcnt(0)
  s_waitcnt vmcnt(0)
  ds_read_b64_tr_b16 a[192:193], v9 offset:16384
  ds_read_b64_tr_b16 a[194:195], v9 offset:16896
  ds_read_b64_tr_b16 a[196:197], v12 offset:16384
  ds_read_b64_tr_b16 a[198:199], v12 offset:16896
  ds_read_b64_tr_b16 a[200:201], v9 offset:18432
  ds_read_b64_tr_b16 a[202:203], v9 offset:18944
  ds_read_b64_tr_b16 a[204:205], v12 offset:18432
  ds_read_b64_tr_b16 a[206:207], v12 offset:18944
  ds_read_b64_tr_b16 a[208:209], v9 offset:20480
  ds_read_b64_tr_b16 a[210:211], v9 offset:20992
  ds_read_b64_tr_b16 a[212:213], v12 offset:20480
  ds_read_b64_tr_b16 a[214:215], v12 offset:20992
  ds_read_b64_tr_b16 a[216:217], v9 offset:22528
  ds_read_b64_tr_b16 a[218:219], v9 offset:23040
  ds_read_b64_tr_b16 a[220:221], v12 offset:22528
  ds_read_b64_tr_b16 a[222:223], v12 offset:23040
  s_waitcnt lgkmcnt(0)
  v_lshlrev_b32 v1, 4, v0
  v_lshrrev_b32 v8, 4, v0
  v_and_b32 v9, 15, v0
  v_lshlrev_b32 v10, 4, v9
  v_lshl_add_u32 v10, v8, 9, v10
  v_mov_b32 v20, v10
  v_add_u32 v21, 256, v10
  v_add_u32 v22, 0x10000, v20
  v_add_u32 v23, 0x10000, v21
  s_lshl_b32 s70, s54, 10
  v_add_u32 v2, s70, v1
  v_and_b32 v3, 31, v0
  v_min_u32 v3, s81, v3
  v_lshlrev_b32 v3, 4, v3
  v_lshrrev_b32 v24, 5, v0
  v_mul_u32_u24 v24, 512, v24
  v_add_u32 v3, v3, v24
  s_and_b32 s59, s56, 7
  s_lshl_b32 s59, s59, 2
  s_add_u32 s59, s59, s54
  s_mul_i32 s59, s59, 14
  v_add_u32 v24, s59, v0
  v_min_u32 v24, 447, v24
  v_lshlrev_b32 v24, 7, v24
  v_mov_b32 v25, 0x7ff00000
  v_mov_b32 v29, 0x7ff00000
  v_cmp_gt_u32 vcc, 14, v0
  s_nop 1
  v_cndmask_b32 v24, v25, v24, vcc
  v_mov_b32 v6, 0
  v_mov_b32 v5, 0x7ff00000
  v_cmp_eq_u32 vcc, 0, v0
  s_nop 1
  v_cndmask_b32 v5, v5, v6, vcc
  v_mov_b32 v6, 1
  v_bfe_u32 v11, v0, 2, 2
  v_lshlrev_b32 v4, 16, v11
  v_and_b32 v11, 3, v0
  v_lshl_add_u32 v4, v11, 4, v4
  v_lshrrev_b32 v11, 5, v0
  v_lshl_add_u32 v4, v11, 8, v4
  s_lshl_b32 s59, s54, 9
  v_add_u32 v4, s59, v4
  v_bfe_u32 v11, v0, 4, 1
  v_lshl_add_u32 v4, v11, 6, v4
  s_mov_b32 s80, s64
  s_barrier
  s_branch gf_193
gl_191:
  s_mov_b32 s64, s80
  s_add_u32 s80, s64, 1
  ds_read_b128 v[88:91], v20 offset:6144
  s_waitcnt lgkmcnt(6)
  v_mfma_f32_16x16x32_bf16 v[32:35], a[0:3], v[64:67], 0
  v_mfma_f32_16x16x32_bf16 v[36:39], a[4:7], v[64:67], 0
  v_and_b32 v16, v16, v17
  v_and_b32 v18, v18, v19
  s_lshl_b32 s74, s80, 18
  s_add_u32 s74, s74, s66
  ds_read_b128 v[92:95], v21 offset:6144
  s_waitcnt lgkmcnt(6)
  v_mfma_f32_16x16x32_bf16 v[40:43], a[0:3], v[68:71], 0
  v_mfma_f32_16x16x32_bf16 v[44:47], a[4:7], v[68:71], 0
  v_and_b32 v16, v16, v18
  v_cmp_ne_u32 vcc, 1, v16
  s_cmp_lt_u32 s80, s65
  s_cselect_b32 vcc_lo, vcc_lo, -1
  s_cmp_eq_u32 vcc_lo, 0
  s_cselect_b32 s59, 0, 0x7ff00000
  v_add_u32 v7, s59, v2
  ds_read_b128 v[64:67], v20 offset:8192
  s_waitcnt lgkmcnt(6)
  v_mfma_f32_16x16x32_bf16 v[32:35], a[8:11], v[72:75], v[32:35]
  v_mfma_f32_16x16x32_bf16 v[36:39], a[12:15], v[72:75], v[36:39]
  s_add_u32 s59, s80, 1
  s_cmp_lt_u32 s59, s65
  s_cselect_b32 vcc_hi, vcc_hi, -1
  s_cmp_eq_u32 vcc_hi, 0
  s_cselect_b32 s59, 0, 0x7ff00000
  s_mov_b32 vcc_hi, 0
  v_add_u32 v25, s59, v24
  s_add_u32 m0, s70, 65536
  s_add_u32 s62, s74, 0
  buffer_load_dwordx4 v7, s[8:11], s62 offen sc1 lds
  ds_read_b128 v[68:71], v21 offset:8192
  s_waitcnt lgkmcnt(6)
  v_mfma_f32_16x16x32_bf16 v[40:43], a[8:11], v[76:79], v[40:43]
  v_mfma_f32_16x16x32_bf16 v[44:47], a[12:15], v[76:79], v[44:47]
  v_add_u32 v27, s73, v4
  v_add_u32 v28, s71, v5
  ds_read_b128 v[72:75], v20 offset:10240
  s_waitcnt lgkmcnt(6)
  v_mfma_f32_16x16x32_bf16 v[32:35], a[16:19], v[80:83], v[32:35]
  v_mfma_f32_16x16x32_bf16 v[36:39], a[20:23], v[80:83], v[36:39]
  s_lshl_b32 s61, s64, 19
  s_add_u32 s61, s61, s68
  s_sub_u32 s61, s61, 524288
  s_add_u32 s63, s61, 262144
  buffer_store_dwordx4 v[104:107], v27, s[8:11], s61 offen offset:0 sc1
  ds_read_b128 v[76:79], v21 offset:10240
  s_waitcnt lgkmcnt(6)
  v_mfma_f32_16x16x32_bf16 v[40:43], a[16:19], v[84:87], v[40:43]
  v_mfma_f32_16x16x32_bf16 v[44:47], a[20:23], v[84:87], v[44:47]
  ds_read_b128 v[80:83], v20 offset:12288
  s_waitcnt lgkmcnt(6)
  v_mfma_f32_16x16x32_bf16 v[32:35], a[24:27], v[88:91], v[32:35]
  v_mfma_f32_16x16x32_bf16 v[36:39], a[28:31], v[88:91], v[36:39]
  s_add_u32 m0, s70, 69632
  s_add_u32 s62, s74, 4096
  buffer_load_dwordx4 v7, s[8:11], s62 offen sc1 lds
  ds_read_b128 v[84:87], v21 offset:12288
  s_waitcnt lgkmcnt(6)
  v_mfma_f32_16x16x32_bf16 v[40:43], a[24:27], v[92:95], v[40:43]
  v_mfma_f32_16x16x32_bf16 v[44:47], a[28:31], v[92:95], v[44:47]
  ds_read_b128 v[88:91], v20 offset:14336
  s_waitcnt lgkmcnt(6)
  v_mfma_f32_16x16x32_bf16 v[32:35], a[32:35], v[64:67], v[32:35]
  v_mfma_f32_16x16x32_bf16 v[36:39], a[36:39], v[64:67], v[36:39]
  buffer_store_dwordx4 v[108:111], v27, s[8:11], s61 offen offset:128 sc1
  ds_read_b128 v[92:95], v21 offset:14336
  s_waitcnt lgkmcnt(6)
  v_mfma_f32_16x16x32_bf16 v[40:43], a[32:35], v[68:71], v[40:43]
  v_mfma_f32_16x16x32_bf16 v[44:47], a[36:39], v[68:71], v[44:47]
  s_waitcnt vmcnt(13)
  s_barrier
  ds_read_b128 v[64:67], v20 offset:16384
  s_waitcnt lgkmcnt(6)
  v_mfma_f32_16x16x32_bf16 v[32:35], a[40:43], v[72:75], v[32:35]
  v_mfma_f32_16x16x32_bf16 v[36:39], a[44:47], v[72:75], v[36:39]
  s_add_u32 m0, s70, 73728
  s_add_u32 s62, s74, 8192
  buffer_load_dwordx4 v7, s[8:11], s62 offen sc1 lds
  ds_read_b128 v[68:71], v21 offset:16384
  s_waitcnt lgkmcnt(6)
  v_mfma_f32_16x16x32_bf16 v[40:43], a[40:43], v[76:79], v[40:43]
  v_mfma_f32_16x16x32_bf16 v[44:47], a[44:47], v[76:79], v[44:47]
  ds_read_b128 v[72:75], v20 offset:18432
  s_waitcnt lgkmcnt(6)
  v_mfma_f32_16x16x32_bf16 v[32:35], a[48:51], v[80:83], v[32:35]
  v_mfma_f32_16x16x32_bf16 v[36:39], a[52:55], v[80:83], v[36:39]
  buffer_store_dwordx4 v[112:115], v27, s[8:11], s63 offen offset:0 sc1
  ds_read_b128 v[76:79], v21 offset:18432
  s_waitcnt lgkmcnt(6)
  v_mfma_f32_16x16x32_bf16 v[40:43], a[48:51], v[84:87], v[40:43]
  v_mfma_f32_16x16x32_bf16 v[44:47], a[52:55], v[84:87], v[44:47]
  ds_read_b128 v[80:83], v20 offset:20480
  s_waitcnt lgkmcnt(6)
  v_mfma_f32_16x16x32_bf16 v[32:35], a[56:59], v[88:91], v[32:35]
  v_mfma_f32_16x16x32_bf16 v[36:39], a[60:63], v[88:91], v[36:39]
  s_add_u32 m0, s70, 77824
  s_add_u32 s62, s74, 12288
  buffer_load_dwordx4 v7, s[8:11], s62 offen sc1 lds
  ds_read_b128 v[84:87], v21 offset:20480
  s_waitcnt lgkmcnt(6)
  v_mfma_f32_16x16x32_bf16 v[40:43], a[56:59], v[92:95], v[40:43]
  v_mfma_f32_16x16x32_bf16 v[44:47], a[60:63], v[92:95], v[44:47]
  ds_read_b128 v[88:91], v20 offset:22528
  s_waitcnt lgkmcnt(6)
  v_mfma_f32_16x16x32_bf16 v[32:35], a[64:67], v[64:67], v[32:35]
  v_mfma_f32_16x16x32_bf16 v[36:39], a[68:71], v[64:67], v[36:39]
  buffer_store_dwordx4 v[116:119], v27, s[8:11], s63 offen offset:128 sc1
  ds_read_b128 v[92:95], v21 offset:22528
  s_waitcnt lgkmcnt(6)
  v_mfma_f32_16x16x32_bf16 v[40:43], a[64:67], v[68:71], v[40:43]
  v_mfma_f32_16x16x32_bf16 v[44:47], a[68:71], v[68:71], v[44:47]
  ds_read_b128 v[64:67], v20 offset:24576
  s_waitcnt lgkmcnt(6)
  v_mfma_f32_16x16x32_bf16 v[32:35], a[72:75], v[72:75], v[32:35]
  v_mfma_f32_16x16x32_bf16 v[36:39], a[76:79], v[72:75], v[36:39]
  s_add_u32 m0, s70, 81920
  s_add_u32 s62, s74, 16384
  buffer_load_dwordx4 v7, s[8:11], s62 offen sc1 lds
  ds_read_b128 v[68:71], v21 offset:24576
  s_waitcnt lgkmcnt(6)
  v_mfma_f32_16x16x32_bf16 v[40:43], a[72:75], v[76:79], v[40:43]
  v_mfma_f32_16x16x32_bf16 v[44:47], a[76:79], v[76:79], v[44:47]
  ds_read_b128 v[72:75], v20 offset:26624
  s_waitcnt lgkmcnt(6)
  v_mfma_f32_16x16x32_bf16 v[32:35], a[80:83], v[80:83], v[32:35]
  v_mfma_f32_16x16x32_bf16 v[36:39], a[84:87], v[80:83], v[36:39]
  ds_read_b128 v[76:79], v21 offset:26624
  s_waitcnt lgkmcnt(6)
  v_mfma_f32_16x16x32_bf16 v[40:43], a[80:83], v[84:87], v[40:43]
  v_mfma_f32_16x16x32_bf16 v[44:47], a[84:87], v[84:87], v[44:47]
  ds_read_b128 v[80:83], v20 offset:28672
  s_waitcnt lgkmcnt(6)
  v_mfma_f32_16x16x32_bf16 v[32:35], a[88:91], v[88:91], v[32:35]
  v_mfma_f32_16x16x32_bf16 v[36:39], a[92:95], v[88:91], v[36:39]
  s_add_u32 m0, s70, 86016
  s_add_u32 s62, s74, 20480
  buffer_load_dwordx4 v7, s[8:11], s62 offen sc1 lds
  ds_read_b128 v[84:87], v21 offset:28672
  s_waitcnt lgkmcnt(6)
  v_mfma_f32_16x16x32_bf16 v[40:43], a[88:91], v[92:95], v[40:43]
  v_mfma_f32_16x16x32_bf16 v[44:47], a[92:95], v[92:95], v[44:47]
  ds_read_b128 v[88:91], v20 offset:30720
  s_waitcnt lgkmcnt(6)
  v_mfma_f32_16x16x32_bf16 v[32:35], a[96:99], v[64:67], v[32:35]
  v_mfma_f32_16x16x32_bf16 v[36:39], a[100:103], v[64:67], v[36:39]
  ds_read_b128 v[92:95], v21 offset:30720
  s_waitcnt lgkmcnt(6)
  v_mfma_f32_16x16x32_bf16 v[40:43], a[96:99], v[68:71], v[40:43]
  v_mfma_f32_16x16x32_bf16 v[44:47], a[100:103], v[68:71], v[44:47]
  s_waitcnt vmcnt(12)
  s_barrier
  ds_read_b128 v[64:67], v20 offset:32768
  s_waitcnt lgkmcnt(6)
  v_mfma_f32_16x16x32_bf16 v[32:35], a[104:107], v[72:75], v[32:35]
  v_mfma_f32_16x16x32_bf16 v[36:39], a[108:111], v[72:75], v[36:39]
  s_add_u32 m0, s70, 90112
  s_add_u32 s62, s74, 24576
  buffer_load_dwordx4 v7, s[8:11], s62 offen sc1 lds
  ds_read_b128 v[68:71], v21 offset:32768
  s_waitcnt lgkmcnt(6)
  v_mfma_f32_16x16x32_bf16 v[40:43], a[104:107], v[76:79], v[40:43]
  v_mfma_f32_16x16x32_bf16 v[44:47], a[108:111], v[76:79], v[44:47]
  ds_read_b128 v[72:75], v20 offset:34816
  s_waitcnt lgkmcnt(6)
  v_mfma_f32_16x16x32_bf16 v[32:35], a[112:115], v[80:83], v[32:35]
  v_mfma_f32_16x16x32_bf16 v[36:39], a[116:119], v[80:83], v[36:39]
  ds_read_b128 v[76:79], v21 offset:34816
  s_waitcnt lgkmcnt(6)
  v_mfma_f32_16x16x32_bf16 v[40:43], a[112:115], v[84:87], v[40:43]
  v_mfma_f32_16x16x32_bf16 v[44:47], a[116:119], v[84:87], v[44:47]
  ds_read_b128 v[80:83], v20 offset:36864
  s_waitcnt lgkmcnt(6)
  v_mfma_f32_16x16x32_bf16 v[32:35], a[120:123], v[88:91], v[32:35]
  v_mfma_f32_16x16x32_bf16 v[36:39], a[124:127], v[88:91], v[36:39]
  s_add_u32 m0, s70, 94208
  s_add_u32 s62, s74, 28672
  buffer_load_dwordx4 v7, s[8:11], s62 offen sc1 lds
  ds_read_b128 v[84:87], v21 offset:36864
  s_waitcnt lgkmcnt(6)
  v_mfma_f32_16x16x32_bf16 v[40:43], a[120:123], v[92:95], v[40:43]
  v_mfma_f32_16x16x32_bf16 v[44:47], a[124:127], v[92:95], v[44:47]
  ds_read_b128 v[88:91], v20 offset:38912
  s_waitcnt lgkmcnt(6)
  v_mfma_f32_16x16x32_bf16 v[32:35], a[128:131], v[64:67], v[32:35]
  v_mfma_f32_16x16x32_bf16 v[36:39], a[132:135], v[64:67], v[36:39]
  s_mul_i32 s60, s80, 512
  s_add_u32 s60, s60, s67
  s_add_u32 s60, s60, 512
  buffer_load_dwordx4 v[16:19], v3, s[8:11], s60 offen sc1
  ds_read_b128 v[92:95], v21 offset:38912
  s_waitcnt lgkmcnt(6)
  v_mfma_f32_16x16x32_bf16 v[40:43], a[128:131], v[68:71], v[40:43]
  v_mfma_f32_16x16x32_bf16 v[44:47], a[132:135], v[68:71], v[44:47]
  ds_read_b128 v[64:67], v20 offset:40960
  s_waitcnt lgkmcnt(6)
  v_mfma_f32_16x16x32_bf16 v[32:35], a[136:139], v[72:75], v[32:35]
  v_mfma_f32_16x16x32_bf16 v[36:39], a[140:143], v[72:75], v[36:39]
  s_add_u32 m0, s70, 98304
  s_add_u32 s62, s74, 32768
  buffer_load_dwordx4 v7, s[8:11], s62 offen sc1 lds
  ds_read_b128 v[68:71], v21 offset:40960
  s_waitcnt lgkmcnt(6)
  v_mfma_f32_16x16x32_bf16 v[40:43], a[136:139], v[76:79], v[40:43]
  v_mfma_f32_16x16x32_bf16 v[44:47], a[140:143], v[76:79], v[44:47]
  ds_read_b128 v[72:75], v20 offset:43008
  s_waitcnt lgkmcnt(6)
  v_mfma_f32_16x16x32_bf16 v[32:35], a[144:147], v[80:83], v[32:35]
  v_mfma_f32_16x16x32_bf16 v[36:39], a[148:151], v[80:83], v[36:39]
  s_add_u32 s59, s74, 262144
  buffer_load_dword v26, v25, s[8:11], s59 offen sc1
  ds_read_b128 v[76:79], v21 offset:43008
  s_waitcnt lgkmcnt(6)
  v_mfma_f32_16x16x32_bf16 v[40:43], a[144:147], v[84:87], v[40:43]
  v_mfma_f32_16x16x32_bf16 v[44:47], a[148:151], v[84:87], v[44:47]
  ds_read_b128 v[80:83], v20 offset:45056
  s_waitcnt lgkmcnt(6)
  v_mfma_f32_16x16x32_bf16 v[32:35], a[152:155], v[88:91], v[32:35]
  v_mfma_f32_16x16x32_bf16 v[36:39], a[156:159], v[88:91], v[36:39]
  s_add_u32 m0, s70, 102400
  s_add_u32 s62, s74, 36864
  buffer_load_dwordx4 v7, s[8:11], s62 offen sc1 lds
  ds_read_b128 v[84:87], v21 offset:45056
  s_waitcnt lgkmcnt(6)
  v_mfma_f32_16x16x32_bf16 v[40:43], a[152:155], v[92:95], v[40:43]
  v_mfma_f32_16x16x32_bf16 v[44:47], a[156:159], v[92:95], v[44:47]
  ds_read_b128 v[88:91], v20 offset:47104
  s_waitcnt lgkmcnt(6)
  v_mfma_f32_16x16x32_bf16 v[32:35], a[160:163], v[64:67], v[32:35]
  v_mfma_f32_16x16x32_bf16 v[36:39], a[164:167], v[64:67], v[36:39]
  ds_read_b128 v[92:95], v21 offset:47104
  s_waitcnt lgkmcnt(6)
  v_mfma_f32_16x16x32_bf16 v[40:43], a[160:163], v[68:71], v[40:43]
  v_mfma_f32_16x16x32_bf16 v[44:47], a[164:167], v[68:71], v[44:47]
  s_waitcnt vmcnt(16)
  s_barrier
  ds_read_b128 v[64:67], v20 offset:49152
  s_waitcnt lgkmcnt(6)
  v_mfma_f32_16x16x32_bf16 v[32:35], a[168:171], v[72:75], v[32:35]
  v_mfma_f32_16x16x32_bf16 v[36:39], a[172:175], v[72:75], v[36:39]
  s_add_u32 m0, s70, 106496
  s_add_u32 s62, s74, 40960
  buffer_load_dwordx4 v7, s[8:11], s62 offen sc1 lds
  ds_read_b128 v[68:71], v21 offset:49152
  s_waitcnt lgkmcnt(6)
  v_mfma_f32_16x16x32_bf16 v[40:43], a[168:171], v[76:79], v[40:43]
  v_mfma_f32_16x16x32_bf16 v[44:47], a[172:175], v[76:79], v[44:47]
  ds_read_b128 v[72:75], v20 offset:51200
  s_waitcnt lgkmcnt(6)
  v_mfma_f32_16x16x32_bf16 v[32:35], a[176:179], v[80:83], v[32:35]
  v_mfma_f32_16x16x32_bf16 v[36:39], a[180:183], v[80:83], v[36:39]
  s_waitcnt vmcnt(9)
  s_mul_i32 s76, s64, 512
  s_add_u32 s76, s76, s69
  s_sub_u32 s76, s76, 512
  buffer_store_dword v6, v28, s[8:11], s76 offen sc1
  ds_read_b128 v[76:79], v21 offset:51200
  s_waitcnt lgkmcnt(6)
  v_mfma_f32_16x16x32_bf16 v[40:43], a[176:179], v[84:87], v[40:43]
  v_mfma_f32_16x16x32_bf16 v[44:47], a[180:183], v[84:87], v[44:47]
  ds_read_b128 v[80:83], v20 offset:53248
  s_waitcnt lgkmcnt(6)
  v_mfma_f32_16x16x32_bf16 v[32:35], a[184:187], v[88:91], v[32:35]
  v_mfma_f32_16x16x32_bf16 v[36:39], a[188:191], v[88:91], v[36:39]
  s_add_u32 m0, s70, 110592
  s_add_u32 s62, s74, 45056
  buffer_load_dwordx4 v7, s[8:11], s62 offen sc1 lds
  ds_read_b128 v[84:87], v21 offset:53248
  s_waitcnt lgkmcnt(6)
  v_mfma_f32_16x16x32_bf16 v[40:43], a[184:187], v[92:95], v[40:43]
  v_mfma_f32_16x16x32_bf16 v[44:47], a[188:191], v[92:95], v[44:47]
  ds_read_b128 v[88:91], v20 offset:55296
  s_waitcnt lgkmcnt(6)
  v_mfma_f32_16x16x32_bf16 v[32:35], a[192:195], v[64:67], v[32:35]
  v_mfma_f32_16x16x32_bf16 v[36:39], a[196:199], v[64:67], v[36:39]
  ds_read_b128 v[92:95], v21 offset:55296
  s_waitcnt lgkmcnt(6)
  v_mfma_f32_16x16x32_bf16 v[40:43], a[192:195], v[68:71], v[40:43]
  v_mfma_f32_16x16x32_bf16 v[44:47], a[196:199], v[68:71], v[44:47]
  s_cbranch_vccnz gt_195
  s_waitcnt vmcnt(12)
  s_barrier
  ds_read_b128 v[64:67], v22 offset:0
  s_waitcnt lgkmcnt(6)
  v_mfma_f32_16x16x32_bf16 v[32:35], a[200:203], v[72:75], v[32:35]
  v_mfma_f32_16x16x32_bf16 v[36:39], a[204:207], v[72:75], v[36:39]
  s_add_u32 m0, s70, 114688
  s_add_u32 s62, s74, 49152
  buffer_load_dwordx4 v7, s[8:11], s62 offen sc1 lds
  ds_read_b128 v[68:71], v23 offset:0
  s_waitcnt lgkmcnt(6)
  v_mfma_f32_16x16x32_bf16 v[40:43], a[200:203], v[76:79], v[40:43]
  v_mfma_f32_16x16x32_bf16 v[44:47], a[204:207], v[76:79], v[44:47]
  ds_read_b128 v[72:75], v22 offset:2048
  s_waitcnt lgkmcnt(6)
  v_mfma_f32_16x16x32_bf16 v[32:35], a[208:211], v[80:83], v[32:35]
  v_mfma_f32_16x16x32_bf16 v[36:39], a[212:215], v[80:83], v[36:39]
  ds_read_b128 v[76:79], v23 offset:2048
  s_waitcnt lgkmcnt(6)
  v_mfma_f32_16x16x32_bf16 v[40:43], a[208:211], v[84:87], v[40:43]
  v_mfma_f32_16x16x32_bf16 v[44:47], a[212:215], v[84:87], v[44:47]
  ds_read_b128 v[80:83], v22 offset:4096
  s_waitcnt lgkmcnt(6)
  v_mfma_f32_16x16x32_bf16 v[32:35], a[216:219], v[88:91], v[32:35]
  v_mfma_f32_16x16x32_bf16 v[36:39], a[220:223], v[88:91], v[36:39]
  s_add_u32 m0, s70, 118784
  s_add_u32 s62, s74, 53248
  buffer_load_dwordx4 v7, s[8:11], s62 offen sc1 lds
  ds_read_b128 v[84:87], v23 offset:4096
  s_waitcnt lgkmcnt(6)
  v_mfma_f32_16x16x32_bf16 v[40:43], a[216:219], v[92:95], v[40:43]
  v_mfma_f32_16x16x32_bf16 v[44:47], a[220:223], v[92:95], v[44:47]
  s_mov_b32 s73, 0
  s_mov_b32 s71, 0
  s_waitcnt vmcnt(8)
gl_192:
  s_mov_b32 s64, s80
  s_add_u32 s80, s64, 1
  ds_read_b128 v[88:91], v22 offset:6144
  s_waitcnt lgkmcnt(6)
  v_mfma_f32_16x16x32_bf16 v[104:107], a[0:3], v[64:67], 0
  v_mfma_f32_16x16x32_bf16 v[108:111], a[4:7], v[64:67], 0
  v_and_b32 v16, v16, v17
  v_and_b32 v18, v18, v19
  s_lshl_b32 s74, s80, 18
  s_add_u32 s74, s74, s66
  ds_read_b128 v[92:95], v23 offset:6144
  s_waitcnt lgkmcnt(6)
  v_mfma_f32_16x16x32_bf16 v[112:115], a[0:3], v[68:71], 0
  v_mfma_f32_16x16x32_bf16 v[116:119], a[4:7], v[68:71], 0
  v_and_b32 v16, v16, v18
  v_cmp_ne_u32 vcc, 1, v16
  s_cmp_lt_u32 s80, s65
  s_cselect_b32 vcc_lo, vcc_lo, -1
  s_cmp_eq_u32 vcc_lo, 0
  s_cselect_b32 s59, 0, 0x7ff00000
  v_add_u32 v7, s59, v2
  ds_read_b128 v[64:67], v22 offset:8192
  s_waitcnt lgkmcnt(6)
  v_mfma_f32_16x16x32_bf16 v[104:107], a[8:11], v[72:75], v[104:107]
  v_mfma_f32_16x16x32_bf16 v[108:111], a[12:15], v[72:75], v[108:111]
  s_add_u32 s59, s80, 1
  s_cmp_lt_u32 s59, s65
  s_cselect_b32 vcc_hi, vcc_hi, -1
  s_cmp_eq_u32 vcc_hi, 0
  s_cselect_b32 s59, 0, 0x7ff00000
  s_mov_b32 vcc_hi, 0
  v_add_u32 v25, s59, v24
  s_add_u32 m0, s70, 0
  s_add_u32 s62, s74, 0
  buffer_load_dwordx4 v7, s[8:11], s62 offen sc1 lds
  ds_read_b128 v[68:71], v23 offset:8192
  s_waitcnt lgkmcnt(6)
  v_mfma_f32_16x16x32_bf16 v[112:115], a[8:11], v[76:79], v[112:115]
  v_mfma_f32_16x16x32_bf16 v[116:119], a[12:15], v[76:79], v[116:119]
  v_add_u32 v27, s73, v4
  v_add_u32 v28, s71, v5
  ds_read_b128 v[72:75], v22 offset:10240
  s_waitcnt lgkmcnt(6)
  v_mfma_f32_16x16x32_bf16 v[104:107], a[16:19], v[80:83], v[104:107]
  v_mfma_f32_16x16x32_bf16 v[108:111], a[20:23], v[80:83], v[108:111]
  s_lshl_b32 s61, s64, 19
  s_add_u32 s61, s61, s68
  s_sub_u32 s61, s61, 524288
  s_add_u32 s63, s61, 262144
  buffer_store_dwordx4 v[32:35], v27, s[8:11], s61 offen offset:0 sc1
  ds_read_b128 v[76:79], v23 offset:10240
  s_waitcnt lgkmcnt(6)
  v_mfma_f32_16x16x32_bf16 v[112:115], a[16:19], v[84:87], v[112:115]
  v_mfma_f32_16x16x32_bf16 v[116:119], a[20:23], v[84:87], v[116:119]
  ds_read_b128 v[80:83], v22 offset:12288
  s_waitcnt lgkmcnt(6)
  v_mfma_f32_16x16x32_bf16 v[104:107], a[24:27], v[88:91], v[104:107]
  v_mfma_f32_16x16x32_bf16 v[108:111], a[28:31], v[88:91], v[108:111]
  s_add_u32 m0, s70, 4096
  s_add_u32 s62, s74, 4096
  buffer_load_dwordx4 v7, s[8:11], s62 offen sc1 lds
  ds_read_b128 v[84:87], v23 offset:12288
  s_waitcnt lgkmcnt(6)
  v_mfma_f32_16x16x32_bf16 v[112:115], a[24:27], v[92:95], v[112:115]
  v_mfma_f32_16x16x32_bf16 v[116:119], a[28:31], v[92:95], v[116:119]
  ds_read_b128 v[88:91], v22 offset:14336
  s_waitcnt lgkmcnt(6)
  v_mfma_f32_16x16x32_bf16 v[104:107], a[32:35], v[64:67], v[104:107]
  v_mfma_f32_16x16x32_bf16 v[108:111], a[36:39], v[64:67], v[108:111]
  buffer_store_dwordx4 v[36:39], v27, s[8:11], s61 offen offset:128 sc1
  ds_read_b128 v[92:95], v23 offset:14336
  s_waitcnt lgkmcnt(6)
  v_mfma_f32_16x16x32_bf16 v[112:115], a[32:35], v[68:71], v[112:115]
  v_mfma_f32_16x16x32_bf16 v[116:119], a[36:39], v[68:71], v[116:119]
  s_waitcnt vmcnt(13)
  s_barrier
  ds_read_b128 v[64:67], v22 offset:16384
  s_waitcnt lgkmcnt(6)
  v_mfma_f32_16x16x32_bf16 v[104:107], a[40:43], v[72:75], v[104:107]
  v_mfma_f32_16x16x32_bf16 v[108:111], a[44:47], v[72:75], v[108:111]
  s_add_u32 m0, s70, 8192
  s_add_u32 s62, s74, 8192
  buffer_load_dwordx4 v7, s[8:11], s62 offen sc1 lds
  ds_read_b128 v[68:71], v23 offset:16384
  s_waitcnt lgkmcnt(6)
  v_mfma_f32_16x16x32_bf16 v[112:115], a[40:43], v[76:79], v[112:115]
  v_mfma_f32_16x16x32_bf16 v[116:119], a[44:47], v[76:79], v[116:119]
  ds_read_b128 v[72:75], v22 offset:18432
  s_waitcnt lgkmcnt(6)
  v_mfma_f32_16x16x32_bf16 v[104:107], a[48:51], v[80:83], v[104:107]
  v_mfma_f32_16x16x32_bf16 v[108:111], a[52:55], v[80:83], v[108:111]
  buffer_store_dwordx4 v[40:43], v27, s[8:11], s63 offen offset:0 sc1
  ds_read_b128 v[76:79], v23 offset:18432
  s_waitcnt lgkmcnt(6)
  v_mfma_f32_16x16x32_bf16 v[112:115], a[48:51], v[84:87], v[112:115]
  v_mfma_f32_16x16x32_bf16 v[116:119], a[52:55], v[84:87], v[116:119]
  ds_read_b128 v[80:83], v22 offset:20480
  s_waitcnt lgkmcnt(6)
  v_mfma_f32_16x16x32_bf16 v[104:107], a[56:59], v[88:91], v[104:107]
  v_mfma_f32_16x16x32_bf16 v[108:111], a[60:63], v[88:91], v[108:111]
  s_add_u32 m0, s70, 12288
  s_add_u32 s62, s74, 12288
  buffer_load_dwordx4 v7, s[8:11], s62 offen sc1 lds
  ds_read_b128 v[84:87], v23 offset:20480
  s_waitcnt lgkmcnt(6)
  v_mfma_f32_16x16x32_bf16 v[112:115], a[56:59], v[92:95], v[112:115]
  v_mfma_f32_16x16x32_bf16 v[116:119], a[60:63], v[92:95], v[116:119]
  ds_read_b128 v[88:91], v22 offset:22528
  s_waitcnt lgkmcnt(6)
  v_mfma_f32_16x16x32_bf16 v[104:107], a[64:67], v[64:67], v[104:107]
  v_mfma_f32_16x16x32_bf16 v[108:111], a[68:71], v[64:67], v[108:111]
  buffer_store_dwordx4 v[44:47], v27, s[8:11], s63 offen offset:128 sc1
  ds_read_b128 v[92:95], v23 offset:22528
  s_waitcnt lgkmcnt(6)
  v_mfma_f32_16x16x32_bf16 v[112:115], a[64:67], v[68:71], v[112:115]
  v_mfma_f32_16x16x32_bf16 v[116:119], a[68:71], v[68:71], v[116:119]
  ds_read_b128 v[64:67], v22 offset:24576
  s_waitcnt lgkmcnt(6)
  v_mfma_f32_16x16x32_bf16 v[104:107], a[72:75], v[72:75], v[104:107]
  v_mfma_f32_16x16x32_bf16 v[108:111], a[76:79], v[72:75], v[108:111]
  s_add_u32 m0, s70, 16384
  s_add_u32 s62, s74, 16384
  buffer_load_dwordx4 v7, s[8:11], s62 offen sc1 lds
  ds_read_b128 v[68:71], v23 offset:24576
  s_waitcnt lgkmcnt(6)
  v_mfma_f32_16x16x32_bf16 v[112:115], a[72:75], v[76:79], v[112:115]
  v_mfma_f32_16x16x32_bf16 v[116:119], a[76:79], v[76:79], v[116:119]
  ds_read_b128 v[72:75], v22 offset:26624
  s_waitcnt lgkmcnt(6)
  v_mfma_f32_16x16x32_bf16 v[104:107], a[80:83], v[80:83], v[104:107]
  v_mfma_f32_16x16x32_bf16 v[108:111], a[84:87], v[80:83], v[108:111]
  ds_read_b128 v[76:79], v23 offset:26624
  s_waitcnt lgkmcnt(6)
  v_mfma_f32_16x16x32_bf16 v[112:115], a[80:83], v[84:87], v[112:115]
  v_mfma_f32_16x16x32_bf16 v[116:119], a[84:87], v[84:87], v[116:119]
  ds_read_b128 v[80:83], v22 offset:28672
  s_waitcnt lgkmcnt(6)
  v_mfma_f32_16x16x32_bf16 v[104:107], a[88:91], v[88:91], v[104:107]
  v_mfma_f32_16x16x32_bf16 v[108:111], a[92:95], v[88:91], v[108:111]
  s_add_u32 m0, s70, 20480
  s_add_u32 s62, s74, 20480
  buffer_load_dwordx4 v7, s[8:11], s62 offen sc1 lds
  ds_read_b128 v[84:87], v23 offset:28672
  s_waitcnt lgkmcnt(6)
  v_mfma_f32_16x16x32_bf16 v[112:115], a[88:91], v[92:95], v[112:115]
  v_mfma_f32_16x16x32_bf16 v[116:119], a[92:95], v[92:95], v[116:119]
  ds_read_b128 v[88:91], v22 offset:30720
  s_waitcnt lgkmcnt(6)
  v_mfma_f32_16x16x32_bf16 v[104:107], a[96:99], v[64:67], v[104:107]
  v_mfma_f32_16x16x32_bf16 v[108:111], a[100:103], v[64:67], v[108:111]
  ds_read_b128 v[92:95], v23 offset:30720
  s_waitcnt lgkmcnt(6)
  v_mfma_f32_16x16x32_bf16 v[112:115], a[96:99], v[68:71], v[112:115]
  v_mfma_f32_16x16x32_bf16 v[116:119], a[100:103], v[68:71], v[116:119]
  s_waitcnt vmcnt(12)
  s_barrier
  ds_read_b128 v[64:67], v22 offset:32768
  s_waitcnt lgkmcnt(6)
  v_mfma_f32_16x16x32_bf16 v[104:107], a[104:107], v[72:75], v[104:107]
  v_mfma_f32_16x16x32_bf16 v[108:111], a[108:111], v[72:75], v[108:111]
  s_add_u32 m0, s70, 24576
  s_add_u32 s62, s74, 24576
  buffer_load_dwordx4 v7, s[8:11], s62 offen sc1 lds
  ds_read_b128 v[68:71], v23 offset:32768
  s_waitcnt lgkmcnt(6)
  v_mfma_f32_16x16x32_bf16 v[112:115], a[104:107], v[76:79], v[112:115]
  v_mfma_f32_16x16x32_bf16 v[116:119], a[108:111], v[76:79], v[116:119]
  ds_read_b128 v[72:75], v22 offset:34816
  s_waitcnt lgkmcnt(6)
  v_mfma_f32_16x16x32_bf16 v[104:107], a[112:115], v[80:83], v[104:107]
  v_mfma_f32_16x16x32_bf16 v[108:111], a[116:119], v[80:83], v[108:111]
  ds_read_b128 v[76:79], v23 offset:34816
  s_waitcnt lgkmcnt(6)
  v_mfma_f32_16x16x32_bf16 v[112:115], a[112:115], v[84:87], v[112:115]
  v_mfma_f32_16x16x32_bf16 v[116:119], a[116:119], v[84:87], v[116:119]
  ds_read_b128 v[80:83], v22 offset:36864
  s_waitcnt lgkmcnt(6)
  v_mfma_f32_16x16x32_bf16 v[104:107], a[120:123], v[88:91], v[104:107]
  v_mfma_f32_16x16x32_bf16 v[108:111], a[124:127], v[88:91], v[108:111]
  s_add_u32 m0, s70, 28672
  s_add_u32 s62, s74, 28672
  buffer_load_dwordx4 v7, s[8:11], s62 offen sc1 lds
  ds_read_b128 v[84:87], v23 offset:36864
  s_waitcnt lgkmcnt(6)
  v_mfma_f32_16x16x32_bf16 v[112:115], a[120:123], v[92:95], v[112:115]
  v_mfma_f32_16x16x32_bf16 v[116:119], a[124:127], v[92:95], v[116:119]
  ds_read_b128 v[88:91], v22 offset:38912
  s_waitcnt lgkmcnt(6)
  v_mfma_f32_16x16x32_bf16 v[104:107], a[128:131], v[64:67], v[104:107]
  v_mfma_f32_16x16x32_bf16 v[108:111], a[132:135], v[64:67], v[108:111]
  s_mul_i32 s60, s80, 512
  s_add_u32 s60, s60, s67
  s_add_u32 s60, s60, 512
  buffer_load_dwordx4 v[16:19], v3, s[8:11], s60 offen sc1
  ds_read_b128 v[92:95], v23 offset:38912
  s_waitcnt lgkmcnt(6)
  v_mfma_f32_16x16x32_bf16 v[112:115], a[128:131], v[68:71], v[112:115]
  v_mfma_f32_16x16x32_bf16 v[116:119], a[132:135], v[68:71], v[116:119]
  ds_read_b128 v[64:67], v22 offset:40960
  s_waitcnt lgkmcnt(6)
  v_mfma_f32_16x16x32_bf16 v[104:107], a[136:139], v[72:75], v[104:107]
  v_mfma_f32_16x16x32_bf16 v[108:111], a[140:143], v[72:75], v[108:111]
  s_add_u32 m0, s70, 32768
  s_add_u32 s62, s74, 32768
  buffer_load_dwordx4 v7, s[8:11], s62 offen sc1 lds
  ds_read_b128 v[68:71], v23 offset:40960
  s_waitcnt lgkmcnt(6)
  v_mfma_f32_16x16x32_bf16 v[112:115], a[136:139], v[76:79], v[112:115]
  v_mfma_f32_16x16x32_bf16 v[116:119], a[140:143], v[76:79], v[116:119]
  ds_read_b128 v[72:75], v22 offset:43008
  s_waitcnt lgkmcnt(6)
  v_mfma_f32_16x16x32_bf16 v[104:107], a[144:147], v[80:83], v[104:107]
  v_mfma_f32_16x16x32_bf16 v[108:111], a[148:151], v[80:83], v[108:111]
  s_add_u32 s59, s74, 262144
  buffer_load_dword v26, v25, s[8:11], s59 offen sc1
  ds_read_b128 v[76:79], v23 offset:43008
  s_waitcnt lgkmcnt(6)
  v_mfma_f32_16x16x32_bf16 v[112:115], a[144:147], v[84:87], v[112:115]
  v_mfma_f32_16x16x32_bf16 v[116:119], a[148:151], v[84:87], v[116:119]
  ds_read_b128 v[80:83], v22 offset:45056
  s_waitcnt lgkmcnt(6)
  v_mfma_f32_16x16x32_bf16 v[104:107], a[152:155], v[88:91], v[104:107]
  v_mfma_f32_16x16x32_bf16 v[108:111], a[156:159], v[88:91], v[108:111]
  s_add_u32 m0, s70, 36864
  s_add_u32 s62, s74, 36864
  buffer_load_dwordx4 v7, s[8:11], s62 offen sc1 lds
  ds_read_b128 v[84:87], v23 offset:45056
  s_waitcnt lgkmcnt(6)
  v_mfma_f32_16x16x32_bf16 v[112:115], a[152:155], v[92:95], v[112:115]
  v_mfma_f32_16x16x32_bf16 v[116:119], a[156:159], v[92:95], v[116:119]
  ds_read_b128 v[88:91], v22 offset:47104
  s_waitcnt lgkmcnt(6)
  v_mfma_f32_16x16x32_bf16 v[104:107], a[160:163], v[64:67], v[104:107]
  v_mfma_f32_16x16x32_bf16 v[108:111], a[164:167], v[64:67], v[108:111]
  ds_read_b128 v[92:95], v23 offset:47104
  s_waitcnt lgkmcnt(6)
  v_mfma_f32_16x16x32_bf16 v[112:115], a[160:163], v[68:71], v[112:115]
  v_mfma_f32_16x16x32_bf16 v[116:119], a[164:167], v[68:71], v[116:119]
  s_waitcnt vmcnt(16)
  s_barrier
  ds_read_b128 v[64:67], v22 offset:49152
  s_waitcnt lgkmcnt(6)
  v_mfma_f32_16x16x32_bf16 v[104:107], a[168:171], v[72:75], v[104:107]
  v_mfma_f32_16x16x32_bf16 v[108:111], a[172:175], v[72:75], v[108:111]
  s_add_u32 m0, s70, 40960
  s_add_u32 s62, s74, 40960
  buffer_load_dwordx4 v7, s[8:11], s62 offen sc1 lds
  ds_read_b128 v[68:71], v23 offset:49152
  s_waitcnt lgkmcnt(6)
  v_mfma_f32_16x16x32_bf16 v[112:115], a[168:171], v[76:79], v[112:115]
  v_mfma_f32_16x16x32_bf16 v[116:119], a[172:175], v[76:79], v[116:119]
  ds_read_b128 v[72:75], v22 offset:51200
  s_waitcnt lgkmcnt(6)
  v_mfma_f32_16x16x32_bf16 v[104:107], a[176:179], v[80:83], v[104:107]
  v_mfma_f32_16x16x32_bf16 v[108:111], a[180:183], v[80:83], v[108:111]
  s_waitcnt vmcnt(9)
  s_mul_i32 s76, s64, 512
  s_add_u32 s76, s76, s69
  s_sub_u32 s76, s76, 512
  buffer_store_dword v6, v28, s[8:11], s76 offen sc1
  ds_read_b128 v[76:79], v23 offset:51200
  s_waitcnt lgkmcnt(6)
  v_mfma_f32_16x16x32_bf16 v[112:115], a[176:179], v[84:87], v[112:115]
  v_mfma_f32_16x16x32_bf16 v[116:119], a[180:183], v[84:87], v[116:119]
  ds_read_b128 v[80:83], v22 offset:53248
  s_waitcnt lgkmcnt(6)
  v_mfma_f32_16x16x32_bf16 v[104:107], a[184:187], v[88:91], v[104:107]
  v_mfma_f32_16x16x32_bf16 v[108:111], a[188:191], v[88:91], v[108:111]
  s_add_u32 m0, s70, 45056
  s_add_u32 s62, s74, 45056
  buffer_load_dwordx4 v7, s[8:11], s62 offen sc1 lds
  ds_read_b128 v[84:87], v23 offset:53248
  s_waitcnt lgkmcnt(6)
  v_mfma_f32_16x16x32_bf16 v[112:115], a[184:187], v[92:95], v[112:115]
  v_mfma_f32_16x16x32_bf16 v[116:119], a[188:191], v[92:95], v[116:119]
  ds_read_b128 v[88:91], v22 offset:55296
  s_waitcnt lgkmcnt(6)
  v_mfma_f32_16x16x32_bf16 v[104:107], a[192:195], v[64:67], v[104:107]
  v_mfma_f32_16x16x32_bf16 v[108:111], a[196:199], v[64:67], v[108:111]
  ds_read_b128 v[92:95], v23 offset:55296
  s_waitcnt lgkmcnt(6)
  v_mfma_f32_16x16x32_bf16 v[112:115], a[192:195], v[68:71], v[112:115]
  v_mfma_f32_16x16x32_bf16 v[116:119], a[196:199], v[68:71], v[116:119]
  s_cbranch_vccnz gt_196
  s_waitcnt vmcnt(12)
  s_barrier
  ds_read_b128 v[64:67], v20 offset:0
  s_waitcnt lgkmcnt(6)
  v_mfma_f32_16x16x32_bf16 v[104:107], a[200:203], v[72:75], v[104:107]
  v_mfma_f32_16x16x32_bf16 v[108:111], a[204:207], v[72:75], v[108:111]
  s_add_u32 m0, s70, 49152
  s_add_u32 s62, s74, 49152
  buffer_load_dwordx4 v7, s[8:11], s62 offen sc1 lds
  ds_read_b128 v[68:71], v21 offset:0
  s_waitcnt lgkmcnt(6)
  v_mfma_f32_16x16x32_bf16 v[112:115], a[200:203], v[76:79], v[112:115]
  v_mfma_f32_16x16x32_bf16 v[116:119], a[204:207], v[76:79], v[116:119]
  ds_read_b128 v[72:75], v20 offset:2048
  s_waitcnt lgkmcnt(6)
  v_mfma_f32_16x16x32_bf16 v[104:107], a[208:211], v[80:83], v[104:107]
  v_mfma_f32_16x16x32_bf16 v[108:111], a[212:215], v[80:83], v[108:111]
  ds_read_b128 v[76:79], v21 offset:2048
  s_waitcnt lgkmcnt(6)
  v_mfma_f32_16x16x32_bf16 v[112:115], a[208:211], v[84:87], v[112:115]
  v_mfma_f32_16x16x32_bf16 v[116:119], a[212:215], v[84:87], v[116:119]
  ds_read_b128 v[80:83], v20 offset:4096
  s_waitcnt lgkmcnt(6)
  v_mfma_f32_16x16x32_bf16 v[104:107], a[216:219], v[88:91], v[104:107]
  v_mfma_f32_16x16x32_bf16 v[108:111], a[220:223], v[88:91], v[108:111]
  s_add_u32 m0, s70, 53248
  s_add_u32 s62, s74, 53248
  buffer_load_dwordx4 v7, s[8:11], s62 offen sc1 lds
  ds_read_b128 v[84:87], v21 offset:4096
  s_waitcnt lgkmcnt(6)
  v_mfma_f32_16x16x32_bf16 v[112:115], a[216:219], v[92:95], v[112:115]
  v_mfma_f32_16x16x32_bf16 v[116:119], a[220:223], v[92:95], v[116:119]
  s_mov_b32 s73, 0
  s_mov_b32 s71, 0
  s_waitcnt vmcnt(8)
  s_branch gl_191
gt_195:
  s_mul_i32 s60, s80, 512
  s_add_u32 s60, s60, s67
  buffer_load_dwordx4 v[16:19], v3, s[8:11], s60 offen sc1
  s_waitcnt lgkmcnt(5)
  v_mfma_f32_16x16x32_bf16 v[32:35], a[200:203], v[72:75], v[32:35]
  v_mfma_f32_16x16x32_bf16 v[36:39], a[204:207], v[72:75], v[36:39]
  s_waitcnt lgkmcnt(4)
  v_mfma_f32_16x16x32_bf16 v[40:43], a[200:203], v[76:79], v[40:43]
  v_mfma_f32_16x16x32_bf16 v[44:47], a[204:207], v[76:79], v[44:47]
  s_waitcnt lgkmcnt(3)
  v_mfma_f32_16x16x32_bf16 v[32:35], a[208:211], v[80:83], v[32:35]
  v_mfma_f32_16x16x32_bf16 v[36:39], a[212:215], v[80:83], v[36:39]
  s_waitcnt lgkmcnt(2)
  v_mfma_f32_16x16x32_bf16 v[40:43], a[208:211], v[84:87], v[40:43]
  v_mfma_f32_16x16x32_bf16 v[44:47], a[212:215], v[84:87], v[44:47]
  s_waitcnt lgkmcnt(1)
  v_mfma_f32_16x16x32_bf16 v[32:35], a[216:219], v[88:91], v[32:35]
  v_mfma_f32_16x16x32_bf16 v[36:39], a[220:223], v[88:91], v[36:39]
  s_waitcnt lgkmcnt(0)
  v_mfma_f32_16x16x32_bf16 v[40:43], a[216:219], v[92:95], v[40:43]
  v_mfma_f32_16x16x32_bf16 v[44:47], a[220:223], v[92:95], v[44:47]
  s_lshl_b32 s61, s64, 19
  s_add_u32 s61, s61, s68
  s_add_u32 s63, s61, 262144
  s_nop 0
  buffer_store_dwordx4 v[32:35], v4, s[8:11], s61 offen offset:0 sc1
  buffer_store_dwordx4 v[36:39], v4, s[8:11], s61 offen offset:128 sc1
  s_nop 0
  buffer_store_dwordx4 v[40:43], v4, s[8:11], s63 offen offset:0 sc1
  buffer_store_dwordx4 v[44:47], v4, s[8:11], s63 offen offset:128 sc1
  v_mov_b32 v28, v5
  s_cmp_lt_u32 s80, s65
  s_cbranch_scc0 gl_191_y
  s_waitcnt vmcnt(4)
  v_and_b32 v16, v16, v17
  v_and_b32 v18, v18, v19
  v_and_b32 v16, v16, v18
  v_cmp_ne_u32 vcc, 1, v16
  s_nop 0
  s_cmp_eq_u32 vcc_lo, 0
  s_cbranch_scc1 fs_197
  buffer_load_dwordx4 v[16:19], v3, s[8:11], s60 offen sc1
  s_waitcnt vmcnt(1)
  s_mul_i32 s76, s64, 512
  s_add_u32 s76, s76, s69
  buffer_store_dword v6, v5, s[8:11], s76 offen sc1
  s_waitcnt vmcnt(1)
  v_and_b32 v16, v16, v17
  v_and_b32 v18, v18, v19
  v_and_b32 v16, v16, v18
  v_cmp_ne_u32 vcc, 1, v16
  s_nop 0
  s_cmp_eq_u32 vcc_lo, 0
  s_cbranch_scc1 fq_198
gf_194:
  s_mul_i32 s60, s80, 512
  s_add_u32 s60, s60, s67
pl_199:
  buffer_load_dwordx4 v[16:19], v3, s[8:11], s60 offen sc1
  s_waitcnt vmcnt(0)
  v_and_b32 v16, v16, v17
  v_and_b32 v18, v18, v19
  v_and_b32 v16, v16, v18
  v_cmp_ne_u32 vcc, 1, v16
  s_nop 0
  s_cmp_eq_u32 vcc_lo, 0
  s_cbranch_scc1 pk_200
  s_sub_u32 s57, s57, 1
  s_cbranch_scc0 pl_199
  s_branch ABORT
pk_200:
fq_198:
  v_mov_b32 v28, v29
fs_197:
  s_lshl_b32 s74, s80, 18
  s_add_u32 s74, s74, s66
  s_add_u32 s60, s60, 512
  buffer_load_dwordx4 v[16:19], v3, s[8:11], s60 offen sc1
  s_add_u32 m0, s70, 65536
  s_add_u32 s62, s74, 0
  buffer_load_dwordx4 v2, s[8:11], s62 offen sc1 lds
  s_add_u32 m0, s70, 69632
  s_add_u32 s62, s74, 4096
  buffer_load_dwordx4 v2, s[8:11], s62 offen sc1 lds
  s_add_u32 m0, s70, 73728
  s_add_u32 s62, s74, 8192
  buffer_load_dwordx4 v2, s[8:11], s62 offen sc1 lds
  s_add_u32 m0, s70, 77824
  s_add_u32 s62, s74, 12288
  buffer_load_dwordx4 v2, s[8:11], s62 offen sc1 lds
  s_add_u32 m0, s70, 81920
  s_add_u32 s62, s74, 16384
  buffer_load_dwordx4 v2, s[8:11], s62 offen sc1 lds
  s_add_u32 m0, s70, 86016
  s_add_u32 s62, s74, 20480
  buffer_load_dwordx4 v2, s[8:11], s62 offen sc1 lds
  s_add_u32 m0, s70, 90112
  s_add_u32 s62, s74, 24576
  buffer_load_dwordx4 v2, s[8:11], s62 offen sc1 lds
  s_add_u32 m0, s70, 94208
  s_add_u32 s62, s74, 28672
  buffer_load_dwordx4 v2, s[8:11], s62 offen sc1 lds
  buffer_load_dword v26, v29, s[8:11], 0 offen
  s_add_u32 m0, s70, 98304
  s_add_u32 s62, s74, 32768
  buffer_load_dwordx4 v2, s[8:11], s62 offen sc1 lds
  buffer_load_dword v26, v29, s[8:11], 0 offen
  s_add_u32 m0, s70, 102400
  s_add_u32 s62, s74, 36864
  buffer_load_dwordx4 v2, s[8:11], s62 offen sc1 lds
  s_add_u32 m0, s70, 106496
  s_add_u32 s62, s74, 40960
  buffer_load_dwordx4 v2, s[8:11], s62 offen sc1 lds
  s_add_u32 m0, s70, 110592
  s_add_u32 s62, s74, 45056
  buffer_load_dwordx4 v2, s[8:11], s62 offen sc1 lds
  s_add_u32 m0, s70, 114688
  s_add_u32 s62, s74, 49152
  buffer_load_dwordx4 v2, s[8:11], s62 offen sc1 lds
  s_add_u32 m0, s70, 118784
  s_add_u32 s62, s74, 53248
  buffer_load_dwordx4 v2, s[8:11], s62 offen sc1 lds
  s_mov_b32 s73, 0x7ff00000
  s_mov_b32 s71, 0x7ff00000
  s_waitcnt vmcnt(12)
  s_mul_i32 s76, s64, 512
  s_add_u32 s76, s76, s69
  buffer_store_dword v6, v28, s[8:11], s76 offen sc1
  s_barrier
  ds_read_b128 v[64:67], v22 offset:0
  ds_read_b128 v[68:71], v23 offset:0
  ds_read_b128 v[72:75], v22 offset:2048
  ds_read_b128 v[76:79], v23 offset:2048
  ds_read_b128 v[80:83], v22 offset:4096
  ds_read_b128 v[84:87], v23 offset:4096
  s_branch gl_192
gt_196:
  s_mul_i32 s60, s80, 512
  s_add_u32 s60, s60, s67
  buffer_load_dwordx4 v[16:19], v3, s[8:11], s60 offen sc1
  s_waitcnt lgkmcnt(5)
  v_mfma_f32_16x16x32_bf16 v[104:107], a[200:203], v[72:75], v[104:107]
  v_mfma_f32_16x16x32_bf16 v[108:111], a[204:207], v[72:75], v[108:111]
  s_waitcnt lgkmcnt(4)
  v_mfma_f32_16x16x32_bf16 v[112:115], a[200:203], v[76:79], v[112:115]
  v_mfma_f32_16x16x32_bf16 v[116:119], a[204:207], v[76:79], v[116:119]
  s_waitcnt lgkmcnt(3)
  v_mfma_f32_16x16x32_bf16 v[104:107], a[208:211], v[80:83], v[104:107]
  v_mfma_f32_16x16x32_bf16 v[108:111], a[212:215], v[80:83], v[108:111]
  s_waitcnt lgkmcnt(2)
  v_mfma_f32_16x16x32_bf16 v[112:115], a[208:211], v[84:87], v[112:115]
  v_mfma_f32_16x16x32_bf16 v[116:119], a[212:215], v[84:87], v[116:119]
  s_waitcnt lgkmcnt(1)
  v_mfma_f32_16x16x32_bf16 v[104:107], a[216:219], v[88:91], v[104:107]
  v_mfma_f32_16x16x32_bf16 v[108:111], a[220:223], v[88:91], v[108:111]
  s_waitcnt lgkmcnt(0)
  v_mfma_f32_16x16x32_bf16 v[112:115], a[216:219], v[92:95], v[112:115]
  v_mfma_f32_16x16x32_bf16 v[116:119], a[220:223], v[92:95], v[116:119]
  s_lshl_b32 s61, s64, 19
  s_add_u32 s61, s61, s68
  s_add_u32 s63, s61, 262144
  s_nop 0
  buffer_store_dwordx4 v[104:107], v4, s[8:11], s61 offen offset:0 sc1
  buffer_store_dwordx4 v[108:111], v4, s[8:11], s61 offen offset:128 sc1
  s_nop 0
  buffer_store_dwordx4 v[112:115], v4, s[8:11], s63 offen offset:0 sc1
  buffer_store_dwordx4 v[116:119], v4, s[8:11], s63 offen offset:128 sc1
  v_mov_b32 v28, v5
  s_cmp_lt_u32 s80, s65
  s_cbranch_scc0 gl_191_y
  s_waitcnt vmcnt(4)
  v_and_b32 v16, v16, v17
  v_and_b32 v18, v18, v19
  v_and_b32 v16, v16, v18
  v_cmp_ne_u32 vcc, 1, v16
  s_nop 0
  s_cmp_eq_u32 vcc_lo, 0
  s_cbranch_scc1 fs_201
  buffer_load_dwordx4 v[16:19], v3, s[8:11], s60 offen sc1
  s_waitcnt vmcnt(1)
  s_mul_i32 s76, s64, 512
  s_add_u32 s76, s76, s69
  buffer_store_dword v6, v5, s[8:11], s76 offen sc1
  s_waitcnt vmcnt(1)
  v_and_b32 v16, v16, v17
  v_and_b32 v18, v18, v19
  v_and_b32 v16, v16, v18
  v_cmp_ne_u32 vcc, 1, v16
  s_nop 0
  s_cmp_eq_u32 vcc_lo, 0
  s_cbranch_scc1 fq_202
gf_193:
  s_mul_i32 s60, s80, 512
  s_add_u32 s60, s60, s67
pl_203:
  buffer_load_dwordx4 v[16:19], v3, s[8:11], s60 offen sc1
  s_waitcnt vmcnt(0)
  v_and_b32 v16, v16, v17
  v_and_b32 v18, v18, v19
  v_and_b32 v16, v16, v18
  v_cmp_ne_u32 vcc, 1, v16
  s_nop 0
  s_cmp_eq_u32 vcc_lo, 0
  s_cbranch_scc1 pk_204
  s_sub_u32 s57, s57, 1
  s_cbranch_scc0 pl_203
  s_branch ABORT
pk_204:
fq_202:
  v_mov_b32 v28, v29
fs_201:
  s_lshl_b32 s74, s80, 18
  s_add_u32 s74, s74, s66
  s_add_u32 s60, s60, 512
  buffer_load_dwordx4 v[16:19], v3, s[8:11], s60 offen sc1
  s_add_u32 m0, s70, 0
  s_add_u32 s62, s74, 0
  buffer_load_dwordx4 v2, s[8:11], s62 offen sc1 lds
  s_add_u32 m0, s70, 4096
  s_add_u32 s62, s74, 4096
  buffer_load_dwordx4 v2, s[8:11], s62 offen sc1 lds
  s_add_u32 m0, s70, 8192
  s_add_u32 s62, s74, 8192
  buffer_load_dwordx4 v2, s[8:11], s62 offen sc1 lds
  s_add_u32 m0, s70, 12288
  s_add_u32 s62, s74, 12288
  buffer_load_dwordx4 v2, s[8:11], s62 offen sc1 lds
  s_add_u32 m0, s70, 16384
  s_add_u32 s62, s74, 16384
  buffer_load_dwordx4 v2, s[8:11], s62 offen sc1 lds
  s_add_u32 m0, s70, 20480
  s_add_u32 s62, s74, 20480
  buffer_load_dwordx4 v2, s[8:11], s62 offen sc1 lds
  s_add_u32 m0, s70, 24576
  s_add_u32 s62, s74, 24576
  buffer_load_dwordx4 v2, s[8:11], s62 offen sc1 lds
  s_add_u32 m0, s70, 28672
  s_add_u32 s62, s74, 28672
  buffer_load_dwordx4 v2, s[8:11], s62 offen sc1 lds
  buffer_load_dword v26, v29, s[8:11], 0 offen
  s_add_u32 m0, s70, 32768
  s_add_u32 s62, s74, 32768
  buffer_load_dwordx4 v2, s[8:11], s62 offen sc1 lds
  buffer_load_dword v26, v29, s[8:11], 0 offen
  s_add_u32 m0, s70, 36864
  s_add_u32 s62, s74, 36864
  buffer_load_dwordx4 v2, s[8:11], s62 offen sc1 lds
  s_add_u32 m0, s70, 40960
  s_add_u32 s62, s74, 40960
  buffer_load_dwordx4 v2, s[8:11], s62 offen sc1 lds
  s_add_u32 m0, s70, 45056
  s_add_u32 s62, s74, 45056
  buffer_load_dwordx4 v2, s[8:11], s62 offen sc1 lds
  s_add_u32 m0, s70, 49152
  s_add_u32 s62, s74, 49152
  buffer_load_dwordx4 v2, s[8:11], s62 offen sc1 lds
  s_add_u32 m0, s70, 53248
  s_add_u32 s62, s74, 53248
  buffer_load_dwordx4 v2, s[8:11], s62 offen sc1 lds
  s_mov_b32 s73, 0x7ff00000
  s_mov_b32 s71, 0x7ff00000
  s_waitcnt vmcnt(12)
  s_mul_i32 s76, s64, 512
  s_add_u32 s76, s76, s69
  buffer_store_dword v6, v28, s[8:11], s76 offen sc1
  s_barrier
  ds_read_b128 v[64:67], v20 offset:0
  ds_read_b128 v[68:71], v21 offset:0
  ds_read_b128 v[72:75], v20 offset:2048
  ds_read_b128 v[76:79], v21 offset:2048
  ds_read_b128 v[80:83], v20 offset:4096
  ds_read_b128 v[84:87], v21 offset:4096
  s_branch gl_191
gl_191_y:
  s_waitcnt vmcnt(0)
  s_mul_i32 s76, s64, 512
  s_add_u32 s76, s76, s69
  buffer_store_dword v6, v5, s[8:11], s76 offen sc1
gl_191_x:
  s_barrier
  s_branch DONE
JF1:
  s_cmp_eq_u32 s60, 7
  s_cbranch_scc1 JRED5
  s_add_u32 s69, s69, 2293760
  s_lshl_b32 s68, s60, 13
  s_add_u32 s68, s68, s66
  s_add_u32 s68, s68, 117440512
  s_mov_b32 s66, 8388608
  s_mul_i32 s61, s79, 1792
  s_add_u32 s77, s77, s61
  s_mov_b32 s67, 2334720
  s_mov_b32 s81, 7
  s_mov_b32 s12, s40
  s_mov_b32 s13, s41
  s_mov_b32 s14, 0x700000
  s_mov_b32 s15, 0x00020000
  v_lshrrev_b32 v10, 2, v0
  s_mov_b32 s59, 7168
  v_mul_lo_u32 v8, v10, s59
  v_and_b32 v11, 3, v0
  v_lshl_add_u32 v8, v11, 4, v8
  s_lshl_b32 s59, s54, 6
  s_add_u32 s59, s59, s77
  v_add_u32 v8, s59, v8
  s_lshl_b32 s63, s54, 15
  v_and_b32 v10, 3, v10
  v_mov_b32 v9, 0
  v_bfe_u32 v9, v0, 4, 1
  v_lshl_add_u32 v10, v9, 7, v10
  v_lshrrev_b32 v9, 5, v0
  v_lshl_add_u32 v10, v9, 2, v10
  v_lshlrev_b32 v9, 6, v10
  v_add_u32 v9, s63, v9
  v_lshlrev_b32 v10, 3, v11
  v_and_b32 v12, 2, v11
  v_lshl_add_u32 v12, v12, 3, v10
  s_cmp_eq_u32 s78, 1
  s_cselect_b64 vcc, -1, 0
  s_cselect_b32 s59, 32, 16
  v_cndmask_b32 v10, v12, v10, vcc
  v_add_u32 v9, v9, v10
  v_add_u32 v12, s59, v9
  s_add_u32 m0, s63, 0
  s_mov_b32 s59, 0
  buffer_load_dwordx4 v8, s[12:15], s59 offen lds
  s_add_u32 m0, s63, 1024
  s_mov_b32 s59, 114688
  buffer_load_dwordx4 v8, s[12:15], s59 offen lds
  s_add_u32 m0, s63, 2048
  s_mov_b32 s59, 229376
  buffer_load_dwordx4 v8, s[12:15], s59 offen lds
  s_add_u32 m0, s63, 3072
  s_mov_b32 s59, 344064
  buffer_load_dwordx4 v8, s[12:15], s59 offen lds
  s_add_u32 m0, s63, 4096
  s_mov_b32 s59, 458752
  buffer_load_dwordx4 v8, s[12:15], s59 offen lds
  s_add_u32 m0, s63, 5120
  s_mov_b32 s59, 573440
  buffer_load_dwordx4 v8, s[12:15], s59 offen lds
  s_add_u32 m0, s63, 6144
  s_mov_b32 s59, 688128
  buffer_load_dwordx4 v8, s[12:15], s59 offen lds
  s_add_u32 m0, s63, 7168
  s_mov_b32 s59, 802816
  buffer_load_dwordx4 v8, s[12:15], s59 offen lds
  s_add_u32 m0, s63, 8192
  s_mov_b32 s59, 917504
  buffer_load_dwordx4 v8, s[12:15], s59 offen lds
  s_add_u32 m0, s63, 9216
  s_mov_b32 s59, 1032192
  buffer_load_dwordx4 v8, s[12:15], s59 offen lds
  s_add_u32 m0, s63, 10240
  s_mov_b32 s59, 1146880
  buffer_load_dwordx4 v8, s[12:15], s59 offen lds
  s_add_u32 m0, s63, 11264
  s_mov_b32 s59, 1261568
  buffer_load_dwordx4 v8, s[12:15], s59 offen lds
  s_add_u32 m0, s63, 12288
  s_mov_b32 s59, 1376256
  buffer_load_dwordx4 v8, s[12:15], s59 offen lds
  s_add_u32 m0, s63, 13312
  s_mov_b32 s59, 1490944
  buffer_load_dwordx4 v8, s[12:15], s59 offen lds
  s_add_u32 m0, s63, 14336
  s_mov_b32 s59, 1605632
  buffer_load_dwordx4 v8, s[12:15], s59 offen lds
  s_add_u32 m0, s63, 15360
  s_mov_b32 s59, 1720320
  buffer_load_dwordx4 v8, s[12:15], s59 offen lds
  s_add_u32 m0, s63, 16384
  s_mov_b32 s59, 1835008
  buffer_load_dwordx4 v8, s[12:15], s59 offen lds
  s_add_u32 m0, s63, 17408
  s_mov_b32 s59, 1949696
  buffer_load_dwordx4 v8, s[12:15], s59 offen lds
  s_add_u32 m0, s63, 18432
  s_mov_b32 s59, 2064384
  buffer_load_dwordx4 v8, s[12:15], s59 offen lds
  s_add_u32 m0, s63, 19456
  s_mov_b32 s59, 2179072
  buffer_load_dwordx4 v8, s[12:15], s59 offen lds
  s_add_u32 m0, s63, 20480
  s_mov_b32 s59, 2293760
  buffer_load_dwordx4 v8, s[12:15], s59 offen lds
  s_add_u32 m0, s63, 21504
  s_mov_b32 s59, 2408448
  buffer_load_dwordx4 v8, s[12:15], s59 offen lds
  s_add_u32 m0, s63, 22528
  s_mov_b32 s59, 2523136
  buffer_load_dwordx4 v8, s[12:15], s59 offen lds
  s_add_u32 m0, s63, 23552
  s_mov_b32 s59, 2637824
  buffer_load_dwordx4 v8, s[12:15], s59 offen lds
  s_add_u32 m0, s63, 24576
  s_mov_b32 s59, 2752512
  buffer_load_dwordx4 v8, s[12:15], s59 offen lds
  s_add_u32 m0, s63, 25600
  s_mov_b32 s59, 2867200
  buffer_load_dwordx4 v8, s[12:15], s59 offen lds
  s_add_u32 m0, s63, 26624
  s_mov_b32 s59, 2981888
  buffer_load_dwordx4 v8, s[12:15], s59 offen lds
  s_add_u32 m0, s63, 27648
  s_mov_b32 s59, 3096576
  buffer_load_dwordx4 v8, s[12:15], s59 offen lds
  s_add_u32 m0, s63, 28672
  s_mov_b32 s59, 3211264
  buffer_load_dwordx4 v8, s[12:15], s59 offen lds
  s_add_u32 m0, s63, 29696
  s_mov_b32 s59, 3325952
  buffer_load_dwordx4 v8, s[12:15], s59 offen lds
  s_add_u32 m0, s63, 30720
  s_mov_b32 s59, 3440640
  buffer_load_dwordx4 v8, s[12:15], s59 offen lds
  s_add_u32 m0, s63, 31744
  s_mov_b32 s59, 3555328
  buffer_load_dwordx4 v8, s[12:15], s59 offen lds
  s_waitcnt vmcnt(16)
  ds_read_b64_tr_b16 a[0:1], v9 offset:0
  ds_read_b64_tr_b16 a[2:3], v9 offset:4096
  ds_read_b64_tr_b16 a[4:5], v12 offset:0
  ds_read_b64_tr_b16 a[6:7], v12 offset:4096
  ds_read_b64_tr_b16 a[8:9], v9 offset:512
  ds_read_b64_tr_b16 a[10:11], v9 offset:4608
  ds_read_b64_tr_b16 a[12:13], v12 offset:512
  ds_read_b64_tr_b16 a[14:15], v12 offset:4608
  ds_read_b64_tr_b16 a[16:17], v9 offset:1024
  ds_read_b64_tr_b16 a[18:19], v9 offset:5120
  ds_read_b64_tr_b16 a[20:21], v12 offset:1024
  ds_read_b64_tr_b16 a[22:23], v12 offset:5120
  ds_read_b64_tr_b16 a[24:25], v9 offset:1536
  ds_read_b64_tr_b16 a[26:27], v9 offset:5632
  ds_read_b64_tr_b16 a[28:29], v12 offset:1536
  ds_read_b64_tr_b16 a[30:31], v12 offset:5632
  ds_read_b64_tr_b16 a[32:33], v9 offset:2048
  ds_read_b64_tr_b16 a[34:35], v9 offset:6144
  ds_read_b64_tr_b16 a[36:37], v12 offset:2048
  ds_read_b64_tr_b16 a[38:39], v12 offset:6144
  ds_read_b64_tr_b16 a[40:41], v9 offset:2560
  ds_read_b64_tr_b16 a[42:43], v9 offset:6656
  ds_read_b64_tr_b16 a[44:45], v12 offset:2560
  ds_read_b64_tr_b16 a[46:47], v12 offset:6656
  ds_read_b64_tr_b16 a[48:49], v9 offset:3072
  ds_read_b64_tr_b16 a[50:51], v9 offset:7168
  ds_read_b64_tr_b16 a[52:53], v12 offset:3072
  ds_read_b64_tr_b16 a[54:55], v12 offset:7168
  ds_read_b64_tr_b16 a[56:57], v9 offset:3584
  ds_read_b64_tr_b16 a[58:59], v9 offset:7680
  ds_read_b64_tr_b16 a[60:61], v12 offset:3584
  ds_read_b64_tr_b16 a[62:63], v12 offset:7680
  s_waitcnt lgkmcnt(0)
  s_add_u32 m0, s63, 0
  s_mov_b32 s59, 3670016
  buffer_load_dwordx4 v8, s[12:15], s59 offen lds
  s_add_u32 m0, s63, 1024
  s_mov_b32 s59, 3784704
  buffer_load_dwordx4 v8, s[12:15], s59 offen lds
  s_add_u32 m0, s63, 2048
  s_mov_b32 s59, 3899392
  buffer_load_dwordx4 v8, s[12:15], s59 offen lds
  s_add_u32 m0, s63, 3072
  s_mov_b32 s59, 4014080
  buffer_load_dwordx4 v8, s[12:15], s59 offen lds
  s_add_u32 m0, s63, 4096
  s_mov_b32 s59, 4128768
  buffer_load_dwordx4 v8, s[12:15], s59 offen lds
  s_add_u32 m0, s63, 5120
  s_mov_b32 s59, 4243456
  buffer_load_dwordx4 v8, s[12:15], s59 offen lds
  s_add_u32 m0, s63, 6144
  s_mov_b32 s59, 4358144
  buffer_load_dwordx4 v8, s[12:15], s59 offen lds
  s_add_u32 m0, s63, 7168
  s_mov_b32 s59, 4472832
  buffer_load_dwordx4 v8, s[12:15], s59 offen lds
  s_add_u32 m0, s63, 8192
  s_mov_b32 s59, 4587520
  buffer_load_dwordx4 v8, s[12:15], s59 offen lds
  s_add_u32 m0, s63, 9216
  s_mov_b32 s59, 4702208
  buffer_load_dwordx4 v8, s[12:15], s59 offen lds
  s_add_u32 m0, s63, 10240
  s_mov_b32 s59, 4816896
  buffer_load_dwordx4 v8, s[12:15], s59 offen lds
  s_add_u32 m0, s63, 11264
  s_mov_b32 s59, 4931584
  buffer_load_dwordx4 v8, s[12:15], s59 offen lds
  s_add_u32 m0, s63, 12288
  s_mov_b32 s59, 5046272
  buffer_load_dwordx4 v8, s[12:15], s59 offen lds
  s_add_u32 m0, s63, 13312
  s_mov_b32 s59, 5160960
  buffer_load_dwordx4 v8, s[12:15], s59 offen lds
  s_add_u32 m0, s63, 14336
  s_mov_b32 s59, 5275648
  buffer_load_dwordx4 v8, s[12:15], s59 offen lds
  s_add_u32 m0, s63, 15360
  s_mov_b32 s59, 5390336
  buffer_load_dwordx4 v8, s[12:15], s59 offen lds
  s_waitcnt vmcnt(16)
  ds_read_b64_tr_b16 a[64:65], v9 offset:16384
  ds_read_b64_tr_b16 a[66:67], v9 offset:20480
  ds_read_b64_tr_b16 a[68:69], v12 offset:16384
  ds_read_b64_tr_b16 a[70:71], v12 offset:20480
  ds_read_b64_tr_b16 a[72:73], v9 offset:16896
  ds_read_b64_tr_b16 a[74:75], v9 offset:20992
  ds_read_b64_tr_b16 a[76:77], v12 offset:16896
  ds_read_b64_tr_b16 a[78:79], v12 offset:20992
  ds_read_b64_tr_b16 a[80:81], v9 offset:17408
  ds_read_b64_tr_b16 a[82:83], v9 offset:21504
  ds_read_b64_tr_b16 a[84:85], v12 offset:17408
  ds_read_b64_tr_b16 a[86:87], v12 offset:21504
  ds_read_b64_tr_b16 a[88:89], v9 offset:17920
  ds_read_b64_tr_b16 a[90:91], v9 offset:22016
  ds_read_b64_tr_b16 a[92:93], v12 offset:17920
  ds_read_b64_tr_b16 a[94:95], v12 offset:22016
  ds_read_b64_tr_b16 a[96:97], v9 offset:18432
  ds_read_b64_tr_b16 a[98:99], v9 offset:22528
  ds_read_b64_tr_b16 a[100:101], v12 offset:18432
  ds_read_b64_tr_b16 a[102:103], v12 offset:22528
  ds_read_b64_tr_b16 a[104:105], v9 offset:18944
  ds_read_b64_tr_b16 a[106:107], v9 offset:23040
  ds_read_b64_tr_b16 a[108:109], v12 offset:18944
  ds_read_b64_tr_b16 a[110:111], v12 offset:23040
  ds_read_b64_tr_b16 a[112:113], v9 offset:19456
  ds_read_b64_tr_b16 a[114:115], v9 offset:23552
  ds_read_b64_tr_b16 a[116:117], v12 offset:19456
  ds_read_b64_tr_b16 a[118:119], v12 offset:23552
  ds_read_b64_tr_b16 a[120:121], v9 offset:19968
  ds_read_b64_tr_b16 a[122:123], v9 offset:24064
  ds_read_b64_tr_b16 a[124:125], v12 offset:19968
  ds_read_b64_tr_b16 a[126:127], v12 offset:24064
  s_waitcnt lgkmcnt(0)
  s_add_u32 m0, s63, 16384
  s_mov_b32 s59, 5505024
  buffer_load_dwordx4 v8, s[12:15], s59 offen lds
  s_add_u32 m0, s63, 17408
  s_mov_b32 s59, 5619712
  buffer_load_dwordx4 v8, s[12:15], s59 offen lds
  s_add_u32 m0, s63, 18432
  s_mov_b32 s59, 5734400
  buffer_load_dwordx4 v8, s[12:15], s59 offen lds
  s_add_u32 m0, s63, 19456
  s_mov_b32 s59, 5849088
  buffer_load_dwordx4 v8, s[12:15], s59 offen lds
  s_add_u32 m0, s63, 20480
  s_mov_b32 s59, 5963776
  buffer_load_dwordx4 v8, s[12:15], s59 offen lds
  s_add_u32 m0, s63, 21504
  s_mov_b32 s59, 6078464
  buffer_load_dwordx4 v8, s[12:15], s59 offen lds
  s_add_u32 m0, s63, 22528
  s_mov_b32 s59, 6193152
  buffer_load_dwordx4 v8, s[12:15], s59 offen lds
  s_add_u32 m0, s63, 23552
  s_mov_b32 s59, 6307840
  buffer_load_dwordx4 v8, s[12:15], s59 offen lds
  s_add_u32 m0, s63, 24576
  s_mov_b32 s59, 6422528
  buffer_load_dwordx4 v8, s[12:15], s59 offen lds
  s_add_u32 m0, s63, 25600
  s_mov_b32 s59, 6537216
  buffer_load_dwordx4 v8, s[12:15], s59 offen lds
  s_add_u32 m0, s63, 26624
  s_mov_b32 s59, 6651904
  buffer_load_dwordx4 v8, s[12:15], s59 offen lds
  s_add_u32 m0, s63, 27648
  s_mov_b32 s59, 6766592
  buffer_load_dwordx4 v8, s[12:15], s59 offen lds
  s_add_u32 m0, s63, 28672
  s_mov_b32 s59, 6881280
  buffer_load_dwordx4 v8, s[12:15], s59 offen lds
  s_add_u32 m0, s63, 29696
  s_mov_b32 s59, 6995968
  buffer_load_dwordx4 v8, s[12:15], s59 offen lds
  s_add_u32 m0, s63, 30720
  s_mov_b32 s59, 7110656
  buffer_load_dwordx4 v8, s[12:15], s59 offen lds
  s_add_u32 m0, s63, 31744
  s_mov_b32 s59, 7225344
  buffer_load_dwordx4 v8, s[12:15], s59 offen lds
  s_waitcnt vmcnt(16)
  ds_read_b64_tr_b16 a[128:129], v9 offset:0
  ds_read_b64_tr_b16 a[130:131], v9 offset:4096
  ds_read_b64_tr_b16 a[132:133], v12 offset:0
  ds_read_b64_tr_b16 a[134:135], v12 offset:4096
  ds_read_b64_tr_b16 a[136:137], v9 offset:512
  ds_read_b64_tr_b16 a[138:139], v9 offset:4608
  ds_read_b64_tr_b16 a[140:141], v12 offset:512
  ds_read_b64_tr_b16 a[142:143], v12 offset:4608
  ds_read_b64_tr_b16 a[144:145], v9 offset:1024
  ds_read_b64_tr_b16 a[146:147], v9 offset:5120
  ds_read_b64_tr_b16 a[148:149], v12 offset:1024
  ds_read_b64_tr_b16 a[150:151], v12 offset:5120
  ds_read_b64_tr_b16 a[152:153], v9 offset:1536
  ds_read_b64_tr_b16 a[154:155], v9 offset:5632
  ds_read_b64_tr_b16 a[156:157], v12 offset:1536
  ds_read_b64_tr_b16 a[158:159], v12 offset:5632
  ds_read_b64_tr_b16 a[160:161], v9 offset:2048
  ds_read_b64_tr_b16 a[162:163], v9 offset:6144
  ds_read_b64_tr_b16 a[164:165], v12 offset:2048
  ds_read_b64_tr_b16 a[166:167], v12 offset:6144
  ds_read_b64_tr_b16 a[168:169], v9 offset:2560
  ds_read_b64_tr_b16 a[170:171], v9 offset:6656
  ds_read_b64_tr_b16 a[172:173], v12 offset:2560
  ds_read_b64_tr_b16 a[174:175], v12 offset:6656
  ds_read_b64_tr_b16 a[176:177], v9 offset:3072
  ds_read_b64_tr_b16 a[178:179], v9 offset:7168
  ds_read_b64_tr_b16 a[180:181], v12 offset:3072
  ds_read_b64_tr_b16 a[182:183], v12 offset:7168
  ds_read_b64_tr_b16 a[184:185], v9 offset:3584
  ds_read_b64_tr_b16 a[186:187], v9 offset:7680
  ds_read_b64_tr_b16 a[188:189], v12 offset:3584
  ds_read_b64_tr_b16 a[190:191], v12 offset:7680
  s_waitcnt lgkmcnt(0)
  s_waitcnt vmcnt(0)
  ds_read_b64_tr_b16 a[192:193], v9 offset:16384
  ds_read_b64_tr_b16 a[194:195], v9 offset:20480
  ds_read_b64_tr_b16 a[196:197], v12 offset:16384
  ds_read_b64_tr_b16 a[198:199], v12 offset:20480
  ds_read_b64_tr_b16 a[200:201], v9 offset:16896
  ds_read_b64_tr_b16 a[202:203], v9 offset:20992
  ds_read_b64_tr_b16 a[204:205], v12 offset:16896
  ds_read_b64_tr_b16 a[206:207], v12 offset:20992
  ds_read_b64_tr_b16 a[208:209], v9 offset:17408
  ds_read_b64_tr_b16 a[210:211], v9 offset:21504
  ds_read_b64_tr_b16 a[212:213], v12 offset:17408
  ds_read_b64_tr_b16 a[214:215], v12 offset:21504
  ds_read_b64_tr_b16 a[216:217], v9 offset:17920
  ds_read_b64_tr_b16 a[218:219], v9 offset:22016
  ds_read_b64_tr_b16 a[220:221], v12 offset:17920
  ds_read_b64_tr_b16 a[222:223], v12 offset:22016
  ds_read_b64_tr_b16 a[224:225], v9 offset:18432
  ds_read_b64_tr_b16 a[226:227], v9 offset:22528
  ds_read_b64_tr_b16 a[228:229], v12 offset:18432
  ds_read_b64_tr_b16 a[230:231], v12 offset:22528
  ds_read_b64_tr_b16 a[232:233], v9 offset:18944
  ds_read_b64_tr_b16 a[234:235], v9 offset:23040
  ds_read_b64_tr_b16 a[236:237], v12 offset:18944
  ds_read_b64_tr_b16 a[238:239], v12 offset:23040
  ds_read_b64_tr_b16 a[240:241], v9 offset:19456
  ds_read_b64_tr_b16 a[242:243], v9 offset:23552
  ds_read_b64_tr_b16 a[244:245], v12 offset:19456
  ds_read_b64_tr_b16 a[246:247], v12 offset:23552
  ds_read_b64_tr_b16 a[248:249], v9 offset:19968
  ds_read_b64_tr_b16 a[250:251], v9 offset:24064
  ds_read_b64_tr_b16 a[252:253], v12 offset:19968
  ds_read_b64_tr_b16 a[254:255], v12 offset:24064
  s_waitcnt lgkmcnt(0)
  v_lshlrev_b32 v1, 4, v0
  v_lshrrev_b32 v8, 4, v0
  v_and_b32 v9, 15, v0
  v_lshlrev_b32 v10, 4, v9
  v_lshl_add_u32 v10, v8, 9, v10
  v_mov_b32 v20, v10
  v_add_u32 v21, 256, v10
  v_add_u32 v22, 0x10000, v20
  v_add_u32 v23, 0x10000, v21
  s_lshl_b32 s70, s54, 10
  v_add_u32 v2, s70, v1
  v_and_b32 v3, 31, v0
  v_min_u32 v3, s81, v3
  v_lshlrev_b32 v3, 4, v3
  v_lshrrev_b32 v24, 5, v0
  v_mul_u32_u24 v24, 128, v24
  v_add_u32 v3, v3, v24
  s_and_b32 s59, s56, 7
  s_lshl_b32 s59, s59, 2
  s_add_u32 s59, s59, s54
  s_mul_i32 s59, s59, 19
  v_add_u32 v24, s59, v0
  v_min_u32 v24, 511, v24
  v_lshlrev_b32 v24, 7, v24
  v_mov_b32 v25, 0x7ff00000
  v_mov_b32 v29, 0x7ff00000
  v_cmp_gt_u32 vcc, 19, v0
  s_nop 1
  v_cndmask_b32 v24, v25, v24, vcc
  v_mov_b32 v6, 0
  v_mov_b32 v5, 0x7ff00000
  v_cmp_eq_u32 vcc, 0, v0
  s_nop 1
  v_cndmask_b32 v5, v5, v6, vcc
  v_mov_b32 v6, 1
  s_lshl_b32 s59, s54, 11
  v_add_u32 v4, s59, v10
  s_mov_b32 s80, s64
  s_barrier
  s_branch gf_207
gl_205:
  s_mov_b32 s64, s80
  s_add_u32 s80, s64, 1
  ds_read_b128 v[88:91], v20 offset:6144
  s_waitcnt lgkmcnt(6)
  v_mfma_f32_16x16x32_bf16 v[32:35], a[0:3], v[64:67], 0
  v_mfma_f32_16x16x32_bf16 v[36:39], a[4:7], v[64:67], 0
  v_and_b32 v16, v16, v17
  v_and_b32 v18, v18, v19
  s_lshl_b32 s74, s80, 16
  s_add_u32 s74, s74, s66
  ds_read_b128 v[92:95], v21 offset:6144
  s_waitcnt lgkmcnt(6)
  v_mfma_f32_16x16x32_bf16 v[40:43], a[0:3], v[68:71], 0
  v_mfma_f32_16x16x32_bf16 v[44:47], a[4:7], v[68:71], 0
  v_and_b32 v16, v16, v18
  v_cmp_ne_u32 vcc, 1, v16
  s_cmp_lt_u32 s80, s65
  s_cselect_b32 vcc_lo, vcc_lo, -1
  s_cmp_eq_u32 vcc_lo, 0
  s_cselect_b32 s59, 0, 0x7ff00000
  v_add_u32 v7, s59, v2
  ds_read_b128 v[64:67], v20 offset:8192
  s_waitcnt lgkmcnt(6)
  v_mfma_f32_16x16x32_bf16 v[32:35], a[8:11], v[72:75], v[32:35]
  v_mfma_f32_16x16x32_bf16 v[36:39], a[12:15], v[72:75], v[36:39]
  s_add_u32 s59, s80, 1
  s_cmp_lt_u32 s59, s65
  s_cselect_b32 vcc_hi, vcc_hi, -1
  s_cmp_eq_u32 vcc_hi, 0
  s_cselect_b32 s59, 0, 0x7ff00000
  s_mov_b32 vcc_hi, 0
  v_add_u32 v25, s59, v24
  s_add_u32 m0, s70, 65536
  s_add_u32 s62, s74, 0
  buffer_load_dwordx4 v7, s[8:11], s62 offen sc1 lds
  ds_read_b128 v[68:71], v21 offset:8192
  s_waitcnt lgkmcnt(6)
  v_mfma_f32_16x16x32_bf16 v[40:43], a[8:11], v[76:79], v[40:43]
  v_mfma_f32_16x16x32_bf16 v[44:47], a[12:15], v[76:79], v[44:47]
  v_add_u32 v27, s73, v4
  v_add_u32 v28, s71, v5
  v_max_f32 v104, 0, v104
  v_max_f32 v105, 0, v105
  v_max_f32 v106, 0, v106
  v_max_f32 v107, 0, v107
  ds_read_b128 v[72:75], v20 offset:10240
  s_waitcnt lgkmcnt(6)
  v_mfma_f32_16x16x32_bf16 v[32:35], a[16:19], v[80:83], v[32:35]
  v_mfma_f32_16x16x32_bf16 v[36:39], a[20:23], v[80:83], v[36:39]
  v_max_f32 v108, 0, v108
  v_max_f32 v109, 0, v109
  v_max_f32 v110, 0, v110
  v_max_f32 v111, 0, v111
  ds_read_b128 v[76:79], v21 offset:10240
  s_waitcnt lgkmcnt(6)
  v_mfma_f32_16x16x32_bf16 v[40:43], a[16:19], v[84:87], v[40:43]
  v_mfma_f32_16x16x32_bf16 v[44:47], a[20:23], v[84:87], v[44:47]
  v_max_f32 v112, 0, v112
  v_max_f32 v113, 0, v113
  v_max_f32 v114, 0, v114
  v_max_f32 v115, 0, v115
  ds_read_b128 v[80:83], v20 offset:12288
  s_waitcnt lgkmcnt(6)
  v_mfma_f32_16x16x32_bf16 v[32:35], a[24:27], v[88:91], v[32:35]
  v_mfma_f32_16x16x32_bf16 v[36:39], a[28:31], v[88:91], v[36:39]
  v_max_f32 v116, 0, v116
  v_max_f32 v117, 0, v117
  v_max_f32 v118, 0, v118
  v_max_f32 v119, 0, v119
  s_add_u32 m0, s70, 69632
  s_add_u32 s62, s74, 4096
  buffer_load_dwordx4 v7, s[8:11], s62 offen sc1 lds
  ds_read_b128 v[84:87], v21 offset:12288
  s_waitcnt lgkmcnt(6)
  v_mfma_f32_16x16x32_bf16 v[40:43], a[24:27], v[92:95], v[40:43]
  v_mfma_f32_16x16x32_bf16 v[44:47], a[28:31], v[92:95], v[44:47]
  v_cvt_pk_bf16_f32 v96, v104, v105
  v_cvt_pk_bf16_f32 v97, v106, v107
  v_cvt_pk_bf16_f32 v98, v108, v109
  v_cvt_pk_bf16_f32 v99, v110, v111
  ds_read_b128 v[88:91], v20 offset:14336
  s_waitcnt lgkmcnt(6)
  v_mfma_f32_16x16x32_bf16 v[32:35], a[32:35], v[64:67], v[32:35]
  v_mfma_f32_16x16x32_bf16 v[36:39], a[36:39], v[64:67], v[36:39]
  v_cvt_pk_bf16_f32 v100, v112, v113
  v_cvt_pk_bf16_f32 v101, v114, v115
  v_cvt_pk_bf16_f32 v102, v116, v117
  v_cvt_pk_bf16_f32 v103, v118, v119
  ds_read_b128 v[92:95], v21 offset:14336
  s_waitcnt lgkmcnt(6)
  v_mfma_f32_16x16x32_bf16 v[40:43], a[32:35], v[68:71], v[40:43]
  v_mfma_f32_16x16x32_bf16 v[44:47], a[36:39], v[68:71], v[44:47]
  s_waitcnt vmcnt(13)
  s_barrier
  ds_read_b128 v[64:67], v20 offset:16384
  s_waitcnt lgkmcnt(6)
  v_mfma_f32_16x16x32_bf16 v[32:35], a[40:43], v[72:75], v[32:35]
  v_mfma_f32_16x16x32_bf16 v[36:39], a[44:47], v[72:75], v[36:39]
  s_add_u32 m0, s70, 73728
  s_add_u32 s62, s74, 8192
  buffer_load_dwordx4 v7, s[8:11], s62 offen sc1 lds
  ds_read_b128 v[68:71], v21 offset:16384
  s_waitcnt lgkmcnt(6)
  v_mfma_f32_16x16x32_bf16 v[40:43], a[40:43], v[76:79], v[40:43]
  v_mfma_f32_16x16x32_bf16 v[44:47], a[44:47], v[76:79], v[44:47]
  ds_read_b128 v[72:75], v20 offset:18432
  s_waitcnt lgkmcnt(6)
  v_mfma_f32_16x16x32_bf16 v[32:35], a[48:51], v[80:83], v[32:35]
  v_mfma_f32_16x16x32_bf16 v[36:39], a[52:55], v[80:83], v[36:39]
  s_lshl_b32 s61, s64, 18
  s_add_u32 s61, s61, s68
  s_sub_u32 s61, s61, 262144
  s_cmp_eq_u32 s72, 0
  s_cbranch_scc0 bm_211
  buffer_store_dwordx4 v[96:99], v27, s[8:11], s61 offen offset:0
  s_branch bn_212
bm_211:
  buffer_store_dwordx4 v[96:99], v27, s[8:11], s61 offen offset:0 sc1
bn_212:
  ds_read_b128 v[76:79], v21 offset:18432
  s_waitcnt lgkmcnt(6)
  v_mfma_f32_16x16x32_bf16 v[40:43], a[48:51], v[84:87], v[40:43]
  v_mfma_f32_16x16x32_bf16 v[44:47], a[52:55], v[84:87], v[44:47]
  ds_read_b128 v[80:83], v20 offset:20480
  s_waitcnt lgkmcnt(6)
  v_mfma_f32_16x16x32_bf16 v[32:35], a[56:59], v[88:91], v[32:35]
  v_mfma_f32_16x16x32_bf16 v[36:39], a[60:63], v[88:91], v[36:39]
  s_add_u32 m0, s70, 77824
  s_add_u32 s62, s74, 12288
  buffer_load_dwordx4 v7, s[8:11], s62 offen sc1 lds
  ds_read_b128 v[84:87], v21 offset:20480
  s_waitcnt lgkmcnt(6)
  v_mfma_f32_16x16x32_bf16 v[40:43], a[56:59], v[92:95], v[40:43]
  v_mfma_f32_16x16x32_bf16 v[44:47], a[60:63], v[92:95], v[44:47]
  ds_read_b128 v[88:91], v20 offset:22528
  s_waitcnt lgkmcnt(6)
  v_mfma_f32_16x16x32_bf16 v[32:35], a[64:67], v[64:67], v[32:35]
  v_mfma_f32_16x16x32_bf16 v[36:39], a[68:71], v[64:67], v[36:39]
  s_cmp_eq_u32 s72, 0
  s_cbranch_scc0 bm_213
  buffer_store_dwordx4 v[100:103], v27, s[8:11], s61 offen offset:256
  s_branch bn_214
bm_213:
  buffer_store_dwordx4 v[100:103], v27, s[8:11], s61 offen offset:256 sc1
bn_214:
  ds_read_b128 v[92:95], v21 offset:22528
  s_waitcnt lgkmcnt(6)
  v_mfma_f32_16x16x32_bf16 v[40:43], a[64:67], v[68:71], v[40:43]
  v_mfma_f32_16x16x32_bf16 v[44:47], a[68:71], v[68:71], v[44:47]
  ds_read_b128 v[64:67], v20 offset:24576
  s_waitcnt lgkmcnt(6)
  v_mfma_f32_16x16x32_bf16 v[32:35], a[72:75], v[72:75], v[32:35]
  v_mfma_f32_16x16x32_bf16 v[36:39], a[76:79], v[72:75], v[36:39]
  s_add_u32 m0, s70, 81920
  s_add_u32 s62, s74, 16384
  buffer_load_dwordx4 v7, s[8:11], s62 offen sc1 lds
  ds_read_b128 v[68:71], v21 offset:24576
  s_waitcnt lgkmcnt(6)
  v_mfma_f32_16x16x32_bf16 v[40:43], a[72:75], v[76:79], v[40:43]
  v_mfma_f32_16x16x32_bf16 v[44:47], a[76:79], v[76:79], v[44:47]
  ds_read_b128 v[72:75], v20 offset:26624
  s_waitcnt lgkmcnt(6)
  v_mfma_f32_16x16x32_bf16 v[32:35], a[80:83], v[80:83], v[32:35]
  v_mfma_f32_16x16x32_bf16 v[36:39], a[84:87], v[80:83], v[36:39]
  ds_read_b128 v[76:79], v21 offset:26624
  s_waitcnt lgkmcnt(6)
  v_mfma_f32_16x16x32_bf16 v[40:43], a[80:83], v[84:87], v[40:43]
  v_mfma_f32_16x16x32_bf16 v[44:47], a[84:87], v[84:87], v[44:47]
  ds_read_b128 v[80:83], v20 offset:28672
  s_waitcnt lgkmcnt(6)
  v_mfma_f32_16x16x32_bf16 v[32:35], a[88:91], v[88:91], v[32:35]
  v_mfma_f32_16x16x32_bf16 v[36:39], a[92:95], v[88:91], v[36:39]
  s_add_u32 m0, s70, 86016
  s_add_u32 s62, s74, 20480
  buffer_load_dwordx4 v7, s[8:11], s62 offen sc1 lds
  ds_read_b128 v[84:87], v21 offset:28672
  s_waitcnt lgkmcnt(6)
  v_mfma_f32_16x16x32_bf16 v[40:43], a[88:91], v[92:95], v[40:43]
  v_mfma_f32_16x16x32_bf16 v[44:47], a[92:95], v[92:95], v[44:47]
  ds_read_b128 v[88:91], v20 offset:30720
  s_waitcnt lgkmcnt(6)
  v_mfma_f32_16x16x32_bf16 v[32:35], a[96:99], v[64:67], v[32:35]
  v_mfma_f32_16x16x32_bf16 v[36:39], a[100:103], v[64:67], v[36:39]
  ds_read_b128 v[92:95], v21 offset:30720
  s_waitcnt lgkmcnt(6)
  v_mfma_f32_16x16x32_bf16 v[40:43], a[96:99], v[68:71], v[40:43]
  v_mfma_f32_16x16x32_bf16 v[44:47], a[100:103], v[68:71], v[44:47]
  s_waitcnt vmcnt(12)
  s_barrier
  ds_read_b128 v[64:67], v20 offset:32768
  s_waitcnt lgkmcnt(6)
  v_mfma_f32_16x16x32_bf16 v[32:35], a[104:107], v[72:75], v[32:35]
  v_mfma_f32_16x16x32_bf16 v[36:39], a[108:111], v[72:75], v[36:39]
  s_add_u32 m0, s70, 90112
  s_add_u32 s62, s74, 24576
  buffer_load_dwordx4 v7, s[8:11], s62 offen sc1 lds
  ds_read_b128 v[68:71], v21 offset:32768
  s_waitcnt lgkmcnt(6)
  v_mfma_f32_16x16x32_bf16 v[40:43], a[104:107], v[76:79], v[40:43]
  v_mfma_f32_16x16x32_bf16 v[44:47], a[108:111], v[76:79], v[44:47]
  ds_read_b128 v[72:75], v20 offset:34816
  s_waitcnt lgkmcnt(6)
  v_mfma_f32_16x16x32_bf16 v[32:35], a[112:115], v[80:83], v[32:35]
  v_mfma_f32_16x16x32_bf16 v[36:39], a[116:119], v[80:83], v[36:39]
  ds_read_b128 v[76:79], v21 offset:34816
  s_waitcnt lgkmcnt(6)
  v_mfma_f32_16x16x32_bf16 v[40:43], a[112:115], v[84:87], v[40:43]
  v_mfma_f32_16x16x32_bf16 v[44:47], a[116:119], v[84:87], v[44:47]
  ds_read_b128 v[80:83], v20 offset:36864
  s_waitcnt lgkmcnt(6)
  v_mfma_f32_16x16x32_bf16 v[32:35], a[120:123], v[88:91], v[32:35]
  v_mfma_f32_16x16x32_bf16 v[36:39], a[124:127], v[88:91], v[36:39]
  s_add_u32 m0, s70, 94208
  s_add_u32 s62, s74, 28672
  buffer_load_dwordx4 v7, s[8:11], s62 offen sc1 lds
  ds_read_b128 v[84:87], v21 offset:36864
  s_waitcnt lgkmcnt(6)
  v_mfma_f32_16x16x32_bf16 v[40:43], a[120:123], v[92:95], v[40:43]
  v_mfma_f32_16x16x32_bf16 v[44:47], a[124:127], v[92:95], v[44:47]
  ds_read_b128 v[88:91], v20 offset:38912
  s_waitcnt lgkmcnt(6)
  v_mfma_f32_16x16x32_bf16 v[32:35], a[128:131], v[64:67], v[32:35]
  v_mfma_f32_16x16x32_bf16 v[36:39], a[132:135], v[64:67], v[36:39]
  s_mul_i32 s60, s80, 128
  s_add_u32 s60, s60, s67
  s_add_u32 s60, s60, 128
  buffer_load_dwordx4 v[16:19], v3, s[8:11], s60 offen sc1
  ds_read_b128 v[92:95], v21 offset:38912
  s_waitcnt lgkmcnt(6)
  v_mfma_f32_16x16x32_bf16 v[40:43], a[128:131], v[68:71], v[40:43]
  v_mfma_f32_16x16x32_bf16 v[44:47], a[132:135], v[68:71], v[44:47]
  ds_read_b128 v[64:67], v20 offset:40960
  s_waitcnt lgkmcnt(6)
  v_mfma_f32_16x16x32_bf16 v[32:35], a[136:139], v[72:75], v[32:35]
  v_mfma_f32_16x16x32_bf16 v[36:39], a[140:143], v[72:75], v[36:39]
  s_add_u32 m0, s70, 98304
  s_add_u32 s62, s74, 32768
  buffer_load_dwordx4 v7, s[8:11], s62 offen sc1 lds
  ds_read_b128 v[68:71], v21 offset:40960
  s_waitcnt lgkmcnt(6)
  v_mfma_f32_16x16x32_bf16 v[40:43], a[136:139], v[76:79], v[40:43]
  v_mfma_f32_16x16x32_bf16 v[44:47], a[140:143], v[76:79], v[44:47]
  ds_read_b128 v[72:75], v20 offset:43008
  s_waitcnt lgkmcnt(6)
  v_mfma_f32_16x16x32_bf16 v[32:35], a[144:147], v[80:83], v[32:35]
  v_mfma_f32_16x16x32_bf16 v[36:39], a[148:151], v[80:83], v[36:39]
  s_add_u32 s59, s74, 65536
  buffer_load_dword v26, v25, s[8:11], s59 offen sc1
  ds_read_b128 v[76:79], v21 offset:43008
  s_waitcnt lgkmcnt(6)
  v_mfma_f32_16x16x32_bf16 v[40:43], a[144:147], v[84:87], v[40:43]
  v_mfma_f32_16x16x32_bf16 v[44:47], a[148:151], v[84:87], v[44:47]
  ds_read_b128 v[80:83], v20 offset:45056
  s_waitcnt lgkmcnt(6)
  v_mfma_f32_16x16x32_bf16 v[32:35], a[152:155], v[88:91], v[32:35]
  v_mfma_f32_16x16x32_bf16 v[36:39], a[156:159], v[88:91], v[36:39]
  s_add_u32 m0, s70, 102400
  s_add_u32 s62, s74, 36864
  buffer_load_dwordx4 v7, s[8:11], s62 offen sc1 lds
  ds_read_b128 v[84:87], v21 offset:45056
  s_waitcnt lgkmcnt(6)
  v_mfma_f32_16x16x32_bf16 v[40:43], a[152:155], v[92:95], v[40:43]
  v_mfma_f32_16x16x32_bf16 v[44:47], a[156:159], v[92:95], v[44:47]
  ds_read_b128 v[88:91], v20 offset:47104
  s_waitcnt lgkmcnt(6)
  v_mfma_f32_16x16x32_bf16 v[32:35], a[160:163], v[64:67], v[32:35]
  v_mfma_f32_16x16x32_bf16 v[36:39], a[164:167], v[64:67], v[36:39]
  ds_read_b128 v[92:95], v21 offset:47104
  s_waitcnt lgkmcnt(6)
  v_mfma_f32_16x16x32_bf16 v[40:43], a[160:163], v[68:71], v[40:43]
  v_mfma_f32_16x16x32_bf16 v[44:47], a[164:167], v[68:71], v[44:47]
  s_waitcnt vmcnt(14)
  s_barrier
  ds_read_b128 v[64:67], v20 offset:49152
  s_waitcnt lgkmcnt(6)
  v_mfma_f32_16x16x32_bf16 v[32:35], a[168:171], v[72:75], v[32:35]
  v_mfma_f32_16x16x32_bf16 v[36:39], a[172:175], v[72:75], v[36:39]
  s_add_u32 m0, s70, 106496
  s_add_u32 s62, s74, 40960
  buffer_load_dwordx4 v7, s[8:11], s62 offen sc1 lds
  ds_read_b128 v[68:71], v21 offset:49152
  s_waitcnt lgkmcnt(6)
  v_mfma_f32_16x16x32_bf16 v[40:43], a[168:171], v[76:79], v[40:43]
  v_mfma_f32_16x16x32_bf16 v[44:47], a[172:175], v[76:79], v[44:47]
  ds_read_b128 v[72:75], v20 offset:51200
  s_waitcnt lgkmcnt(6)
  v_mfma_f32_16x16x32_bf16 v[32:35], a[176:179], v[80:83], v[32:35]
  v_mfma_f32_16x16x32_bf16 v[36:39], a[180:183], v[80:83], v[36:39]
  s_waitcnt vmcnt(9)
  s_mul_i32 s76, s64, 512
  s_add_u32 s76, s76, s69
  s_sub_u32 s76, s76, 512
  s_cmp_eq_u32 s72, 0
  s_cbranch_scc0 bm_215
  buffer_store_dword v6, v28, s[8:11], s76 offen
  s_branch bn_216
bm_215:
  buffer_store_dword v6, v28, s[8:11], s76 offen sc1
bn_216:
  ds_read_b128 v[76:79], v21 offset:51200
  s_waitcnt lgkmcnt(6)
  v_mfma_f32_16x16x32_bf16 v[40:43], a[176:179], v[84:87], v[40:43]
  v_mfma_f32_16x16x32_bf16 v[44:47], a[180:183], v[84:87], v[44:47]
  ds_read_b128 v[80:83], v20 offset:53248
  s_waitcnt lgkmcnt(6)
  v_mfma_f32_16x16x32_bf16 v[32:35], a[184:187], v[88:91], v[32:35]
  v_mfma_f32_16x16x32_bf16 v[36:39], a[188:191], v[88:91], v[36:39]
  s_add_u32 m0, s70, 110592
  s_add_u32 s62, s74, 45056
  buffer_load_dwordx4 v7, s[8:11], s62 offen sc1 lds
  ds_read_b128 v[84:87], v21 offset:53248
  s_waitcnt lgkmcnt(6)
  v_mfma_f32_16x16x32_bf16 v[40:43], a[184:187], v[92:95], v[40:43]
  v_mfma_f32_16x16x32_bf16 v[44:47], a[188:191], v[92:95], v[44:47]
  ds_read_b128 v[88:91], v20 offset:55296
  s_waitcnt lgkmcnt(6)
  v_mfma_f32_16x16x32_bf16 v[32:35], a[192:195], v[64:67], v[32:35]
  v_mfma_f32_16x16x32_bf16 v[36:39], a[196:199], v[64:67], v[36:39]
  ds_read_b128 v[92:95], v21 offset:55296
  s_waitcnt lgkmcnt(6)
  v_mfma_f32_16x16x32_bf16 v[40:43], a[192:195], v[68:71], v[40:43]
  v_mfma_f32_16x16x32_bf16 v[44:47], a[196:199], v[68:71], v[44:47]
  ds_read_b128 v[64:67], v20 offset:57344
  s_waitcnt lgkmcnt(6)
  v_mfma_f32_16x16x32_bf16 v[32:35], a[200:203], v[72:75], v[32:35]
  v_mfma_f32_16x16x32_bf16 v[36:39], a[204:207], v[72:75], v[36:39]
  s_add_u32 m0, s70, 114688
  s_add_u32 s62, s74, 49152
  buffer_load_dwordx4 v7, s[8:11], s62 offen sc1 lds
  ds_read_b128 v[68:71], v21 offset:57344
  s_waitcnt lgkmcnt(6)
  v_mfma_f32_16x16x32_bf16 v[40:43], a[200:203], v[76:79], v[40:43]
  v_mfma_f32_16x16x32_bf16 v[44:47], a[204:207], v[76:79], v[44:47]
  ds_read_b128 v[72:75], v20 offset:59392
  s_waitcnt lgkmcnt(6)
  v_mfma_f32_16x16x32_bf16 v[32:35], a[208:211], v[80:83], v[32:35]
  v_mfma_f32_16x16x32_bf16 v[36:39], a[212:215], v[80:83], v[36:39]
  ds_read_b128 v[76:79], v21 offset:59392
  s_waitcnt lgkmcnt(6)
  v_mfma_f32_16x16x32_bf16 v[40:43], a[208:211], v[84:87], v[40:43]
  v_mfma_f32_16x16x32_bf16 v[44:47], a[212:215], v[84:87], v[44:47]
  ds_read_b128 v[80:83], v20 offset:61440
  s_waitcnt lgkmcnt(6)
  v_mfma_f32_16x16x32_bf16 v[32:35], a[216:219], v[88:91], v[32:35]
  v_mfma_f32_16x16x32_bf16 v[36:39], a[220:223], v[88:91], v[36:39]
  s_add_u32 m0, s70, 118784
  s_add_u32 s62, s74, 53248
  buffer_load_dwordx4 v7, s[8:11], s62 offen sc1 lds
  ds_read_b128 v[84:87], v21 offset:61440
  s_waitcnt lgkmcnt(6)
  v_mfma_f32_16x16x32_bf16 v[40:43], a[216:219], v[92:95], v[40:43]
  v_mfma_f32_16x16x32_bf16 v[44:47], a[220:223], v[92:95], v[44:47]
  ds_read_b128 v[88:91], v20 offset:63488
  s_waitcnt lgkmcnt(6)
  v_mfma_f32_16x16x32_bf16 v[32:35], a[224:227], v[64:67], v[32:35]
  v_mfma_f32_16x16x32_bf16 v[36:39], a[228:231], v[64:67], v[36:39]
  ds_read_b128 v[92:95], v21 offset:63488
  s_waitcnt lgkmcnt(6)
  v_mfma_f32_16x16x32_bf16 v[40:43], a[224:227], v[68:71], v[40:43]
  v_mfma_f32_16x16x32_bf16 v[44:47], a[228:231], v[68:71], v[44:47]
  s_cbranch_vccnz gt_209
  s_waitcnt vmcnt(14)
  s_barrier
  ds_read_b128 v[64:67], v22 offset:0
  s_waitcnt lgkmcnt(6)
  v_mfma_f32_16x16x32_bf16 v[32:35], a[232:235], v[72:75], v[32:35]
  v_mfma_f32_16x16x32_bf16 v[36:39], a[236:239], v[72:75], v[36:39]
  s_add_u32 m0, s70, 122880
  s_add_u32 s62, s74, 57344
  buffer_load_dwordx4 v7, s[8:11], s62 offen sc1 lds
  ds_read_b128 v[68:71], v23 offset:0
  s_waitcnt lgkmcnt(6)
  v_mfma_f32_16x16x32_bf16 v[40:43], a[232:235], v[76:79], v[40:43]
  v_mfma_f32_16x16x32_bf16 v[44:47], a[236:239], v[76:79], v[44:47]
  ds_read_b128 v[72:75], v22 offset:2048
  s_waitcnt lgkmcnt(6)
  v_mfma_f32_16x16x32_bf16 v[32:35], a[240:243], v[80:83], v[32:35]
  v_mfma_f32_16x16x32_bf16 v[36:39], a[244:247], v[80:83], v[36:39]
  ds_read_b128 v[76:79], v23 offset:2048
  s_waitcnt lgkmcnt(6)
  v_mfma_f32_16x16x32_bf16 v[40:43], a[240:243], v[84:87], v[40:43]
  v_mfma_f32_16x16x32_bf16 v[44:47], a[244:247], v[84:87], v[44:47]
  ds_read_b128 v[80:83], v22 offset:4096
  s_waitcnt lgkmcnt(6)
  v_mfma_f32_16x16x32_bf16 v[32:35], a[248:251], v[88:91], v[32:35]
  v_mfma_f32_16x16x32_bf16 v[36:39], a[252:255], v[88:91], v[36:39]
  s_add_u32 m0, s70, 126976
  s_add_u32 s62, s74, 61440
  buffer_load_dwordx4 v7, s[8:11], s62 offen sc1 lds
  ds_read_b128 v[84:87], v23 offset:4096
  s_waitcnt lgkmcnt(6)
  v_mfma_f32_16x16x32_bf16 v[40:43], a[248:251], v[92:95], v[40:43]
  v_mfma_f32_16x16x32_bf16 v[44:47], a[252:255], v[92:95], v[44:47]
  s_mov_b32 s73, 0
  s_mov_b32 s71, 0
  s_waitcnt vmcnt(10)
gl_206:
  s_mov_b32 s64, s80
  s_add_u32 s80, s64, 1
  ds_read_b128 v[88:91], v22 offset:6144
  s_waitcnt lgkmcnt(6)
  v_mfma_f32_16x16x32_bf16 v[104:107], a[0:3], v[64:67], 0
  v_mfma_f32_16x16x32_bf16 v[108:111], a[4:7], v[64:67], 0
  v_and_b32 v16, v16, v17
  v_and_b32 v18, v18, v19
  s_lshl_b32 s74, s80, 16
  s_add_u32 s74, s74, s66
  ds_read_b128 v[92:95], v23 offset:6144
  s_waitcnt lgkmcnt(6)
  v_mfma_f32_16x16x32_bf16 v[112:115], a[0:3], v[68:71], 0
  v_mfma_f32_16x16x32_bf16 v[116:119], a[4:7], v[68:71], 0
  v_and_b32 v16, v16, v18
  v_cmp_ne_u32 vcc, 1, v16
  s_cmp_lt_u32 s80, s65
  s_cselect_b32 vcc_lo, vcc_lo, -1
  s_cmp_eq_u32 vcc_lo, 0
  s_cselect_b32 s59, 0, 0x7ff00000
  v_add_u32 v7, s59, v2
  ds_read_b128 v[64:67], v22 offset:8192
  s_waitcnt lgkmcnt(6)
  v_mfma_f32_16x16x32_bf16 v[104:107], a[8:11], v[72:75], v[104:107]
  v_mfma_f32_16x16x32_bf16 v[108:111], a[12:15], v[72:75], v[108:111]
  s_add_u32 s59, s80, 1
  s_cmp_lt_u32 s59, s65
  s_cselect_b32 vcc_hi, vcc_hi, -1
  s_cmp_eq_u32 vcc_hi, 0
  s_cselect_b32 s59, 0, 0x7ff00000
  s_mov_b32 vcc_hi, 0
  v_add_u32 v25, s59, v24
  s_add_u32 m0, s70, 0
  s_add_u32 s62, s74, 0
  buffer_load_dwordx4 v7, s[8:11], s62 offen sc1 lds
  ds_read_b128 v[68:71], v23 offset:8192
  s_waitcnt lgkmcnt(6)
  v_mfma_f32_16x16x32_bf16 v[112:115], a[8:11], v[76:79], v[112:115]
  v_mfma_f32_16x16x32_bf16 v[116:119], a[12:15], v[76:79], v[116:119]
  v_add_u32 v27, s73, v4
  v_add_u32 v28, s71, v5
  v_max_f32 v32, 0, v32
  v_max_f32 v33, 0, v33
  v_max_f32 v34, 0, v34
  v_max_f32 v35, 0, v35
  ds_read_b128 v[72:75], v22 offset:10240
  s_waitcnt lgkmcnt(6)
  v_mfma_f32_16x16x32_bf16 v[104:107], a[16:19], v[80:83], v[104:107]
  v_mfma_f32_16x16x32_bf16 v[108:111], a[20:23], v[80:83], v[108:111]
  v_max_f32 v36, 0, v36
  v_max_f32 v37, 0, v37
  v_max_f32 v38, 0, v38
  v_max_f32 v39, 0, v39
  ds_read_b128 v[76:79], v23 offset:10240
  s_waitcnt lgkmcnt(6)
  v_mfma_f32_16x16x32_bf16 v[112:115], a[16:19], v[84:87], v[112:115]
  v_mfma_f32_16x16x32_bf16 v[116:119], a[20:23], v[84:87], v[116:119]
  v_max_f32 v40, 0, v40
  v_max_f32 v41, 0, v41
  v_max_f32 v42, 0, v42
  v_max_f32 v43, 0, v43
  ds_read_b128 v[80:83], v22 offset:12288
  s_waitcnt lgkmcnt(6)
  v_mfma_f32_16x16x32_bf16 v[104:107], a[24:27], v[88:91], v[104:107]
  v_mfma_f32_16x16x32_bf16 v[108:111], a[28:31], v[88:91], v[108:111]
  v_max_f32 v44, 0, v44
  v_max_f32 v45, 0, v45
  v_max_f32 v46, 0, v46
  v_max_f32 v47, 0, v47
  s_add_u32 m0, s70, 4096
  s_add_u32 s62, s74, 4096
  buffer_load_dwordx4 v7, s[8:11], s62 offen sc1 lds
  ds_read_b128 v[84:87], v23 offset:12288
  s_waitcnt lgkmcnt(6)
  v_mfma_f32_16x16x32_bf16 v[112:115], a[24:27], v[92:95], v[112:115]
  v_mfma_f32_16x16x32_bf16 v[116:119], a[28:31], v[92:95], v[116:119]
  v_cvt_pk_bf16_f32 v96, v32, v33
  v_cvt_pk_bf16_f32 v97, v34, v35
  v_cvt_pk_bf16_f32 v98, v36, v37
  v_cvt_pk_bf16_f32 v99, v38, v39
  ds_read_b128 v[88:91], v22 offset:14336
  s_waitcnt lgkmcnt(6)
  v_mfma_f32_16x16x32_bf16 v[104:107], a[32:35], v[64:67], v[104:107]
  v_mfma_f32_16x16x32_bf16 v[108:111], a[36:39], v[64:67], v[108:111]
  v_cvt_pk_bf16_f32 v100, v40, v41
  v_cvt_pk_bf16_f32 v101, v42, v43
  v_cvt_pk_bf16_f32 v102, v44, v45
  v_cvt_pk_bf16_f32 v103, v46, v47
  ds_read_b128 v[92:95], v23 offset:14336
  s_waitcnt lgkmcnt(6)
  v_mfma_f32_16x16x32_bf16 v[112:115], a[32:35], v[68:71], v[112:115]
  v_mfma_f32_16x16x32_bf16 v[116:119], a[36:39], v[68:71], v[116:119]
  s_waitcnt vmcnt(13)
  s_barrier
  ds_read_b128 v[64:67], v22 offset:16384
  s_waitcnt lgkmcnt(6)
  v_mfma_f32_16x16x32_bf16 v[104:107], a[40:43], v[72:75], v[104:107]
  v_mfma_f32_16x16x32_bf16 v[108:111], a[44:47], v[72:75], v[108:111]
  s_add_u32 m0, s70, 8192
  s_add_u32 s62, s74, 8192
  buffer_load_dwordx4 v7, s[8:11], s62 offen sc1 lds
  ds_read_b128 v[68:71], v23 offset:16384
  s_waitcnt lgkmcnt(6)
  v_mfma_f32_16x16x32_bf16 v[112:115], a[40:43], v[76:79], v[112:115]
  v_mfma_f32_16x16x32_bf16 v[116:119], a[44:47], v[76:79], v[116:119]
  ds_read_b128 v[72:75], v22 offset:18432
  s_waitcnt lgkmcnt(6)
  v_mfma_f32_16x16x32_bf16 v[104:107], a[48:51], v[80:83], v[104:107]
  v_mfma_f32_16x16x32_bf16 v[108:111], a[52:55], v[80:83], v[108:111]
  s_lshl_b32 s61, s64, 18
  s_add_u32 s61, s61, s68
  s_sub_u32 s61, s61, 262144
  s_cmp_eq_u32 s72, 0
  s_cbranch_scc0 bm_217
  buffer_store_dwordx4 v[96:99], v27, s[8:11], s61 offen offset:0
  s_branch bn_218
bm_217:
  buffer_store_dwordx4 v[96:99], v27, s[8:11], s61 offen offset:0 sc1
bn_218:
  ds_read_b128 v[76:79], v23 offset:18432
  s_waitcnt lgkmcnt(6)
  v_mfma_f32_16x16x32_bf16 v[112:115], a[48:51], v[84:87], v[112:115]
  v_mfma_f32_16x16x32_bf16 v[116:119], a[52:55], v[84:87], v[116:119]
  ds_read_b128 v[80:83], v22 offset:20480
  s_waitcnt lgkmcnt(6)
  v_mfma_f32_16x16x32_bf16 v[104:107], a[56:59], v[88:91], v[104:107]
  v_mfma_f32_16x16x32_bf16 v[108:111], a[60:63], v[88:91], v[108:111]
  s_add_u32 m0, s70, 12288
  s_add_u32 s62, s74, 12288
  buffer_load_dwordx4 v7, s[8:11], s62 offen sc1 lds
  ds_read_b128 v[84:87], v23 offset:20480
  s_waitcnt lgkmcnt(6)
  v_mfma_f32_16x16x32_bf16 v[112:115], a[56:59], v[92:95], v[112:115]
  v_mfma_f32_16x16x32_bf16 v[116:119], a[60:63], v[92:95], v[116:119]
  ds_read_b128 v[88:91], v22 offset:22528
  s_waitcnt lgkmcnt(6)
  v_mfma_f32_16x16x32_bf16 v[104:107], a[64:67], v[64:67], v[104:107]
  v_mfma_f32_16x16x32_bf16 v[108:111], a[68:71], v[64:67], v[108:111]
  s_cmp_eq_u32 s72, 0
  s_cbranch_scc0 bm_219
  buffer_store_dwordx4 v[100:103], v27, s[8:11], s61 offen offset:256
  s_branch bn_220
bm_219:
  buffer_store_dwordx4 v[100:103], v27, s[8:11], s61 offen offset:256 sc1
bn_220:
  ds_read_b128 v[92:95], v23 offset:22528
  s_waitcnt lgkmcnt(6)
  v_mfma_f32_16x16x32_bf16 v[112:115], a[64:67], v[68:71], v[112:115]
  v_mfma_f32_16x16x32_bf16 v[116:119], a[68:71], v[68:71], v[116:119]
  ds_read_b128 v[64:67], v22 offset:24576
  s_waitcnt lgkmcnt(6)
  v_mfma_f32_16x16x32_bf16 v[104:107], a[72:75], v[72:75], v[104:107]
  v_mfma_f32_16x16x32_bf16 v[108:111], a[76:79], v[72:75], v[108:111]
  s_add_u32 m0, s70, 16384
  s_add_u32 s62, s74, 16384
  buffer_load_dwordx4 v7, s[8:11], s62 offen sc1 lds
  ds_read_b128 v[68:71], v23 offset:24576
  s_waitcnt lgkmcnt(6)
  v_mfma_f32_16x16x32_bf16 v[112:115], a[72:75], v[76:79], v[112:115]
  v_mfma_f32_16x16x32_bf16 v[116:119], a[76:79], v[76:79], v[116:119]
  ds_read_b128 v[72:75], v22 offset:26624
  s_waitcnt lgkmcnt(6)
  v_mfma_f32_16x16x32_bf16 v[104:107], a[80:83], v[80:83], v[104:107]
  v_mfma_f32_16x16x32_bf16 v[108:111], a[84:87], v[80:83], v[108:111]
  ds_read_b128 v[76:79], v23 offset:26624
  s_waitcnt lgkmcnt(6)
  v_mfma_f32_16x16x32_bf16 v[112:115], a[80:83], v[84:87], v[112:115]
  v_mfma_f32_16x16x32_bf16 v[116:119], a[84:87], v[84:87], v[116:119]
  ds_read_b128 v[80:83], v22 offset:28672
  s_waitcnt lgkmcnt(6)
  v_mfma_f32_16x16x32_bf16 v[104:107], a[88:91], v[88:91], v[104:107]
  v_mfma_f32_16x16x32_bf16 v[108:111], a[92:95], v[88:91], v[108:111]
  s_add_u32 m0, s70, 20480
  s_add_u32 s62, s74, 20480
  buffer_load_dwordx4 v7, s[8:11], s62 offen sc1 lds
  ds_read_b128 v[84:87], v23 offset:28672
  s_waitcnt lgkmcnt(6)
  v_mfma_f32_16x16x32_bf16 v[112:115], a[88:91], v[92:95], v[112:115]
  v_mfma_f32_16x16x32_bf16 v[116:119], a[92:95], v[92:95], v[116:119]
  ds_read_b128 v[88:91], v22 offset:30720
  s_waitcnt lgkmcnt(6)
  v_mfma_f32_16x16x32_bf16 v[104:107], a[96:99], v[64:67], v[104:107]
  v_mfma_f32_16x16x32_bf16 v[108:111], a[100:103], v[64:67], v[108:111]
  ds_read_b128 v[92:95], v23 offset:30720
  s_waitcnt lgkmcnt(6)
  v_mfma_f32_16x16x32_bf16 v[112:115], a[96:99], v[68:71], v[112:115]
  v_mfma_f32_16x16x32_bf16 v[116:119], a[100:103], v[68:71], v[116:119]
  s_waitcnt vmcnt(12)
  s_barrier
  ds_read_b128 v[64:67], v22 offset:32768
  s_waitcnt lgkmcnt(6)
  v_mfma_f32_16x16x32_bf16 v[104:107], a[104:107], v[72:75], v[104:107]
  v_mfma_f32_16x16x32_bf16 v[108:111], a[108:111], v[72:75], v[108:111]
  s_add_u32 m0, s70, 24576
  s_add_u32 s62, s74, 24576
  buffer_load_dwordx4 v7, s[8:11], s62 offen sc1 lds
  ds_read_b128 v[68:71], v23 offset:32768
  s_waitcnt lgkmcnt(6)
  v_mfma_f32_16x16x32_bf16 v[112:115], a[104:107], v[76:79], v[112:115]
  v_mfma_f32_16x16x32_bf16 v[116:119], a[108:111], v[76:79], v[116:119]
  ds_read_b128 v[72:75], v22 offset:34816
  s_waitcnt lgkmcnt(6)
  v_mfma_f32_16x16x32_bf16 v[104:107], a[112:115], v[80:83], v[104:107]
  v_mfma_f32_16x16x32_bf16 v[108:111], a[116:119], v[80:83], v[108:111]
  ds_read_b128 v[76:79], v23 offset:34816
  s_waitcnt lgkmcnt(6)
  v_mfma_f32_16x16x32_bf16 v[112:115], a[112:115], v[84:87], v[112:115]
  v_mfma_f32_16x16x32_bf16 v[116:119], a[116:119], v[84:87], v[116:119]
  ds_read_b128 v[80:83], v22 offset:36864
  s_waitcnt lgkmcnt(6)
  v_mfma_f32_16x16x32_bf16 v[104:107], a[120:123], v[88:91], v[104:107]
  v_mfma_f32_16x16x32_bf16 v[108:111], a[124:127], v[88:91], v[108:111]
  s_add_u32 m0, s70, 28672
  s_add_u32 s62, s74, 28672
  buffer_load_dwordx4 v7, s[8:11], s62 offen sc1 lds
  ds_read_b128 v[84:87], v23 offset:36864
  s_waitcnt lgkmcnt(6)
  v_mfma_f32_16x16x32_bf16 v[112:115], a[120:123], v[92:95], v[112:115]
  v_mfma_f32_16x16x32_bf16 v[116:119], a[124:127], v[92:95], v[116:119]
  ds_read_b128 v[88:91], v22 offset:38912
  s_waitcnt lgkmcnt(6)
  v_mfma_f32_16x16x32_bf16 v[104:107], a[128:131], v[64:67], v[104:107]
  v_mfma_f32_16x16x32_bf16 v[108:111], a[132:135], v[64:67], v[108:111]
  s_mul_i32 s60, s80, 128
  s_add_u32 s60, s60, s67
  s_add_u32 s60, s60, 128
  buffer_load_dwordx4 v[16:19], v3, s[8:11], s60 offen sc1
  ds_read_b128 v[92:95], v23 offset:38912
  s_waitcnt lgkmcnt(6)
  v_mfma_f32_16x16x32_bf16 v[112:115], a[128:131], v[68:71], v[112:115]
  v_mfma_f32_16x16x32_bf16 v[116:119], a[132:135], v[68:71], v[116:119]
  ds_read_b128 v[64:67], v22 offset:40960
  s_waitcnt lgkmcnt(6)
  v_mfma_f32_16x16x32_bf16 v[104:107], a[136:139], v[72:75], v[104:107]
  v_mfma_f32_16x16x32_bf16 v[108:111], a[140:143], v[72:75], v[108:111]
  s_add_u32 m0, s70, 32768
  s_add_u32 s62, s74, 32768
  buffer_load_dwordx4 v7, s[8:11], s62 offen sc1 lds
  ds_read_b128 v[68:71], v23 offset:40960
  s_waitcnt lgkmcnt(6)
  v_mfma_f32_16x16x32_bf16 v[112:115], a[136:139], v[76:79], v[112:115]
  v_mfma_f32_16x16x32_bf16 v[116:119], a[140:143], v[76:79], v[116:119]
  ds_read_b128 v[72:75], v22 offset:43008
  s_waitcnt lgkmcnt(6)
  v_mfma_f32_16x16x32_bf16 v[104:107], a[144:147], v[80:83], v[104:107]
  v_mfma_f32_16x16x32_bf16 v[108:111], a[148:151], v[80:83], v[108:111]
  s_add_u32 s59, s74, 65536
  buffer_load_dword v26, v25, s[8:11], s59 offen sc1
  ds_read_b128 v[76:79], v23 offset:43008
  s_waitcnt lgkmcnt(6)
  v_mfma_f32_16x16x32_bf16 v[112:115], a[144:147], v[84:87], v[112:115]
  v_mfma_f32_16x16x32_bf16 v[116:119], a[148:151], v[84:87], v[116:119]
  ds_read_b128 v[80:83], v22 offset:45056
  s_waitcnt lgkmcnt(6)
  v_mfma_f32_16x16x32_bf16 v[104:107], a[152:155], v[88:91], v[104:107]
  v_mfma_f32_16x16x32_bf16 v[108:111], a[156:159], v[88:91], v[108:111]
  s_add_u32 m0, s70, 36864
  s_add_u32 s62, s74, 36864
  buffer_load_dwordx4 v7, s[8:11], s62 offen sc1 lds
  ds_read_b128 v[84:87], v23 offset:45056
  s_waitcnt lgkmcnt(6)
  v_mfma_f32_16x16x32_bf16 v[112:115], a[152:155], v[92:95], v[112:115]
  v_mfma_f32_16x16x32_bf16 v[116:119], a[156:159], v[92:95], v[116:119]
  ds_read_b128 v[88:91], v22 offset:47104
  s_waitcnt lgkmcnt(6)
  v_mfma_f32_16x16x32_bf16 v[104:107], a[160:163], v[64:67], v[104:107]
  v_mfma_f32_16x16x32_bf16 v[108:111], a[164:167], v[64:67], v[108:111]
  ds_read_b128 v[92:95], v23 offset:47104
  s_waitcnt lgkmcnt(6)
  v_mfma_f32_16x16x32_bf16 v[112:115], a[160:163], v[68:71], v[112:115]
  v_mfma_f32_16x16x32_bf16 v[116:119], a[164:167], v[68:71], v[116:119]
  s_waitcnt vmcnt(14)
  s_barrier
  ds_read_b128 v[64:67], v22 offset:49152
  s_waitcnt lgkmcnt(6)
  v_mfma_f32_16x16x32_bf16 v[104:107], a[168:171], v[72:75], v[104:107]
  v_mfma_f32_16x16x32_bf16 v[108:111], a[172:175], v[72:75], v[108:111]
  s_add_u32 m0, s70, 40960
  s_add_u32 s62, s74, 40960
  buffer_load_dwordx4 v7, s[8:11], s62 offen sc1 lds
  ds_read_b128 v[68:71], v23 offset:49152
  s_waitcnt lgkmcnt(6)
  v_mfma_f32_16x16x32_bf16 v[112:115], a[168:171], v[76:79], v[112:115]
  v_mfma_f32_16x16x32_bf16 v[116:119], a[172:175], v[76:79], v[116:119]
  ds_read_b128 v[72:75], v22 offset:51200
  s_waitcnt lgkmcnt(6)
  v_mfma_f32_16x16x32_bf16 v[104:107], a[176:179], v[80:83], v[104:107]
  v_mfma_f32_16x16x32_bf16 v[108:111], a[180:183], v[80:83], v[108:111]
  s_waitcnt vmcnt(9)
  s_mul_i32 s76, s64, 512
  s_add_u32 s76, s76, s69
  s_sub_u32 s76, s76, 512
  s_cmp_eq_u32 s72, 0
  s_cbranch_scc0 bm_221
  buffer_store_dword v6, v28, s[8:11], s76 offen
  s_branch bn_222
bm_221:
  buffer_store_dword v6, v28, s[8:11], s76 offen sc1
bn_222:
  ds_read_b128 v[76:79], v23 offset:51200
  s_waitcnt lgkmcnt(6)
  v_mfma_f32_16x16x32_bf16 v[112:115], a[176:179], v[84:87], v[112:115]
  v_mfma_f32_16x16x32_bf16 v[116:119], a[180:183], v[84:87], v[116:119]
  ds_read_b128 v[80:83], v22 offset:53248
  s_waitcnt lgkmcnt(6)
  v_mfma_f32_16x16x32_bf16 v[104:107], a[184:187], v[88:91], v[104:107]
  v_mfma_f32_16x16x32_bf16 v[108:111], a[188:191], v[88:91], v[108:111]
  s_add_u32 m0, s70, 45056
  s_add_u32 s62, s74, 45056
  buffer_load_dwordx4 v7, s[8:11], s62 offen sc1 lds
  ds_read_b128 v[84:87], v23 offset:53248
  s_waitcnt lgkmcnt(6)
  v_mfma_f32_16x16x32_bf16 v[112:115], a[184:187], v[92:95], v[112:115]
  v_mfma_f32_16x16x32_bf16 v[116:119], a[188:191], v[92:95], v[116:119]
  ds_read_b128 v[88:91], v22 offset:55296
  s_waitcnt lgkmcnt(6)
  v_mfma_f32_16x16x32_bf16 v[104:107], a[192:195], v[64:67], v[104:107]
  v_mfma_f32_16x16x32_bf16 v[108:111], a[196:199], v[64:67], v[108:111]
  ds_read_b128 v[92:95], v23 offset:55296
  s_waitcnt lgkmcnt(6)
  v_mfma_f32_16x16x32_bf16 v[112:115], a[192:195], v[68:71], v[112:115]
  v_mfma_f32_16x16x32_bf16 v[116:119], a[196:199], v[68:71], v[116:119]
  ds_read_b128 v[64:67], v22 offset:57344
  s_waitcnt lgkmcnt(6)
  v_mfma_f32_16x16x32_bf16 v[104:107], a[200:203], v[72:75], v[104:107]
  v_mfma_f32_16x16x32_bf16 v[108:111], a[204:207], v[72:75], v[108:111]
  s_add_u32 m0, s70, 49152
  s_add_u32 s62, s74, 49152
  buffer_load_dwordx4 v7, s[8:11], s62 offen sc1 lds
  ds_read_b128 v[68:71], v23 offset:57344
  s_waitcnt lgkmcnt(6)
  v_mfma_f32_16x16x32_bf16 v[112:115], a[200:203], v[76:79], v[112:115]
  v_mfma_f32_16x16x32_bf16 v[116:119], a[204:207], v[76:79], v[116:119]
  ds_read_b128 v[72:75], v22 offset:59392
  s_waitcnt lgkmcnt(6)
  v_mfma_f32_16x16x32_bf16 v[104:107], a[208:211], v[80:83], v[104:107]
  v_mfma_f32_16x16x32_bf16 v[108:111], a[212:215], v[80:83], v[108:111]
  ds_read_b128 v[76:79], v23 offset:59392
  s_waitcnt lgkmcnt(6)
  v_mfma_f32_16x16x32_bf16 v[112:115], a[208:211], v[84:87], v[112:115]
  v_mfma_f32_16x16x32_bf16 v[116:119], a[212:215], v[84:87], v[116:119]
  ds_read_b128 v[80:83], v22 offset:61440
  s_waitcnt lgkmcnt(6)
  v_mfma_f32_16x16x32_bf16 v[104:107], a[216:219], v[88:91], v[104:107]
  v_mfma_f32_16x16x32_bf16 v[108:111], a[220:223], v[88:91], v[108:111]
  s_add_u32 m0, s70, 53248
  s_add_u32 s62, s74, 53248
  buffer_load_dwordx4 v7, s[8:11], s62 offen sc1 lds
  ds_read_b128 v[84:87], v23 offset:61440
  s_waitcnt lgkmcnt(6)
  v_mfma_f32_16x16x32_bf16 v[112:115], a[216:219], v[92:95], v[112:115]
  v_mfma_f32_16x16x32_bf16 v[116:119], a[220:223], v[92:95], v[116:119]
  ds_read_b128 v[88:91], v22 offset:63488
  s_waitcnt lgkmcnt(6)
  v_mfma_f32_16x16x32_bf16 v[104:107], a[224:227], v[64:67], v[104:107]
  v_mfma_f32_16x16x32_bf16 v[108:111], a[228:231], v[64:67], v[108:111]
  ds_read_b128 v[92:95], v23 offset:63488
  s_waitcnt lgkmcnt(6)
  v_mfma_f32_16x16x32_bf16 v[112:115], a[224:227], v[68:71], v[112:115]
  v_mfma_f32_16x16x32_bf16 v[116:119], a[228:231], v[68:71], v[116:119]
  s_cbranch_vccnz gt_210
  s_waitcnt vmcnt(14)
  s_barrier
  ds_read_b128 v[64:67], v20 offset:0
  s_waitcnt lgkmcnt(6)
  v_mfma_f32_16x16x32_bf16 v[104:107], a[232:235], v[72:75], v[104:107]
  v_mfma_f32_16x16x32_bf16 v[108:111], a[236:239], v[72:75], v[108:111]
  s_add_u32 m0, s70, 57344
  s_add_u32 s62, s74, 57344
  buffer_load_dwordx4 v7, s[8:11], s62 offen sc1 lds
  ds_read_b128 v[68:71], v21 offset:0
  s_waitcnt lgkmcnt(6)
  v_mfma_f32_16x16x32_bf16 v[112:115], a[232:235], v[76:79], v[112:115]
  v_mfma_f32_16x16x32_bf16 v[116:119], a[236:239], v[76:79], v[116:119]
  ds_read_b128 v[72:75], v20 offset:2048
  s_waitcnt lgkmcnt(6)
  v_mfma_f32_16x16x32_bf16 v[104:107], a[240:243], v[80:83], v[104:107]
  v_mfma_f32_16x16x32_bf16 v[108:111], a[244:247], v[80:83], v[108:111]
  ds_read_b128 v[76:79], v21 offset:2048
  s_waitcnt lgkmcnt(6)
  v_mfma_f32_16x16x32_bf16 v[112:115], a[240:243], v[84:87], v[112:115]
  v_mfma_f32_16x16x32_bf16 v[116:119], a[244:247], v[84:87], v[116:119]
  ds_read_b128 v[80:83], v20 offset:4096
  s_waitcnt lgkmcnt(6)
  v_mfma_f32_16x16x32_bf16 v[104:107], a[248:251], v[88:91], v[104:107]
  v_mfma_f32_16x16x32_bf16 v[108:111], a[252:255], v[88:91], v[108:111]
  s_add_u32 m0, s70, 61440
  s_add_u32 s62, s74, 61440
  buffer_load_dwordx4 v7, s[8:11], s62 offen sc1 lds
  ds_read_b128 v[84:87], v21 offset:4096
  s_waitcnt lgkmcnt(6)
  v_mfma_f32_16x16x32_bf16 v[112:115], a[248:251], v[92:95], v[112:115]
  v_mfma_f32_16x16x32_bf16 v[116:119], a[252:255], v[92:95], v[116:119]
  s_mov_b32 s73, 0
  s_mov_b32 s71, 0
  s_waitcnt vmcnt(10)
  s_branch gl_205
gt_209:
  s_mul_i32 s60, s80, 128
  s_add_u32 s60, s60, s67
  buffer_load_dwordx4 v[16:19], v3, s[8:11], s60 offen sc1
  s_waitcnt lgkmcnt(5)
  v_mfma_f32_16x16x32_bf16 v[32:35], a[232:235], v[72:75], v[32:35]
  v_mfma_f32_16x16x32_bf16 v[36:39], a[236:239], v[72:75], v[36:39]
  s_waitcnt lgkmcnt(4)
  v_mfma_f32_16x16x32_bf16 v[40:43], a[232:235], v[76:79], v[40:43]
  v_mfma_f32_16x16x32_bf16 v[44:47], a[236:239], v[76:79], v[44:47]
  s_waitcnt lgkmcnt(3)
  v_mfma_f32_16x16x32_bf16 v[32:35], a[240:243], v[80:83], v[32:35]
  v_mfma_f32_16x16x32_bf16 v[36:39], a[244:247], v[80:83], v[36:39]
  s_waitcnt lgkmcnt(2)
  v_mfma_f32_16x16x32_bf16 v[40:43], a[240:243], v[84:87], v[40:43]
  v_mfma_f32_16x16x32_bf16 v[44:47], a[244:247], v[84:87], v[44:47]
  s_waitcnt lgkmcnt(1)
  v_mfma_f32_16x16x32_bf16 v[32:35], a[248:251], v[88:91], v[32:35]
  v_mfma_f32_16x16x32_bf16 v[36:39], a[252:255], v[88:91], v[36:39]
  s_waitcnt lgkmcnt(0)
  v_mfma_f32_16x16x32_bf16 v[40:43], a[248:251], v[92:95], v[40:43]
  v_mfma_f32_16x16x32_bf16 v[44:47], a[252:255], v[92:95], v[44:47]
  s_nop 3
  v_max_f32 v32, 0, v32
  v_max_f32 v33, 0, v33
  v_max_f32 v34, 0, v34
  v_max_f32 v35, 0, v35
  v_max_f32 v36, 0, v36
  v_max_f32 v37, 0, v37
  v_max_f32 v38, 0, v38
  v_max_f32 v39, 0, v39
  v_max_f32 v40, 0, v40
  v_max_f32 v41, 0, v41
  v_max_f32 v42, 0, v42
  v_max_f32 v43, 0, v43
  v_max_f32 v44, 0, v44
  v_max_f32 v45, 0, v45
  v_max_f32 v46, 0, v46
  v_max_f32 v47, 0, v47
  v_cvt_pk_bf16_f32 v96, v32, v33
  v_cvt_pk_bf16_f32 v97, v34, v35
  v_cvt_pk_bf16_f32 v98, v36, v37
  v_cvt_pk_bf16_f32 v99, v38, v39
  v_cvt_pk_bf16_f32 v100, v40, v41
  v_cvt_pk_bf16_f32 v101, v42, v43
  v_cvt_pk_bf16_f32 v102, v44, v45
  v_cvt_pk_bf16_f32 v103, v46, v47
  s_lshl_b32 s61, s64, 18
  s_add_u32 s61, s61, s68
  s_cmp_eq_u32 s72, 0
  s_cbranch_scc0 bm_225
  buffer_store_dwordx4 v[96:99], v4, s[8:11], s61 offen offset:0
  s_branch bn_226
bm_225:
  buffer_store_dwordx4 v[96:99], v4, s[8:11], s61 offen offset:0 sc1
bn_226:
  s_cmp_eq_u32 s72, 0
  s_cbranch_scc0 bm_227
  buffer_store_dwordx4 v[100:103], v4, s[8:11], s61 offen offset:256
  s_branch bn_228
bm_227:
  buffer_store_dwordx4 v[100:103], v4, s[8:11], s61 offen offset:256 sc1
bn_228:
  v_mov_b32 v28, v5
  s_cmp_lt_u32 s80, s65
  s_cbranch_scc0 gl_205_y
  s_waitcnt vmcnt(2)
  v_and_b32 v16, v16, v17
  v_and_b32 v18, v18, v19
  v_and_b32 v16, v16, v18
  v_cmp_ne_u32 vcc, 1, v16
  s_nop 0
  s_cmp_eq_u32 vcc_lo, 0
  s_cbranch_scc1 fs_223
  buffer_load_dwordx4 v[16:19], v3, s[8:11], s60 offen sc1
  s_waitcnt vmcnt(1)
  s_mul_i32 s76, s64, 512
  s_add_u32 s76, s76, s69
  s_cmp_eq_u32 s72, 0
  s_cbranch_scc0 bm_229
  buffer_store_dword v6, v5, s[8:11], s76 offen
  s_branch bn_230
bm_229:
  buffer_store_dword v6, v5, s[8:11], s76 offen sc1
bn_230:
  s_waitcnt vmcnt(1)
  v_and_b32 v16, v16, v17
  v_and_b32 v18, v18, v19
  v_and_b32 v16, v16, v18
  v_cmp_ne_u32 vcc, 1, v16
  s_nop 0
  s_cmp_eq_u32 vcc_lo, 0
  s_cbranch_scc1 fq_224
gf_208:
  s_mul_i32 s60, s80, 128
  s_add_u32 s60, s60, s67
pl_231:
  buffer_load_dwordx4 v[16:19], v3, s[8:11], s60 offen sc1
  s_waitcnt vmcnt(0)
  v_and_b32 v16, v16, v17
  v_and_b32 v18, v18, v19
  v_and_b32 v16, v16, v18
  v_cmp_ne_u32 vcc, 1, v16
  s_nop 0
  s_cmp_eq_u32 vcc_lo, 0
  s_cbranch_scc1 pk_232
  s_sub_u32 s57, s57, 1
  s_cbranch_scc0 pl_231
  s_branch ABORT
pk_232:
fq_224:
  v_mov_b32 v28, v29
fs_223:
  s_lshl_b32 s74, s80, 16
  s_add_u32 s74, s74, s66
  s_add_u32 s60, s60, 128
  buffer_load_dwordx4 v[16:19], v3, s[8:11], s60 offen sc1
  s_add_u32 m0, s70, 65536
  s_add_u32 s62, s74, 0
  buffer_load_dwordx4 v2, s[8:11], s62 offen sc1 lds
  s_add_u32 m0, s70, 69632
  s_add_u32 s62, s74, 4096
  buffer_load_dwordx4 v2, s[8:11], s62 offen sc1 lds
  s_add_u32 m0, s70, 73728
  s_add_u32 s62, s74, 8192
  buffer_load_dwordx4 v2, s[8:11], s62 offen sc1 lds
  s_add_u32 m0, s70, 77824
  s_add_u32 s62, s74, 12288
  buffer_load_dwordx4 v2, s[8:11], s62 offen sc1 lds
  s_add_u32 m0, s70, 81920
  s_add_u32 s62, s74, 16384
  buffer_load_dwordx4 v2, s[8:11], s62 offen sc1 lds
  s_add_u32 m0, s70, 86016
  s_add_u32 s62, s74, 20480
  buffer_load_dwordx4 v2, s[8:11], s62 offen sc1 lds
  s_add_u32 m0, s70, 90112
  s_add_u32 s62, s74, 24576
  buffer_load_dwordx4 v2, s[8:11], s62 offen sc1 lds
  s_add_u32 m0, s70, 94208
  s_add_u32 s62, s74, 28672
  buffer_load_dwordx4 v2, s[8:11], s62 offen sc1 lds
  buffer_load_dword v26, v29, s[8:11], 0 offen
  s_add_u32 m0, s70, 98304
  s_add_u32 s62, s74, 32768
  buffer_load_dwordx4 v2, s[8:11], s62 offen sc1 lds
  buffer_load_dword v26, v29, s[8:11], 0 offen
  s_add_u32 m0, s70, 102400
  s_add_u32 s62, s74, 36864
  buffer_load_dwordx4 v2, s[8:11], s62 offen sc1 lds
  s_add_u32 m0, s70, 106496
  s_add_u32 s62, s74, 40960
  buffer_load_dwordx4 v2, s[8:11], s62 offen sc1 lds
  s_add_u32 m0, s70, 110592
  s_add_u32 s62, s74, 45056
  buffer_load_dwordx4 v2, s[8:11], s62 offen sc1 lds
  s_add_u32 m0, s70, 114688
  s_add_u32 s62, s74, 49152
  buffer_load_dwordx4 v2, s[8:11], s62 offen sc1 lds
  s_add_u32 m0, s70, 118784
  s_add_u32 s62, s74, 53248
  buffer_load_dwordx4 v2, s[8:11], s62 offen sc1 lds
  s_add_u32 m0, s70, 122880
  s_add_u32 s62, s74, 57344
  buffer_load_dwordx4 v2, s[8:11], s62 offen sc1 lds
  s_add_u32 m0, s70, 126976
  s_add_u32 s62, s74, 61440
  buffer_load_dwordx4 v2, s[8:11], s62 offen sc1 lds
  s_mov_b32 s73, 0x7ff00000
  s_mov_b32 s71, 0x7ff00000
  s_waitcnt vmcnt(14)
  s_mul_i32 s76, s64, 512
  s_add_u32 s76, s76, s69
  s_cmp_eq_u32 s72, 0
  s_cbranch_scc0 bm_233
  buffer_store_dword v6, v28, s[8:11], s76 offen
  s_branch bn_234
bm_233:
  buffer_store_dword v6, v28, s[8:11], s76 offen sc1
bn_234:
  s_barrier
  ds_read_b128 v[64:67], v22 offset:0
  ds_read_b128 v[68:71], v23 offset:0
  ds_read_b128 v[72:75], v22 offset:2048
  ds_read_b128 v[76:79], v23 offset:2048
  ds_read_b128 v[80:83], v22 offset:4096
  ds_read_b128 v[84:87], v23 offset:4096
  s_branch gl_206
gt_210:
  s_mul_i32 s60, s80, 128
  s_add_u32 s60, s60, s67
  buffer_load_dwordx4 v[16:19], v3, s[8:11], s60 offen sc1
  s_waitcnt lgkmcnt(5)
  v_mfma_f32_16x16x32_bf16 v[104:107], a[232:235], v[72:75], v[104:107]
  v_mfma_f32_16x16x32_bf16 v[108:111], a[236:239], v[72:75], v[108:111]
  s_waitcnt lgkmcnt(4)
  v_mfma_f32_16x16x32_bf16 v[112:115], a[232:235], v[76:79], v[112:115]
  v_mfma_f32_16x16x32_bf16 v[116:119], a[236:239], v[76:79], v[116:119]
  s_waitcnt lgkmcnt(3)
  v_mfma_f32_16x16x32_bf16 v[104:107], a[240:243], v[80:83], v[104:107]
  v_mfma_f32_16x16x32_bf16 v[108:111], a[244:247], v[80:83], v[108:111]
  s_waitcnt lgkmcnt(2)
  v_mfma_f32_16x16x32_bf16 v[112:115], a[240:243], v[84:87], v[112:115]
  v_mfma_f32_16x16x32_bf16 v[116:119], a[244:247], v[84:87], v[116:119]
  s_waitcnt lgkmcnt(1)
  v_mfma_f32_16x16x32_bf16 v[104:107], a[248:251], v[88:91], v[104:107]
  v_mfma_f32_16x16x32_bf16 v[108:111], a[252:255], v[88:91], v[108:111]
  s_waitcnt lgkmcnt(0)
  v_mfma_f32_16x16x32_bf16 v[112:115], a[248:251], v[92:95], v[112:115]
  v_mfma_f32_16x16x32_bf16 v[116:119], a[252:255], v[92:95], v[116:119]
  s_nop 3
  v_max_f32 v104, 0, v104
  v_max_f32 v105, 0, v105
  v_max_f32 v106, 0, v106
  v_max_f32 v107, 0, v107
  v_max_f32 v108, 0, v108
  v_max_f32 v109, 0, v109
  v_max_f32 v110, 0, v110
  v_max_f32 v111, 0, v111
  v_max_f32 v112, 0, v112
  v_max_f32 v113, 0, v113
  v_max_f32 v114, 0, v114
  v_max_f32 v115, 0, v115
  v_max_f32 v116, 0, v116
  v_max_f32 v117, 0, v117
  v_max_f32 v118, 0, v118
  v_max_f32 v119, 0, v119
  v_cvt_pk_bf16_f32 v96, v104, v105
  v_cvt_pk_bf16_f32 v97, v106, v107
  v_cvt_pk_bf16_f32 v98, v108, v109
  v_cvt_pk_bf16_f32 v99, v110, v111
  v_cvt_pk_bf16_f32 v100, v112, v113
  v_cvt_pk_bf16_f32 v101, v114, v115
  v_cvt_pk_bf16_f32 v102, v116, v117
  v_cvt_pk_bf16_f32 v103, v118, v119
  s_lshl_b32 s61, s64, 18
  s_add_u32 s61, s61, s68
  s_cmp_eq_u32 s72, 0
  s_cbranch_scc0 bm_237
  buffer_store_dwordx4 v[96:99], v4, s[8:11], s61 offen offset:0
  s_branch bn_238
bm_237:
  buffer_store_dwordx4 v[96:99], v4, s[8:11], s61 offen offset:0 sc1
bn_238:
  s_cmp_eq_u32 s72, 0
  s_cbranch_scc0 bm_239
  buffer_store_dwordx4 v[100:103], v4, s[8:11], s61 offen offset:256
  s_branch bn_240
bm_239:
  buffer_store_dwordx4 v[100:103], v4, s[8:11], s61 offen offset:256 sc1
bn_240:
  v_mov_b32 v28, v5
  s_cmp_lt_u32 s80, s65
  s_cbranch_scc0 gl_205_y
  s_waitcnt vmcnt(2)
  v_and_b32 v16, v16, v17
  v_and_b32 v18, v18, v19
  v_and_b32 v16, v16, v18
  v_cmp_ne_u32 vcc, 1, v16
  s_nop 0
  s_cmp_eq_u32 vcc_lo, 0
  s_cbranch_scc1 fs_235
  buffer_load_dwordx4 v[16:19], v3, s[8:11], s60 offen sc1
  s_waitcnt vmcnt(1)
  s_mul_i32 s76, s64, 512
  s_add_u32 s76, s76, s69
  s_cmp_eq_u32 s72, 0
  s_cbranch_scc0 bm_241
  buffer_store_dword v6, v5, s[8:11], s76 offen
  s_branch bn_242
bm_241:
  buffer_store_dword v6, v5, s[8:11], s76 offen sc1
bn_242:
  s_waitcnt vmcnt(1)
  v_and_b32 v16, v16, v17
  v_and_b32 v18, v18, v19
  v_and_b32 v16, v16, v18
  v_cmp_ne_u32 vcc, 1, v16
  s_nop 0
  s_cmp_eq_u32 vcc_lo, 0
  s_cbranch_scc1 fq_236
gf_207:
  s_mul_i32 s60, s80, 128
  s_add_u32 s60, s60, s67
pl_243:
  buffer_load_dwordx4 v[16:19], v3, s[8:11], s60 offen sc1
  s_waitcnt vmcnt(0)
  v_and_b32 v16, v16, v17
  v_and_b32 v18, v18, v19
  v_and_b32 v16, v16, v18
  v_cmp_ne_u32 vcc, 1, v16
  s_nop 0
  s_cmp_eq_u32 vcc_lo, 0
  s_cbranch_scc1 pk_244
  s_sub_u32 s57, s57, 1
  s_cbranch_scc0 pl_243
  s_branch ABORT
pk_244:
fq_236:
  v_mov_b32 v28, v29
fs_235:
  s_lshl_b32 s74, s80, 16
  s_add_u32 s74, s74, s66
  s_add_u32 s60, s60, 128
  buffer_load_dwordx4 v[16:19], v3, s[8:11], s60 offen sc1
  s_add_u32 m0, s70, 0
  s_add_u32 s62, s74, 0
  buffer_load_dwordx4 v2, s[8:11], s62 offen sc1 lds
  s_add_u32 m0, s70, 4096
  s_add_u32 s62, s74, 4096
  buffer_load_dwordx4 v2, s[8:11], s62 offen sc1 lds
  s_add_u32 m0, s70, 8192
  s_add_u32 s62, s74, 8192
  buffer_load_dwordx4 v2, s[8:11], s62 offen sc1 lds
  s_add_u32 m0, s70, 12288
  s_add_u32 s62, s74, 12288
  buffer_load_dwordx4 v2, s[8:11], s62 offen sc1 lds
  s_add_u32 m0, s70, 16384
  s_add_u32 s62, s74, 16384
  buffer_load_dwordx4 v2, s[8:11], s62 offen sc1 lds
  s_add_u32 m0, s70, 20480
  s_add_u32 s62, s74, 20480
  buffer_load_dwordx4 v2, s[8:11], s62 offen sc1 lds
  s_add_u32 m0, s70, 24576
  s_add_u32 s62, s74, 24576
  buffer_load_dwordx4 v2, s[8:11], s62 offen sc1 lds
  s_add_u32 m0, s70, 28672
  s_add_u32 s62, s74, 28672
  buffer_load_dwordx4 v2, s[8:11], s62 offen sc1 lds
  buffer_load_dword v26, v29, s[8:11], 0 offen
  s_add_u32 m0, s70, 32768
  s_add_u32 s62, s74, 32768
  buffer_load_dwordx4 v2, s[8:11], s62 offen sc1 lds
  buffer_load_dword v26, v29, s[8:11], 0 offen
  s_add_u32 m0, s70, 36864
  s_add_u32 s62, s74, 36864
  buffer_load_dwordx4 v2, s[8:11], s62 offen sc1 lds
  s_add_u32 m0, s70, 40960
  s_add_u32 s62, s74, 40960
  buffer_load_dwordx4 v2, s[8:11], s62 offen sc1 lds
  s_add_u32 m0, s70, 45056
  s_add_u32 s62, s74, 45056
  buffer_load_dwordx4 v2, s[8:11], s62 offen sc1 lds
  s_add_u32 m0, s70, 49152
  s_add_u32 s62, s74, 49152
  buffer_load_dwordx4 v2, s[8:11], s62 offen sc1 lds
  s_add_u32 m0, s70, 53248
  s_add_u32 s62, s74, 53248
  buffer_load_dwordx4 v2, s[8:11], s62 offen sc1 lds
  s_add_u32 m0, s70, 57344
  s_add_u32 s62, s74, 57344
  buffer_load_dwordx4 v2, s[8:11], s62 offen sc1 lds
  s_add_u32 m0, s70, 61440
  s_add_u32 s62, s74, 61440
  buffer_load_dwordx4 v2, s[8:11], s62 offen sc1 lds
  s_mov_b32 s73, 0x7ff00000
  s_mov_b32 s71, 0x7ff00000
  s_waitcnt vmcnt(14)
  s_mul_i32 s76, s64, 512
  s_add_u32 s76, s76, s69
  s_cmp_eq_u32 s72, 0
  s_cbranch_scc0 bm_245
  buffer_store_dword v6, v28, s[8:11], s76 offen
  s_branch bn_246
bm_245:
  buffer_store_dword v6, v28, s[8:11], s76 offen sc1
bn_246:
  s_barrier
  ds_read_b128 v[64:67], v20 offset:0
  ds_read_b128 v[68:71], v21 offset:0
  ds_read_b128 v[72:75], v20 offset:2048
  ds_read_b128 v[76:79], v21 offset:2048
  ds_read_b128 v[80:83], v20 offset:4096
  ds_read_b128 v[84:87], v21 offset:4096
  s_branch gl_205
gl_205_y:
  s_waitcnt vmcnt(0)
  s_mul_i32 s76, s64, 512
  s_add_u32 s76, s76, s69
  s_cmp_eq_u32 s72, 0
  s_cbranch_scc0 bm_247
  buffer_store_dword v6, v5, s[8:11], s76 offen
  s_branch bn_248
bm_247:
  buffer_store_dword v6, v5, s[8:11], s76 offen sc1
bn_248:
gl_205_x:
  s_barrier
  s_branch DONE
JRED1:
  s_cmp_eq_u32 s18, 64
  s_cbranch_scc1 DONE
  s_barrier
  s_sub_u32 s79, s55, 4
  s_and_b32 s60, s56, 7
JRED1B:
  s_lshl_b32 s66, s79, 1
  s_and_b32 s61, s60, 1
  s_add_u32 s66, s66, s61
  s_mov_b32 s86, s66
  s_bfe_u32 s84, s60, 0x10001
  s_add_u32 s85, s84, 2
  s_mov_b32 s87, 5
  s_mov_b32 s88, 26
  s_branch JRED1C
JRED5:
  s_lshl_b32 s66, s79, 1
  s_add_u32 s86, s66, 1
  s_mov_b32 s84, 4
  s_mov_b32 s85, 4
  s_mov_b32 s87, 5
  s_mov_b32 s88, 24
JRED1C:
  v_lshrrev_b32 v12, 2, v0
  v_and_b32 v13, 3, v0
  s_lshl_b32 s59, s54, 10
  v_lshl_add_u32 v1, v12, 4, s59
  s_lshl_b32 s59, s54, 14
  v_lshl_add_u32 v2, v12, 10, s59
  v_lshl_add_u32 v2, v13, 4, v2
  s_lshl_b32 s59, s54, 9
  v_lshl_add_u32 v3, v12, 3, s59
  v_lshl_add_u32 v3, v13, 11, v3
  v_lshlrev_b32 v5, 5, v13
  v_add_u32 v5, 132096, v5
  s_lshl_b32 s59, s54, 3
  v_add_u32 v4, s59, v5
  s_lshl_b32 s59, s54, 12
  v_lshl_add_u32 v6, v0, 4, s59
  s_lshl_b32 s59, s54, 11
  v_lshl_add_u32 v10, v0, 4, s59
  v_and_b32 v7, 31, v0
  v_lshlrev_b32 v7, 4, v7
  v_lshrrev_b32 v12, 5, v0
  v_lshlrev_b32 v12, 9, v12
  s_sub_u32 s59, s85, s84
  s_sub_u32 s60, s87, s59
  v_mad_u32_u24 v11, v12, s60, v7
  v_mad_u32_u24 v7, v12, s59, v7
  s_lshl_b32 s59, s54, 2
  v_mov_b32 v9, s59
  v_mov_b32 v8, 0x7ff00000
  v_cmp_eq_u32 vcc, 0, v0
  s_nop 1
  v_cndmask_b32 v8, v8, v9, vcc
  v_mov_b32 v9, 1
  s_mov_b32 s59, 2367488
  buffer_load_dwordx4 v[20:23], v1, s[8:11], s59 offen offset:0 sc1
  buffer_load_dwordx4 v[24:27], v1, s[8:11], s59 offen offset:256 sc1
  buffer_load_dwordx4 v[28:31], v1, s[8:11], s59 offen offset:512 sc1
  buffer_load_dwordx4 v[32:35], v1, s[8:11], s59 offen offset:768 sc1
  s_mov_b32 s59, 2375680
  buffer_load_dwordx4 v[36:39], v1, s[8:11], s59 offen offset:0 sc1
  buffer_load_dwordx4 v[40:43], v1, s[8:11], s59 offen offset:256 sc1
  buffer_load_dwordx4 v[44:47], v1, s[8:11], s59 offen offset:512 sc1
  buffer_load_dwordx4 v[48:51], v1, s[8:11], s59 offen offset:768 sc1
  s_mov_b32 s59, 2371584
  buffer_load_dwordx4 v[52:55], v1, s[8:11], s59 offen offset:0 sc1
  buffer_load_dwordx4 v[56:59], v1, s[8:11], s59 offen offset:256 sc1
  buffer_load_dwordx4 v[60:63], v1, s[8:11], s59 offen offset:512 sc1
  buffer_load_dwordx4 v[64:67], v1, s[8:11], s59 offen offset:768 sc1
  s_mov_b32 s16, s24
  s_mov_b32 s17, s25
  s_mov_b32 s18, 0x400000
  s_mov_b32 s19, 0x00020000
  s_waitcnt vmcnt(0)
  v_add_f32 v36, 1.0, v36
  v_add_f32 v37, 1.0, v37
  v_add_f32 v38, 1.0, v38
  v_add_f32 v39, 1.0, v39
  v_add_f32 v40, 1.0, v40
  v_add_f32 v41, 1.0, v41
  v_add_f32 v42, 1.0, v42
  v_add_f32 v43, 1.0, v43
  v_add_f32 v44, 1.0, v44
  v_add_f32 v45, 1.0, v45
  v_add_f32 v46, 1.0, v46
  v_add_f32 v47, 1.0, v47
  v_add_f32 v48, 1.0, v48
  v_add_f32 v49, 1.0, v49
  v_add_f32 v50, 1.0, v50
  v_add_f32 v51, 1.0, v51
  v_cvt_pk_bf16_f32 v12, v36, v37
  v_lshlrev_b32 v36, 16, v12
  v_and_b32 v37, 0xffff0000, v12
  v_cvt_pk_bf16_f32 v13, v38, v39
  v_lshlrev_b32 v38, 16, v13
  v_and_b32 v39, 0xffff0000, v13
  v_cvt_pk_bf16_f32 v14, v40, v41
  v_lshlrev_b32 v40, 16, v14
  v_and_b32 v41, 0xffff0000, v14
  v_cvt_pk_bf16_f32 v15, v42, v43
  v_lshlrev_b32 v42, 16, v15
  v_and_b32 v43, 0xffff0000, v15
  v_cvt_pk_bf16_f32 v12, v44, v45
  v_lshlrev_b32 v44, 16, v12
  v_and_b32 v45, 0xffff0000, v12
  v_cvt_pk_bf16_f32 v13, v46, v47
  v_lshlrev_b32 v46, 16, v13
  v_and_b32 v47, 0xffff0000, v13
  v_cvt_pk_bf16_f32 v14, v48, v49
  v_lshlrev_b32 v48, 16, v14
  v_and_b32 v49, 0xffff0000, v14
  v_cvt_pk_bf16_f32 v15, v50, v51
  v_lshlrev_b32 v50, 16, v15
  v_and_b32 v51, 0xffff0000, v15
  s_lshl_b32 s66, s66, 13
  s_lshl_b32 s86, s86, 13
  s_mov_b32 s64, 0
  s_mov_b32 s80, 0
rf_251:
  s_lshr_b32 s60, s80, 1
  s_mul_i32 s60, s60, s87
  s_add_u32 s60, s60, s84
  s_lshl_b32 s60, s60, 9
  s_add_u32 s60, s60, 2228224
  buffer_load_dwordx4 v[16:19], v7, s[8:11], s60 offen sc1
  s_waitcnt vmcnt(0)
  v_and_b32 v16, v16, v17
  v_and_b32 v18, v18, v19
  v_and_b32 v16, v16, v18
  v_cmp_ne_u32 vcc, 1, v16
  s_nop 0
  s_cmp_eq_u32 vcc_lo, 0
  s_cbranch_scc1 rk_253
  s_sub_u32 s57, s57, 1
  s_cbranch_scc0 rf_251
  s_branch ABORT
rk_253:
  s_add_u32 s60, s80, 1
  s_lshr_b32 s60, s60, 1
  s_mul_i32 s60, s60, s87
  s_add_u32 s60, s60, s85
  s_lshl_b32 s60, s60, 9
  s_add_u32 s60, s60, 2228224
  buffer_load_dwordx4 v[16:19], v11, s[8:11], s60 offen sc1
  s_lshr_b32 s61, s80, 1
  s_mul_i32 s61, s61, s87
  s_add_u32 s61, s61, s84
  s_lshl_b32 s61, s61, 16
  s_add_u32 s61, s61, s66
  s_lshl_b32 s67, s61, 3
  s_add_u32 s67, s67, 83886080
  buffer_load_dwordx4 v[68:71], v6, s[8:11], s67 offen offset:0 sc1
  buffer_load_dwordx4 v[72:75], v6, s[8:11], s67 offen offset:1024 sc1
  buffer_load_dwordx4 v[76:79], v6, s[8:11], s67 offen offset:2048 sc1
  buffer_load_dwordx4 v[80:83], v6, s[8:11], s67 offen offset:3072 sc1
  s_add_u32 s67, s67, 16384
  buffer_load_dwordx4 v[84:87], v6, s[8:11], s67 offen offset:0 sc1
  buffer_load_dwordx4 v[88:91], v6, s[8:11], s67 offen offset:1024 sc1
  buffer_load_dwordx4 v[92:95], v6, s[8:11], s67 offen offset:2048 sc1
  buffer_load_dwordx4 v[96:99], v6, s[8:11], s67 offen offset:3072 sc1
  s_add_u32 s67, s67, 16384
  buffer_load_dwordx4 v[100:103], v6, s[8:11], s67 offen offset:0 sc1
  buffer_load_dwordx4 v[104:107], v6, s[8:11], s67 offen offset:1024 sc1
  buffer_load_dwordx4 v[108:111], v6, s[8:11], s67 offen offset:2048 sc1
  buffer_load_dwordx4 v[112:115], v6, s[8:11], s67 offen offset:3072 sc1
  s_add_u32 s67, s67, 16384
  buffer_load_dwordx4 v[116:119], v6, s[8:11], s67 offen offset:0 sc1
  buffer_load_dwordx4 v[120:123], v6, s[8:11], s67 offen offset:1024 sc1
  buffer_load_dwordx4 v[124:127], v6, s[8:11], s67 offen offset:2048 sc1
  buffer_load_dwordx4 v[128:131], v6, s[8:11], s67 offen offset:3072 sc1
  buffer_load_dwordx2 v[196:197], v3, s[16:19], s61 offen offset:0
  buffer_load_dwordx2 v[198:199], v3, s[16:19], s61 offen offset:128
  buffer_load_dwordx2 v[200:201], v3, s[16:19], s61 offen offset:256
  buffer_load_dwordx2 v[202:203], v3, s[16:19], s61 offen offset:384
  s_add_u32 s80, s80, 1
  s_mov_b32 s73, 0
  s_waitcnt vmcnt(0)
rt_249:
  v_and_b32 v16, v16, v17
  v_and_b32 v18, v18, v19
  v_and_b32 v16, v16, v18
  v_cmp_ne_u32 vcc, 1, v16
  s_mov_b32 s74, s80
  s_mov_b64 s[82:83], vcc
  v_pk_add_f32 v[68:69], v[68:69], v[84:85]
  v_pk_add_f32 v[70:71], v[70:71], v[86:87]
  v_pk_add_f32 v[72:73], v[72:73], v[88:89]
  v_pk_add_f32 v[74:75], v[74:75], v[90:91]
  v_pk_add_f32 v[76:77], v[76:77], v[92:93]
  v_pk_add_f32 v[78:79], v[78:79], v[94:95]
  v_pk_add_f32 v[80:81], v[80:81], v[96:97]
  v_pk_add_f32 v[82:83], v[82:83], v[98:99]
  v_pk_add_f32 v[100:101], v[100:101], v[116:117]
  v_pk_add_f32 v[102:103], v[102:103], v[118:119]
  v_pk_add_f32 v[104:105], v[104:105], v[120:121]
  v_pk_add_f32 v[106:107], v[106:107], v[122:123]
  v_pk_add_f32 v[108:109], v[108:109], v[124:125]
  v_pk_add_f32 v[110:111], v[110:111], v[126:127]
  v_pk_add_f32 v[112:113], v[112:113], v[128:129]
  v_pk_add_f32 v[114:115], v[114:115], v[130:131]
  v_pk_add_f32 v[228:229], v[68:69], v[100:101]
  v_pk_add_f32 v[230:231], v[70:71], v[102:103]
  v_pk_add_f32 v[232:233], v[72:73], v[104:105]
  v_pk_add_f32 v[234:235], v[74:75], v[106:107]
  v_pk_add_f32 v[236:237], v[76:77], v[108:109]
  v_pk_add_f32 v[238:239], v[78:79], v[110:111]
  v_pk_add_f32 v[240:241], v[80:81], v[112:113]
  v_pk_add_f32 v[242:243], v[82:83], v[114:115]
  v_lshlrev_b32 v212, 16, v196
  v_and_b32 v213, 0xffff0000, v196
  v_lshlrev_b32 v214, 16, v197
  v_and_b32 v215, 0xffff0000, v197
  v_lshlrev_b32 v216, 16, v198
  v_and_b32 v217, 0xffff0000, v198
  v_lshlrev_b32 v218, 16, v199
  v_and_b32 v219, 0xffff0000, v199
  v_lshlrev_b32 v220, 16, v200
  v_and_b32 v221, 0xffff0000, v200
  v_lshlrev_b32 v222, 16, v201
  v_and_b32 v223, 0xffff0000, v201
  v_lshlrev_b32 v224, 16, v202
  v_and_b32 v225, 0xffff0000, v202
  v_lshlrev_b32 v226, 16, v203
  v_and_b32 v227, 0xffff0000, v203
  s_add_u32 s60, s64, 2
  s_lshr_b32 s60, s60, 1
  s_mul_i32 s60, s60, s87
  s_add_u32 s60, s60, s84
  s_lshl_b32 s60, s60, 9
  s_add_u32 s60, s60, 2228224
  buffer_load_dwordx4 v[16:19], v7, s[8:11], s60 offen sc1
  s_lshr_b32 s68, s64, 1
  s_mul_i32 s68, s68, s87
  s_add_u32 s68, s68, s84
  s_lshl_b32 s68, s68, 16
  s_add_u32 s68, s68, s66
  s_sub_u32 s59, s80, s64
  s_cmp_eq_u32 s59, 1
  s_cbranch_scc0 ra_254
  s_cmp_lt_u32 s80, s88
  s_cselect_b32 s82, s82, 1
  s_cmp_eq_u32 s82, 0
  s_cbranch_scc0 rb_255
  s_lshr_b32 s61, s80, 1
  s_mul_i32 s61, s61, s87
  s_add_u32 s61, s61, s85
  s_lshl_b32 s61, s61, 16
  s_add_u32 s61, s61, s86
  s_lshl_b32 s67, s61, 3
  s_add_u32 s67, s67, 83886080
  buffer_load_dwordx4 v[132:135], v6, s[8:11], s67 offen offset:0 sc1
  buffer_load_dwordx4 v[136:139], v6, s[8:11], s67 offen offset:1024 sc1
  buffer_load_dwordx4 v[140:143], v6, s[8:11], s67 offen offset:2048 sc1
  buffer_load_dwordx4 v[144:147], v6, s[8:11], s67 offen offset:3072 sc1
  s_add_u32 s67, s67, 16384
  buffer_load_dwordx4 v[148:151], v6, s[8:11], s67 offen offset:0 sc1
  buffer_load_dwordx4 v[152:155], v6, s[8:11], s67 offen offset:1024 sc1
  buffer_load_dwordx4 v[156:159], v6, s[8:11], s67 offen offset:2048 sc1
  buffer_load_dwordx4 v[160:163], v6, s[8:11], s67 offen offset:3072 sc1
  s_add_u32 s67, s67, 16384
  buffer_load_dwordx4 v[164:167], v6, s[8:11], s67 offen offset:0 sc1
  buffer_load_dwordx4 v[168:171], v6, s[8:11], s67 offen offset:1024 sc1
  buffer_load_dwordx4 v[172:175], v6, s[8:11], s67 offen offset:2048 sc1
  buffer_load_dwordx4 v[176:179], v6, s[8:11], s67 offen offset:3072 sc1
  s_add_u32 s67, s67, 16384
  buffer_load_dwordx4 v[180:183], v6, s[8:11], s67 offen offset:0 sc1
  buffer_load_dwordx4 v[184:187], v6, s[8:11], s67 offen offset:1024 sc1
  buffer_load_dwordx4 v[188:191], v6, s[8:11], s67 offen offset:2048 sc1
  buffer_load_dwordx4 v[192:195], v6, s[8:11], s67 offen offset:3072 sc1
  buffer_load_dwordx2 v[204:205], v3, s[16:19], s61 offen offset:0
  buffer_load_dwordx2 v[206:207], v3, s[16:19], s61 offen offset:128
  buffer_load_dwordx2 v[208:209], v3, s[16:19], s61 offen offset:256
  buffer_load_dwordx2 v[210:211], v3, s[16:19], s61 offen offset:384
  s_add_u32 s80, s80, 1
ra_254:
  s_cmp_lt_u32 s80, s88
  s_cselect_b32 s83, s83, 1
  s_cmp_eq_u32 s83, 0
  s_cbranch_scc0 rb_255
  s_lshr_b32 s61, s80, 1
  s_mul_i32 s61, s61, s87
  s_add_u32 s61, s61, s84
  s_lshl_b32 s61, s61, 16
  s_add_u32 s61, s61, s66
  s_lshl_b32 s67, s61, 3
  s_add_u32 s67, s67, 83886080
  buffer_load_dwordx4 v[68:71], v6, s[8:11], s67 offen offset:0 sc1
  buffer_load_dwordx4 v[72:75], v6, s[8:11], s67 offen offset:1024 sc1
  buffer_load_dwordx4 v[76:79], v6, s[8:11], s67 offen offset:2048 sc1
  buffer_load_dwordx4 v[80:83], v6, s[8:11], s67 offen offset:3072 sc1
  s_add_u32 s67, s67, 16384
  buffer_load_dwordx4 v[84:87], v6, s[8:11], s67 offen offset:0 sc1
  buffer_load_dwordx4 v[88:91], v6, s[8:11], s67 offen offset:1024 sc1
  buffer_load_dwordx4 v[92:95], v6, s[8:11], s67 offen offset:2048 sc1
  buffer_load_dwordx4 v[96:99], v6, s[8:11], s67 offen offset:3072 sc1
  s_add_u32 s67, s67, 16384
  buffer_load_dwordx4 v[100:103], v6, s[8:11], s67 offen offset:0 sc1
  buffer_load_dwordx4 v[104:107], v6, s[8:11], s67 offen offset:1024 sc1
  buffer_load_dwordx4 v[108:111], v6, s[8:11], s67 offen offset:2048 sc1
  buffer_load_dwordx4 v[112:115], v6, s[8:11], s67 offen offset:3072 sc1
  s_add_u32 s67, s67, 16384
  buffer_load_dwordx4 v[116:119], v6, s[8:11], s67 offen offset:0 sc1
  buffer_load_dwordx4 v[120:123], v6, s[8:11], s67 offen offset:1024 sc1
  buffer_load_dwordx4 v[124:127], v6, s[8:11], s67 offen offset:2048 sc1
  buffer_load_dwordx4 v[128:131], v6, s[8:11], s67 offen offset:3072 sc1
  buffer_load_dwordx2 v[196:197], v3, s[16:19], s61 offen offset:0
  buffer_load_dwordx2 v[198:199], v3, s[16:19], s61 offen offset:128
  buffer_load_dwordx2 v[200:201], v3, s[16:19], s61 offen offset:256
  buffer_load_dwordx2 v[202:203], v3, s[16:19], s61 offen offset:384
  s_add_u32 s80, s80, 1
rb_255:
  v_cvt_pk_bf16_f32 v12, v228, v229
  v_lshlrev_b32 v228, 16, v12
  v_and_b32 v229, 0xffff0000, v12
  v_cvt_pk_bf16_f32 v13, v230, v231
  v_lshlrev_b32 v230, 16, v13
  v_and_b32 v231, 0xffff0000, v13
  v_cvt_pk_bf16_f32 v14, v232, v233
  v_lshlrev_b32 v232, 16, v14
  v_and_b32 v233, 0xffff0000, v14
  v_cvt_pk_bf16_f32 v15, v234, v235
  v_lshlrev_b32 v234, 16, v15
  v_and_b32 v235, 0xffff0000, v15
  v_cvt_pk_bf16_f32 v12, v236, v237
  v_lshlrev_b32 v236, 16, v12
  v_and_b32 v237, 0xffff0000, v12
  v_cvt_pk_bf16_f32 v13, v238, v239
  v_lshlrev_b32 v238, 16, v13
  v_and_b32 v239, 0xffff0000, v13
  v_cvt_pk_bf16_f32 v14, v240, v241
  v_lshlrev_b32 v240, 16, v14
  v_and_b32 v241, 0xffff0000, v14
  v_cvt_pk_bf16_f32 v15, v242, v243
  v_lshlrev_b32 v242, 16, v15
  v_and_b32 v243, 0xffff0000, v15
  v_pk_mul_f32 v[228:229], v[228:229], v[20:21]
  v_pk_mul_f32 v[230:231], v[230:231], v[22:23]
  v_pk_mul_f32 v[232:233], v[232:233], v[24:25]
  v_pk_mul_f32 v[234:235], v[234:235], v[26:27]
  v_pk_mul_f32 v[236:237], v[236:237], v[28:29]
  v_pk_mul_f32 v[238:239], v[238:239], v[30:31]
  v_pk_mul_f32 v[240:241], v[240:241], v[32:33]
  v_pk_mul_f32 v[242:243], v[242:243], v[34:35]
  v_cvt_pk_bf16_f32 v12, v228, v229
  v_lshlrev_b32 v228, 16, v12
  v_and_b32 v229, 0xffff0000, v12
  v_cvt_pk_bf16_f32 v13, v230, v231
  v_lshlrev_b32 v230, 16, v13
  v_and_b32 v231, 0xffff0000, v13
  v_cvt_pk_bf16_f32 v14, v232, v233
  v_lshlrev_b32 v232, 16, v14
  v_and_b32 v233, 0xffff0000, v14
  v_cvt_pk_bf16_f32 v15, v234, v235
  v_lshlrev_b32 v234, 16, v15
  v_and_b32 v235, 0xffff0000, v15
  v_cvt_pk_bf16_f32 v12, v236, v237
  v_lshlrev_b32 v236, 16, v12
  v_and_b32 v237, 0xffff0000, v12
  v_cvt_pk_bf16_f32 v13, v238, v239
  v_lshlrev_b32 v238, 16, v13
  v_and_b32 v239, 0xffff0000, v13
  v_cvt_pk_bf16_f32 v14, v240, v241
  v_lshlrev_b32 v240, 16, v14
  v_and_b32 v241, 0xffff0000, v14
  v_cvt_pk_bf16_f32 v15, v242, v243
  v_lshlrev_b32 v242, 16, v15
  v_and_b32 v243, 0xffff0000, v15
  v_pk_add_f32 v[212:213], v[212:213], v[228:229]
  v_pk_add_f32 v[214:215], v[214:215], v[230:231]
  v_pk_add_f32 v[216:217], v[216:217], v[232:233]
  v_pk_add_f32 v[218:219], v[218:219], v[234:235]
  v_pk_add_f32 v[220:221], v[220:221], v[236:237]
  v_pk_add_f32 v[222:223], v[222:223], v[238:239]
  v_pk_add_f32 v[224:225], v[224:225], v[240:241]
  v_pk_add_f32 v[226:227], v[226:227], v[242:243]
  v_cvt_pk_bf16_f32 v248, v212, v213
  v_cvt_pk_bf16_f32 v249, v214, v215
  v_cvt_pk_bf16_f32 v250, v216, v217
  v_cvt_pk_bf16_f32 v251, v218, v219
  v_cvt_pk_bf16_f32 v252, v220, v221
  v_cvt_pk_bf16_f32 v253, v222, v223
  v_cvt_pk_bf16_f32 v254, v224, v225
  v_cvt_pk_bf16_f32 v255, v226, v227
  s_add_u32 s69, s68, 12582912
  buffer_store_dwordx4 v[248:251], v10, s[8:11], s69 offen offset:0 sc1
  buffer_store_dwordx4 v[252:255], v10, s[8:11], s69 offen offset:1024 sc1
  v_lshlrev_b32 v212, 16, v248
  v_and_b32 v213, 0xffff0000, v248
  v_lshlrev_b32 v214, 16, v249
  v_and_b32 v215, 0xffff0000, v249
  v_lshlrev_b32 v216, 16, v250
  v_and_b32 v217, 0xffff0000, v250
  v_lshlrev_b32 v218, 16, v251
  v_and_b32 v219, 0xffff0000, v251
  v_lshlrev_b32 v220, 16, v252
  v_and_b32 v221, 0xffff0000, v252
  v_lshlrev_b32 v222, 16, v253
  v_and_b32 v223, 0xffff0000, v253
  v_lshlrev_b32 v224, 16, v254
  v_and_b32 v225, 0xffff0000, v254
  v_lshlrev_b32 v226, 16, v255
  v_and_b32 v227, 0xffff0000, v255
  v_pk_add_f32 v[228:229], v[212:213], v[220:221]
  v_pk_add_f32 v[230:231], v[214:215], v[222:223]
  v_pk_add_f32 v[232:233], v[216:217], v[224:225]
  v_pk_add_f32 v[234:235], v[218:219], v[226:227]
  v_pk_add_f32 v[228:229], v[228:229], v[232:233]
  v_pk_add_f32 v[230:231], v[230:231], v[234:235]
  v_pk_add_f32 v[228:229], v[228:229], v[230:231]
  v_add_f32 v244, v228, v229
  s_nop 1
  v_add_f32_dpp v244, v244, v244 row_ror:4 row_mask:0xf bank_mask:0xf
  s_nop 1
  v_add_f32_dpp v244, v244, v244 row_ror:8 row_mask:0xf bank_mask:0xf
  v_mov_b32 v246, v244
  s_nop 1
  v_permlane16_swap_b32 v246, v244
  v_add_f32 v244, v244, v246
  v_mov_b32 v246, v244
  s_nop 1
  v_permlane32_swap_b32 v246, v244
  v_add_f32 v244, v244, v246
  v_mul_f32 v244, 0x3b800000, v244
  v_mov_b32 v245, v244
  v_pk_add_f32 v[228:229], v[212:213], v[244:245] neg_lo:[0,1] neg_hi:[0,1]
  v_pk_add_f32 v[230:231], v[214:215], v[244:245] neg_lo:[0,1] neg_hi:[0,1]
  v_pk_add_f32 v[232:233], v[216:217], v[244:245] neg_lo:[0,1] neg_hi:[0,1]
  v_pk_add_f32 v[234:235], v[218:219], v[244:245] neg_lo:[0,1] neg_hi:[0,1]
  v_pk_add_f32 v[236:237], v[220:221], v[244:245] neg_lo:[0,1] neg_hi:[0,1]
  v_pk_add_f32 v[238:239], v[222:223], v[244:245] neg_lo:[0,1] neg_hi:[0,1]
  v_pk_add_f32 v[240:241], v[224:225], v[244:245] neg_lo:[0,1] neg_hi:[0,1]
  v_pk_add_f32 v[242:243], v[226:227], v[244:245] neg_lo:[0,1] neg_hi:[0,1]
  v_pk_mul_f32 v[228:229], v[228:229], v[228:229]
  v_pk_fma_f32 v[228:229], v[230:231], v[230:231], v[228:229]
  v_pk_fma_f32 v[228:229], v[232:233], v[232:233], v[228:229]
  v_pk_fma_f32 v[228:229], v[234:235], v[234:235], v[228:229]
  v_pk_fma_f32 v[228:229], v[236:237], v[236:237], v[228:229]
  v_pk_fma_f32 v[228:229], v[238:239], v[238:239], v[228:229]
  v_pk_fma_f32 v[228:229], v[240:241], v[240:241], v[228:229]
  v_pk_fma_f32 v[228:229], v[242:243], v[242:243], v[228:229]
  v_add_f32 v245, v228, v229
  s_nop 1
  v_add_f32_dpp v245, v245, v245 row_ror:4 row_mask:0xf bank_mask:0xf
  s_nop 1
  v_add_f32_dpp v245, v245, v245 row_ror:8 row_mask:0xf bank_mask:0xf
  v_mov_b32 v246, v245
  s_nop 1
  v_permlane16_swap_b32 v246, v245
  v_add_f32 v245, v245, v246
  v_mov_b32 v246, v245
  s_nop 1
  v_permlane32_swap_b32 v246, v245
  v_add_f32 v245, v245, v246
  s_mov_b64 exec, 15
  ds_write_b64 v4, v[244:245] offset:0
  s_mov_b64 exec, -1
  s_waitcnt lgkmcnt(0)
  s_barrier
  ds_read_b128 v[228:231], v5 offset:0
  ds_read_b128 v[232:235], v5 offset:16
  s_waitcnt lgkmcnt(0)
  v_pk_add_f32 v[236:237], v[228:229], v[230:231]
  v_pk_add_f32 v[238:239], v[232:233], v[234:235]
  v_pk_add_f32 v[236:237], v[236:237], v[238:239]
  v_mul_f32 v236, 0x3e800000, v236
  v_sub_f32 v228, v228, v236
  v_sub_f32 v230, v230, v236
  v_sub_f32 v232, v232, v236
  v_sub_f32 v234, v234, v236
  v_mul_f32 v228, v228, v228
  v_fmac_f32 v228, v230, v230
  v_fmac_f32 v228, v232, v232
  v_fmac_f32 v228, v234, v234
  v_mul_f32 v237, 0x3a800000, v237
  v_fmac_f32 v237, 0x3e800000, v228
  v_cvt_pk_bf16_f32 v238, v236, v237
  v_lshlrev_b32 v236, 16, v238
  v_and_b32 v237, 0xffff0000, v238
  v_add_f32 v237, 0x3727c5ac, v237
  v_cvt_pk_bf16_f32 v237, v237, v237
  v_and_b32 v237, 0xffff0000, v237
  v_sqrt_f32 v237, v237
  s_nop 0
  v_cvt_pk_bf16_f32 v237, v237, v237
  v_and_b32 v237, 0xffff0000, v237
  v_rcp_f32 v238, v237
  v_mov_b32 v237, v236
  v_mov_b32 v239, v238
  v_pk_add_f32 v[212:213], v[212:213], v[236:237] neg_lo:[0,1] neg_hi:[0,1]
  v_pk_add_f32 v[214:215], v[214:215], v[236:237] neg_lo:[0,1] neg_hi:[0,1]
  v_pk_add_f32 v[216:217], v[216:217], v[236:237] neg_lo:[0,1] neg_hi:[0,1]
  v_pk_add_f32 v[218:219], v[218:219], v[236:237] neg_lo:[0,1] neg_hi:[0,1]
  v_pk_add_f32 v[220:221], v[220:221], v[236:237] neg_lo:[0,1] neg_hi:[0,1]
  v_pk_add_f32 v[222:223], v[222:223], v[236:237] neg_lo:[0,1] neg_hi:[0,1]
  v_pk_add_f32 v[224:225], v[224:225], v[236:237] neg_lo:[0,1] neg_hi:[0,1]
  v_pk_add_f32 v[226:227], v[226:227], v[236:237] neg_lo:[0,1] neg_hi:[0,1]
  v_cvt_pk_bf16_f32 v240, v212, v213
  v_lshlrev_b32 v212, 16, v240
  v_and_b32 v213, 0xffff0000, v240
  v_cvt_pk_bf16_f32 v241, v214, v215
  v_lshlrev_b32 v214, 16, v241
  v_and_b32 v215, 0xffff0000, v241
  v_cvt_pk_bf16_f32 v242, v216, v217
  v_lshlrev_b32 v216, 16, v242
  v_and_b32 v217, 0xffff0000, v242
  v_cvt_pk_bf16_f32 v243, v218, v219
  v_lshlrev_b32 v218, 16, v243
  v_and_b32 v219, 0xffff0000, v243
  v_cvt_pk_bf16_f32 v240, v220, v221
  v_lshlrev_b32 v220, 16, v240
  v_and_b32 v221, 0xffff0000, v240
  v_cvt_pk_bf16_f32 v241, v222, v223
  v_lshlrev_b32 v222, 16, v241
  v_and_b32 v223, 0xffff0000, v241
  v_cvt_pk_bf16_f32 v242, v224, v225
  v_lshlrev_b32 v224, 16, v242
  v_and_b32 v225, 0xffff0000, v242
  v_cvt_pk_bf16_f32 v243, v226, v227
  v_lshlrev_b32 v226, 16, v243
  v_and_b32 v227, 0xffff0000, v243
  v_pk_mul_f32 v[212:213], v[212:213], v[238:239]
  v_pk_mul_f32 v[214:215], v[214:215], v[238:239]
  v_pk_mul_f32 v[216:217], v[216:217], v[238:239]
  v_pk_mul_f32 v[218:219], v[218:219], v[238:239]
  v_pk_mul_f32 v[220:221], v[220:221], v[238:239]
  v_pk_mul_f32 v[222:223], v[222:223], v[238:239]
  v_pk_mul_f32 v[224:225], v[224:225], v[238:239]
  v_pk_mul_f32 v[226:227], v[226:227], v[238:239]
  v_xor_b32 v4, 128, v4
  v_xor_b32 v5, 128, v5
  v_cvt_pk_bf16_f32 v12, v212, v213
  v_lshlrev_b32 v212, 16, v12
  v_and_b32 v213, 0xffff0000, v12
  v_cvt_pk_bf16_f32 v13, v214, v215
  v_lshlrev_b32 v214, 16, v13
  v_and_b32 v215, 0xffff0000, v13
  v_cvt_pk_bf16_f32 v14, v216, v217
  v_lshlrev_b32 v216, 16, v14
  v_and_b32 v217, 0xffff0000, v14
  v_cvt_pk_bf16_f32 v15, v218, v219
  v_lshlrev_b32 v218, 16, v15
  v_and_b32 v219, 0xffff0000, v15
  v_cvt_pk_bf16_f32 v12, v220, v221
  v_lshlrev_b32 v220, 16, v12
  v_and_b32 v221, 0xffff0000, v12
  v_cvt_pk_bf16_f32 v13, v222, v223
  v_lshlrev_b32 v222, 16, v13
  v_and_b32 v223, 0xffff0000, v13
  v_cvt_pk_bf16_f32 v14, v224, v225
  v_lshlrev_b32 v224, 16, v14
  v_and_b32 v225, 0xffff0000, v14
  v_cvt_pk_bf16_f32 v15, v226, v227
  v_lshlrev_b32 v226, 16, v15
  v_and_b32 v227, 0xffff0000, v15
  v_pk_mul_f32 v[212:213], v[212:213], v[36:37]
  v_pk_mul_f32 v[214:215], v[214:215], v[38:39]
  v_pk_mul_f32 v[216:217], v[216:217], v[40:41]
  v_pk_mul_f32 v[218:219], v[218:219], v[42:43]
  v_pk_mul_f32 v[220:221], v[220:221], v[44:45]
  v_pk_mul_f32 v[222:223], v[222:223], v[46:47]
  v_pk_mul_f32 v[224:225], v[224:225], v[48:49]
  v_pk_mul_f32 v[226:227], v[226:227], v[50:51]
  v_cvt_pk_bf16_f32 v12, v212, v213
  v_lshlrev_b32 v212, 16, v12
  v_and_b32 v213, 0xffff0000, v12
  v_cvt_pk_bf16_f32 v13, v214, v215
  v_lshlrev_b32 v214, 16, v13
  v_and_b32 v215, 0xffff0000, v13
  v_cvt_pk_bf16_f32 v14, v216, v217
  v_lshlrev_b32 v216, 16, v14
  v_and_b32 v217, 0xffff0000, v14
  v_cvt_pk_bf16_f32 v15, v218, v219
  v_lshlrev_b32 v218, 16, v15
  v_and_b32 v219, 0xffff0000, v15
  v_cvt_pk_bf16_f32 v12, v220, v221
  v_lshlrev_b32 v220, 16, v12
  v_and_b32 v221, 0xffff0000, v12
  v_cvt_pk_bf16_f32 v13, v222, v223
  v_lshlrev_b32 v222, 16, v13
  v_and_b32 v223, 0xffff0000, v13
  v_cvt_pk_bf16_f32 v14, v224, v225
  v_lshlrev_b32 v224, 16, v14
  v_and_b32 v225, 0xffff0000, v14
  v_cvt_pk_bf16_f32 v15, v226, v227
  v_lshlrev_b32 v226, 16, v15
  v_and_b32 v227, 0xffff0000, v15
  v_pk_add_f32 v[212:213], v[212:213], v[52:53]
  v_pk_add_f32 v[214:215], v[214:215], v[54:55]
  v_pk_add_f32 v[216:217], v[216:217], v[56:57]
  v_pk_add_f32 v[218:219], v[218:219], v[58:59]
  v_pk_add_f32 v[220:221], v[220:221], v[60:61]
  v_pk_add_f32 v[222:223], v[222:223], v[62:63]
  v_pk_add_f32 v[224:225], v[224:225], v[64:65]
  v_pk_add_f32 v[226:227], v[226:227], v[66:67]
  v_cvt_pk_bf16_f32 v228, v212, v213
  v_cvt_pk_bf16_f32 v229, v214, v215
  v_cvt_pk_bf16_f32 v230, v216, v217
  v_cvt_pk_bf16_f32 v231, v218, v219
  v_cvt_pk_bf16_f32 v232, v220, v221
  v_cvt_pk_bf16_f32 v233, v222, v223
  v_cvt_pk_bf16_f32 v234, v224, v225
  v_cvt_pk_bf16_f32 v235, v226, v227
  s_cmp_eq_u32 s73, 0
  s_cbranch_scc1 rm_256
  s_mov_b32 s73, 0
  s_sub_u32 s59, s80, s74
  s_cmp_gt_u32 s59, 1
  s_cbranch_scc1 rm_258
  s_cmp_eq_u32 s59, 1
  s_cbranch_scc1 rm_257
  s_waitcnt vmcnt(3)
rm_257:
  s_waitcnt vmcnt(23)
rm_258:
  s_waitcnt vmcnt(43)
  s_sub_u32 s59, s64, 1
  s_lshr_b32 s59, s59, 1
  s_mul_i32 s59, s59, s87
  s_add_u32 s59, s59, s85
  s_lshl_b32 s59, s59, 7
  s_lshr_b32 s62, s86, 9
  s_add_u32 s59, s59, s62
  s_add_u32 s59, s59, 2334720
  buffer_store_dword v9, v8, s[8:11], s59 offen sc1
rm_256:
  s_and_b32 s60, s68, 0xffff0000
  s_lshr_b32 s59, s66, 7
  s_add_u32 s60, s60, s59
  s_add_u32 s60, s60, 8388608
  buffer_store_dwordx4 v[228:231], v2, s[8:11], s60 offen offset:0 sc1
  buffer_store_dwordx4 v[232:235], v2, s[8:11], s60 offen offset:512 sc1
  s_sub_u32 s59, s80, s64
  s_add_u32 s64, s64, 1
  s_cmp_eq_u32 s59, 1
  s_cbranch_scc1 rb_259
  s_add_u32 s73, s73, 1
  s_cmp_eq_u32 s59, 3
  s_cbranch_scc1 rd_260
  s_waitcnt vmcnt(4)
  s_branch rt_250
rd_260:
  s_waitcnt vmcnt(24)
  s_branch rt_250
rb_259:
  s_waitcnt vmcnt(0)
  s_cmp_eq_u32 s73, 0
  s_cbranch_scc1 rq_261
  s_sub_u32 s59, s64, 2
  s_lshr_b32 s59, s59, 1
  s_mul_i32 s59, s59, s87
  s_add_u32 s59, s59, s85
  s_lshl_b32 s59, s59, 7
  s_lshr_b32 s62, s86, 9
  s_add_u32 s59, s59, s62
  s_add_u32 s59, s59, 2334720
  buffer_store_dword v9, v8, s[8:11], s59 offen sc1
rq_261:
  s_sub_u32 s59, s64, 1
  s_lshr_b32 s59, s59, 1
  s_mul_i32 s59, s59, s87
  s_add_u32 s59, s59, s84
  s_lshl_b32 s59, s59, 7
  s_lshr_b32 s62, s66, 9
  s_add_u32 s59, s59, s62
  s_add_u32 s59, s59, 2334720
  buffer_store_dword v9, v8, s[8:11], s59 offen sc1
  s_cmp_lt_u32 s64, s88
  s_cbranch_scc0 DONE
rf_252:
  s_lshr_b32 s60, s80, 1
  s_mul_i32 s60, s60, s87
  s_add_u32 s60, s60, s85
  s_lshl_b32 s60, s60, 9
  s_add_u32 s60, s60, 2228224
  buffer_load_dwordx4 v[16:19], v11, s[8:11], s60 offen sc1
  s_waitcnt vmcnt(0)
  v_and_b32 v16, v16, v17
  v_and_b32 v18, v18, v19
  v_and_b32 v16, v16, v18
  v_cmp_ne_u32 vcc, 1, v16
  s_nop 0
  s_cmp_eq_u32 vcc_lo, 0
  s_cbranch_scc1 rk_262
  s_sub_u32 s57, s57, 1
  s_cbranch_scc0 rf_252
  s_branch ABORT
rk_262:
  s_add_u32 s60, s80, 1
  s_lshr_b32 s60, s60, 1
  s_mul_i32 s60, s60, s87
  s_add_u32 s60, s60, s84
  s_lshl_b32 s60, s60, 9
  s_add_u32 s60, s60, 2228224
  buffer_load_dwordx4 v[16:19], v7, s[8:11], s60 offen sc1
  s_lshr_b32 s61, s80, 1
  s_mul_i32 s61, s61, s87
  s_add_u32 s61, s61, s85
  s_lshl_b32 s61, s61, 16
  s_add_u32 s61, s61, s86
  s_lshl_b32 s67, s61, 3
  s_add_u32 s67, s67, 83886080
  buffer_load_dwordx4 v[132:135], v6, s[8:11], s67 offen offset:0 sc1
  buffer_load_dwordx4 v[136:139], v6, s[8:11], s67 offen offset:1024 sc1
  buffer_load_dwordx4 v[140:143], v6, s[8:11], s67 offen offset:2048 sc1
  buffer_load_dwordx4 v[144:147], v6, s[8:11], s67 offen offset:3072 sc1
  s_add_u32 s67, s67, 16384
  buffer_load_dwordx4 v[148:151], v6, s[8:11], s67 offen offset:0 sc1
  buffer_load_dwordx4 v[152:155], v6, s[8:11], s67 offen offset:1024 sc1
  buffer_load_dwordx4 v[156:159], v6, s[8:11], s67 offen offset:2048 sc1
  buffer_load_dwordx4 v[160:163], v6, s[8:11], s67 offen offset:3072 sc1
  s_add_u32 s67, s67, 16384
  buffer_load_dwordx4 v[164:167], v6, s[8:11], s67 offen offset:0 sc1
  buffer_load_dwordx4 v[168:171], v6, s[8:11], s67 offen offset:1024 sc1
  buffer_load_dwordx4 v[172:175], v6, s[8:11], s67 offen offset:2048 sc1
  buffer_load_dwordx4 v[176:179], v6, s[8:11], s67 offen offset:3072 sc1
  s_add_u32 s67, s67, 16384
  buffer_load_dwordx4 v[180:183], v6, s[8:11], s67 offen offset:0 sc1
  buffer_load_dwordx4 v[184:187], v6, s[8:11], s67 offen offset:1024 sc1
  buffer_load_dwordx4 v[188:191], v6, s[8:11], s67 offen offset:2048 sc1
  buffer_load_dwordx4 v[192:195], v6, s[8:11], s67 offen offset:3072 sc1
  buffer_load_dwordx2 v[204:205], v3, s[16:19], s61 offen offset:0
  buffer_load_dwordx2 v[206:207], v3, s[16:19], s61 offen offset:128
  buffer_load_dwordx2 v[208:209], v3, s[16:19], s61 offen offset:256
  buffer_load_dwordx2 v[210:211], v3, s[16:19], s61 offen offset:384
  s_add_u32 s80, s80, 1
  s_mov_b32 s73, 0
  s_waitcnt vmcnt(0)
rt_250:
  v_and_b32 v16, v16, v17
  v_and_b32 v18, v18, v19
  v_and_b32 v16, v16, v18
  v_cmp_ne_u32 vcc, 1, v16
  s_mov_b32 s74, s80
  s_mov_b64 s[82:83], vcc
  v_pk_add_f32 v[132:133], v[132:133], v[148:149]
  v_pk_add_f32 v[134:135], v[134:135], v[150:151]
  v_pk_add_f32 v[136:137], v[136:137], v[152:153]
  v_pk_add_f32 v[138:139], v[138:139], v[154:155]
  v_pk_add_f32 v[140:141], v[140:141], v[156:157]
  v_pk_add_f32 v[142:143], v[142:143], v[158:159]
  v_pk_add_f32 v[144:145], v[144:145], v[160:161]
  v_pk_add_f32 v[146:147], v[146:147], v[162:163]
  v_pk_add_f32 v[164:165], v[164:165], v[180:181]
  v_pk_add_f32 v[166:167], v[166:167], v[182:183]
  v_pk_add_f32 v[168:169], v[168:169], v[184:185]
  v_pk_add_f32 v[170:171], v[170:171], v[186:187]
  v_pk_add_f32 v[172:173], v[172:173], v[188:189]
  v_pk_add_f32 v[174:175], v[174:175], v[190:191]
  v_pk_add_f32 v[176:177], v[176:177], v[192:193]
  v_pk_add_f32 v[178:179], v[178:179], v[194:195]
  v_pk_add_f32 v[228:229], v[132:133], v[164:165]
  v_pk_add_f32 v[230:231], v[134:135], v[166:167]
  v_pk_add_f32 v[232:233], v[136:137], v[168:169]
  v_pk_add_f32 v[234:235], v[138:139], v[170:171]
  v_pk_add_f32 v[236:237], v[140:141], v[172:173]
  v_pk_add_f32 v[238:239], v[142:143], v[174:175]
  v_pk_add_f32 v[240:241], v[144:145], v[176:177]
  v_pk_add_f32 v[242:243], v[146:147], v[178:179]
  v_lshlrev_b32 v212, 16, v204
  v_and_b32 v213, 0xffff0000, v204
  v_lshlrev_b32 v214, 16, v205
  v_and_b32 v215, 0xffff0000, v205
  v_lshlrev_b32 v216, 16, v206
  v_and_b32 v217, 0xffff0000, v206
  v_lshlrev_b32 v218, 16, v207
  v_and_b32 v219, 0xffff0000, v207
  v_lshlrev_b32 v220, 16, v208
  v_and_b32 v221, 0xffff0000, v208
  v_lshlrev_b32 v222, 16, v209
  v_and_b32 v223, 0xffff0000, v209
  v_lshlrev_b32 v224, 16, v210
  v_and_b32 v225, 0xffff0000, v210
  v_lshlrev_b32 v226, 16, v211
  v_and_b32 v227, 0xffff0000, v211
  s_add_u32 s60, s64, 2
  s_lshr_b32 s60, s60, 1
  s_mul_i32 s60, s60, s87
  s_add_u32 s60, s60, s85
  s_lshl_b32 s60, s60, 9
  s_add_u32 s60, s60, 2228224
  buffer_load_dwordx4 v[16:19], v11, s[8:11], s60 offen sc1
  s_lshr_b32 s68, s64, 1
  s_mul_i32 s68, s68, s87
  s_add_u32 s68, s68, s85
  s_lshl_b32 s68, s68, 16
  s_add_u32 s68, s68, s86
  s_sub_u32 s59, s80, s64
  s_cmp_eq_u32 s59, 1
  s_cbranch_scc0 ra_263
  s_cmp_lt_u32 s80, s88
  s_cselect_b32 s82, s82, 1
  s_cmp_eq_u32 s82, 0
  s_cbranch_scc0 rb_264
  s_lshr_b32 s61, s80, 1
  s_mul_i32 s61, s61, s87
  s_add_u32 s61, s61, s84
  s_lshl_b32 s61, s61, 16
  s_add_u32 s61, s61, s66
  s_lshl_b32 s67, s61, 3
  s_add_u32 s67, s67, 83886080
  buffer_load_dwordx4 v[68:71], v6, s[8:11], s67 offen offset:0 sc1
  buffer_load_dwordx4 v[72:75], v6, s[8:11], s67 offen offset:1024 sc1
  buffer_load_dwordx4 v[76:79], v6, s[8:11], s67 offen offset:2048 sc1
  buffer_load_dwordx4 v[80:83], v6, s[8:11], s67 offen offset:3072 sc1
  s_add_u32 s67, s67, 16384
  buffer_load_dwordx4 v[84:87], v6, s[8:11], s67 offen offset:0 sc1
  buffer_load_dwordx4 v[88:91], v6, s[8:11], s67 offen offset:1024 sc1
  buffer_load_dwordx4 v[92:95], v6, s[8:11], s67 offen offset:2048 sc1
  buffer_load_dwordx4 v[96:99], v6, s[8:11], s67 offen offset:3072 sc1
  s_add_u32 s67, s67, 16384
  buffer_load_dwordx4 v[100:103], v6, s[8:11], s67 offen offset:0 sc1
  buffer_load_dwordx4 v[104:107], v6, s[8:11], s67 offen offset:1024 sc1
  buffer_load_dwordx4 v[108:111], v6, s[8:11], s67 offen offset:2048 sc1
  buffer_load_dwordx4 v[112:115], v6, s[8:11], s67 offen offset:3072 sc1
  s_add_u32 s67, s67, 16384
  buffer_load_dwordx4 v[116:119], v6, s[8:11], s67 offen offset:0 sc1
  buffer_load_dwordx4 v[120:123], v6, s[8:11], s67 offen offset:1024 sc1
  buffer_load_dwordx4 v[124:127], v6, s[8:11], s67 offen offset:2048 sc1
  buffer_load_dwordx4 v[128:131], v6, s[8:11], s67 offen offset:3072 sc1
  buffer_load_dwordx2 v[196:197], v3, s[16:19], s61 offen offset:0
  buffer_load_dwordx2 v[198:199], v3, s[16:19], s61 offen offset:128
  buffer_load_dwordx2 v[200:201], v3, s[16:19], s61 offen offset:256
  buffer_load_dwordx2 v[202:203], v3, s[16:19], s61 offen offset:384
  s_add_u32 s80, s80, 1
ra_263:
  s_cmp_lt_u32 s80, s88
  s_cselect_b32 s83, s83, 1
  s_cmp_eq_u32 s83, 0
  s_cbranch_scc0 rb_264
  s_lshr_b32 s61, s80, 1
  s_mul_i32 s61, s61, s87
  s_add_u32 s61, s61, s85
  s_lshl_b32 s61, s61, 16
  s_add_u32 s61, s61, s86
  s_lshl_b32 s67, s61, 3
  s_add_u32 s67, s67, 83886080
  buffer_load_dwordx4 v[132:135], v6, s[8:11], s67 offen offset:0 sc1
  buffer_load_dwordx4 v[136:139], v6, s[8:11], s67 offen offset:1024 sc1
  buffer_load_dwordx4 v[140:143], v6, s[8:11], s67 offen offset:2048 sc1
  buffer_load_dwordx4 v[144:147], v6, s[8:11], s67 offen offset:3072 sc1
  s_add_u32 s67, s67, 16384
  buffer_load_dwordx4 v[148:151], v6, s[8:11], s67 offen offset:0 sc1
  buffer_load_dwordx4 v[152:155], v6, s[8:11], s67 offen offset:1024 sc1
  buffer_load_dwordx4 v[156:159], v6, s[8:11], s67 offen offset:2048 sc1
  buffer_load_dwordx4 v[160:163], v6, s[8:11], s67 offen offset:3072 sc1
  s_add_u32 s67, s67, 16384
  buffer_load_dwordx4 v[164:167], v6, s[8:11], s67 offen offset:0 sc1
  buffer_load_dwordx4 v[168:171], v6, s[8:11], s67 offen offset:1024 sc1
  buffer_load_dwordx4 v[172:175], v6, s[8:11], s67 offen offset:2048 sc1
  buffer_load_dwordx4 v[176:179], v6, s[8:11], s67 offen offset:3072 sc1
  s_add_u32 s67, s67, 16384
  buffer_load_dwordx4 v[180:183], v6, s[8:11], s67 offen offset:0 sc1
  buffer_load_dwordx4 v[184:187], v6, s[8:11], s67 offen offset:1024 sc1
  buffer_load_dwordx4 v[188:191], v6, s[8:11], s67 offen offset:2048 sc1
  buffer_load_dwordx4 v[192:195], v6, s[8:11], s67 offen offset:3072 sc1
  buffer_load_dwordx2 v[204:205], v3, s[16:19], s61 offen offset:0
  buffer_load_dwordx2 v[206:207], v3, s[16:19], s61 offen offset:128
  buffer_load_dwordx2 v[208:209], v3, s[16:19], s61 offen offset:256
  buffer_load_dwordx2 v[210:211], v3, s[16:19], s61 offen offset:384
  s_add_u32 s80, s80, 1
rb_264:
  v_cvt_pk_bf16_f32 v12, v228, v229
  v_lshlrev_b32 v228, 16, v12
  v_and_b32 v229, 0xffff0000, v12
  v_cvt_pk_bf16_f32 v13, v230, v231
  v_lshlrev_b32 v230, 16, v13
  v_and_b32 v231, 0xffff0000, v13
  v_cvt_pk_bf16_f32 v14, v232, v233
  v_lshlrev_b32 v232, 16, v14
  v_and_b32 v233, 0xffff0000, v14
  v_cvt_pk_bf16_f32 v15, v234, v235
  v_lshlrev_b32 v234, 16, v15
  v_and_b32 v235, 0xffff0000, v15
  v_cvt_pk_bf16_f32 v12, v236, v237
  v_lshlrev_b32 v236, 16, v12
  v_and_b32 v237, 0xffff0000, v12
  v_cvt_pk_bf16_f32 v13, v238, v239
  v_lshlrev_b32 v238, 16, v13
  v_and_b32 v239, 0xffff0000, v13
  v_cvt_pk_bf16_f32 v14, v240, v241
  v_lshlrev_b32 v240, 16, v14
  v_and_b32 v241, 0xffff0000, v14
  v_cvt_pk_bf16_f32 v15, v242, v243
  v_lshlrev_b32 v242, 16, v15
  v_and_b32 v243, 0xffff0000, v15
  v_pk_mul_f32 v[228:229], v[228:229], v[20:21]
  v_pk_mul_f32 v[230:231], v[230:231], v[22:23]
  v_pk_mul_f32 v[232:233], v[232:233], v[24:25]
  v_pk_mul_f32 v[234:235], v[234:235], v[26:27]
  v_pk_mul_f32 v[236:237], v[236:237], v[28:29]
  v_pk_mul_f32 v[238:239], v[238:239], v[30:31]
  v_pk_mul_f32 v[240:241], v[240:241], v[32:33]
  v_pk_mul_f32 v[242:243], v[242:243], v[34:35]
  v_cvt_pk_bf16_f32 v12, v228, v229
  v_lshlrev_b32 v228, 16, v12
  v_and_b32 v229, 0xffff0000, v12
  v_cvt_pk_bf16_f32 v13, v230, v231
  v_lshlrev_b32 v230, 16, v13
  v_and_b32 v231, 0xffff0000, v13
  v_cvt_pk_bf16_f32 v14, v232, v233
  v_lshlrev_b32 v232, 16, v14
  v_and_b32 v233, 0xffff0000, v14
  v_cvt_pk_bf16_f32 v15, v234, v235
  v_lshlrev_b32 v234, 16, v15
  v_and_b32 v235, 0xffff0000, v15
  v_cvt_pk_bf16_f32 v12, v236, v237
  v_lshlrev_b32 v236, 16, v12
  v_and_b32 v237, 0xffff0000, v12
  v_cvt_pk_bf16_f32 v13, v238, v239
  v_lshlrev_b32 v238, 16, v13
  v_and_b32 v239, 0xffff0000, v13
  v_cvt_pk_bf16_f32 v14, v240, v241
  v_lshlrev_b32 v240, 16, v14
  v_and_b32 v241, 0xffff0000, v14
  v_cvt_pk_bf16_f32 v15, v242, v243
  v_lshlrev_b32 v242, 16, v15
  v_and_b32 v243, 0xffff0000, v15
  v_pk_add_f32 v[212:213], v[212:213], v[228:229]
  v_pk_add_f32 v[214:215], v[214:215], v[230:231]
  v_pk_add_f32 v[216:217], v[216:217], v[232:233]
  v_pk_add_f32 v[218:219], v[218:219], v[234:235]
  v_pk_add_f32 v[220:221], v[220:221], v[236:237]
  v_pk_add_f32 v[222:223], v[222:223], v[238:239]
  v_pk_add_f32 v[224:225], v[224:225], v[240:241]
  v_pk_add_f32 v[226:227], v[226:227], v[242:243]
  v_cvt_pk_bf16_f32 v248, v212, v213
  v_cvt_pk_bf16_f32 v249, v214, v215
  v_cvt_pk_bf16_f32 v250, v216, v217
  v_cvt_pk_bf16_f32 v251, v218, v219
  v_cvt_pk_bf16_f32 v252, v220, v221
  v_cvt_pk_bf16_f32 v253, v222, v223
  v_cvt_pk_bf16_f32 v254, v224, v225
  v_cvt_pk_bf16_f32 v255, v226, v227
  s_add_u32 s69, s68, 12582912
  buffer_store_dwordx4 v[248:251], v10, s[8:11], s69 offen offset:0 sc1
  buffer_store_dwordx4 v[252:255], v10, s[8:11], s69 offen offset:1024 sc1
  v_lshlrev_b32 v212, 16, v248
  v_and_b32 v213, 0xffff0000, v248
  v_lshlrev_b32 v214, 16, v249
  v_and_b32 v215, 0xffff0000, v249
  v_lshlrev_b32 v216, 16, v250
  v_and_b32 v217, 0xffff0000, v250
  v_lshlrev_b32 v218, 16, v251
  v_and_b32 v219, 0xffff0000, v251
  v_lshlrev_b32 v220, 16, v252
  v_and_b32 v221, 0xffff0000, v252
  v_lshlrev_b32 v222, 16, v253
  v_and_b32 v223, 0xffff0000, v253
  v_lshlrev_b32 v224, 16, v254
  v_and_b32 v225, 0xffff0000, v254
  v_lshlrev_b32 v226, 16, v255
  v_and_b32 v227, 0xffff0000, v255
  v_pk_add_f32 v[228:229], v[212:213], v[220:221]
  v_pk_add_f32 v[230:231], v[214:215], v[222:223]
  v_pk_add_f32 v[232:233], v[216:217], v[224:225]
  v_pk_add_f32 v[234:235], v[218:219], v[226:227]
  v_pk_add_f32 v[228:229], v[228:229], v[232:233]
  v_pk_add_f32 v[230:231], v[230:231], v[234:235]
  v_pk_add_f32 v[228:229], v[228:229], v[230:231]
  v_add_f32 v244, v228, v229
  s_nop 1
  v_add_f32_dpp v244, v244, v244 row_ror:4 row_mask:0xf bank_mask:0xf
  s_nop 1
  v_add_f32_dpp v244, v244, v244 row_ror:8 row_mask:0xf bank_mask:0xf
  v_mov_b32 v246, v244
  s_nop 1
  v_permlane16_swap_b32 v246, v244
  v_add_f32 v244, v244, v246
  v_mov_b32 v246, v244
  s_nop 1
  v_permlane32_swap_b32 v246, v244
  v_add_f32 v244, v244, v246
  v_mul_f32 v244, 0x3b800000, v244
  v_mov_b32 v245, v244
  v_pk_add_f32 v[228:229], v[212:213], v[244:245] neg_lo:[0,1] neg_hi:[0,1]
  v_pk_add_f32 v[230:231], v[214:215], v[244:245] neg_lo:[0,1] neg_hi:[0,1]
  v_pk_add_f32 v[232:233], v[216:217], v[244:245] neg_lo:[0,1] neg_hi:[0,1]
  v_pk_add_f32 v[234:235], v[218:219], v[244:245] neg_lo:[0,1] neg_hi:[0,1]
  v_pk_add_f32 v[236:237], v[220:221], v[244:245] neg_lo:[0,1] neg_hi:[0,1]
  v_pk_add_f32 v[238:239], v[222:223], v[244:245] neg_lo:[0,1] neg_hi:[0,1]
  v_pk_add_f32 v[240:241], v[224:225], v[244:245] neg_lo:[0,1] neg_hi:[0,1]
  v_pk_add_f32 v[242:243], v[226:227], v[244:245] neg_lo:[0,1] neg_hi:[0,1]
  v_pk_mul_f32 v[228:229], v[228:229], v[228:229]
  v_pk_fma_f32 v[228:229], v[230:231], v[230:231], v[228:229]
  v_pk_fma_f32 v[228:229], v[232:233], v[232:233], v[228:229]
  v_pk_fma_f32 v[228:229], v[234:235], v[234:235], v[228:229]
  v_pk_fma_f32 v[228:229], v[236:237], v[236:237], v[228:229]
  v_pk_fma_f32 v[228:229], v[238:239], v[238:239], v[228:229]
  v_pk_fma_f32 v[228:229], v[240:241], v[240:241], v[228:229]
  v_pk_fma_f32 v[228:229], v[242:243], v[242:243], v[228:229]
  v_add_f32 v245, v228, v229
  s_nop 1
  v_add_f32_dpp v245, v245, v245 row_ror:4 row_mask:0xf bank_mask:0xf
  s_nop 1
  v_add_f32_dpp v245, v245, v245 row_ror:8 row_mask:0xf bank_mask:0xf
  v_mov_b32 v246, v245
  s_nop 1
  v_permlane16_swap_b32 v246, v245
  v_add_f32 v245, v245, v246
  v_mov_b32 v246, v245
  s_nop 1
  v_permlane32_swap_b32 v246, v245
  v_add_f32 v245, v245, v246
  s_mov_b64 exec, 15
  ds_write_b64 v4, v[244:245] offset:0
  s_mov_b64 exec, -1
  s_waitcnt lgkmcnt(0)
  s_barrier
  ds_read_b128 v[228:231], v5 offset:0
  ds_read_b128 v[232:235], v5 offset:16
  s_waitcnt lgkmcnt(0)
  v_pk_add_f32 v[236:237], v[228:229], v[230:231]
  v_pk_add_f32 v[238:239], v[232:233], v[234:235]
  v_pk_add_f32 v[236:237], v[236:237], v[238:239]
  v_mul_f32 v236, 0x3e800000, v236
  v_sub_f32 v228, v228, v236
  v_sub_f32 v230, v230, v236
  v_sub_f32 v232, v232, v236
  v_sub_f32 v234, v234, v236
  v_mul_f32 v228, v228, v228
  v_fmac_f32 v228, v230, v230
  v_fmac_f32 v228, v232, v232
  v_fmac_f32 v228, v234, v234
  v_mul_f32 v237, 0x3a800000, v237
  v_fmac_f32 v237, 0x3e800000, v228
  v_cvt_pk_bf16_f32 v238, v236, v237
  v_lshlrev_b32 v236, 16, v238
  v_and_b32 v237, 0xffff0000, v238
  v_add_f32 v237, 0x3727c5ac, v237
  v_cvt_pk_bf16_f32 v237, v237, v237
  v_and_b32 v237, 0xffff0000, v237
  v_sqrt_f32 v237, v237
  s_nop 0
  v_cvt_pk_bf16_f32 v237, v237, v237
  v_and_b32 v237, 0xffff0000, v237
  v_rcp_f32 v238, v237
  v_mov_b32 v237, v236
  v_mov_b32 v239, v238
  v_pk_add_f32 v[212:213], v[212:213], v[236:237] neg_lo:[0,1] neg_hi:[0,1]
  v_pk_add_f32 v[214:215], v[214:215], v[236:237] neg_lo:[0,1] neg_hi:[0,1]
  v_pk_add_f32 v[216:217], v[216:217], v[236:237] neg_lo:[0,1] neg_hi:[0,1]
  v_pk_add_f32 v[218:219], v[218:219], v[236:237] neg_lo:[0,1] neg_hi:[0,1]
  v_pk_add_f32 v[220:221], v[220:221], v[236:237] neg_lo:[0,1] neg_hi:[0,1]
  v_pk_add_f32 v[222:223], v[222:223], v[236:237] neg_lo:[0,1] neg_hi:[0,1]
  v_pk_add_f32 v[224:225], v[224:225], v[236:237] neg_lo:[0,1] neg_hi:[0,1]
  v_pk_add_f32 v[226:227], v[226:227], v[236:237] neg_lo:[0,1] neg_hi:[0,1]
  v_cvt_pk_bf16_f32 v240, v212, v213
  v_lshlrev_b32 v212, 16, v240
  v_and_b32 v213, 0xffff0000, v240
  v_cvt_pk_bf16_f32 v241, v214, v215
  v_lshlrev_b32 v214, 16, v241
  v_and_b32 v215, 0xffff0000, v241
  v_cvt_pk_bf16_f32 v242, v216, v217
  v_lshlrev_b32 v216, 16, v242
  v_and_b32 v217, 0xffff0000, v242
  v_cvt_pk_bf16_f32 v243, v218, v219
  v_lshlrev_b32 v218, 16, v243
  v_and_b32 v219, 0xffff0000, v243
  v_cvt_pk_bf16_f32 v240, v220, v221
  v_lshlrev_b32 v220, 16, v240
  v_and_b32 v221, 0xffff0000, v240
  v_cvt_pk_bf16_f32 v241, v222, v223
  v_lshlrev_b32 v222, 16, v241
  v_and_b32 v223, 0xffff0000, v241
  v_cvt_pk_bf16_f32 v242, v224, v225
  v_lshlrev_b32 v224, 16, v242
  v_and_b32 v225, 0xffff0000, v242
  v_cvt_pk_bf16_f32 v243, v226, v227
  v_lshlrev_b32 v226, 16, v243
  v_and_b32 v227, 0xffff0000, v243
  v_pk_mul_f32 v[212:213], v[212:213], v[238:239]
  v_pk_mul_f32 v[214:215], v[214:215], v[238:239]
  v_pk_mul_f32 v[216:217], v[216:217], v[238:239]
  v_pk_mul_f32 v[218:219], v[218:219], v[238:239]
  v_pk_mul_f32 v[220:221], v[220:221], v[238:239]
  v_pk_mul_f32 v[222:223], v[222:223], v[238:239]
  v_pk_mul_f32 v[224:225], v[224:225], v[238:239]
  v_pk_mul_f32 v[226:227], v[226:227], v[238:239]
  v_xor_b32 v4, 128, v4
  v_xor_b32 v5, 128, v5
  v_cvt_pk_bf16_f32 v12, v212, v213
  v_lshlrev_b32 v212, 16, v12
  v_and_b32 v213, 0xffff0000, v12
  v_cvt_pk_bf16_f32 v13, v214, v215
  v_lshlrev_b32 v214, 16, v13
  v_and_b32 v215, 0xffff0000, v13
  v_cvt_pk_bf16_f32 v14, v216, v217
  v_lshlrev_b32 v216, 16, v14
  v_and_b32 v217, 0xffff0000, v14
  v_cvt_pk_bf16_f32 v15, v218, v219
  v_lshlrev_b32 v218, 16, v15
  v_and_b32 v219, 0xffff0000, v15
  v_cvt_pk_bf16_f32 v12, v220, v221
  v_lshlrev_b32 v220, 16, v12
  v_and_b32 v221, 0xffff0000, v12
  v_cvt_pk_bf16_f32 v13, v222, v223
  v_lshlrev_b32 v222, 16, v13
  v_and_b32 v223, 0xffff0000, v13
  v_cvt_pk_bf16_f32 v14, v224, v225
  v_lshlrev_b32 v224, 16, v14
  v_and_b32 v225, 0xffff0000, v14
  v_cvt_pk_bf16_f32 v15, v226, v227
  v_lshlrev_b32 v226, 16, v15
  v_and_b32 v227, 0xffff0000, v15
  v_pk_mul_f32 v[212:213], v[212:213], v[36:37]
  v_pk_mul_f32 v[214:215], v[214:215], v[38:39]
  v_pk_mul_f32 v[216:217], v[216:217], v[40:41]
  v_pk_mul_f32 v[218:219], v[218:219], v[42:43]
  v_pk_mul_f32 v[220:221], v[220:221], v[44:45]
  v_pk_mul_f32 v[222:223], v[222:223], v[46:47]
  v_pk_mul_f32 v[224:225], v[224:225], v[48:49]
  v_pk_mul_f32 v[226:227], v[226:227], v[50:51]
  v_cvt_pk_bf16_f32 v12, v212, v213
  v_lshlrev_b32 v212, 16, v12
  v_and_b32 v213, 0xffff0000, v12
  v_cvt_pk_bf16_f32 v13, v214, v215
  v_lshlrev_b32 v214, 16, v13
  v_and_b32 v215, 0xffff0000, v13
  v_cvt_pk_bf16_f32 v14, v216, v217
  v_lshlrev_b32 v216, 16, v14
  v_and_b32 v217, 0xffff0000, v14
  v_cvt_pk_bf16_f32 v15, v218, v219
  v_lshlrev_b32 v218, 16, v15
  v_and_b32 v219, 0xffff0000, v15
  v_cvt_pk_bf16_f32 v12, v220, v221
  v_lshlrev_b32 v220, 16, v12
  v_and_b32 v221, 0xffff0000, v12
  v_cvt_pk_bf16_f32 v13, v222, v223
  v_lshlrev_b32 v222, 16, v13
  v_and_b32 v223, 0xffff0000, v13
  v_cvt_pk_bf16_f32 v14, v224, v225
  v_lshlrev_b32 v224, 16, v14
  v_and_b32 v225, 0xffff0000, v14
  v_cvt_pk_bf16_f32 v15, v226, v227
  v_lshlrev_b32 v226, 16, v15
  v_and_b32 v227, 0xffff0000, v15
  v_pk_add_f32 v[212:213], v[212:213], v[52:53]
  v_pk_add_f32 v[214:215], v[214:215], v[54:55]
  v_pk_add_f32 v[216:217], v[216:217], v[56:57]
  v_pk_add_f32 v[218:219], v[218:219], v[58:59]
  v_pk_add_f32 v[220:221], v[220:221], v[60:61]
  v_pk_add_f32 v[222:223], v[222:223], v[62:63]
  v_pk_add_f32 v[224:225], v[224:225], v[64:65]
  v_pk_add_f32 v[226:227], v[226:227], v[66:67]
  v_cvt_pk_bf16_f32 v228, v212, v213
  v_cvt_pk_bf16_f32 v229, v214, v215
  v_cvt_pk_bf16_f32 v230, v216, v217
  v_cvt_pk_bf16_f32 v231, v218, v219
  v_cvt_pk_bf16_f32 v232, v220, v221
  v_cvt_pk_bf16_f32 v233, v222, v223
  v_cvt_pk_bf16_f32 v234, v224, v225
  v_cvt_pk_bf16_f32 v235, v226, v227
  s_cmp_eq_u32 s73, 0
  s_cbranch_scc1 rm_265
  s_mov_b32 s73, 0
  s_sub_u32 s59, s80, s74
  s_cmp_gt_u32 s59, 1
  s_cbranch_scc1 rm_267
  s_cmp_eq_u32 s59, 1
  s_cbranch_scc1 rm_266
  s_waitcnt vmcnt(3)
rm_266:
  s_waitcnt vmcnt(23)
rm_267:
  s_waitcnt vmcnt(43)
  s_sub_u32 s59, s64, 1
  s_lshr_b32 s59, s59, 1
  s_mul_i32 s59, s59, s87
  s_add_u32 s59, s59, s84
  s_lshl_b32 s59, s59, 7
  s_lshr_b32 s62, s66, 9
  s_add_u32 s59, s59, s62
  s_add_u32 s59, s59, 2334720
  buffer_store_dword v9, v8, s[8:11], s59 offen sc1
rm_265:
  s_and_b32 s60, s68, 0xffff0000
  s_lshr_b32 s59, s86, 7
  s_add_u32 s60, s60, s59
  s_add_u32 s60, s60, 8388608
  buffer_store_dwordx4 v[228:231], v2, s[8:11], s60 offen offset:0 sc1
  buffer_store_dwordx4 v[232:235], v2, s[8:11], s60 offen offset:512 sc1
  s_sub_u32 s59, s80, s64
  s_add_u32 s64, s64, 1
  s_cmp_eq_u32 s59, 1
  s_cbranch_scc1 rb_268
  s_add_u32 s73, s73, 1
  s_cmp_eq_u32 s59, 3
  s_cbranch_scc1 rd_269
  s_waitcnt vmcnt(4)
  s_branch rt_249
rd_269:
  s_waitcnt vmcnt(24)
  s_branch rt_249
rb_268:
  s_waitcnt vmcnt(0)
  s_cmp_eq_u32 s73, 0
  s_cbranch_scc1 rq_270
  s_sub_u32 s59, s64, 2
  s_lshr_b32 s59, s59, 1
  s_mul_i32 s59, s59, s87
  s_add_u32 s59, s59, s84
  s_lshl_b32 s59, s59, 7
  s_lshr_b32 s62, s66, 9
  s_add_u32 s59, s59, s62
  s_add_u32 s59, s59, 2334720
  buffer_store_dword v9, v8, s[8:11], s59 offen sc1
rq_270:
  s_sub_u32 s59, s64, 1
  s_lshr_b32 s59, s59, 1
  s_mul_i32 s59, s59, s87
  s_add_u32 s59, s59, s85
  s_lshl_b32 s59, s59, 7
  s_lshr_b32 s62, s86, 9
  s_add_u32 s59, s59, s62
  s_add_u32 s59, s59, 2334720
  buffer_store_dword v9, v8, s[8:11], s59 offen sc1
  s_cmp_lt_u32 s64, s88
  s_cbranch_scc0 DONE
  s_branch rf_251
JR2:
  s_and_b32 s66, s56, 7
  s_mov_b32 s86, s66
  s_lshr_b32 s84, s56, 3
  s_lshl_b32 s59, s55, 2
  s_add_u32 s84, s84, s59
  s_add_u32 s85, s84, 16
  s_mov_b32 s87, 32
  s_mov_b32 s88, 4
  v_lshrrev_b32 v12, 2, v0
  v_and_b32 v13, 3, v0
  s_lshl_b32 s59, s54, 10
  v_lshl_add_u32 v1, v12, 4, s59
  s_lshl_b32 s59, s54, 14
  v_lshl_add_u32 v2, v12, 10, s59
  v_lshl_add_u32 v2, v13, 4, v2
  s_lshl_b32 s59, s54, 9
  v_lshl_add_u32 v3, v12, 3, s59
  v_lshl_add_u32 v3, v13, 11, v3
  v_lshlrev_b32 v5, 5, v13
  v_add_u32 v5, 132096, v5
  s_lshl_b32 s59, s54, 3
  v_add_u32 v4, s59, v5
  s_lshl_b32 s59, s54, 12
  v_lshl_add_u32 v6, v0, 4, s59
  s_lshl_b32 s59, s54, 11
  v_lshl_add_u32 v10, v0, 4, s59
  v_and_b32 v7, 31, v0
  v_lshlrev_b32 v7, 4, v7
  v_lshrrev_b32 v12, 5, v0
  v_lshlrev_b32 v12, 9, v12
  s_sub_u32 s59, s85, s84
  s_sub_u32 s60, s87, s59
  s_mov_b32 s59, 6
  s_mov_b32 s60, 6
  v_mad_u32_u24 v11, v12, s60, v7
  v_mad_u32_u24 v7, v12, s59, v7
  s_lshl_b32 s59, s54, 2
  v_mov_b32 v9, s59
  v_mov_b32 v8, 0x7ff00000
  v_cmp_eq_u32 vcc, 0, v0
  s_nop 1
  v_cndmask_b32 v8, v8, v9, vcc
  v_mov_b32 v9, 1
  s_mov_b32 s59, 2379776
  buffer_load_dwordx4 v[20:23], v1, s[8:11], s59 offen offset:0 sc1
  buffer_load_dwordx4 v[24:27], v1, s[8:11], s59 offen offset:256 sc1
  buffer_load_dwordx4 v[28:31], v1, s[8:11], s59 offen offset:512 sc1
  buffer_load_dwordx4 v[32:35], v1, s[8:11], s59 offen offset:768 sc1
  s_mov_b32 s16, s48
  s_mov_b32 s17, s49
  s_mov_b32 s18, 0x400000
  s_mov_b32 s19, 0x00020000
  s_lshl_b32 s66, s66, 13
  s_lshl_b32 s86, s86, 13
  s_mov_b32 s64, 0
  s_mov_b32 s80, 0
rf_273:
  s_lshr_b32 s60, s80, 1
  s_mul_i32 s60, s60, s87
  s_add_u32 s60, s60, s84
  s_mul_i32 s60, s60, 24
  s_lshr_b32 s60, s60, 6
  s_add_u32 s60, s60, 40
  s_lshl_b32 s60, s60, 9
  s_add_u32 s60, s60, 2260992
  buffer_load_dwordx4 v[16:19], v7, s[8:11], s60 offen sc1
  s_waitcnt vmcnt(0)
  v_and_b32 v16, v16, v17
  v_and_b32 v18, v18, v19
  v_and_b32 v16, v16, v18
  v_cmp_ne_u32 vcc, 1, v16
  s_nop 0
  s_cmp_eq_u32 vcc_lo, 0
  s_cbranch_scc1 rk_275
  s_sub_u32 s57, s57, 1
  s_cbranch_scc0 rf_273
  s_branch ABORT
rk_275:
  s_add_u32 s60, s80, 1
  s_lshr_b32 s60, s60, 1
  s_mul_i32 s60, s60, s87
  s_add_u32 s60, s60, s85
  s_mul_i32 s60, s60, 24
  s_lshr_b32 s60, s60, 6
  s_add_u32 s60, s60, 40
  s_lshl_b32 s60, s60, 9
  s_add_u32 s60, s60, 2260992
  buffer_load_dwordx4 v[16:19], v11, s[8:11], s60 offen sc1
  s_lshr_b32 s61, s80, 1
  s_mul_i32 s61, s61, s87
  s_add_u32 s61, s61, s84
  s_lshl_b32 s61, s61, 16
  s_add_u32 s61, s61, s66
  s_lshl_b32 s67, s61, 3
  s_add_u32 s67, s67, 134217728
  buffer_load_dwordx4 v[68:71], v6, s[8:11], s67 offen offset:0 sc1
  buffer_load_dwordx4 v[72:75], v6, s[8:11], s67 offen offset:1024 sc1
  buffer_load_dwordx4 v[76:79], v6, s[8:11], s67 offen offset:2048 sc1
  buffer_load_dwordx4 v[80:83], v6, s[8:11], s67 offen offset:3072 sc1
  s_add_u32 s67, s67, 16384
  buffer_load_dwordx4 v[84:87], v6, s[8:11], s67 offen offset:0 sc1
  buffer_load_dwordx4 v[88:91], v6, s[8:11], s67 offen offset:1024 sc1
  buffer_load_dwordx4 v[92:95], v6, s[8:11], s67 offen offset:2048 sc1
  buffer_load_dwordx4 v[96:99], v6, s[8:11], s67 offen offset:3072 sc1
  s_add_u32 s67, s67, 16384
  buffer_load_dwordx4 v[100:103], v6, s[8:11], s67 offen offset:0 sc1
  buffer_load_dwordx4 v[104:107], v6, s[8:11], s67 offen offset:1024 sc1
  buffer_load_dwordx4 v[108:111], v6, s[8:11], s67 offen offset:2048 sc1
  buffer_load_dwordx4 v[112:115], v6, s[8:11], s67 offen offset:3072 sc1
  s_add_u32 s67, s67, 16384
  buffer_load_dwordx4 v[116:119], v6, s[8:11], s67 offen offset:0 sc1
  buffer_load_dwordx4 v[120:123], v6, s[8:11], s67 offen offset:1024 sc1
  buffer_load_dwordx4 v[124:127], v6, s[8:11], s67 offen offset:2048 sc1
  buffer_load_dwordx4 v[128:131], v6, s[8:11], s67 offen offset:3072 sc1
  s_add_u32 s61, s61, 12582912
  buffer_load_dwordx4 v[196:199], v10, s[8:11], s61 offen offset:0 sc1
  buffer_load_dwordx4 v[200:203], v10, s[8:11], s61 offen offset:1024 sc1
  s_add_u32 s80, s80, 1
  s_mov_b32 s73, 0
  s_waitcnt vmcnt(0)
rt_271:
  v_and_b32 v16, v16, v17
  v_and_b32 v18, v18, v19
  v_and_b32 v16, v16, v18
  v_cmp_ne_u32 vcc, 1, v16
  s_mov_b32 s74, s80
  s_mov_b64 s[82:83], vcc
  v_pk_add_f32 v[68:69], v[68:69], v[84:85]
  v_pk_add_f32 v[70:71], v[70:71], v[86:87]
  v_pk_add_f32 v[72:73], v[72:73], v[88:89]
  v_pk_add_f32 v[74:75], v[74:75], v[90:91]
  v_pk_add_f32 v[76:77], v[76:77], v[92:93]
  v_pk_add_f32 v[78:79], v[78:79], v[94:95]
  v_pk_add_f32 v[80:81], v[80:81], v[96:97]
  v_pk_add_f32 v[82:83], v[82:83], v[98:99]
  v_pk_add_f32 v[100:101], v[100:101], v[116:117]
  v_pk_add_f32 v[102:103], v[102:103], v[118:119]
  v_pk_add_f32 v[104:105], v[104:105], v[120:121]
  v_pk_add_f32 v[106:107], v[106:107], v[122:123]
  v_pk_add_f32 v[108:109], v[108:109], v[124:125]
  v_pk_add_f32 v[110:111], v[110:111], v[126:127]
  v_pk_add_f32 v[112:113], v[112:113], v[128:129]
  v_pk_add_f32 v[114:115], v[114:115], v[130:131]
  v_pk_add_f32 v[228:229], v[68:69], v[100:101]
  v_pk_add_f32 v[230:231], v[70:71], v[102:103]
  v_pk_add_f32 v[232:233], v[72:73], v[104:105]
  v_pk_add_f32 v[234:235], v[74:75], v[106:107]
  v_pk_add_f32 v[236:237], v[76:77], v[108:109]
  v_pk_add_f32 v[238:239], v[78:79], v[110:111]
  v_pk_add_f32 v[240:241], v[80:81], v[112:113]
  v_pk_add_f32 v[242:243], v[82:83], v[114:115]
  v_lshlrev_b32 v212, 16, v196
  v_and_b32 v213, 0xffff0000, v196
  v_lshlrev_b32 v214, 16, v197
  v_and_b32 v215, 0xffff0000, v197
  v_lshlrev_b32 v216, 16, v198
  v_and_b32 v217, 0xffff0000, v198
  v_lshlrev_b32 v218, 16, v199
  v_and_b32 v219, 0xffff0000, v199
  v_lshlrev_b32 v220, 16, v200
  v_and_b32 v221, 0xffff0000, v200
  v_lshlrev_b32 v222, 16, v201
  v_and_b32 v223, 0xffff0000, v201
  v_lshlrev_b32 v224, 16, v202
  v_and_b32 v225, 0xffff0000, v202
  v_lshlrev_b32 v226, 16, v203
  v_and_b32 v227, 0xffff0000, v203
  s_add_u32 s60, s64, 2
  s_lshr_b32 s60, s60, 1
  s_mul_i32 s60, s60, s87
  s_add_u32 s60, s60, s84
  s_mul_i32 s60, s60, 24
  s_lshr_b32 s60, s60, 6
  s_add_u32 s60, s60, 40
  s_lshl_b32 s60, s60, 9
  s_add_u32 s60, s60, 2260992
  buffer_load_dwordx4 v[16:19], v7, s[8:11], s60 offen sc1
  s_lshr_b32 s68, s64, 1
  s_mul_i32 s68, s68, s87
  s_add_u32 s68, s68, s84
  s_lshl_b32 s68, s68, 16
  s_add_u32 s68, s68, s66
  s_sub_u32 s59, s80, s64
  s_cmp_eq_u32 s59, 1
  s_cbranch_scc0 ra_276
  s_cmp_lt_u32 s80, s88
  s_cselect_b32 s82, s82, 1
  s_cmp_eq_u32 s82, 0
  s_cbranch_scc0 rb_277
  s_lshr_b32 s61, s80, 1
  s_mul_i32 s61, s61, s87
  s_add_u32 s61, s61, s85
  s_lshl_b32 s61, s61, 16
  s_add_u32 s61, s61, s86
  s_lshl_b32 s67, s61, 3
  s_add_u32 s67, s67, 134217728
  buffer_load_dwordx4 v[132:135], v6, s[8:11], s67 offen offset:0 sc1
  buffer_load_dwordx4 v[136:139], v6, s[8:11], s67 offen offset:1024 sc1
  buffer_load_dwordx4 v[140:143], v6, s[8:11], s67 offen offset:2048 sc1
  buffer_load_dwordx4 v[144:147], v6, s[8:11], s67 offen offset:3072 sc1
  s_add_u32 s67, s67, 16384
  buffer_load_dwordx4 v[148:151], v6, s[8:11], s67 offen offset:0 sc1
  buffer_load_dwordx4 v[152:155], v6, s[8:11], s67 offen offset:1024 sc1
  buffer_load_dwordx4 v[156:159], v6, s[8:11], s67 offen offset:2048 sc1
  buffer_load_dwordx4 v[160:163], v6, s[8:11], s67 offen offset:3072 sc1
  s_add_u32 s67, s67, 16384
  buffer_load_dwordx4 v[164:167], v6, s[8:11], s67 offen offset:0 sc1
  buffer_load_dwordx4 v[168:171], v6, s[8:11], s67 offen offset:1024 sc1
  buffer_load_dwordx4 v[172:175], v6, s[8:11], s67 offen offset:2048 sc1
  buffer_load_dwordx4 v[176:179], v6, s[8:11], s67 offen offset:3072 sc1
  s_add_u32 s67, s67, 16384
  buffer_load_dwordx4 v[180:183], v6, s[8:11], s67 offen offset:0 sc1
  buffer_load_dwordx4 v[184:187], v6, s[8:11], s67 offen offset:1024 sc1
  buffer_load_dwordx4 v[188:191], v6, s[8:11], s67 offen offset:2048 sc1
  buffer_load_dwordx4 v[192:195], v6, s[8:11], s67 offen offset:3072 sc1
  s_add_u32 s61, s61, 12582912
  buffer_load_dwordx4 v[204:207], v10, s[8:11], s61 offen offset:0 sc1
  buffer_load_dwordx4 v[208:211], v10, s[8:11], s61 offen offset:1024 sc1
  s_add_u32 s80, s80, 1
ra_276:
  s_cmp_lt_u32 s80, s88
  s_cselect_b32 s83, s83, 1
  s_cmp_eq_u32 s83, 0
  s_cbranch_scc0 rb_277
  s_lshr_b32 s61, s80, 1
  s_mul_i32 s61, s61, s87
  s_add_u32 s61, s61, s84
  s_lshl_b32 s61, s61, 16
  s_add_u32 s61, s61, s66
  s_lshl_b32 s67, s61, 3
  s_add_u32 s67, s67, 134217728
  buffer_load_dwordx4 v[68:71], v6, s[8:11], s67 offen offset:0 sc1
  buffer_load_dwordx4 v[72:75], v6, s[8:11], s67 offen offset:1024 sc1
  buffer_load_dwordx4 v[76:79], v6, s[8:11], s67 offen offset:2048 sc1
  buffer_load_dwordx4 v[80:83], v6, s[8:11], s67 offen offset:3072 sc1
  s_add_u32 s67, s67, 16384
  buffer_load_dwordx4 v[84:87], v6, s[8:11], s67 offen offset:0 sc1
  buffer_load_dwordx4 v[88:91], v6, s[8:11], s67 offen offset:1024 sc1
  buffer_load_dwordx4 v[92:95], v6, s[8:11], s67 offen offset:2048 sc1
  buffer_load_dwordx4 v[96:99], v6, s[8:11], s67 offen offset:3072 sc1
  s_add_u32 s67, s67, 16384
  buffer_load_dwordx4 v[100:103], v6, s[8:11], s67 offen offset:0 sc1
  buffer_load_dwordx4 v[104:107], v6, s[8:11], s67 offen offset:1024 sc1
  buffer_load_dwordx4 v[108:111], v6, s[8:11], s67 offen offset:2048 sc1
  buffer_load_dwordx4 v[112:115], v6, s[8:11], s67 offen offset:3072 sc1
  s_add_u32 s67, s67, 16384
  buffer_load_dwordx4 v[116:119], v6, s[8:11], s67 offen offset:0 sc1
  buffer_load_dwordx4 v[120:123], v6, s[8:11], s67 offen offset:1024 sc1
  buffer_load_dwordx4 v[124:127], v6, s[8:11], s67 offen offset:2048 sc1
  buffer_load_dwordx4 v[128:131], v6, s[8:11], s67 offen offset:3072 sc1
  s_add_u32 s61, s61, 12582912
  buffer_load_dwordx4 v[196:199], v10, s[8:11], s61 offen offset:0 sc1
  buffer_load_dwordx4 v[200:203], v10, s[8:11], s61 offen offset:1024 sc1
  s_add_u32 s80, s80, 1
rb_277:
  v_cvt_pk_bf16_f32 v12, v228, v229
  v_lshlrev_b32 v228, 16, v12
  v_and_b32 v229, 0xffff0000, v12
  v_cvt_pk_bf16_f32 v13, v230, v231
  v_lshlrev_b32 v230, 16, v13
  v_and_b32 v231, 0xffff0000, v13
  v_cvt_pk_bf16_f32 v14, v232, v233
  v_lshlrev_b32 v232, 16, v14
  v_and_b32 v233, 0xffff0000, v14
  v_cvt_pk_bf16_f32 v15, v234, v235
  v_lshlrev_b32 v234, 16, v15
  v_and_b32 v235, 0xffff0000, v15
  v_cvt_pk_bf16_f32 v12, v236, v237
  v_lshlrev_b32 v236, 16, v12
  v_and_b32 v237, 0xffff0000, v12
  v_cvt_pk_bf16_f32 v13, v238, v239
  v_lshlrev_b32 v238, 16, v13
  v_and_b32 v239, 0xffff0000, v13
  v_cvt_pk_bf16_f32 v14, v240, v241
  v_lshlrev_b32 v240, 16, v14
  v_and_b32 v241, 0xffff0000, v14
  v_cvt_pk_bf16_f32 v15, v242, v243
  v_lshlrev_b32 v242, 16, v15
  v_and_b32 v243, 0xffff0000, v15
  v_pk_mul_f32 v[228:229], v[228:229], v[20:21]
  v_pk_mul_f32 v[230:231], v[230:231], v[22:23]
  v_pk_mul_f32 v[232:233], v[232:233], v[24:25]
  v_pk_mul_f32 v[234:235], v[234:235], v[26:27]
  v_pk_mul_f32 v[236:237], v[236:237], v[28:29]
  v_pk_mul_f32 v[238:239], v[238:239], v[30:31]
  v_pk_mul_f32 v[240:241], v[240:241], v[32:33]
  v_pk_mul_f32 v[242:243], v[242:243], v[34:35]
  v_cvt_pk_bf16_f32 v12, v228, v229
  v_lshlrev_b32 v228, 16, v12
  v_and_b32 v229, 0xffff0000, v12
  v_cvt_pk_bf16_f32 v13, v230, v231
  v_lshlrev_b32 v230, 16, v13
  v_and_b32 v231, 0xffff0000, v13
  v_cvt_pk_bf16_f32 v14, v232, v233
  v_lshlrev_b32 v232, 16, v14
  v_and_b32 v233, 0xffff0000, v14
  v_cvt_pk_bf16_f32 v15, v234, v235
  v_lshlrev_b32 v234, 16, v15
  v_and_b32 v235, 0xffff0000, v15
  v_cvt_pk_bf16_f32 v12, v236, v237
  v_lshlrev_b32 v236, 16, v12
  v_and_b32 v237, 0xffff0000, v12
  v_cvt_pk_bf16_f32 v13, v238, v239
  v_lshlrev_b32 v238, 16, v13
  v_and_b32 v239, 0xffff0000, v13
  v_cvt_pk_bf16_f32 v14, v240, v241
  v_lshlrev_b32 v240, 16, v14
  v_and_b32 v241, 0xffff0000, v14
  v_cvt_pk_bf16_f32 v15, v242, v243
  v_lshlrev_b32 v242, 16, v15
  v_and_b32 v243, 0xffff0000, v15
  v_pk_add_f32 v[212:213], v[212:213], v[228:229]
  v_pk_add_f32 v[214:215], v[214:215], v[230:231]
  v_pk_add_f32 v[216:217], v[216:217], v[232:233]
  v_pk_add_f32 v[218:219], v[218:219], v[234:235]
  v_pk_add_f32 v[220:221], v[220:221], v[236:237]
  v_pk_add_f32 v[222:223], v[222:223], v[238:239]
  v_pk_add_f32 v[224:225], v[224:225], v[240:241]
  v_pk_add_f32 v[226:227], v[226:227], v[242:243]
  v_cvt_pk_bf16_f32 v248, v212, v213
  v_cvt_pk_bf16_f32 v249, v214, v215
  v_cvt_pk_bf16_f32 v250, v216, v217
  v_cvt_pk_bf16_f32 v251, v218, v219
  v_cvt_pk_bf16_f32 v252, v220, v221
  v_cvt_pk_bf16_f32 v253, v222, v223
  v_cvt_pk_bf16_f32 v254, v224, v225
  v_cvt_pk_bf16_f32 v255, v226, v227
  buffer_store_dwordx2 v[248:249], v3, s[16:19], s68 offen offset:0
  buffer_store_dwordx2 v[250:251], v3, s[16:19], s68 offen offset:128
  buffer_store_dwordx2 v[252:253], v3, s[16:19], s68 offen offset:256
  buffer_store_dwordx2 v[254:255], v3, s[16:19], s68 offen offset:384
  s_sub_u32 s59, s80, s64
  s_add_u32 s64, s64, 1
  s_cmp_eq_u32 s59, 1
  s_cbranch_scc1 rb_278
  s_add_u32 s73, s73, 1
  s_cmp_eq_u32 s59, 3
  s_cbranch_scc1 rd_279
  s_waitcnt vmcnt(4)
  s_branch rt_272
rd_279:
  s_waitcnt vmcnt(22)
  s_branch rt_272
rb_278:
  s_cmp_lt_u32 s64, s88
  s_cbranch_scc0 DONE
rf_274:
  s_lshr_b32 s60, s80, 1
  s_mul_i32 s60, s60, s87
  s_add_u32 s60, s60, s85
  s_mul_i32 s60, s60, 24
  s_lshr_b32 s60, s60, 6
  s_add_u32 s60, s60, 40
  s_lshl_b32 s60, s60, 9
  s_add_u32 s60, s60, 2260992
  buffer_load_dwordx4 v[16:19], v11, s[8:11], s60 offen sc1
  s_waitcnt vmcnt(0)
  v_and_b32 v16, v16, v17
  v_and_b32 v18, v18, v19
  v_and_b32 v16, v16, v18
  v_cmp_ne_u32 vcc, 1, v16
  s_nop 0
  s_cmp_eq_u32 vcc_lo, 0
  s_cbranch_scc1 rk_280
  s_sub_u32 s57, s57, 1
  s_cbranch_scc0 rf_274
  s_branch ABORT
rk_280:
  s_add_u32 s60, s80, 1
  s_lshr_b32 s60, s60, 1
  s_mul_i32 s60, s60, s87
  s_add_u32 s60, s60, s84
  s_mul_i32 s60, s60, 24
  s_lshr_b32 s60, s60, 6
  s_add_u32 s60, s60, 40
  s_lshl_b32 s60, s60, 9
  s_add_u32 s60, s60, 2260992
  buffer_load_dwordx4 v[16:19], v7, s[8:11], s60 offen sc1
  s_lshr_b32 s61, s80, 1
  s_mul_i32 s61, s61, s87
  s_add_u32 s61, s61, s85
  s_lshl_b32 s61, s61, 16
  s_add_u32 s61, s61, s86
  s_lshl_b32 s67, s61, 3
  s_add_u32 s67, s67, 134217728
  buffer_load_dwordx4 v[132:135], v6, s[8:11], s67 offen offset:0 sc1
  buffer_load_dwordx4 v[136:139], v6, s[8:11], s67 offen offset:1024 sc1
  buffer_load_dwordx4 v[140:143], v6, s[8:11], s67 offen offset:2048 sc1
  buffer_load_dwordx4 v[144:147], v6, s[8:11], s67 offen offset:3072 sc1
  s_add_u32 s67, s67, 16384
  buffer_load_dwordx4 v[148:151], v6, s[8:11], s67 offen offset:0 sc1
  buffer_load_dwordx4 v[152:155], v6, s[8:11], s67 offen offset:1024 sc1
  buffer_load_dwordx4 v[156:159], v6, s[8:11], s67 offen offset:2048 sc1
  buffer_load_dwordx4 v[160:163], v6, s[8:11], s67 offen offset:3072 sc1
  s_add_u32 s67, s67, 16384
  buffer_load_dwordx4 v[164:167], v6, s[8:11], s67 offen offset:0 sc1
  buffer_load_dwordx4 v[168:171], v6, s[8:11], s67 offen offset:1024 sc1
  buffer_load_dwordx4 v[172:175], v6, s[8:11], s67 offen offset:2048 sc1
  buffer_load_dwordx4 v[176:179], v6, s[8:11], s67 offen offset:3072 sc1
  s_add_u32 s67, s67, 16384
  buffer_load_dwordx4 v[180:183], v6, s[8:11], s67 offen offset:0 sc1
  buffer_load_dwordx4 v[184:187], v6, s[8:11], s67 offen offset:1024 sc1
  buffer_load_dwordx4 v[188:191], v6, s[8:11], s67 offen offset:2048 sc1
  buffer_load_dwordx4 v[192:195], v6, s[8:11], s67 offen offset:3072 sc1
  s_add_u32 s61, s61, 12582912
  buffer_load_dwordx4 v[204:207], v10, s[8:11], s61 offen offset:0 sc1
  buffer_load_dwordx4 v[208:211], v10, s[8:11], s61 offen offset:1024 sc1
  s_add_u32 s80, s80, 1
  s_mov_b32 s73, 0
  s_waitcnt vmcnt(0)
rt_272:
  v_and_b32 v16, v16, v17
  v_and_b32 v18, v18, v19
  v_and_b32 v16, v16, v18
  v_cmp_ne_u32 vcc, 1, v16
  s_mov_b32 s74, s80
  s_mov_b64 s[82:83], vcc
  v_pk_add_f32 v[132:133], v[132:133], v[148:149]
  v_pk_add_f32 v[134:135], v[134:135], v[150:151]
  v_pk_add_f32 v[136:137], v[136:137], v[152:153]
  v_pk_add_f32 v[138:139], v[138:139], v[154:155]
  v_pk_add_f32 v[140:141], v[140:141], v[156:157]
  v_pk_add_f32 v[142:143], v[142:143], v[158:159]
  v_pk_add_f32 v[144:145], v[144:145], v[160:161]
  v_pk_add_f32 v[146:147], v[146:147], v[162:163]
  v_pk_add_f32 v[164:165], v[164:165], v[180:181]
  v_pk_add_f32 v[166:167], v[166:167], v[182:183]
  v_pk_add_f32 v[168:169], v[168:169], v[184:185]
  v_pk_add_f32 v[170:171], v[170:171], v[186:187]
  v_pk_add_f32 v[172:173], v[172:173], v[188:189]
  v_pk_add_f32 v[174:175], v[174:175], v[190:191]
  v_pk_add_f32 v[176:177], v[176:177], v[192:193]
  v_pk_add_f32 v[178:179], v[178:179], v[194:195]
  v_pk_add_f32 v[228:229], v[132:133], v[164:165]
  v_pk_add_f32 v[230:231], v[134:135], v[166:167]
  v_pk_add_f32 v[232:233], v[136:137], v[168:169]
  v_pk_add_f32 v[234:235], v[138:139], v[170:171]
  v_pk_add_f32 v[236:237], v[140:141], v[172:173]
  v_pk_add_f32 v[238:239], v[142:143], v[174:175]
  v_pk_add_f32 v[240:241], v[144:145], v[176:177]
  v_pk_add_f32 v[242:243], v[146:147], v[178:179]
  v_lshlrev_b32 v212, 16, v204
  v_and_b32 v213, 0xffff0000, v204
  v_lshlrev_b32 v214, 16, v205
  v_and_b32 v215, 0xffff0000, v205
  v_lshlrev_b32 v216, 16, v206
  v_and_b32 v217, 0xffff0000, v206
  v_lshlrev_b32 v218, 16, v207
  v_and_b32 v219, 0xffff0000, v207
  v_lshlrev_b32 v220, 16, v208
  v_and_b32 v221, 0xffff0000, v208
  v_lshlrev_b32 v222, 16, v209
  v_and_b32 v223, 0xffff0000, v209
  v_lshlrev_b32 v224, 16, v210
  v_and_b32 v225, 0xffff0000, v210
  v_lshlrev_b32 v226, 16, v211
  v_and_b32 v227, 0xffff0000, v211
  s_add_u32 s60, s64, 2
  s_lshr_b32 s60, s60, 1
  s_mul_i32 s60, s60, s87
  s_add_u32 s60, s60, s85
  s_mul_i32 s60, s60, 24
  s_lshr_b32 s60, s60, 6
  s_add_u32 s60, s60, 40
  s_lshl_b32 s60, s60, 9
  s_add_u32 s60, s60, 2260992
  buffer_load_dwordx4 v[16:19], v11, s[8:11], s60 offen sc1
  s_lshr_b32 s68, s64, 1
  s_mul_i32 s68, s68, s87
  s_add_u32 s68, s68, s85
  s_lshl_b32 s68, s68, 16
  s_add_u32 s68, s68, s86
  s_sub_u32 s59, s80, s64
  s_cmp_eq_u32 s59, 1
  s_cbranch_scc0 ra_281
  s_cmp_lt_u32 s80, s88
  s_cselect_b32 s82, s82, 1
  s_cmp_eq_u32 s82, 0
  s_cbranch_scc0 rb_282
  s_lshr_b32 s61, s80, 1
  s_mul_i32 s61, s61, s87
  s_add_u32 s61, s61, s84
  s_lshl_b32 s61, s61, 16
  s_add_u32 s61, s61, s66
  s_lshl_b32 s67, s61, 3
  s_add_u32 s67, s67, 134217728
  buffer_load_dwordx4 v[68:71], v6, s[8:11], s67 offen offset:0 sc1
  buffer_load_dwordx4 v[72:75], v6, s[8:11], s67 offen offset:1024 sc1
  buffer_load_dwordx4 v[76:79], v6, s[8:11], s67 offen offset:2048 sc1
  buffer_load_dwordx4 v[80:83], v6, s[8:11], s67 offen offset:3072 sc1
  s_add_u32 s67, s67, 16384
  buffer_load_dwordx4 v[84:87], v6, s[8:11], s67 offen offset:0 sc1
  buffer_load_dwordx4 v[88:91], v6, s[8:11], s67 offen offset:1024 sc1
  buffer_load_dwordx4 v[92:95], v6, s[8:11], s67 offen offset:2048 sc1
  buffer_load_dwordx4 v[96:99], v6, s[8:11], s67 offen offset:3072 sc1
  s_add_u32 s67, s67, 16384
  buffer_load_dwordx4 v[100:103], v6, s[8:11], s67 offen offset:0 sc1
  buffer_load_dwordx4 v[104:107], v6, s[8:11], s67 offen offset:1024 sc1
  buffer_load_dwordx4 v[108:111], v6, s[8:11], s67 offen offset:2048 sc1
  buffer_load_dwordx4 v[112:115], v6, s[8:11], s67 offen offset:3072 sc1
  s_add_u32 s67, s67, 16384
  buffer_load_dwordx4 v[116:119], v6, s[8:11], s67 offen offset:0 sc1
  buffer_load_dwordx4 v[120:123], v6, s[8:11], s67 offen offset:1024 sc1
  buffer_load_dwordx4 v[124:127], v6, s[8:11], s67 offen offset:2048 sc1
  buffer_load_dwordx4 v[128:131], v6, s[8:11], s67 offen offset:3072 sc1
  s_add_u32 s61, s61, 12582912
  buffer_load_dwordx4 v[196:199], v10, s[8:11], s61 offen offset:0 sc1
  buffer_load_dwordx4 v[200:203], v10, s[8:11], s61 offen offset:1024 sc1
  s_add_u32 s80, s80, 1
ra_281:
  s_cmp_lt_u32 s80, s88
  s_cselect_b32 s83, s83, 1
  s_cmp_eq_u32 s83, 0
  s_cbranch_scc0 rb_282
  s_lshr_b32 s61, s80, 1
  s_mul_i32 s61, s61, s87
  s_add_u32 s61, s61, s85
  s_lshl_b32 s61, s61, 16
  s_add_u32 s61, s61, s86
  s_lshl_b32 s67, s61, 3
  s_add_u32 s67, s67, 134217728
  buffer_load_dwordx4 v[132:135], v6, s[8:11], s67 offen offset:0 sc1
  buffer_load_dwordx4 v[136:139], v6, s[8:11], s67 offen offset:1024 sc1
  buffer_load_dwordx4 v[140:143], v6, s[8:11], s67 offen offset:2048 sc1
  buffer_load_dwordx4 v[144:147], v6, s[8:11], s67 offen offset:3072 sc1
  s_add_u32 s67, s67, 16384
  buffer_load_dwordx4 v[148:151], v6, s[8:11], s67 offen offset:0 sc1
  buffer_load_dwordx4 v[152:155], v6, s[8:11], s67 offen offset:1024 sc1
  buffer_load_dwordx4 v[156:159], v6, s[8:11], s67 offen offset:2048 sc1
  buffer_load_dwordx4 v[160:163], v6, s[8:11], s67 offen offset:3072 sc1
  s_add_u32 s67, s67, 16384
  buffer_load_dwordx4 v[164:167], v6, s[8:11], s67 offen offset:0 sc1
  buffer_load_dwordx4 v[168:171], v6, s[8:11], s67 offen offset:1024 sc1
  buffer_load_dwordx4 v[172:175], v6, s[8:11], s67 offen offset:2048 sc1
  buffer_load_dwordx4 v[176:179], v6, s[8:11], s67 offen offset:3072 sc1
  s_add_u32 s67, s67, 16384
  buffer_load_dwordx4 v[180:183], v6, s[8:11], s67 offen offset:0 sc1
  buffer_load_dwordx4 v[184:187], v6, s[8:11], s67 offen offset:1024 sc1
  buffer_load_dwordx4 v[188:191], v6, s[8:11], s67 offen offset:2048 sc1
  buffer_load_dwordx4 v[192:195], v6, s[8:11], s67 offen offset:3072 sc1
  s_add_u32 s61, s61, 12582912
  buffer_load_dwordx4 v[204:207], v10, s[8:11], s61 offen offset:0 sc1
  buffer_load_dwordx4 v[208:211], v10, s[8:11], s61 offen offset:1024 sc1
  s_add_u32 s80, s80, 1
rb_282:
  v_cvt_pk_bf16_f32 v12, v228, v229
  v_lshlrev_b32 v228, 16, v12
  v_and_b32 v229, 0xffff0000, v12
  v_cvt_pk_bf16_f32 v13, v230, v231
  v_lshlrev_b32 v230, 16, v13
  v_and_b32 v231, 0xffff0000, v13
  v_cvt_pk_bf16_f32 v14, v232, v233
  v_lshlrev_b32 v232, 16, v14
  v_and_b32 v233, 0xffff0000, v14
  v_cvt_pk_bf16_f32 v15, v234, v235
  v_lshlrev_b32 v234, 16, v15
  v_and_b32 v235, 0xffff0000, v15
  v_cvt_pk_bf16_f32 v12, v236, v237
  v_lshlrev_b32 v236, 16, v12
  v_and_b32 v237, 0xffff0000, v12
  v_cvt_pk_bf16_f32 v13, v238, v239
  v_lshlrev_b32 v238, 16, v13
  v_and_b32 v239, 0xffff0000, v13
  v_cvt_pk_bf16_f32 v14, v240, v241
  v_lshlrev_b32 v240, 16, v14
  v_and_b32 v241, 0xffff0000, v14
  v_cvt_pk_bf16_f32 v15, v242, v243
  v_lshlrev_b32 v242, 16, v15
  v_and_b32 v243, 0xffff0000, v15
  v_pk_mul_f32 v[228:229], v[228:229], v[20:21]
  v_pk_mul_f32 v[230:231], v[230:231], v[22:23]
  v_pk_mul_f32 v[232:233], v[232:233], v[24:25]
  v_pk_mul_f32 v[234:235], v[234:235], v[26:27]
  v_pk_mul_f32 v[236:237], v[236:237], v[28:29]
  v_pk_mul_f32 v[238:239], v[238:239], v[30:31]
  v_pk_mul_f32 v[240:241], v[240:241], v[32:33]
  v_pk_mul_f32 v[242:243], v[242:243], v[34:35]
  v_cvt_pk_bf16_f32 v12, v228, v229
  v_lshlrev_b32 v228, 16, v12
  v_and_b32 v229, 0xffff0000, v12
  v_cvt_pk_bf16_f32 v13, v230, v231
  v_lshlrev_b32 v230, 16, v13
  v_and_b32 v231, 0xffff0000, v13
  v_cvt_pk_bf16_f32 v14, v232, v233
  v_lshlrev_b32 v232, 16, v14
  v_and_b32 v233, 0xffff0000, v14
  v_cvt_pk_bf16_f32 v15, v234, v235
  v_lshlrev_b32 v234, 16, v15
  v_and_b32 v235, 0xffff0000, v15
  v_cvt_pk_bf16_f32 v12, v236, v237
  v_lshlrev_b32 v236, 16, v12
  v_and_b32 v237, 0xffff0000, v12
  v_cvt_pk_bf16_f32 v13, v238, v239
  v_lshlrev_b32 v238, 16, v13
  v_and_b32 v239, 0xffff0000, v13
  v_cvt_pk_bf16_f32 v14, v240, v241
  v_lshlrev_b32 v240, 16, v14
  v_and_b32 v241, 0xffff0000, v14
  v_cvt_pk_bf16_f32 v15, v242, v243
  v_lshlrev_b32 v242, 16, v15
  v_and_b32 v243, 0xffff0000, v15
  v_pk_add_f32 v[212:213], v[212:213], v[228:229]
  v_pk_add_f32 v[214:215], v[214:215], v[230:231]
  v_pk_add_f32 v[216:217], v[216:217], v[232:233]
  v_pk_add_f32 v[218:219], v[218:219], v[234:235]
  v_pk_add_f32 v[220:221], v[220:221], v[236:237]
  v_pk_add_f32 v[222:223], v[222:223], v[238:239]
  v_pk_add_f32 v[224:225], v[224:225], v[240:241]
  v_pk_add_f32 v[226:227], v[226:227], v[242:243]
  v_cvt_pk_bf16_f32 v248, v212, v213
  v_cvt_pk_bf16_f32 v249, v214, v215
  v_cvt_pk_bf16_f32 v250, v216, v217
  v_cvt_pk_bf16_f32 v251, v218, v219
  v_cvt_pk_bf16_f32 v252, v220, v221
  v_cvt_pk_bf16_f32 v253, v222, v223
  v_cvt_pk_bf16_f32 v254, v224, v225
  v_cvt_pk_bf16_f32 v255, v226, v227
  buffer_store_dwordx2 v[248:249], v3, s[16:19], s68 offen offset:0
  buffer_store_dwordx2 v[250:251], v3, s[16:19], s68 offen offset:128
  buffer_store_dwordx2 v[252:253], v3, s[16:19], s68 offen offset:256
  buffer_store_dwordx2 v[254:255], v3, s[16:19], s68 offen offset:384
  s_sub_u32 s59, s80, s64
  s_add_u32 s64, s64, 1
  s_cmp_eq_u32 s59, 1
  s_cbranch_scc1 rb_283
  s_add_u32 s73, s73, 1
  s_cmp_eq_u32 s59, 3
  s_cbranch_scc1 rd_284
  s_waitcnt vmcnt(4)
  s_branch rt_271
rd_284:
  s_waitcnt vmcnt(22)
  s_branch rt_271
rb_283:
  s_cmp_lt_u32 s64, s88
  s_cbranch_scc0 DONE
  s_branch rf_273
JMISC:
  s_cmp_lt_u32 s60, 4
  s_cselect_b32 s18, 64, 8
  s_lshl_b32 s60, s60, 2
  s_add_u32 s60, s60, s54
  s_lshr_b32 s64, s60, 3
  s_and_b32 s60, s60, 7
  s_lshl_b32 s65, s79, 3
  s_add_u32 s65, s65, s60
  s_lshl_b32 s59, s65, 13
  v_lshl_add_u32 v1, v0, 4, s59
  v_lshrrev_b32 v8, 5, v0
  v_and_b32 v9, 7, v0
  s_lshl_b32 s59, s65, 11
  v_lshl_add_u32 v2, v8, 7, s59
  v_lshl_add_u32 v2, v9, 4, v2
  v_lshl_add_u32 v3, v0, 3, s59
  s_lshl_b32 s59, s65, 4
  v_mov_b32 v5, s59
  v_min_u32 v4, 2, v0
  v_lshl_add_u32 v4, v4, 9, s59
  v_and_b32 v9, 31, v0
  v_lshlrev_b32 v8, 2, v8
  v_sub_u32 v8, v9, v8
  s_and_b32 s59, s65, 7
  s_lshl_b32 s59, s59, 2
  s_lshl_b32 s60, s79, 11
  s_add_u32 s59, s59, s60
  v_mov_b32 v7, s59
  s_mov_b32 s58, 0
  s_mov_b32 s3, s72
  v_mov_b32 v6, 0x7ff00000
  v_cmp_eq_u32 vcc, 0, v0
  s_nop 1
  v_cndmask_b32 v6, v6, v7, vcc
  v_mov_b32 v7, 1
  s_mov_b32 s66, 0x3db504f3
  s_mov_b32 s67, 0x3db504f3
  v_cmp_gt_i32 s[68:69], 0, v8
  v_cmp_gt_i32 s[70:71], 1, v8
  v_cmp_gt_i32 s[72:73], 2, v8
  v_cmp_gt_i32 s[74:75], 3, v8
  v_cmp_gt_i32 s[76:77], 8, v8
  v_cmp_gt_i32 s[78:79], 9, v8
  v_cmp_gt_i32 s[80:81], 10, v8
  v_cmp_gt_i32 s[82:83], 11, v8
  v_cmp_gt_i32 s[84:85], 16, v8
  v_cmp_gt_i32 s[86:87], 17, v8
  v_cmp_gt_i32 s[88:89], 18, v8
  v_cmp_gt_i32 s[90:91], 19, v8
  v_cmp_gt_i32 s[92:93], 24, v8
  v_cmp_gt_i32 s[94:95], 25, v8
  v_cmp_gt_i32 s[96:97], 26, v8
  v_cmp_gt_i32 s[98:99], 27, v8
  s_mul_i32 s60, s64, 1536
  s_add_u32 s60, s60, 2097152
  s_cmp_lt_u32 s64, 8
  s_cselect_b32 s59, 4, 2
  s_add_u32 s16, s64, s59
  s_cmp_lt_u32 s16, 8
  s_cselect_b32 s59, 4, 2
  s_add_u32 s17, s16, s59
pl_285:
  buffer_load_dwordx4 v[16:19], v4, s[8:11], s60 offen sc1
  s_waitcnt vmcnt(0)
  v_and_b32 v16, v16, v17
  v_and_b32 v18, v18, v19
  v_and_b32 v16, v16, v18
  v_cmp_ne_u32 vcc, 1, v16
  s_cbranch_vccz pk_286
  s_sub_u32 s57, s57, 1
  s_cbranch_scc0 pl_285
  s_branch ABORT
pk_286:
  s_cmp_lt_u32 s64, s18
  s_cselect_b32 s62, s64, s64
  s_cselect_b32 s59, 0, 0x7ff00000
  v_add_u32 v13, s59, v1
  s_lshl_b32 s62, s62, 18
  s_add_u32 s59, s62, 167772160
  buffer_load_dwordx4 a[0:3], v13, s[8:11], s59 offen offset:0 sc1
  buffer_load_dwordx4 a[4:7], v13, s[8:11], s59 offen offset:1024 sc1
  buffer_load_dwordx4 a[8:11], v13, s[8:11], s59 offen offset:2048 sc1
  buffer_load_dwordx4 a[12:15], v13, s[8:11], s59 offen offset:3072 sc1
  s_add_u32 s59, s62, 167776256
  buffer_load_dwordx4 a[16:19], v13, s[8:11], s59 offen offset:0 sc1
  buffer_load_dwordx4 a[20:23], v13, s[8:11], s59 offen offset:1024 sc1
  buffer_load_dwordx4 a[24:27], v13, s[8:11], s59 offen offset:2048 sc1
  buffer_load_dwordx4 a[28:31], v13, s[8:11], s59 offen offset:3072 sc1
  s_add_u32 s59, s62, 16777216
  buffer_load_dwordx4 a[32:35], v13, s[8:11], s59 offen offset:0 sc1
  buffer_load_dwordx4 a[36:39], v13, s[8:11], s59 offen offset:1024 sc1
  buffer_load_dwordx4 a[40:43], v13, s[8:11], s59 offen offset:2048 sc1
  buffer_load_dwordx4 a[44:47], v13, s[8:11], s59 offen offset:3072 sc1
  s_add_u32 s59, s62, 16781312
  buffer_load_dwordx4 a[48:51], v13, s[8:11], s59 offen offset:0 sc1
  buffer_load_dwordx4 a[52:55], v13, s[8:11], s59 offen offset:1024 sc1
  buffer_load_dwordx4 a[56:59], v13, s[8:11], s59 offen offset:2048 sc1
  buffer_load_dwordx4 a[60:63], v13, s[8:11], s59 offen offset:3072 sc1
  s_add_u32 s59, s62, 33554432
  buffer_load_dwordx4 a[64:67], v13, s[8:11], s59 offen offset:0 sc1
  buffer_load_dwordx4 a[68:71], v13, s[8:11], s59 offen offset:1024 sc1
  buffer_load_dwordx4 a[72:75], v13, s[8:11], s59 offen offset:2048 sc1
  buffer_load_dwordx4 a[76:79], v13, s[8:11], s59 offen offset:3072 sc1
  s_add_u32 s59, s62, 33558528
  buffer_load_dwordx4 a[80:83], v13, s[8:11], s59 offen offset:0 sc1
  buffer_load_dwordx4 a[84:87], v13, s[8:11], s59 offen offset:1024 sc1
  buffer_load_dwordx4 a[88:91], v13, s[8:11], s59 offen offset:2048 sc1
  buffer_load_dwordx4 a[92:95], v13, s[8:11], s59 offen offset:3072 sc1
  s_mul_i32 s59, s16, 1536
  s_add_u32 s59, s59, 2097152
  buffer_load_dwordx4 v[16:19], v4, s[8:11], s59 offen sc1
  s_lshl_b32 s59, s64, 9
  s_add_u32 s59, s59, 2195456
  buffer_load_dwordx4 v[96:99], v5, s[8:11], s59 offen sc1
  s_waitcnt vmcnt(0)
al_287:
  v_mfma_f32_32x32x16_bf16 v[168:183], a[32:35], a[0:3], 0
  v_mfma_f32_32x32x16_bf16 v[168:183], a[36:39], a[4:7], v[168:183]
  v_mfma_f32_32x32x16_bf16 v[168:183], a[40:43], a[8:11], v[168:183]
  v_mfma_f32_32x32x16_bf16 v[168:183], a[44:47], a[12:15], v[168:183]
  v_mfma_f32_32x32x16_bf16 v[168:183], a[48:51], a[16:19], v[168:183]
  v_mfma_f32_32x32x16_bf16 v[168:183], a[52:55], a[20:23], v[168:183]
  v_mfma_f32_32x32x16_bf16 v[168:183], a[56:59], a[24:27], v[168:183]
  v_mfma_f32_32x32x16_bf16 v[168:183], a[60:63], a[28:31], v[168:183]
  v_and_b32 v96, v96, v97
  v_and_b32 v98, v98, v99
  v_and_b32 v96, v96, v98
  v_cmp_ne_u32 vcc, 1, v96
  s_mov_b32 s101, 0
  s_cbranch_vccz a1_288
  s_mov_b32 s101, 0x7ff00000
  s_waitcnt vmcnt(0)
  s_cmp_eq_u32 s58, 0
  s_cbranch_scc1 of_290
  s_mov_b32 s58, 0
  s_cmp_eq_u32 s3, 0
  s_cbranch_scc0 bm_291
  buffer_store_dword v7, v6, s[8:11], s100 offen
  s_branch bn_292
bm_291:
  buffer_store_dword v7, v6, s[8:11], s100 offen sc1
bn_292:
of_290:
  s_lshl_b32 s60, s64, 9
  s_add_u32 s60, s60, 2195456
pl_293:
  buffer_load_dwordx4 v[96:99], v5, s[8:11], s60 offen sc1
  s_waitcnt vmcnt(0)
  v_and_b32 v96, v96, v97
  v_and_b32 v98, v98, v99
  v_and_b32 v96, v96, v98
  v_cmp_ne_u32 vcc, 1, v96
  s_cbranch_vccz pk_294
  s_sub_u32 s57, s57, 1
  s_cbranch_scc0 pl_293
  s_branch ABORT
pk_294:
a1_288:
  s_lshl_b32 s59, s64, 16
  s_add_u32 s60, s59, 54525952
  s_add_u32 s59, s59, 50331648
  buffer_load_dwordx4 v[128:131], v2, s[8:11], s59 offen offset:0 sc1
  buffer_load_dwordx4 v[132:135], v2, s[8:11], s59 offen offset:256 sc1
  buffer_load_dwordx4 v[136:139], v2, s[8:11], s59 offen offset:512 sc1
  buffer_load_dwordx4 v[140:143], v2, s[8:11], s59 offen offset:768 sc1
  buffer_load_dwordx4 v[144:147], v2, s[8:11], s59 offen offset:1024 sc1
  buffer_load_dwordx4 v[148:151], v2, s[8:11], s59 offen offset:1280 sc1
  buffer_load_dwordx4 v[152:155], v2, s[8:11], s59 offen offset:1536 sc1
  buffer_load_dwordx4 v[156:159], v2, s[8:11], s59 offen offset:1792 sc1
  buffer_load_dwordx2 v[160:161], v3, s[8:11], s60 offen offset:0 sc1
  buffer_load_dwordx2 v[162:163], v3, s[8:11], s60 offen offset:512 sc1
  buffer_load_dwordx2 v[164:165], v3, s[8:11], s60 offen offset:1024 sc1
  buffer_load_dwordx2 v[166:167], v3, s[8:11], s60 offen offset:1536 sc1
  v_and_b32 v16, v16, v17
  v_and_b32 v18, v18, v19
  v_and_b32 v16, v16, v18
  v_cmp_ne_u32 vcc, 1, v16
  s_cbranch_vccz a2_289
  s_cmp_ge_u32 s16, s18
  s_cbranch_scc1 a2_289
  s_mul_i32 s60, s16, 1536
  s_add_u32 s60, s60, 2097152
pl_295:
  buffer_load_dwordx4 v[16:19], v4, s[8:11], s60 offen sc1
  s_waitcnt vmcnt(0)
  v_and_b32 v16, v16, v17
  v_and_b32 v18, v18, v19
  v_and_b32 v16, v16, v18
  v_cmp_ne_u32 vcc, 1, v16
  s_cbranch_vccz pk_296
  s_sub_u32 s57, s57, 1
  s_cbranch_scc0 pl_295
  s_branch ABORT
pk_296:
a2_289:
  s_cmp_lt_u32 s16, s18
  s_cselect_b32 s62, s16, s64
  s_cselect_b32 s59, 0, 0x7ff00000
  s_or_b32 s59, s59, s101
  v_add_u32 v13, s59, v1
  s_lshl_b32 s62, s62, 18
  s_add_u32 s59, s62, 167772160
  buffer_load_dwordx4 a[96:99], v13, s[8:11], s59 offen offset:0 sc1
  buffer_load_dwordx4 a[100:103], v13, s[8:11], s59 offen offset:1024 sc1
  buffer_load_dwordx4 a[104:107], v13, s[8:11], s59 offen offset:2048 sc1
  buffer_load_dwordx4 a[108:111], v13, s[8:11], s59 offen offset:3072 sc1
  s_add_u32 s59, s62, 167776256
  buffer_load_dwordx4 a[112:115], v13, s[8:11], s59 offen offset:0 sc1
  buffer_load_dwordx4 a[116:119], v13, s[8:11], s59 offen offset:1024 sc1
  buffer_load_dwordx4 a[120:123], v13, s[8:11], s59 offen offset:2048 sc1
  buffer_load_dwordx4 a[124:127], v13, s[8:11], s59 offen offset:3072 sc1
  s_add_u32 s59, s62, 16777216
  buffer_load_dwordx4 a[128:131], v13, s[8:11], s59 offen offset:0 sc1
  buffer_load_dwordx4 a[132:135], v13, s[8:11], s59 offen offset:1024 sc1
  buffer_load_dwordx4 a[136:139], v13, s[8:11], s59 offen offset:2048 sc1
  buffer_load_dwordx4 a[140:143], v13, s[8:11], s59 offen offset:3072 sc1
  s_add_u32 s59, s62, 16781312
  buffer_load_dwordx4 a[144:147], v13, s[8:11], s59 offen offset:0 sc1
  buffer_load_dwordx4 a[148:151], v13, s[8:11], s59 offen offset:1024 sc1
  buffer_load_dwordx4 a[152:155], v13, s[8:11], s59 offen offset:2048 sc1
  buffer_load_dwordx4 a[156:159], v13, s[8:11], s59 offen offset:3072 sc1
  s_add_u32 s59, s62, 33554432
  buffer_load_dwordx4 a[160:163], v13, s[8:11], s59 offen offset:0 sc1
  buffer_load_dwordx4 a[164:167], v13, s[8:11], s59 offen offset:1024 sc1
  buffer_load_dwordx4 a[168:171], v13, s[8:11], s59 offen offset:2048 sc1
  buffer_load_dwordx4 a[172:175], v13, s[8:11], s59 offen offset:3072 sc1
  s_add_u32 s59, s62, 33558528
  buffer_load_dwordx4 a[176:179], v13, s[8:11], s59 offen offset:0 sc1
  buffer_load_dwordx4 a[180:183], v13, s[8:11], s59 offen offset:1024 sc1
  buffer_load_dwordx4 a[184:187], v13, s[8:11], s59 offen offset:2048 sc1
  buffer_load_dwordx4 a[188:191], v13, s[8:11], s59 offen offset:3072 sc1
  s_mul_i32 s59, s17, 1536
  s_add_u32 s59, s59, 2097152
  buffer_load_dwordx4 v[16:19], v4, s[8:11], s59 offen sc1
  s_lshl_b32 s59, s16, 9
  s_add_u32 s59, s59, 2195456
  buffer_load_dwordx4 v[96:99], v5, s[8:11], s59 offen sc1
  v_cvt_pk_bf16_f32 v8, v168, v169
  v_lshlrev_b32 v168, 16, v8
  v_and_b32 v169, 0xffff0000, v8
  v_cvt_pk_bf16_f32 v9, v170, v171
  v_lshlrev_b32 v170, 16, v9
  v_and_b32 v171, 0xffff0000, v9
  v_cvt_pk_bf16_f32 v10, v172, v173
  v_lshlrev_b32 v172, 16, v10
  v_and_b32 v173, 0xffff0000, v10
  v_cvt_pk_bf16_f32 v11, v174, v175
  v_lshlrev_b32 v174, 16, v11
  v_and_b32 v175, 0xffff0000, v11
  v_cvt_pk_bf16_f32 v8, v176, v177
  v_lshlrev_b32 v176, 16, v8
  v_and_b32 v177, 0xffff0000, v8
  v_cvt_pk_bf16_f32 v9, v178, v179
  v_lshlrev_b32 v178, 16, v9
  v_and_b32 v179, 0xffff0000, v9
  v_cvt_pk_bf16_f32 v10, v180, v181
  v_lshlrev_b32 v180, 16, v10
  v_and_b32 v181, 0xffff0000, v10
  v_cvt_pk_bf16_f32 v11, v182, v183
  v_lshlrev_b32 v182, 16, v11
  v_and_b32 v183, 0xffff0000, v11
  v_pk_mul_f32 v[168:169], v[168:169], s[66:67]
  v_pk_mul_f32 v[170:171], v[170:171], s[66:67]
  v_pk_mul_f32 v[172:173], v[172:173], s[66:67]
  v_pk_mul_f32 v[174:175], v[174:175], s[66:67]
  v_pk_mul_f32 v[176:177], v[176:177], s[66:67]
  v_pk_mul_f32 v[178:179], v[178:179], s[66:67]
  v_pk_mul_f32 v[180:181], v[180:181], s[66:67]
  v_pk_mul_f32 v[182:183], v[182:183], s[66:67]
  v_cvt_pk_bf16_f32 v8, v168, v169
  v_lshlrev_b32 v168, 16, v8
  v_and_b32 v169, 0xffff0000, v8
  v_cvt_pk_bf16_f32 v9, v170, v171
  v_lshlrev_b32 v170, 16, v9
  v_and_b32 v171, 0xffff0000, v9
  v_cvt_pk_bf16_f32 v10, v172, v173
  v_lshlrev_b32 v172, 16, v10
  v_and_b32 v173, 0xffff0000, v10
  v_cvt_pk_bf16_f32 v11, v174, v175
  v_lshlrev_b32 v174, 16, v11
  v_and_b32 v175, 0xffff0000, v11
  v_cvt_pk_bf16_f32 v8, v176, v177
  v_lshlrev_b32 v176, 16, v8
  v_and_b32 v177, 0xffff0000, v8
  v_cvt_pk_bf16_f32 v9, v178, v179
  v_lshlrev_b32 v178, 16, v9
  v_and_b32 v179, 0xffff0000, v9
  v_cvt_pk_bf16_f32 v10, v180, v181
  v_lshlrev_b32 v180, 16, v10
  v_and_b32 v181, 0xffff0000, v10
  v_cvt_pk_bf16_f32 v11, v182, v183
  v_lshlrev_b32 v182, 16, v11
  v_and_b32 v183, 0xffff0000, v11
  v_mov_b32 v31, 0xce6e6b28
  v_cndmask_b32 v168, v168, v31, s[68:69]
  v_cndmask_b32 v169, v169, v31, s[70:71]
  v_cndmask_b32 v170, v170, v31, s[72:73]
  v_cndmask_b32 v171, v171, v31, s[74:75]
  v_cndmask_b32 v172, v172, v31, s[76:77]
  v_cndmask_b32 v173, v173, v31, s[78:79]
  v_cndmask_b32 v174, v174, v31, s[80:81]
  v_cndmask_b32 v175, v175, v31, s[82:83]
  v_cndmask_b32 v176, v176, v31, s[84:85]
  v_cndmask_b32 v177, v177, v31, s[86:87]
  v_cndmask_b32 v178, v178, v31, s[88:89]
  v_cndmask_b32 v179, v179, v31, s[90:91]
  v_cndmask_b32 v180, v180, v31, s[92:93]
  v_cndmask_b32 v181, v181, v31, s[94:95]
  v_cndmask_b32 v182, v182, v31, s[96:97]
  v_cndmask_b32 v183, v183, v31, s[98:99]
  v_max3_f32 v30, v168, v169, v170
  v_max3_f32 v30, v30, v171, v172
  v_max3_f32 v30, v30, v173, v174
  v_max3_f32 v30, v30, v175, v176
  v_max3_f32 v30, v30, v177, v178
  v_max3_f32 v30, v30, v179, v180
  v_max3_f32 v30, v30, v181, v182
  v_max_f32 v30, v30, v183
  s_waitcnt vmcnt(37)
  v_mfma_f32_32x32x16_bf16 v[184:199], v[128:131], a[0:3], 0
  s_waitcnt vmcnt(36)
  v_mfma_f32_32x32x16_bf16 v[184:199], v[132:135], a[4:7], v[184:199]
  s_waitcnt vmcnt(35)
  v_mfma_f32_32x32x16_bf16 v[184:199], v[136:139], a[8:11], v[184:199]
  s_waitcnt vmcnt(34)
  v_mfma_f32_32x32x16_bf16 v[184:199], v[140:143], a[12:15], v[184:199]
  s_waitcnt vmcnt(33)
  v_mfma_f32_32x32x16_bf16 v[184:199], v[144:147], a[16:19], v[184:199]
  s_waitcnt vmcnt(32)
  v_mfma_f32_32x32x16_bf16 v[184:199], v[148:151], a[20:23], v[184:199]
  s_waitcnt vmcnt(31)
  v_mfma_f32_32x32x16_bf16 v[184:199], v[152:155], a[24:27], v[184:199]
  s_waitcnt vmcnt(30)
  v_mfma_f32_32x32x16_bf16 v[184:199], v[156:159], a[28:31], v[184:199]
  s_waitcnt vmcnt(26)
  s_cmp_eq_u32 s58, 0
  s_cbranch_scc1 of_297
  s_mov_b32 s58, 0
  s_cmp_eq_u32 s3, 0
  s_cbranch_scc0 bm_298
  buffer_store_dword v7, v6, s[8:11], s100 offen
  s_branch bn_299
bm_298:
  buffer_store_dword v7, v6, s[8:11], s100 offen sc1
bn_299:
of_297:
  v_cvt_pk_bf16_f32 v8, v184, v185
  v_lshlrev_b32 v184, 16, v8
  v_and_b32 v185, 0xffff0000, v8
  v_cvt_pk_bf16_f32 v9, v186, v187
  v_lshlrev_b32 v186, 16, v9
  v_and_b32 v187, 0xffff0000, v9
  v_pk_mul_f32 v[184:185], v[184:185], s[66:67]
  v_pk_mul_f32 v[186:187], v[186:187], s[66:67]
  v_cvt_pk_bf16_f32 v8, v184, v185
  v_lshlrev_b32 v184, 16, v8
  v_and_b32 v185, 0xffff0000, v8
  v_cvt_pk_bf16_f32 v9, v186, v187
  v_lshlrev_b32 v186, 16, v9
  v_and_b32 v187, 0xffff0000, v9
  v_max3_f32 v30, v30, v184, v185
  v_max3_f32 v30, v30, v186, v187
  v_mov_b32 v31, v30
  s_nop 1
  v_permlane32_swap_b32 v31, v30
  v_max_f32 v30, v30, v31
  v_mul_f32 v30, 0x3fb8aa3b, v30
  s_mov_b32 s59, 0x3fb8aa3b
  v_fma_f32 v168, v168, s59, -v30
  v_fma_f32 v169, v169, s59, -v30
  v_fma_f32 v170, v170, s59, -v30
  v_fma_f32 v171, v171, s59, -v30
  v_fma_f32 v172, v172, s59, -v30
  v_fma_f32 v173, v173, s59, -v30
  v_fma_f32 v174, v174, s59, -v30
  v_fma_f32 v175, v175, s59, -v30
  v_fma_f32 v176, v176, s59, -v30
  v_fma_f32 v177, v177, s59, -v30
  v_fma_f32 v178, v178, s59, -v30
  v_fma_f32 v179, v179, s59, -v30
  v_fma_f32 v180, v180, s59, -v30
  v_fma_f32 v181, v181, s59, -v30
  v_fma_f32 v182, v182, s59, -v30
  v_fma_f32 v183, v183, s59, -v30
  v_fma_f32 v184, v184, s59, -v30
  v_fma_f32 v185, v185, s59, -v30
  v_fma_f32 v186, v186, s59, -v30
  v_fma_f32 v187, v187, s59, -v30
  v_exp_f32 v168, v168
  v_exp_f32 v169, v169
  v_exp_f32 v170, v170
  v_exp_f32 v171, v171
  v_exp_f32 v172, v172
  v_exp_f32 v173, v173
  v_exp_f32 v174, v174
  v_exp_f32 v175, v175
  v_exp_f32 v176, v176
  v_exp_f32 v177, v177
  v_exp_f32 v178, v178
  v_exp_f32 v179, v179
  v_exp_f32 v180, v180
  v_exp_f32 v181, v181
  v_exp_f32 v182, v182
  v_exp_f32 v183, v183
  v_exp_f32 v184, v184
  v_exp_f32 v185, v185
  v_exp_f32 v186, v186
  v_exp_f32 v187, v187
  v_pk_add_f32 v[8:9], v[168:169], v[170:171]
  v_pk_add_f32 v[10:11], v[172:173], v[174:175]
  v_pk_add_f32 v[8:9], v[8:9], v[176:177]
  v_pk_add_f32 v[10:11], v[10:11], v[178:179]
  v_pk_add_f32 v[8:9], v[8:9], v[180:181]
  v_pk_add_f32 v[10:11], v[10:11], v[182:183]
  v_pk_add_f32 v[8:9], v[8:9], v[184:185]
  v_pk_add_f32 v[10:11], v[10:11], v[186:187]
  v_pk_add_f32 v[8:9], v[8:9], v[10:11]
  v_add_f32 v30, v8, v9
  v_mov_b32 v31, v30
  s_nop 1
  v_permlane32_swap_b32 v31, v30
  v_add_f32 v30, v30, v31
  v_rcp_f32 v30, v30
  s_nop 0
  v_mov_b32 v31, v30
  v_pk_mul_f32 v[168:169], v[168:169], v[30:31]
  v_pk_mul_f32 v[170:171], v[170:171], v[30:31]
  v_pk_mul_f32 v[172:173], v[172:173], v[30:31]
  v_pk_mul_f32 v[174:175], v[174:175], v[30:31]
  v_pk_mul_f32 v[176:177], v[176:177], v[30:31]
  v_pk_mul_f32 v[178:179], v[178:179], v[30:31]
  v_pk_mul_f32 v[180:181], v[180:181], v[30:31]
  v_pk_mul_f32 v[182:183], v[182:183], v[30:31]
  v_pk_mul_f32 v[184:185], v[184:185], v[30:31]
  v_pk_mul_f32 v[186:187], v[186:187], v[30:31]
  v_cvt_pk_bf16_f32 v20, v168, v169
  v_cvt_pk_bf16_f32 v21, v170, v171
  v_cvt_pk_bf16_f32 v22, v172, v173
  v_cvt_pk_bf16_f32 v23, v174, v175
  v_cvt_pk_bf16_f32 v24, v176, v177
  v_cvt_pk_bf16_f32 v25, v178, v179
  v_cvt_pk_bf16_f32 v26, v180, v181
  v_cvt_pk_bf16_f32 v27, v182, v183
  v_cvt_pk_bf16_f32 v28, v184, v185
  v_cvt_pk_bf16_f32 v29, v186, v187
  s_nop 1
  v_mfma_f32_32x32x8_bf16 v[32:47], v[160:161], v[28:29], 0
  v_mfma_f32_32x32x8_bf16 v[48:63], v[162:163], v[28:29], 0
  v_mfma_f32_32x32x8_bf16 v[64:79], v[164:165], v[28:29], 0
  v_mfma_f32_32x32x8_bf16 v[80:95], v[166:167], v[28:29], 0
  s_nop 6
  v_mfma_f32_32x32x16_bf16 v[32:47], a[64:67], v[20:23], v[32:47]
  v_mfma_f32_32x32x16_bf16 v[48:63], a[72:75], v[20:23], v[48:63]
  v_mfma_f32_32x32x16_bf16 v[64:79], a[80:83], v[20:23], v[64:79]
  v_mfma_f32_32x32x16_bf16 v[80:95], a[88:91], v[20:23], v[80:95]
  v_mfma_f32_32x32x16_bf16 v[32:47], a[68:71], v[24:27], v[32:47]
  v_mfma_f32_32x32x16_bf16 v[48:63], a[76:79], v[24:27], v[48:63]
  v_mfma_f32_32x32x16_bf16 v[64:79], a[84:87], v[24:27], v[64:79]
  v_mfma_f32_32x32x16_bf16 v[80:95], a[92:95], v[24:27], v[80:95]
  s_lshl_b32 s59, s64, 18
  s_add_u32 s59, s59, 67108864
  s_add_u32 s60, s59, 4096
  s_nop 5
  v_cvt_pk_bf16_f32 v128, v32, v33
  v_cvt_pk_bf16_f32 v129, v34, v35
  v_cvt_pk_bf16_f32 v130, v36, v37
  v_cvt_pk_bf16_f32 v131, v38, v39
  v_cvt_pk_bf16_f32 v132, v40, v41
  v_cvt_pk_bf16_f32 v133, v42, v43
  v_cvt_pk_bf16_f32 v134, v44, v45
  v_cvt_pk_bf16_f32 v135, v46, v47
  v_cvt_pk_bf16_f32 v136, v48, v49
  v_cvt_pk_bf16_f32 v137, v50, v51
  v_cvt_pk_bf16_f32 v138, v52, v53
  v_cvt_pk_bf16_f32 v139, v54, v55
  v_cvt_pk_bf16_f32 v140, v56, v57
  v_cvt_pk_bf16_f32 v141, v58, v59
  v_cvt_pk_bf16_f32 v142, v60, v61
  v_cvt_pk_bf16_f32 v143, v62, v63
  v_cvt_pk_bf16_f32 v144, v64, v65
  v_cvt_pk_bf16_f32 v145, v66, v67
  v_cvt_pk_bf16_f32 v146, v68, v69
  v_cvt_pk_bf16_f32 v147, v70, v71
  v_cvt_pk_bf16_f32 v148, v72, v73
  v_cvt_pk_bf16_f32 v149, v74, v75
  v_cvt_pk_bf16_f32 v150, v76, v77
  v_cvt_pk_bf16_f32 v151, v78, v79
  v_cvt_pk_bf16_f32 v152, v80, v81
  v_cvt_pk_bf16_f32 v153, v82, v83
  v_cvt_pk_bf16_f32 v154, v84, v85
  v_cvt_pk_bf16_f32 v155, v86, v87
  v_cvt_pk_bf16_f32 v156, v88, v89
  v_cvt_pk_bf16_f32 v157, v90, v91
  v_cvt_pk_bf16_f32 v158, v92, v93
  v_cvt_pk_bf16_f32 v159, v94, v95
  s_cmp_eq_u32 s3, 0
  s_cbranch_scc0 bm_300
  buffer_store_dwordx4 v[128:131], v1, s[8:11], s59 offen offset:0
  buffer_store_dwordx4 v[132:135], v1, s[8:11], s59 offen offset:1024
  buffer_store_dwordx4 v[136:139], v1, s[8:11], s59 offen offset:2048
  buffer_store_dwordx4 v[140:143], v1, s[8:11], s59 offen offset:3072
  buffer_store_dwordx4 v[144:147], v1, s[8:11], s60 offen offset:0
  buffer_store_dwordx4 v[148:151], v1, s[8:11], s60 offen offset:1024
  buffer_store_dwordx4 v[152:155], v1, s[8:11], s60 offen offset:2048
  buffer_store_dwordx4 v[156:159], v1, s[8:11], s60 offen offset:3072
  s_branch bn_301
bm_300:
  buffer_store_dwordx4 v[128:131], v1, s[8:11], s59 offen offset:0 sc1
  buffer_store_dwordx4 v[132:135], v1, s[8:11], s59 offen offset:1024 sc1
  buffer_store_dwordx4 v[136:139], v1, s[8:11], s59 offen offset:2048 sc1
  buffer_store_dwordx4 v[140:143], v1, s[8:11], s59 offen offset:3072 sc1
  buffer_store_dwordx4 v[144:147], v1, s[8:11], s60 offen offset:0 sc1
  buffer_store_dwordx4 v[148:151], v1, s[8:11], s60 offen offset:1024 sc1
  buffer_store_dwordx4 v[152:155], v1, s[8:11], s60 offen offset:2048 sc1
  buffer_store_dwordx4 v[156:159], v1, s[8:11], s60 offen offset:3072 sc1
bn_301:
  s_lshl_b32 s100, s64, 5
  s_add_u32 s100, s100, 2326528
  s_mov_b32 s58, 1
  s_mov_b32 s64, s16
  s_mov_b32 s16, s17
  s_cmp_lt_u32 s16, 8
  s_cselect_b32 s59, 4, 2
  s_add_u32 s17, s16, s59
  s_waitcnt vmcnt(8)
  s_cmp_eq_u32 s101, 0
  s_cbranch_scc1 a3_302
  s_waitcnt vmcnt(0)
  s_cmp_eq_u32 s58, 0
  s_cbranch_scc1 of_303
  s_mov_b32 s58, 0
  s_cmp_eq_u32 s3, 0
  s_cbranch_scc0 bm_304
  buffer_store_dword v7, v6, s[8:11], s100 offen
  s_branch bn_305
bm_304:
  buffer_store_dword v7, v6, s[8:11], s100 offen sc1
bn_305:
of_303:
  s_cmp_lt_u32 s64, s18
  s_cselect_b32 s62, s64, s64
  s_cselect_b32 s59, 0, 0x7ff00000
  v_add_u32 v13, s59, v1
  s_lshl_b32 s62, s62, 18
  s_add_u32 s59, s62, 167772160
  buffer_load_dwordx4 a[96:99], v13, s[8:11], s59 offen offset:0 sc1
  buffer_load_dwordx4 a[100:103], v13, s[8:11], s59 offen offset:1024 sc1
  buffer_load_dwordx4 a[104:107], v13, s[8:11], s59 offen offset:2048 sc1
  buffer_load_dwordx4 a[108:111], v13, s[8:11], s59 offen offset:3072 sc1
  s_add_u32 s59, s62, 167776256
  buffer_load_dwordx4 a[112:115], v13, s[8:11], s59 offen offset:0 sc1
  buffer_load_dwordx4 a[116:119], v13, s[8:11], s59 offen offset:1024 sc1
  buffer_load_dwordx4 a[120:123], v13, s[8:11], s59 offen offset:2048 sc1
  buffer_load_dwordx4 a[124:127], v13, s[8:11], s59 offen offset:3072 sc1
  s_add_u32 s59, s62, 16777216
  buffer_load_dwordx4 a[128:131], v13, s[8:11], s59 offen offset:0 sc1
  buffer_load_dwordx4 a[132:135], v13, s[8:11], s59 offen offset:1024 sc1
  buffer_load_dwordx4 a[136:139], v13, s[8:11], s59 offen offset:2048 sc1
  buffer_load_dwordx4 a[140:143], v13, s[8:11], s59 offen offset:3072 sc1
  s_add_u32 s59, s62, 16781312
  buffer_load_dwordx4 a[144:147], v13, s[8:11], s59 offen offset:0 sc1
  buffer_load_dwordx4 a[148:151], v13, s[8:11], s59 offen offset:1024 sc1
  buffer_load_dwordx4 a[152:155], v13, s[8:11], s59 offen offset:2048 sc1
  buffer_load_dwordx4 a[156:159], v13, s[8:11], s59 offen offset:3072 sc1
  s_add_u32 s59, s62, 33554432
  buffer_load_dwordx4 a[160:163], v13, s[8:11], s59 offen offset:0 sc1
  buffer_load_dwordx4 a[164:167], v13, s[8:11], s59 offen offset:1024 sc1
  buffer_load_dwordx4 a[168:171], v13, s[8:11], s59 offen offset:2048 sc1
  buffer_load_dwordx4 a[172:175], v13, s[8:11], s59 offen offset:3072 sc1
  s_add_u32 s59, s62, 33558528
  buffer_load_dwordx4 a[176:179], v13, s[8:11], s59 offen offset:0 sc1
  buffer_load_dwordx4 a[180:183], v13, s[8:11], s59 offen offset:1024 sc1
  buffer_load_dwordx4 a[184:187], v13, s[8:11], s59 offen offset:2048 sc1
  buffer_load_dwordx4 a[188:191], v13, s[8:11], s59 offen offset:3072 sc1
  s_mul_i32 s59, s16, 1536
  s_add_u32 s59, s59, 2097152
  buffer_load_dwordx4 v[16:19], v4, s[8:11], s59 offen sc1
  s_lshl_b32 s59, s64, 9
  s_add_u32 s59, s59, 2195456
  buffer_load_dwordx4 v[96:99], v5, s[8:11], s59 offen sc1
  s_waitcnt vmcnt(0)
a3_302:
  v_mfma_f32_32x32x16_bf16 v[168:183], a[128:131], a[96:99], 0
  v_mfma_f32_32x32x16_bf16 v[168:183], a[132:135], a[100:103], v[168:183]
  v_mfma_f32_32x32x16_bf16 v[168:183], a[136:139], a[104:107], v[168:183]
  v_mfma_f32_32x32x16_bf16 v[168:183], a[140:143], a[108:111], v[168:183]
  v_mfma_f32_32x32x16_bf16 v[168:183], a[144:147], a[112:115], v[168:183]
  v_mfma_f32_32x32x16_bf16 v[168:183], a[148:151], a[116:119], v[168:183]
  v_mfma_f32_32x32x16_bf16 v[168:183], a[152:155], a[120:123], v[168:183]
  v_mfma_f32_32x32x16_bf16 v[168:183], a[156:159], a[124:127], v[168:183]
  v_and_b32 v96, v96, v97
  v_and_b32 v98, v98, v99
  v_and_b32 v96, v96, v98
  v_cmp_ne_u32 vcc, 1, v96
  s_mov_b32 s101, 0
  s_cbranch_vccz a1_306
  s_mov_b32 s101, 0x7ff00000
  s_waitcnt vmcnt(0)
  s_cmp_eq_u32 s58, 0
  s_cbranch_scc1 of_308
  s_mov_b32 s58, 0
  s_cmp_eq_u32 s3, 0
  s_cbranch_scc0 bm_309
  buffer_store_dword v7, v6, s[8:11], s100 offen
  s_branch bn_310
bm_309:
  buffer_store_dword v7, v6, s[8:11], s100 offen sc1
bn_310:
of_308:
  s_lshl_b32 s60, s64, 9
  s_add_u32 s60, s60, 2195456
pl_311:
  buffer_load_dwordx4 v[96:99], v5, s[8:11], s60 offen sc1
  s_waitcnt vmcnt(0)
  v_and_b32 v96, v96, v97
  v_and_b32 v98, v98, v99
  v_and_b32 v96, v96, v98
  v_cmp_ne_u32 vcc, 1, v96
  s_cbranch_vccz pk_312
  s_sub_u32 s57, s57, 1
  s_cbranch_scc0 pl_311
  s_branch ABORT
pk_312:
a1_306:
  s_lshl_b32 s59, s64, 16
  s_add_u32 s60, s59, 54525952
  s_add_u32 s59, s59, 50331648
  buffer_load_dwordx4 v[128:131], v2, s[8:11], s59 offen offset:0 sc1
  buffer_load_dwordx4 v[132:135], v2, s[8:11], s59 offen offset:256 sc1
  buffer_load_dwordx4 v[136:139], v2, s[8:11], s59 offen offset:512 sc1
  buffer_load_dwordx4 v[140:143], v2, s[8:11], s59 offen offset:768 sc1
  buffer_load_dwordx4 v[144:147], v2, s[8:11], s59 offen offset:1024 sc1
  buffer_load_dwordx4 v[148:151], v2, s[8:11], s59 offen offset:1280 sc1
  buffer_load_dwordx4 v[152:155], v2, s[8:11], s59 offen offset:1536 sc1
  buffer_load_dwordx4 v[156:159], v2, s[8:11], s59 offen offset:1792 sc1
  buffer_load_dwordx2 v[160:161], v3, s[8:11], s60 offen offset:0 sc1
  buffer_load_dwordx2 v[162:163], v3, s[8:11], s60 offen offset:512 sc1
  buffer_load_dwordx2 v[164:165], v3, s[8:11], s60 offen offset:1024 sc1
  buffer_load_dwordx2 v[166:167], v3, s[8:11], s60 offen offset:1536 sc1
  v_and_b32 v16, v16, v17
  v_and_b32 v18, v18, v19
  v_and_b32 v16, v16, v18
  v_cmp_ne_u32 vcc, 1, v16
  s_cbranch_vccz a2_307
  s_cmp_ge_u32 s16, s18
  s_cbranch_scc1 a2_307
  s_mul_i32 s60, s16, 1536
  s_add_u32 s60, s60, 2097152
pl_313:
  buffer_load_dwordx4 v[16:19], v4, s[8:11], s60 offen sc1
  s_waitcnt vmcnt(0)
  v_and_b32 v16, v16, v17
  v_and_b32 v18, v18, v19
  v_and_b32 v16, v16, v18
  v_cmp_ne_u32 vcc, 1, v16
  s_cbranch_vccz pk_314
  s_sub_u32 s57, s57, 1
  s_cbranch_scc0 pl_313
  s_branch ABORT
pk_314:
a2_307:
  s_cmp_lt_u32 s16, s18
  s_cselect_b32 s62, s16, s64
  s_cselect_b32 s59, 0, 0x7ff00000
  s_or_b32 s59, s59, s101
  v_add_u32 v13, s59, v1
  s_lshl_b32 s62, s62, 18
  s_add_u32 s59, s62, 167772160
  buffer_load_dwordx4 a[0:3], v13, s[8:11], s59 offen offset:0 sc1
  buffer_load_dwordx4 a[4:7], v13, s[8:11], s59 offen offset:1024 sc1
  buffer_load_dwordx4 a[8:11], v13, s[8:11], s59 offen offset:2048 sc1
  buffer_load_dwordx4 a[12:15], v13, s[8:11], s59 offen offset:3072 sc1
  s_add_u32 s59, s62, 167776256
  buffer_load_dwordx4 a[16:19], v13, s[8:11], s59 offen offset:0 sc1
  buffer_load_dwordx4 a[20:23], v13, s[8:11], s59 offen offset:1024 sc1
  buffer_load_dwordx4 a[24:27], v13, s[8:11], s59 offen offset:2048 sc1
  buffer_load_dwordx4 a[28:31], v13, s[8:11], s59 offen offset:3072 sc1
  s_add_u32 s59, s62, 16777216
  buffer_load_dwordx4 a[32:35], v13, s[8:11], s59 offen offset:0 sc1
  buffer_load_dwordx4 a[36:39], v13, s[8:11], s59 offen offset:1024 sc1
  buffer_load_dwordx4 a[40:43], v13, s[8:11], s59 offen offset:2048 sc1
  buffer_load_dwordx4 a[44:47], v13, s[8:11], s59 offen offset:3072 sc1
  s_add_u32 s59, s62, 16781312
  buffer_load_dwordx4 a[48:51], v13, s[8:11], s59 offen offset:0 sc1
  buffer_load_dwordx4 a[52:55], v13, s[8:11], s59 offen offset:1024 sc1
  buffer_load_dwordx4 a[56:59], v13, s[8:11], s59 offen offset:2048 sc1
  buffer_load_dwordx4 a[60:63], v13, s[8:11], s59 offen offset:3072 sc1
  s_add_u32 s59, s62, 33554432
  buffer_load_dwordx4 a[64:67], v13, s[8:11], s59 offen offset:0 sc1
  buffer_load_dwordx4 a[68:71], v13, s[8:11], s59 offen offset:1024 sc1
  buffer_load_dwordx4 a[72:75], v13, s[8:11], s59 offen offset:2048 sc1
  buffer_load_dwordx4 a[76:79], v13, s[8:11], s59 offen offset:3072 sc1
  s_add_u32 s59, s62, 33558528
  buffer_load_dwordx4 a[80:83], v13, s[8:11], s59 offen offset:0 sc1
  buffer_load_dwordx4 a[84:87], v13, s[8:11], s59 offen offset:1024 sc1
  buffer_load_dwordx4 a[88:91], v13, s[8:11], s59 offen offset:2048 sc1
  buffer_load_dwordx4 a[92:95], v13, s[8:11], s59 offen offset:3072 sc1
  s_mul_i32 s59, s17, 1536
  s_add_u32 s59, s59, 2097152
  buffer_load_dwordx4 v[16:19], v4, s[8:11], s59 offen sc1
  s_lshl_b32 s59, s16, 9
  s_add_u32 s59, s59, 2195456
  buffer_load_dwordx4 v[96:99], v5, s[8:11], s59 offen sc1
  v_cvt_pk_bf16_f32 v8, v168, v169
  v_lshlrev_b32 v168, 16, v8
  v_and_b32 v169, 0xffff0000, v8
  v_cvt_pk_bf16_f32 v9, v170, v171
  v_lshlrev_b32 v170, 16, v9
  v_and_b32 v171, 0xffff0000, v9
  v_cvt_pk_bf16_f32 v10, v172, v173
  v_lshlrev_b32 v172, 16, v10
  v_and_b32 v173, 0xffff0000, v10
  v_cvt_pk_bf16_f32 v11, v174, v175
  v_lshlrev_b32 v174, 16, v11
  v_and_b32 v175, 0xffff0000, v11
  v_cvt_pk_bf16_f32 v8, v176, v177
  v_lshlrev_b32 v176, 16, v8
  v_and_b32 v177, 0xffff0000, v8
  v_cvt_pk_bf16_f32 v9, v178, v179
  v_lshlrev_b32 v178, 16, v9
  v_and_b32 v179, 0xffff0000, v9
  v_cvt_pk_bf16_f32 v10, v180, v181
  v_lshlrev_b32 v180, 16, v10
  v_and_b32 v181, 0xffff0000, v10
  v_cvt_pk_bf16_f32 v11, v182, v183
  v_lshlrev_b32 v182, 16, v11
  v_and_b32 v183, 0xffff0000, v11
  v_pk_mul_f32 v[168:169], v[168:169], s[66:67]
  v_pk_mul_f32 v[170:171], v[170:171], s[66:67]
  v_pk_mul_f32 v[172:173], v[172:173], s[66:67]
  v_pk_mul_f32 v[174:175], v[174:175], s[66:67]
  v_pk_mul_f32 v[176:177], v[176:177], s[66:67]
  v_pk_mul_f32 v[178:179], v[178:179], s[66:67]
  v_pk_mul_f32 v[180:181], v[180:181], s[66:67]
  v_pk_mul_f32 v[182:183], v[182:183], s[66:67]
  v_cvt_pk_bf16_f32 v8, v168, v169
  v_lshlrev_b32 v168, 16, v8
  v_and_b32 v169, 0xffff0000, v8
  v_cvt_pk_bf16_f32 v9, v170, v171
  v_lshlrev_b32 v170, 16, v9
  v_and_b32 v171, 0xffff0000, v9
  v_cvt_pk_bf16_f32 v10, v172, v173
  v_lshlrev_b32 v172, 16, v10
  v_and_b32 v173, 0xffff0000, v10
  v_cvt_pk_bf16_f32 v11, v174, v175
  v_lshlrev_b32 v174, 16, v11
  v_and_b32 v175, 0xffff0000, v11
  v_cvt_pk_bf16_f32 v8, v176, v177
  v_lshlrev_b32 v176, 16, v8
  v_and_b32 v177, 0xffff0000, v8
  v_cvt_pk_bf16_f32 v9, v178, v179
  v_lshlrev_b32 v178, 16, v9
  v_and_b32 v179, 0xffff0000, v9
  v_cvt_pk_bf16_f32 v10, v180, v181
  v_lshlrev_b32 v180, 16, v10
  v_and_b32 v181, 0xffff0000, v10
  v_cvt_pk_bf16_f32 v11, v182, v183
  v_lshlrev_b32 v182, 16, v11
  v_and_b32 v183, 0xffff0000, v11
  v_mov_b32 v31, 0xce6e6b28
  v_cndmask_b32 v168, v168, v31, s[68:69]
  v_cndmask_b32 v169, v169, v31, s[70:71]
  v_cndmask_b32 v170, v170, v31, s[72:73]
  v_cndmask_b32 v171, v171, v31, s[74:75]
  v_cndmask_b32 v172, v172, v31, s[76:77]
  v_cndmask_b32 v173, v173, v31, s[78:79]
  v_cndmask_b32 v174, v174, v31, s[80:81]
  v_cndmask_b32 v175, v175, v31, s[82:83]
  v_cndmask_b32 v176, v176, v31, s[84:85]
  v_cndmask_b32 v177, v177, v31, s[86:87]
  v_cndmask_b32 v178, v178, v31, s[88:89]
  v_cndmask_b32 v179, v179, v31, s[90:91]
  v_cndmask_b32 v180, v180, v31, s[92:93]
  v_cndmask_b32 v181, v181, v31, s[94:95]
  v_cndmask_b32 v182, v182, v31, s[96:97]
  v_cndmask_b32 v183, v183, v31, s[98:99]
  v_max3_f32 v30, v168, v169, v170
  v_max3_f32 v30, v30, v171, v172
  v_max3_f32 v30, v30, v173, v174
  v_max3_f32 v30, v30, v175, v176
  v_max3_f32 v30, v30, v177, v178
  v_max3_f32 v30, v30, v179, v180
  v_max3_f32 v30, v30, v181, v182
  v_max_f32 v30, v30, v183
  s_waitcnt vmcnt(37)
  v_mfma_f32_32x32x16_bf16 v[184:199], v[128:131], a[96:99], 0
  s_waitcnt vmcnt(36)
  v_mfma_f32_32x32x16_bf16 v[184:199], v[132:135], a[100:103], v[184:199]
  s_waitcnt vmcnt(35)
  v_mfma_f32_32x32x16_bf16 v[184:199], v[136:139], a[104:107], v[184:199]
  s_waitcnt vmcnt(34)
  v_mfma_f32_32x32x16_bf16 v[184:199], v[140:143], a[108:111], v[184:199]
  s_waitcnt vmcnt(33)
  v_mfma_f32_32x32x16_bf16 v[184:199], v[144:147], a[112:115], v[184:199]
  s_waitcnt vmcnt(32)
  v_mfma_f32_32x32x16_bf16 v[184:199], v[148:151], a[116:119], v[184:199]
  s_waitcnt vmcnt(31)
  v_mfma_f32_32x32x16_bf16 v[184:199], v[152:155], a[120:123], v[184:199]
  s_waitcnt vmcnt(30)
  v_mfma_f32_32x32x16_bf16 v[184:199], v[156:159], a[124:127], v[184:199]
  s_waitcnt vmcnt(26)
  s_cmp_eq_u32 s58, 0
  s_cbranch_scc1 of_315
  s_mov_b32 s58, 0
  s_cmp_eq_u32 s3, 0
  s_cbranch_scc0 bm_316
  buffer_store_dword v7, v6, s[8:11], s100 offen
  s_branch bn_317
bm_316:
  buffer_store_dword v7, v6, s[8:11], s100 offen sc1
bn_317:
of_315:
  v_cvt_pk_bf16_f32 v8, v184, v185
  v_lshlrev_b32 v184, 16, v8
  v_and_b32 v185, 0xffff0000, v8
  v_cvt_pk_bf16_f32 v9, v186, v187
  v_lshlrev_b32 v186, 16, v9
  v_and_b32 v187, 0xffff0000, v9
  v_pk_mul_f32 v[184:185], v[184:185], s[66:67]
  v_pk_mul_f32 v[186:187], v[186:187], s[66:67]
  v_cvt_pk_bf16_f32 v8, v184, v185
  v_lshlrev_b32 v184, 16, v8
  v_and_b32 v185, 0xffff0000, v8
  v_cvt_pk_bf16_f32 v9, v186, v187
  v_lshlrev_b32 v186, 16, v9
  v_and_b32 v187, 0xffff0000, v9
  v_max3_f32 v30, v30, v184, v185
  v_max3_f32 v30, v30, v186, v187
  v_mov_b32 v31, v30
  s_nop 1
  v_permlane32_swap_b32 v31, v30
  v_max_f32 v30, v30, v31
  v_mul_f32 v30, 0x3fb8aa3b, v30
  s_mov_b32 s59, 0x3fb8aa3b
  v_fma_f32 v168, v168, s59, -v30
  v_fma_f32 v169, v169, s59, -v30
  v_fma_f32 v170, v170, s59, -v30
  v_fma_f32 v171, v171, s59, -v30
  v_fma_f32 v172, v172, s59, -v30
  v_fma_f32 v173, v173, s59, -v30
  v_fma_f32 v174, v174, s59, -v30
  v_fma_f32 v175, v175, s59, -v30
  v_fma_f32 v176, v176, s59, -v30
  v_fma_f32 v177, v177, s59, -v30
  v_fma_f32 v178, v178, s59, -v30
  v_fma_f32 v179, v179, s59, -v30
  v_fma_f32 v180, v180, s59, -v30
  v_fma_f32 v181, v181, s59, -v30
  v_fma_f32 v182, v182, s59, -v30
  v_fma_f32 v183, v183, s59, -v30
  v_fma_f32 v184, v184, s59, -v30
  v_fma_f32 v185, v185, s59, -v30
  v_fma_f32 v186, v186, s59, -v30
  v_fma_f32 v187, v187, s59, -v30
  v_exp_f32 v168, v168
  v_exp_f32 v169, v169
  v_exp_f32 v170, v170
  v_exp_f32 v171, v171
  v_exp_f32 v172, v172
  v_exp_f32 v173, v173
  v_exp_f32 v174, v174
  v_exp_f32 v175, v175
  v_exp_f32 v176, v176
  v_exp_f32 v177, v177
  v_exp_f32 v178, v178
  v_exp_f32 v179, v179
  v_exp_f32 v180, v180
  v_exp_f32 v181, v181
  v_exp_f32 v182, v182
  v_exp_f32 v183, v183
  v_exp_f32 v184, v184
  v_exp_f32 v185, v185
  v_exp_f32 v186, v186
  v_exp_f32 v187, v187
  v_pk_add_f32 v[8:9], v[168:169], v[170:171]
  v_pk_add_f32 v[10:11], v[172:173], v[174:175]
  v_pk_add_f32 v[8:9], v[8:9], v[176:177]
  v_pk_add_f32 v[10:11], v[10:11], v[178:179]
  v_pk_add_f32 v[8:9], v[8:9], v[180:181]
  v_pk_add_f32 v[10:11], v[10:11], v[182:183]
  v_pk_add_f32 v[8:9], v[8:9], v[184:185]
  v_pk_add_f32 v[10:11], v[10:11], v[186:187]
  v_pk_add_f32 v[8:9], v[8:9], v[10:11]
  v_add_f32 v30, v8, v9
  v_mov_b32 v31, v30
  s_nop 1
  v_permlane32_swap_b32 v31, v30
  v_add_f32 v30, v30, v31
  v_rcp_f32 v30, v30
  s_nop 0
  v_mov_b32 v31, v30
  v_pk_mul_f32 v[168:169], v[168:169], v[30:31]
  v_pk_mul_f32 v[170:171], v[170:171], v[30:31]
  v_pk_mul_f32 v[172:173], v[172:173], v[30:31]
  v_pk_mul_f32 v[174:175], v[174:175], v[30:31]
  v_pk_mul_f32 v[176:177], v[176:177], v[30:31]
  v_pk_mul_f32 v[178:179], v[178:179], v[30:31]
  v_pk_mul_f32 v[180:181], v[180:181], v[30:31]
  v_pk_mul_f32 v[182:183], v[182:183], v[30:31]
  v_pk_mul_f32 v[184:185], v[184:185], v[30:31]
  v_pk_mul_f32 v[186:187], v[186:187], v[30:31]
  v_cvt_pk_bf16_f32 v20, v168, v169
  v_cvt_pk_bf16_f32 v21, v170, v171
  v_cvt_pk_bf16_f32 v22, v172, v173
  v_cvt_pk_bf16_f32 v23, v174, v175
  v_cvt_pk_bf16_f32 v24, v176, v177
  v_cvt_pk_bf16_f32 v25, v178, v179
  v_cvt_pk_bf16_f32 v26, v180, v181
  v_cvt_pk_bf16_f32 v27, v182, v183
  v_cvt_pk_bf16_f32 v28, v184, v185
  v_cvt_pk_bf16_f32 v29, v186, v187
  s_nop 1
  v_mfma_f32_32x32x8_bf16 v[32:47], v[160:161], v[28:29], 0
  v_mfma_f32_32x32x8_bf16 v[48:63], v[162:163], v[28:29], 0
  v_mfma_f32_32x32x8_bf16 v[64:79], v[164:165], v[28:29], 0
  v_mfma_f32_32x32x8_bf16 v[80:95], v[166:167], v[28:29], 0
  s_nop 6
  v_mfma_f32_32x32x16_bf16 v[32:47], a[160:163], v[20:23], v[32:47]
  v_mfma_f32_32x32x16_bf16 v[48:63], a[168:171], v[20:23], v[48:63]
  v_mfma_f32_32x32x16_bf16 v[64:79], a[176:179], v[20:23], v[64:79]
  v_mfma_f32_32x32x16_bf16 v[80:95], a[184:187], v[20:23], v[80:95]
  v_mfma_f32_32x32x16_bf16 v[32:47], a[164:167], v[24:27], v[32:47]
  v_mfma_f32_32x32x16_bf16 v[48:63], a[172:175], v[24:27], v[48:63]
  v_mfma_f32_32x32x16_bf16 v[64:79], a[180:183], v[24:27], v[64:79]
  v_mfma_f32_32x32x16_bf16 v[80:95], a[188:191], v[24:27], v[80:95]
  s_lshl_b32 s59, s64, 18
  s_add_u32 s59, s59, 67108864
  s_add_u32 s60, s59, 4096
  s_nop 5
  v_cvt_pk_bf16_f32 v128, v32, v33
  v_cvt_pk_bf16_f32 v129, v34, v35
  v_cvt_pk_bf16_f32 v130, v36, v37
  v_cvt_pk_bf16_f32 v131, v38, v39
  v_cvt_pk_bf16_f32 v132, v40, v41
  v_cvt_pk_bf16_f32 v133, v42, v43
  v_cvt_pk_bf16_f32 v134, v44, v45
  v_cvt_pk_bf16_f32 v135, v46, v47
  v_cvt_pk_bf16_f32 v136, v48, v49
  v_cvt_pk_bf16_f32 v137, v50, v51
  v_cvt_pk_bf16_f32 v138, v52, v53
  v_cvt_pk_bf16_f32 v139, v54, v55
  v_cvt_pk_bf16_f32 v140, v56, v57
  v_cvt_pk_bf16_f32 v141, v58, v59
  v_cvt_pk_bf16_f32 v142, v60, v61
  v_cvt_pk_bf16_f32 v143, v62, v63
  v_cvt_pk_bf16_f32 v144, v64, v65
  v_cvt_pk_bf16_f32 v145, v66, v67
  v_cvt_pk_bf16_f32 v146, v68, v69
  v_cvt_pk_bf16_f32 v147, v70, v71
  v_cvt_pk_bf16_f32 v148, v72, v73
  v_cvt_pk_bf16_f32 v149, v74, v75
  v_cvt_pk_bf16_f32 v150, v76, v77
  v_cvt_pk_bf16_f32 v151, v78, v79
  v_cvt_pk_bf16_f32 v152, v80, v81
  v_cvt_pk_bf16_f32 v153, v82, v83
  v_cvt_pk_bf16_f32 v154, v84, v85
  v_cvt_pk_bf16_f32 v155, v86, v87
  v_cvt_pk_bf16_f32 v156, v88, v89
  v_cvt_pk_bf16_f32 v157, v90, v91
  v_cvt_pk_bf16_f32 v158, v92, v93
  v_cvt_pk_bf16_f32 v159, v94, v95
  s_cmp_eq_u32 s3, 0
  s_cbranch_scc0 bm_318
  buffer_store_dwordx4 v[128:131], v1, s[8:11], s59 offen offset:0
  buffer_store_dwordx4 v[132:135], v1, s[8:11], s59 offen offset:1024
  buffer_store_dwordx4 v[136:139], v1, s[8:11], s59 offen offset:2048
  buffer_store_dwordx4 v[140:143], v1, s[8:11], s59 offen offset:3072
  buffer_store_dwordx4 v[144:147], v1, s[8:11], s60 offen offset:0
  buffer_store_dwordx4 v[148:151], v1, s[8:11], s60 offen offset:1024
  buffer_store_dwordx4 v[152:155], v1, s[8:11], s60 offen offset:2048
  buffer_store_dwordx4 v[156:159], v1, s[8:11], s60 offen offset:3072
  s_branch bn_319
bm_318:
  buffer_store_dwordx4 v[128:131], v1, s[8:11], s59 offen offset:0 sc1
  buffer_store_dwordx4 v[132:135], v1, s[8:11], s59 offen offset:1024 sc1
  buffer_store_dwordx4 v[136:139], v1, s[8:11], s59 offen offset:2048 sc1
  buffer_store_dwordx4 v[140:143], v1, s[8:11], s59 offen offset:3072 sc1
  buffer_store_dwordx4 v[144:147], v1, s[8:11], s60 offen offset:0 sc1
  buffer_store_dwordx4 v[148:151], v1, s[8:11], s60 offen offset:1024 sc1
  buffer_store_dwordx4 v[152:155], v1, s[8:11], s60 offen offset:2048 sc1
  buffer_store_dwordx4 v[156:159], v1, s[8:11], s60 offen offset:3072 sc1
bn_319:
  s_lshl_b32 s100, s64, 5
  s_add_u32 s100, s100, 2326528
  s_mov_b32 s58, 1
  s_mov_b32 s64, s16
  s_mov_b32 s16, s17
  s_cmp_lt_u32 s16, 8
  s_cselect_b32 s59, 4, 2
  s_add_u32 s17, s16, s59
  s_waitcnt vmcnt(8)
  s_cmp_eq_u32 s101, 0
  s_cbranch_scc1 a3_320
  s_waitcnt vmcnt(0)
  s_cmp_eq_u32 s58, 0
  s_cbranch_scc1 of_321
  s_mov_b32 s58, 0
  s_cmp_eq_u32 s3, 0
  s_cbranch_scc0 bm_322
  buffer_store_dword v7, v6, s[8:11], s100 offen
  s_branch bn_323
bm_322:
  buffer_store_dword v7, v6, s[8:11], s100 offen sc1
bn_323:
of_321:
  s_cmp_lt_u32 s64, s18
  s_cselect_b32 s62, s64, s64
  s_cselect_b32 s59, 0, 0x7ff00000
  v_add_u32 v13, s59, v1
  s_lshl_b32 s62, s62, 18
  s_add_u32 s59, s62, 167772160
  buffer_load_dwordx4 a[0:3], v13, s[8:11], s59 offen offset:0 sc1
  buffer_load_dwordx4 a[4:7], v13, s[8:11], s59 offen offset:1024 sc1
  buffer_load_dwordx4 a[8:11], v13, s[8:11], s59 offen offset:2048 sc1
  buffer_load_dwordx4 a[12:15], v13, s[8:11], s59 offen offset:3072 sc1
  s_add_u32 s59, s62, 167776256
  buffer_load_dwordx4 a[16:19], v13, s[8:11], s59 offen offset:0 sc1
  buffer_load_dwordx4 a[20:23], v13, s[8:11], s59 offen offset:1024 sc1
  buffer_load_dwordx4 a[24:27], v13, s[8:11], s59 offen offset:2048 sc1
  buffer_load_dwordx4 a[28:31], v13, s[8:11], s59 offen offset:3072 sc1
  s_add_u32 s59, s62, 16777216
  buffer_load_dwordx4 a[32:35], v13, s[8:11], s59 offen offset:0 sc1
  buffer_load_dwordx4 a[36:39], v13, s[8:11], s59 offen offset:1024 sc1
  buffer_load_dwordx4 a[40:43], v13, s[8:11], s59 offen offset:2048 sc1
  buffer_load_dwordx4 a[44:47], v13, s[8:11], s59 offen offset:3072 sc1
  s_add_u32 s59, s62, 16781312
  buffer_load_dwordx4 a[48:51], v13, s[8:11], s59 offen offset:0 sc1
  buffer_load_dwordx4 a[52:55], v13, s[8:11], s59 offen offset:1024 sc1
  buffer_load_dwordx4 a[56:59], v13, s[8:11], s59 offen offset:2048 sc1
  buffer_load_dwordx4 a[60:63], v13, s[8:11], s59 offen offset:3072 sc1
  s_add_u32 s59, s62, 33554432
  buffer_load_dwordx4 a[64:67], v13, s[8:11], s59 offen offset:0 sc1
  buffer_load_dwordx4 a[68:71], v13, s[8:11], s59 offen offset:1024 sc1
  buffer_load_dwordx4 a[72:75], v13, s[8:11], s59 offen offset:2048 sc1
  buffer_load_dwordx4 a[76:79], v13, s[8:11], s59 offen offset:3072 sc1
  s_add_u32 s59, s62, 33558528
  buffer_load_dwordx4 a[80:83], v13, s[8:11], s59 offen offset:0 sc1
  buffer_load_dwordx4 a[84:87], v13, s[8:11], s59 offen offset:1024 sc1
  buffer_load_dwordx4 a[88:91], v13, s[8:11], s59 offen offset:2048 sc1
  buffer_load_dwordx4 a[92:95], v13, s[8:11], s59 offen offset:3072 sc1
  s_mul_i32 s59, s16, 1536
  s_add_u32 s59, s59, 2097152
  buffer_load_dwordx4 v[16:19], v4, s[8:11], s59 offen sc1
  s_lshl_b32 s59, s64, 9
  s_add_u32 s59, s59, 2195456
  buffer_load_dwordx4 v[96:99], v5, s[8:11], s59 offen sc1
  s_waitcnt vmcnt(0)
a3_320:
  s_cmp_lt_u32 s64, s18
  s_cbranch_scc1 al_287
  s_waitcnt vmcnt(0)
  s_cmp_eq_u32 s58, 0
  s_cbranch_scc1 of_324
  s_mov_b32 s58, 0
  s_cmp_eq_u32 s3, 0
  s_cbranch_scc0 bm_325
  buffer_store_dword v7, v6, s[8:11], s100 offen
  s_branch bn_326
bm_325:
  buffer_store_dword v7, v6, s[8:11], s100 offen sc1
bn_326:
of_324:
  s_branch JRED1
DONE:
  s_waitcnt vmcnt(0)
  s_endpgm
ABORT:
  v_mov_b32 v1, 0xdead
  v_mov_b32 v2, 252
  buffer_store_dword v1, v2, s[20:23], 0 offen
EXIT:
  s_endpgm
.section .rodata,"a"
.p2align 6
.amdhsa_kernel adaLN_cond__memory_aug_recurrent_mem_tr__dense_activation_relu__prompt_kernel
  .amdhsa_next_free_vgpr 512
  .amdhsa_next_free_sgpr 102
  .amdhsa_accum_offset 256
  .amdhsa_group_segment_fixed_size 0
  .amdhsa_kernarg_size 120
  .amdhsa_user_sgpr_count 2
  .amdhsa_user_sgpr_kernarg_segment_ptr 1
  .amdhsa_system_sgpr_workgroup_id_x 1
.end_amdhsa_kernel
```
